```python
import torch

def _softmax(x, axis=-1):
    return torch.softmax(x, dim=axis)

def _gelu(x):
    return torch.nn.functional.gelu(x, approximate='tanh')

def _silu(x):
    return torch.nn.functional.silu(x)

def _sigmoid(x):
    return torch.sigmoid(x)

def _layernorm(x, axis=-1, eps=1e-05):
    m = x.mean(dim=axis, keepdim=True)
    v = x.var(dim=axis, keepdim=True, unbiased=False)
    return (x - m) / torch.sqrt(v + eps)

def _scatter_add(tgt, idx, src, axis=0):
    return tgt.clone().index_add_(axis, idx, src)

def _segment_sum(src, seg, n):
    out = torch.zeros((n,) + src.shape[1:], dtype=src.dtype)
    return out.index_add_(0, seg, src)

def _pad(x, pw):
    flat = tuple((v for pair in reversed(pw) for v in pair))
    return torch.nn.functional.pad(x, flat)
kernel_name = 'interleave_layers__memory_aug_recurrent_mem_tr__dense_activation_silu__prompt'

def setup_inputs():

    _w = lambda a: (lambda t: t.to(torch.bfloat16) if t.is_floating_point() else t)(torch.as_tensor(a))

    def _A_setup():
        B, S, Dm = (1, 2048, 640)
        H, Dh = (32, 128)
        M, seg = (8, 32)
        seg = min(seg, S)
        S = S // seg * seg
        return {'x': _w((lambda *s: torch.randn(*s, dtype=torch.bfloat16) * 0.05)(B, S, Dm)), 'mem0': _w((lambda *s: torch.randn(*s, dtype=torch.bfloat16) * 0.4)(B, M, Dm)), 'Wq': _w((lambda *s: torch.randn(*s, dtype=torch.bfloat16) * 1.6)(Dm, H, Dh) * Dm ** (-0.5)), 'Wk': _w((lambda *s: torch.randn(*s, dtype=torch.bfloat16) * 1.6)(Dm, H, Dh) * Dm ** (-0.5)), 'Wv': _w((lambda *s: torch.randn(*s, dtype=torch.bfloat16) * 0.4)(Dm, H, Dh) * Dm ** (-0.5)), 'Wo': _w((lambda *s: torch.randn(*s, dtype=torch.bfloat16) * 0.4)(H, Dh, Dm) * (H * Dh) ** (-0.5)), 'seg_len': seg}
    _A_in = _A_setup()

    def _B_setup():
        B, S, D, F = (1, 2048, 640, 1728)
        return {'x': _w((lambda *s: torch.randn(*s, dtype=torch.bfloat16) * 0.05)(B, S, D)), 'w1': _w((lambda *s: torch.randn(*s, dtype=torch.bfloat16) * 1.6)(D, F) * D ** (-0.5)), 'w2': _w((lambda *s: torch.randn(*s, dtype=torch.bfloat16) * 0.2)(F, D) * F ** (-0.5))}
    _B_in = _B_setup()
    return {'A_x': _A_in['x'], 'A_mem0': _A_in['mem0'], 'A_Wq': _A_in['Wq'], 'A_Wk': _A_in['Wk'], 'A_Wv': _A_in['Wv'], 'A_Wo': _A_in['Wo'], 'A_seg_len': _A_in['seg_len'], 'B_x': _B_in['x'], 'B_w1': _B_in['w1'], 'B_w2': _B_in['w2']}

def reference(A_x, A_mem0, A_Wq, A_Wk, A_Wv, A_Wo, A_seg_len, B_x, B_w1, B_w2):

    def _A_ref(x, mem0, Wq, Wk, Wv, Wo, seg_len):
        B, S, Dm = x.shape
        H, Dh = (Wq.shape[1], Wq.shape[2])
        M = mem0.shape[1]
        scale = Dh ** (-0.5)
        n_seg = S // seg_len
        L = M + seg_len
        idx = torch.arange(L)
        mask = (idx[:, None] < M) | (idx[:, None] >= idx[None, :])
        mem = mem0
        outs = []
        for s in range(n_seg):
            xs = x[:, s * seg_len:(s + 1) * seg_len, :].clone()
            h = torch.concatenate([mem, xs], axis=1)
            q = torch.einsum('btd,dhe->bhte', h, Wq)
            k = torch.einsum('btd,dhe->bhte', h, Wk)
            v = torch.einsum('btd,dhe->bhte', h, Wv)
            scores = torch.einsum('bhqe,bhke->bhqk', q, k) * scale
            scores = torch.where(mask[None, None], scores, -1000000000.0)
            p = _softmax(scores, axis=-1)
            o = torch.einsum('bhqk,bhke->bhqe', p, v)
            o = torch.einsum('bhte,hed->btd', o, Wo)
            mem = o[:, :M, :].clone()
            outs.append(o[:, M:, :])
        return torch.concatenate(outs, axis=1)

    def _B_ref(x, w1, w2):
        h = torch.einsum('bsd,df->bsf', x, w1)
        h = _silu(h)
        out = torch.einsum('bsf,fd->bsd', h, w2)
        return out
    x = A_x
    x = x + _A_ref(_layernorm(x, axis=-1), A_mem0, A_Wq, A_Wk, A_Wv, A_Wo, A_seg_len)
    x = x + _B_ref(_layernorm(x, axis=-1), B_w1, B_w2)
    x = x + _A_ref(_layernorm(x, axis=-1), A_mem0, A_Wq, A_Wk, A_Wv, A_Wo, A_seg_len)
    x = x + _B_ref(_layernorm(x, axis=-1), B_w1, B_w2)
    return x
```

```asm
; @launch grid=(256,1,1) block=(256,1,1) lds=163840
.amdgcn_target "amdgcn-amd-amdhsa--gfx950"
.text
.globl interleave_layers__memory_aug_recurrent_mem_tr__dense_activation_silu__prompt_kernel
.p2align 8
.type interleave_layers__memory_aug_recurrent_mem_tr__dense_activation_silu__prompt_kernel,@function
interleave_layers__memory_aug_recurrent_mem_tr__dense_activation_silu__prompt_kernel:
s_cmp_ge_u32 s2, 256
s_cbranch_scc1 L_end
s_load_dwordx16 s[36:51], s[0:1], 0
s_load_dwordx8 s[52:59], s[0:1], 64
s_load_dwordx2 s[60:61], s[0:1], 96
s_getreg_b32 s3, hwreg(HW_REG_XCC_ID, 0, 4)
v_lshrrev_b32 v1, 6, v0
s_waitcnt lgkmcnt(0)
v_readfirstlane_b32 s25, v1
s_mov_b32 s4, s60
s_mov_b32 s5, s61
s_mov_b32 s6, 268435456
s_mov_b32 s7, 0x20000
s_mov_b32 s8, s58
s_mov_b32 s9, s59
s_mov_b32 s10, 256
s_mov_b32 s11, 0x20000
s_cmp_ge_u32 s2, 208
s_cselect_b32 s30, -1, 0
v_mov_b32 v4, s30
v_mov_b32 v5, s30
v_mov_b32 v6, s30
v_mov_b32 v7, s30
v_lshlrev_b32 v2, 4, v0
s_lshl_b32 s31, s2, 12
s_and_b32 s3, s3, 7
buffer_store_dwordx4 v[4:7], v2, s[4:7], s31 offen sc1
v_mov_b64 v[8:9], 0
v_mov_b64 v[10:11], 0
s_add_u32 s31, s31, 1048576
buffer_store_dwordx4 v[8:11], v2, s[4:7], s31 offen sc1
s_mov_b32 s27, s3
s_lshr_b32 s24, s2, 3
s_mov_b32 s26, 0
L_dispatch:
s_cmp_lt_u32 s27, 2
s_cbranch_scc1 L_roleR
s_cmp_eq_u32 s27, 2
s_cbranch_scc1 L_roleK
s_cmp_eq_u32 s27, 3
s_cbranch_scc1 L_roleV
s_cmp_eq_u32 s27, 4
s_cbranch_scc1 L_roleQ
s_sub_u32 s71, s27, 5
s_lshr_b32 s33, s24, 4
s_mul_i32 s33, s33, 3
s_add_u32 s71, s71, s33
s_and_b32 s70, s24, 15
s_cmp_lt_u32 s71, 3
s_cbranch_scc1 L_roleA
s_branch L_roleLN
L_rank:
s_waitcnt vmcnt(0) lgkmcnt(0)
s_barrier
v_and_b32 v1, 63, v0
v_lshlrev_b32 v1, 2, v1
buffer_load_dword v2, v1, s[8:11], 0 offen sc1
s_mov_b32 s24, 0
s_mov_b32 s31, 0
s_waitcnt vmcnt(0)
v_bfe_u32 v4, v2, 0, 3
v_add_u32 v3, 0, v1
v_cmp_gt_u32 s[32:33], s2, v3
v_cmp_eq_u32 vcc, s3, v4
s_nop 0
s_and_b64 vcc, vcc, s[32:33]
s_bcnt1_i32_b64 s30, vcc
s_add_u32 s24, s24, s30
v_bfe_u32 v5, v2, 8, 3
v_add_u32 v3, 1, v1
v_cmp_gt_u32 s[32:33], s2, v3
v_cmp_eq_u32 vcc, s3, v5
s_nop 0
s_and_b64 vcc, vcc, s[32:33]
s_bcnt1_i32_b64 s30, vcc
s_add_u32 s24, s24, s30
v_bfe_u32 v6, v2, 16, 3
v_add_u32 v3, 2, v1
v_cmp_gt_u32 s[32:33], s2, v3
v_cmp_eq_u32 vcc, s3, v6
s_nop 0
s_and_b64 vcc, vcc, s[32:33]
s_bcnt1_i32_b64 s30, vcc
s_add_u32 s24, s24, s30
v_bfe_u32 v7, v2, 24, 3
v_add_u32 v3, 3, v1
v_cmp_gt_u32 s[32:33], s2, v3
v_cmp_eq_u32 vcc, s3, v7
s_nop 0
s_and_b64 vcc, vcc, s[32:33]
s_bcnt1_i32_b64 s30, vcc
s_add_u32 s24, s24, s30
s_mov_b32 s34, 0
v_cmp_eq_u32 vcc, 0, v4
s_nop 0
s_bcnt1_i32_b64 s30, vcc
s_add_u32 s34, s34, s30
v_cmp_eq_u32 vcc, 0, v5
s_nop 0
s_bcnt1_i32_b64 s30, vcc
s_add_u32 s34, s34, s30
v_cmp_eq_u32 vcc, 0, v6
s_nop 0
s_bcnt1_i32_b64 s30, vcc
s_add_u32 s34, s34, s30
v_cmp_eq_u32 vcc, 0, v7
s_nop 0
s_bcnt1_i32_b64 s30, vcc
s_add_u32 s34, s34, s30
s_xor_b32 s34, s34, 32
s_or_b32 s31, s31, s34
s_mov_b32 s34, 0
v_cmp_eq_u32 vcc, 1, v4
s_nop 0
s_bcnt1_i32_b64 s30, vcc
s_add_u32 s34, s34, s30
v_cmp_eq_u32 vcc, 1, v5
s_nop 0
s_bcnt1_i32_b64 s30, vcc
s_add_u32 s34, s34, s30
v_cmp_eq_u32 vcc, 1, v6
s_nop 0
s_bcnt1_i32_b64 s30, vcc
s_add_u32 s34, s34, s30
v_cmp_eq_u32 vcc, 1, v7
s_nop 0
s_bcnt1_i32_b64 s30, vcc
s_add_u32 s34, s34, s30
s_xor_b32 s34, s34, 32
s_or_b32 s31, s31, s34
s_mov_b32 s34, 0
v_cmp_eq_u32 vcc, 2, v4
s_nop 0
s_bcnt1_i32_b64 s30, vcc
s_add_u32 s34, s34, s30
v_cmp_eq_u32 vcc, 2, v5
s_nop 0
s_bcnt1_i32_b64 s30, vcc
s_add_u32 s34, s34, s30
v_cmp_eq_u32 vcc, 2, v6
s_nop 0
s_bcnt1_i32_b64 s30, vcc
s_add_u32 s34, s34, s30
v_cmp_eq_u32 vcc, 2, v7
s_nop 0
s_bcnt1_i32_b64 s30, vcc
s_add_u32 s34, s34, s30
s_xor_b32 s34, s34, 32
s_or_b32 s31, s31, s34
s_mov_b32 s34, 0
v_cmp_eq_u32 vcc, 3, v4
s_nop 0
s_bcnt1_i32_b64 s30, vcc
s_add_u32 s34, s34, s30
v_cmp_eq_u32 vcc, 3, v5
s_nop 0
s_bcnt1_i32_b64 s30, vcc
s_add_u32 s34, s34, s30
v_cmp_eq_u32 vcc, 3, v6
s_nop 0
s_bcnt1_i32_b64 s30, vcc
s_add_u32 s34, s34, s30
v_cmp_eq_u32 vcc, 3, v7
s_nop 0
s_bcnt1_i32_b64 s30, vcc
s_add_u32 s34, s34, s30
s_xor_b32 s34, s34, 32
s_or_b32 s31, s31, s34
s_mov_b32 s34, 0
v_cmp_eq_u32 vcc, 4, v4
s_nop 0
s_bcnt1_i32_b64 s30, vcc
s_add_u32 s34, s34, s30
v_cmp_eq_u32 vcc, 4, v5
s_nop 0
s_bcnt1_i32_b64 s30, vcc
s_add_u32 s34, s34, s30
v_cmp_eq_u32 vcc, 4, v6
s_nop 0
s_bcnt1_i32_b64 s30, vcc
s_add_u32 s34, s34, s30
v_cmp_eq_u32 vcc, 4, v7
s_nop 0
s_bcnt1_i32_b64 s30, vcc
s_add_u32 s34, s34, s30
s_xor_b32 s34, s34, 32
s_or_b32 s31, s31, s34
s_mov_b32 s34, 0
v_cmp_eq_u32 vcc, 5, v4
s_nop 0
s_bcnt1_i32_b64 s30, vcc
s_add_u32 s34, s34, s30
v_cmp_eq_u32 vcc, 5, v5
s_nop 0
s_bcnt1_i32_b64 s30, vcc
s_add_u32 s34, s34, s30
v_cmp_eq_u32 vcc, 5, v6
s_nop 0
s_bcnt1_i32_b64 s30, vcc
s_add_u32 s34, s34, s30
v_cmp_eq_u32 vcc, 5, v7
s_nop 0
s_bcnt1_i32_b64 s30, vcc
s_add_u32 s34, s34, s30
s_xor_b32 s34, s34, 32
s_or_b32 s31, s31, s34
s_mov_b32 s34, 0
v_cmp_eq_u32 vcc, 6, v4
s_nop 0
s_bcnt1_i32_b64 s30, vcc
s_add_u32 s34, s34, s30
v_cmp_eq_u32 vcc, 6, v5
s_nop 0
s_bcnt1_i32_b64 s30, vcc
s_add_u32 s34, s34, s30
v_cmp_eq_u32 vcc, 6, v6
s_nop 0
s_bcnt1_i32_b64 s30, vcc
s_add_u32 s34, s34, s30
v_cmp_eq_u32 vcc, 6, v7
s_nop 0
s_bcnt1_i32_b64 s30, vcc
s_add_u32 s34, s34, s30
s_xor_b32 s34, s34, 32
s_or_b32 s31, s31, s34
s_mov_b32 s34, 0
v_cmp_eq_u32 vcc, 7, v4
s_nop 0
s_bcnt1_i32_b64 s30, vcc
s_add_u32 s34, s34, s30
v_cmp_eq_u32 vcc, 7, v5
s_nop 0
s_bcnt1_i32_b64 s30, vcc
s_add_u32 s34, s34, s30
v_cmp_eq_u32 vcc, 7, v6
s_nop 0
s_bcnt1_i32_b64 s30, vcc
s_add_u32 s34, s34, s30
v_cmp_eq_u32 vcc, 7, v7
s_nop 0
s_bcnt1_i32_b64 s30, vcc
s_add_u32 s34, s34, s30
s_xor_b32 s34, s34, 32
s_or_b32 s31, s31, s34
s_mov_b32 s26, 1
s_cmp_eq_u32 s31, 0
s_cbranch_scc1 L_dispatch
s_mov_b32 s26, 2
s_lshr_b32 s27, s2, 5
s_and_b32 s24, s2, 31
s_branch L_dispatch
L_abort:
s_lshl_b32 s30, s27, 16
s_lshl_b32 s31, s24, 8
s_or_b32 s29, s29, s30
s_or_b32 s29, s29, s31
v_mov_b32 v1, s29
s_lshl_b32 s30, s27, 2
s_add_u32 s30, s30, 61440
buffer_store_dword v1, off, s[4:7], s30
L_end:
s_endpgm
L_wb:
s_endpgm
L_roleR:
v_and_b32 v1, 63, v0
s_lshl_b32 s33, s24, 8
v_lshrrev_b32 v8, 4, v1
s_lshl_b32 s30, s25, 4
v_add_u32 v8, s30, v8
v_mul_u32_u24 v8, 8192, v8
v_and_b32 v32, 15, v1
v_lshl_add_u32 v8, v32, 4, v8
v_add_u32 v8, s33, v8
s_mul_i32 s33, s24, 163840
v_lshrrev_b32 v9, 4, v1
s_lshl_b32 s30, s25, 4
v_add_u32 v9, s30, v9
v_mul_u32_u24 v9, 1280, v9
v_and_b32 v32, 15, v1
v_lshl_add_u32 v9, v32, 4, v9
v_add_u32 v9, s33, v9
v_bfe_u32 v10, v1, 4, 1
v_mul_u32_u24 v10, 256, v10
v_bfe_u32 v11, v1, 5, 1
v_mul_u32_u24 v11, 38912, v11
v_add_u32 v10, v10, v11
v_and_b32 v11, 15, v1
v_lshl_add_u32 v10, v11, 2, v10
s_lshl_b32 s30, s25, 6
s_add_u32 s30, s30, 8192
v_add_u32 v10, s30, v10
v_add_u32 v11, 77824, v10
v_bfe_u32 v12, v1, 4, 1
v_mul_u32_u24 v12, 1024, v12
v_bfe_u32 v13, v1, 5, 1
v_mul_u32_u24 v13, 38912, v13
v_add_u32 v12, v12, v13
v_and_b32 v13, 15, v1
v_lshl_add_u32 v12, v13, 2, v12
s_lshl_b32 s30, s25, 6
s_add_u32 s30, s30, 8192
v_add_u32 v12, s30, v12
v_add_u32 v13, 77824, v12
s_mov_b32 s12, s40
s_mov_b32 s13, s41
s_mov_b32 s14, 5242880
s_mov_b32 s15, 0x20000
s_mov_b32 s16, s42
s_mov_b32 s17, s43
s_mov_b32 s18, 5242880
s_mov_b32 s19, 0x20000
s_mov_b32 s20, s44
s_mov_b32 s21, s45
s_mov_b32 s22, 5242880
s_mov_b32 s23, 0x20000
s_mov_b32 s96, s46
s_mov_b32 s97, s47
s_mov_b32 s98, 5242880
s_mov_b32 s99, 0x20000
v_lshlrev_b32 v6, 4, v1
s_mul_i32 s33, s25, 38912
s_add_u32 s33, s33, 8192
v_add_u32 v2, s33, v6
s_mul_i32 s67, s27, 0
s_add_u32 s67, s67, s24
s_lshr_b32 s67, s67, 0
s_lshl_b32 s67, s67, 2
s_add_u32 s67, s67, s25
s_mul_i32 s67, s67, 18432
s_add_u32 s67, s67, 25165824
s_add_u32 s93, s67, 5242880
s_lshl_b32 s95, s24, 2
s_add_u32 s95, s95, s25
s_lshl_b32 s95, s95, 7
s_add_u32 s95, s95, 65536
s_cmp_eq_u32 s27, 0
s_cbranch_scc1 r1
s_mov_b32 s31, 0x05040100
s_mov_b32 s32, 0x07060302
s_mul_i32 s34, s25, 38912
s_add_u32 s34, s34, 8192
s_add_u32 m0, s34, 0
s_mov_b32 s30, 0
buffer_load_dwordx4 v8, s[12:15], s30 offen  lds
s_add_u32 m0, s34, 1024
s_mov_b32 s30, 32768
buffer_load_dwordx4 v8, s[12:15], s30 offen  lds
s_add_u32 m0, s34, 2048
s_mov_b32 s30, 65536
buffer_load_dwordx4 v8, s[12:15], s30 offen  lds
s_add_u32 m0, s34, 3072
s_mov_b32 s30, 98304
buffer_load_dwordx4 v8, s[12:15], s30 offen  lds
s_add_u32 m0, s34, 4096
s_mov_b32 s30, 0
buffer_load_dwordx4 v8, s[16:19], s30 offen  lds
s_add_u32 m0, s34, 5120
s_mov_b32 s30, 32768
buffer_load_dwordx4 v8, s[16:19], s30 offen  lds
s_add_u32 m0, s34, 6144
s_mov_b32 s30, 65536
buffer_load_dwordx4 v8, s[16:19], s30 offen  lds
s_add_u32 m0, s34, 7168
s_mov_b32 s30, 98304
buffer_load_dwordx4 v8, s[16:19], s30 offen  lds
s_waitcnt vmcnt(4)
s_barrier
s_cmp_lg_u32 s25, 0
s_cbranch_scc1 ar2
s_or_b32 s33, s3, 0x80
v_mov_b32 v7, s33
s_mov_b64 exec, 1
buffer_store_byte v7, off, s[8:11], s2 sc1
s_mov_b64 exec, -1
ar2:
s_add_u32 m0, s34, 8192
s_mov_b32 s30, 0
buffer_load_dwordx4 v8, s[20:23], s30 offen  lds
s_add_u32 m0, s34, 9216
s_mov_b32 s30, 32768
buffer_load_dwordx4 v8, s[20:23], s30 offen  lds
s_add_u32 m0, s34, 10240
s_mov_b32 s30, 65536
buffer_load_dwordx4 v8, s[20:23], s30 offen  lds
s_add_u32 m0, s34, 11264
s_mov_b32 s30, 98304
buffer_load_dwordx4 v8, s[20:23], s30 offen  lds
ds_read2st64_b32 v[16:17], v10 offset0:0 offset1:2
ds_read2st64_b32 v[18:19], v10 offset0:8 offset1:10
ds_read2st64_b32 v[20:21], v10 offset0:4 offset1:6
ds_read2st64_b32 v[22:23], v10 offset0:12 offset1:14
ds_read2st64_b32 v[24:25], v11 offset0:0 offset1:2
ds_read2st64_b32 v[26:27], v11 offset0:8 offset1:10
ds_read2st64_b32 v[28:29], v11 offset0:4 offset1:6
ds_read2st64_b32 v[30:31], v11 offset0:12 offset1:14
s_waitcnt lgkmcnt(4)
v_perm_b32 v32, v17, v16, s31
v_perm_b32 v33, v19, v18, s31
v_perm_b32 v34, v21, v20, s31
v_perm_b32 v35, v23, v22, s31
v_perm_b32 v36, v17, v16, s32
v_perm_b32 v37, v19, v18, s32
v_perm_b32 v38, v21, v20, s32
v_perm_b32 v39, v23, v22, s32
s_add_u32 s33, s67, 0
buffer_store_dwordx4 v[32:35], v6, s[4:7], s33 offen sc1
s_add_u32 s33, s93, 0
buffer_store_dwordx4 v[36:39], v6, s[4:7], s33 offen sc1
s_waitcnt lgkmcnt(0)
v_perm_b32 v32, v25, v24, s31
v_perm_b32 v33, v27, v26, s31
v_perm_b32 v34, v29, v28, s31
v_perm_b32 v35, v31, v30, s31
v_perm_b32 v36, v25, v24, s32
v_perm_b32 v37, v27, v26, s32
v_perm_b32 v38, v29, v28, s32
v_perm_b32 v39, v31, v30, s32
s_add_u32 s33, s67, 1024
buffer_store_dwordx4 v[32:35], v6, s[4:7], s33 offen sc1
s_add_u32 s33, s93, 1024
buffer_store_dwordx4 v[36:39], v6, s[4:7], s33 offen sc1
s_waitcnt vmcnt(8)
s_barrier
s_add_u32 m0, s34, 0
s_mov_b32 s30, 1572864
buffer_load_dwordx4 v8, s[16:19], s30 offen  lds
s_add_u32 m0, s34, 1024
s_mov_b32 s30, 1605632
buffer_load_dwordx4 v8, s[16:19], s30 offen  lds
s_add_u32 m0, s34, 2048
s_mov_b32 s30, 1638400
buffer_load_dwordx4 v8, s[16:19], s30 offen  lds
s_add_u32 m0, s34, 3072
s_mov_b32 s30, 1671168
buffer_load_dwordx4 v8, s[16:19], s30 offen  lds
ds_read2st64_b32 v[16:17], v10 offset0:16 offset1:18
ds_read2st64_b32 v[18:19], v10 offset0:24 offset1:26
ds_read2st64_b32 v[20:21], v10 offset0:20 offset1:22
ds_read2st64_b32 v[22:23], v10 offset0:28 offset1:30
ds_read2st64_b32 v[24:25], v11 offset0:16 offset1:18
ds_read2st64_b32 v[26:27], v11 offset0:24 offset1:26
ds_read2st64_b32 v[28:29], v11 offset0:20 offset1:22
ds_read2st64_b32 v[30:31], v11 offset0:28 offset1:30
s_waitcnt lgkmcnt(4)
v_perm_b32 v32, v17, v16, s31
v_perm_b32 v33, v19, v18, s31
v_perm_b32 v34, v21, v20, s31
v_perm_b32 v35, v23, v22, s31
v_perm_b32 v36, v17, v16, s32
v_perm_b32 v37, v19, v18, s32
v_perm_b32 v38, v21, v20, s32
v_perm_b32 v39, v23, v22, s32
s_add_u32 s33, s67, 2048
buffer_store_dwordx4 v[32:35], v6, s[4:7], s33 offen sc1
s_add_u32 s33, s93, 2048
buffer_store_dwordx4 v[36:39], v6, s[4:7], s33 offen sc1
s_waitcnt lgkmcnt(0)
v_perm_b32 v32, v25, v24, s31
v_perm_b32 v33, v27, v26, s31
v_perm_b32 v34, v29, v28, s31
v_perm_b32 v35, v31, v30, s31
v_perm_b32 v36, v25, v24, s32
v_perm_b32 v37, v27, v26, s32
v_perm_b32 v38, v29, v28, s32
v_perm_b32 v39, v31, v30, s32
s_add_u32 s33, s67, 3072
buffer_store_dwordx4 v[32:35], v6, s[4:7], s33 offen sc1
s_add_u32 s33, s93, 3072
buffer_store_dwordx4 v[36:39], v6, s[4:7], s33 offen sc1
s_waitcnt vmcnt(12)
s_barrier
s_add_u32 m0, s34, 4096
s_mov_b32 s30, 2097152
buffer_load_dwordx4 v8, s[16:19], s30 offen  lds
s_add_u32 m0, s34, 5120
s_mov_b32 s30, 2129920
buffer_load_dwordx4 v8, s[16:19], s30 offen  lds
s_add_u32 m0, s34, 6144
s_mov_b32 s30, 2162688
buffer_load_dwordx4 v8, s[16:19], s30 offen  lds
s_add_u32 m0, s34, 7168
s_mov_b32 s30, 2195456
buffer_load_dwordx4 v8, s[16:19], s30 offen  lds
ds_read2st64_b32 v[16:17], v10 offset0:32 offset1:34
ds_read2st64_b32 v[18:19], v10 offset0:40 offset1:42
ds_read2st64_b32 v[20:21], v10 offset0:36 offset1:38
ds_read2st64_b32 v[22:23], v10 offset0:44 offset1:46
ds_read2st64_b32 v[24:25], v11 offset0:32 offset1:34
ds_read2st64_b32 v[26:27], v11 offset0:40 offset1:42
ds_read2st64_b32 v[28:29], v11 offset0:36 offset1:38
ds_read2st64_b32 v[30:31], v11 offset0:44 offset1:46
s_waitcnt lgkmcnt(4)
v_perm_b32 v32, v17, v16, s31
v_perm_b32 v33, v19, v18, s31
v_perm_b32 v34, v21, v20, s31
v_perm_b32 v35, v23, v22, s31
v_perm_b32 v36, v17, v16, s32
v_perm_b32 v37, v19, v18, s32
v_perm_b32 v38, v21, v20, s32
v_perm_b32 v39, v23, v22, s32
s_add_u32 s33, s67, 4096
buffer_store_dwordx4 v[32:35], v6, s[4:7], s33 offen sc1
s_add_u32 s33, s93, 4096
buffer_store_dwordx4 v[36:39], v6, s[4:7], s33 offen sc1
s_waitcnt lgkmcnt(0)
v_perm_b32 v32, v25, v24, s31
v_perm_b32 v33, v27, v26, s31
v_perm_b32 v34, v29, v28, s31
v_perm_b32 v35, v31, v30, s31
v_perm_b32 v36, v25, v24, s32
v_perm_b32 v37, v27, v26, s32
v_perm_b32 v38, v29, v28, s32
v_perm_b32 v39, v31, v30, s32
s_add_u32 s33, s67, 5120
buffer_store_dwordx4 v[32:35], v6, s[4:7], s33 offen sc1
s_add_u32 s33, s93, 5120
buffer_store_dwordx4 v[36:39], v6, s[4:7], s33 offen sc1
s_waitcnt vmcnt(12)
s_barrier
s_add_u32 m0, s34, 8192
s_mov_b32 s30, 2621440
buffer_load_dwordx4 v8, s[20:23], s30 offen  lds
s_add_u32 m0, s34, 9216
s_mov_b32 s30, 2654208
buffer_load_dwordx4 v8, s[20:23], s30 offen  lds
s_add_u32 m0, s34, 10240
s_mov_b32 s30, 2686976
buffer_load_dwordx4 v8, s[20:23], s30 offen  lds
s_add_u32 m0, s34, 11264
s_mov_b32 s30, 2719744
buffer_load_dwordx4 v8, s[20:23], s30 offen  lds
ds_read2st64_b32 v[16:17], v10 offset0:0 offset1:2
ds_read2st64_b32 v[18:19], v10 offset0:8 offset1:10
ds_read2st64_b32 v[20:21], v10 offset0:4 offset1:6
ds_read2st64_b32 v[22:23], v10 offset0:12 offset1:14
ds_read2st64_b32 v[24:25], v11 offset0:0 offset1:2
ds_read2st64_b32 v[26:27], v11 offset0:8 offset1:10
ds_read2st64_b32 v[28:29], v11 offset0:4 offset1:6
ds_read2st64_b32 v[30:31], v11 offset0:12 offset1:14
s_waitcnt lgkmcnt(4)
v_perm_b32 v32, v17, v16, s31
v_perm_b32 v33, v19, v18, s31
v_perm_b32 v34, v21, v20, s31
v_perm_b32 v35, v23, v22, s31
v_perm_b32 v36, v17, v16, s32
v_perm_b32 v37, v19, v18, s32
v_perm_b32 v38, v21, v20, s32
v_perm_b32 v39, v23, v22, s32
s_add_u32 s33, s67, 6144
buffer_store_dwordx4 v[32:35], v6, s[4:7], s33 offen sc1
s_add_u32 s33, s93, 6144
buffer_store_dwordx4 v[36:39], v6, s[4:7], s33 offen sc1
s_waitcnt lgkmcnt(0)
v_perm_b32 v32, v25, v24, s31
v_perm_b32 v33, v27, v26, s31
v_perm_b32 v34, v29, v28, s31
v_perm_b32 v35, v31, v30, s31
v_perm_b32 v36, v25, v24, s32
v_perm_b32 v37, v27, v26, s32
v_perm_b32 v38, v29, v28, s32
v_perm_b32 v39, v31, v30, s32
s_add_u32 s33, s67, 7168
buffer_store_dwordx4 v[32:35], v6, s[4:7], s33 offen sc1
s_add_u32 s33, s93, 7168
buffer_store_dwordx4 v[36:39], v6, s[4:7], s33 offen sc1
s_waitcnt vmcnt(12)
s_barrier
s_add_u32 m0, s34, 0
s_mov_b32 s30, 3145728
buffer_load_dwordx4 v8, s[20:23], s30 offen  lds
s_add_u32 m0, s34, 1024
s_mov_b32 s30, 3178496
buffer_load_dwordx4 v8, s[20:23], s30 offen  lds
s_add_u32 m0, s34, 2048
s_mov_b32 s30, 3211264
buffer_load_dwordx4 v8, s[20:23], s30 offen  lds
s_add_u32 m0, s34, 3072
s_mov_b32 s30, 3244032
buffer_load_dwordx4 v8, s[20:23], s30 offen  lds
ds_read2st64_b32 v[16:17], v10 offset0:16 offset1:18
ds_read2st64_b32 v[18:19], v10 offset0:24 offset1:26
ds_read2st64_b32 v[20:21], v10 offset0:20 offset1:22
ds_read2st64_b32 v[22:23], v10 offset0:28 offset1:30
ds_read2st64_b32 v[24:25], v11 offset0:16 offset1:18
ds_read2st64_b32 v[26:27], v11 offset0:24 offset1:26
ds_read2st64_b32 v[28:29], v11 offset0:20 offset1:22
ds_read2st64_b32 v[30:31], v11 offset0:28 offset1:30
s_waitcnt lgkmcnt(4)
v_perm_b32 v32, v17, v16, s31
v_perm_b32 v33, v19, v18, s31
v_perm_b32 v34, v21, v20, s31
v_perm_b32 v35, v23, v22, s31
v_perm_b32 v36, v17, v16, s32
v_perm_b32 v37, v19, v18, s32
v_perm_b32 v38, v21, v20, s32
v_perm_b32 v39, v23, v22, s32
s_add_u32 s33, s93, 8192
buffer_store_dwordx4 v[32:35], v6, s[4:7], s33 offen sc1
s_add_u32 s33, s67, 8192
buffer_store_dwordx4 v[36:39], v6, s[4:7], s33 offen sc1
s_waitcnt lgkmcnt(0)
v_perm_b32 v32, v25, v24, s31
v_perm_b32 v33, v27, v26, s31
v_perm_b32 v34, v29, v28, s31
v_perm_b32 v35, v31, v30, s31
v_perm_b32 v36, v25, v24, s32
v_perm_b32 v37, v27, v26, s32
v_perm_b32 v38, v29, v28, s32
v_perm_b32 v39, v31, v30, s32
s_add_u32 s33, s93, 9216
buffer_store_dwordx4 v[32:35], v6, s[4:7], s33 offen sc1
s_add_u32 s33, s67, 9216
buffer_store_dwordx4 v[36:39], v6, s[4:7], s33 offen sc1
s_waitcnt vmcnt(12)
s_barrier
s_add_u32 m0, s34, 4096
s_mov_b32 s30, 4194304
buffer_load_dwordx4 v8, s[12:15], s30 offen  lds
s_add_u32 m0, s34, 5120
s_mov_b32 s30, 4227072
buffer_load_dwordx4 v8, s[12:15], s30 offen  lds
s_add_u32 m0, s34, 6144
s_mov_b32 s30, 4259840
buffer_load_dwordx4 v8, s[12:15], s30 offen  lds
s_add_u32 m0, s34, 7168
s_mov_b32 s30, 4292608
buffer_load_dwordx4 v8, s[12:15], s30 offen  lds
ds_read2st64_b32 v[16:17], v10 offset0:32 offset1:34
ds_read2st64_b32 v[18:19], v10 offset0:40 offset1:42
ds_read2st64_b32 v[20:21], v10 offset0:36 offset1:38
ds_read2st64_b32 v[22:23], v10 offset0:44 offset1:46
ds_read2st64_b32 v[24:25], v11 offset0:32 offset1:34
ds_read2st64_b32 v[26:27], v11 offset0:40 offset1:42
ds_read2st64_b32 v[28:29], v11 offset0:36 offset1:38
ds_read2st64_b32 v[30:31], v11 offset0:44 offset1:46
s_waitcnt lgkmcnt(4)
v_perm_b32 v32, v17, v16, s31
v_perm_b32 v33, v19, v18, s31
v_perm_b32 v34, v21, v20, s31
v_perm_b32 v35, v23, v22, s31
v_perm_b32 v36, v17, v16, s32
v_perm_b32 v37, v19, v18, s32
v_perm_b32 v38, v21, v20, s32
v_perm_b32 v39, v23, v22, s32
s_add_u32 s33, s67, 10240
buffer_store_dwordx4 v[32:35], v6, s[4:7], s33 offen sc1
s_add_u32 s33, s93, 10240
buffer_store_dwordx4 v[36:39], v6, s[4:7], s33 offen sc1
s_waitcnt lgkmcnt(0)
v_perm_b32 v32, v25, v24, s31
v_perm_b32 v33, v27, v26, s31
v_perm_b32 v34, v29, v28, s31
v_perm_b32 v35, v31, v30, s31
v_perm_b32 v36, v25, v24, s32
v_perm_b32 v37, v27, v26, s32
v_perm_b32 v38, v29, v28, s32
v_perm_b32 v39, v31, v30, s32
s_add_u32 s33, s67, 11264
buffer_store_dwordx4 v[32:35], v6, s[4:7], s33 offen sc1
s_add_u32 s33, s93, 11264
buffer_store_dwordx4 v[36:39], v6, s[4:7], s33 offen sc1
s_waitcnt vmcnt(12)
s_barrier
s_add_u32 m0, s34, 8192
s_mov_b32 s30, 4718592
buffer_load_dwordx4 v8, s[12:15], s30 offen  lds
s_add_u32 m0, s34, 9216
s_mov_b32 s30, 4751360
buffer_load_dwordx4 v8, s[12:15], s30 offen  lds
s_add_u32 m0, s34, 10240
s_mov_b32 s30, 4784128
buffer_load_dwordx4 v8, s[12:15], s30 offen  lds
s_add_u32 m0, s34, 11264
s_mov_b32 s30, 4816896
buffer_load_dwordx4 v8, s[12:15], s30 offen  lds
ds_read2st64_b32 v[16:17], v10 offset0:0 offset1:2
ds_read2st64_b32 v[18:19], v10 offset0:8 offset1:10
ds_read2st64_b32 v[20:21], v10 offset0:4 offset1:6
ds_read2st64_b32 v[22:23], v10 offset0:12 offset1:14
ds_read2st64_b32 v[24:25], v11 offset0:0 offset1:2
ds_read2st64_b32 v[26:27], v11 offset0:8 offset1:10
ds_read2st64_b32 v[28:29], v11 offset0:4 offset1:6
ds_read2st64_b32 v[30:31], v11 offset0:12 offset1:14
s_waitcnt lgkmcnt(4)
v_perm_b32 v32, v17, v16, s31
v_perm_b32 v33, v19, v18, s31
v_perm_b32 v34, v21, v20, s31
v_perm_b32 v35, v23, v22, s31
v_perm_b32 v36, v17, v16, s32
v_perm_b32 v37, v19, v18, s32
v_perm_b32 v38, v21, v20, s32
v_perm_b32 v39, v23, v22, s32
s_add_u32 s33, s93, 12288
buffer_store_dwordx4 v[32:35], v6, s[4:7], s33 offen sc1
s_add_u32 s33, s67, 12288
buffer_store_dwordx4 v[36:39], v6, s[4:7], s33 offen sc1
s_waitcnt lgkmcnt(0)
v_perm_b32 v32, v25, v24, s31
v_perm_b32 v33, v27, v26, s31
v_perm_b32 v34, v29, v28, s31
v_perm_b32 v35, v31, v30, s31
v_perm_b32 v36, v25, v24, s32
v_perm_b32 v37, v27, v26, s32
v_perm_b32 v38, v29, v28, s32
v_perm_b32 v39, v31, v30, s32
s_add_u32 s33, s93, 13312
buffer_store_dwordx4 v[32:35], v6, s[4:7], s33 offen sc1
s_add_u32 s33, s67, 13312
buffer_store_dwordx4 v[36:39], v6, s[4:7], s33 offen sc1
s_waitcnt vmcnt(12)
s_barrier
ds_read2st64_b32 v[16:17], v10 offset0:16 offset1:18
ds_read2st64_b32 v[18:19], v10 offset0:24 offset1:26
ds_read2st64_b32 v[20:21], v10 offset0:20 offset1:22
ds_read2st64_b32 v[22:23], v10 offset0:28 offset1:30
ds_read2st64_b32 v[24:25], v11 offset0:16 offset1:18
ds_read2st64_b32 v[26:27], v11 offset0:24 offset1:26
ds_read2st64_b32 v[28:29], v11 offset0:20 offset1:22
ds_read2st64_b32 v[30:31], v11 offset0:28 offset1:30
s_waitcnt lgkmcnt(4)
v_perm_b32 v32, v17, v16, s31
v_perm_b32 v33, v19, v18, s31
v_perm_b32 v34, v21, v20, s31
v_perm_b32 v35, v23, v22, s31
v_perm_b32 v36, v17, v16, s32
v_perm_b32 v37, v19, v18, s32
v_perm_b32 v38, v21, v20, s32
v_perm_b32 v39, v23, v22, s32
s_add_u32 s33, s67, 14336
buffer_store_dwordx4 v[32:35], v6, s[4:7], s33 offen sc1
s_add_u32 s33, s93, 14336
buffer_store_dwordx4 v[36:39], v6, s[4:7], s33 offen sc1
s_waitcnt lgkmcnt(0)
v_perm_b32 v32, v25, v24, s31
v_perm_b32 v33, v27, v26, s31
v_perm_b32 v34, v29, v28, s31
v_perm_b32 v35, v31, v30, s31
v_perm_b32 v36, v25, v24, s32
v_perm_b32 v37, v27, v26, s32
v_perm_b32 v38, v29, v28, s32
v_perm_b32 v39, v31, v30, s32
s_add_u32 s33, s67, 15360
buffer_store_dwordx4 v[32:35], v6, s[4:7], s33 offen sc1
s_add_u32 s33, s93, 15360
buffer_store_dwordx4 v[36:39], v6, s[4:7], s33 offen sc1
s_waitcnt vmcnt(8)
s_barrier
ds_read2st64_b32 v[16:17], v10 offset0:32 offset1:34
ds_read2st64_b32 v[18:19], v10 offset0:40 offset1:42
ds_read2st64_b32 v[20:21], v10 offset0:36 offset1:38
ds_read2st64_b32 v[22:23], v10 offset0:44 offset1:46
ds_read2st64_b32 v[24:25], v11 offset0:32 offset1:34
ds_read2st64_b32 v[26:27], v11 offset0:40 offset1:42
ds_read2st64_b32 v[28:29], v11 offset0:36 offset1:38
ds_read2st64_b32 v[30:31], v11 offset0:44 offset1:46
s_waitcnt lgkmcnt(4)
v_perm_b32 v32, v17, v16, s31
v_perm_b32 v33, v19, v18, s31
v_perm_b32 v34, v21, v20, s31
v_perm_b32 v35, v23, v22, s31
v_perm_b32 v36, v17, v16, s32
v_perm_b32 v37, v19, v18, s32
v_perm_b32 v38, v21, v20, s32
v_perm_b32 v39, v23, v22, s32
s_add_u32 s33, s93, 16384
buffer_store_dwordx4 v[32:35], v6, s[4:7], s33 offen sc1
s_add_u32 s33, s67, 16384
buffer_store_dwordx4 v[36:39], v6, s[4:7], s33 offen sc1
s_waitcnt lgkmcnt(0)
v_perm_b32 v32, v25, v24, s31
v_perm_b32 v33, v27, v26, s31
v_perm_b32 v34, v29, v28, s31
v_perm_b32 v35, v31, v30, s31
v_perm_b32 v36, v25, v24, s32
v_perm_b32 v37, v27, v26, s32
v_perm_b32 v38, v29, v28, s32
v_perm_b32 v39, v31, v30, s32
s_add_u32 s33, s93, 17408
buffer_store_dwordx4 v[32:35], v6, s[4:7], s33 offen sc1
s_add_u32 s33, s67, 17408
buffer_store_dwordx4 v[36:39], v6, s[4:7], s33 offen sc1
s_waitcnt vmcnt(0) lgkmcnt(0)
s_barrier
s_mov_b32 s28, 0
s_mov_b32 s30, 0x80808080
v_and_b32 v92, 63, v0
v_lshlrev_b32 v92, 2, v92
sy3:
buffer_load_dword v93, v92, s[8:11], 0 offen sc1
s_waitcnt vmcnt(0)
sy6:
v_and_b32 v94, s30, v93
v_cmp_ne_u32 vcc, s30, v94
s_cbranch_vccz sy4
s_sleep 2
s_add_u32 s28, s28, 1
s_cmp_lt_u32 s28, 524288
s_cbranch_scc1 sy3
s_mov_b32 s29, 1
s_branch L_abort
sy4:
s_cmp_lg_u32 s26, 0
s_cbranch_scc1 sy5
v_mov_b32 v95, 0
v_bfe_u32 v94, v93, 0, 3
v_lshlrev_b32 v94, v94, 1
v_or_b32 v95, v95, v94
v_bfe_u32 v94, v93, 8, 3
v_lshlrev_b32 v94, v94, 1
v_or_b32 v95, v95, v94
v_bfe_u32 v94, v93, 16, 3
v_lshlrev_b32 v94, v94, 1
v_or_b32 v95, v95, v94
v_bfe_u32 v94, v93, 24, 3
v_lshlrev_b32 v94, v94, 1
v_or_b32 v95, v95, v94
s_nop 1
v_mov_b32 v94, v95 quad_perm:[1,0,3,2] row_mask:0xf bank_mask:0xf
v_or_b32 v95, v95, v94
v_cmp_ne_u32 vcc, 0xff, v95
s_cbranch_vccnz L_rank
s_mov_b32 s26, 1
sy5:
v_mov_b32 v7, 1
buffer_store_dword v7, off, s[4:7], s95 sc1
r1:
s_mov_b32 s31, 0x05040100
s_mov_b32 s32, 0x07060302
s_mul_i32 s34, s25, 38912
s_add_u32 s34, s34, 8192
s_add_u32 m0, s34, 0
s_mov_b32 s30, 524288
buffer_load_dwordx4 v8, s[12:15], s30 offen  lds
s_add_u32 m0, s34, 1024
s_mov_b32 s30, 557056
buffer_load_dwordx4 v8, s[12:15], s30 offen  lds
s_add_u32 m0, s34, 2048
s_mov_b32 s30, 589824
buffer_load_dwordx4 v8, s[12:15], s30 offen  lds
s_add_u32 m0, s34, 3072
s_mov_b32 s30, 622592
buffer_load_dwordx4 v8, s[12:15], s30 offen  lds
s_add_u32 m0, s34, 4096
s_mov_b32 s30, 524288
buffer_load_dwordx4 v8, s[16:19], s30 offen  lds
s_add_u32 m0, s34, 5120
s_mov_b32 s30, 557056
buffer_load_dwordx4 v8, s[16:19], s30 offen  lds
s_add_u32 m0, s34, 6144
s_mov_b32 s30, 589824
buffer_load_dwordx4 v8, s[16:19], s30 offen  lds
s_add_u32 m0, s34, 7168
s_mov_b32 s30, 622592
buffer_load_dwordx4 v8, s[16:19], s30 offen  lds
s_waitcnt vmcnt(4)
s_barrier
s_cmp_lg_u32 s25, 0
s_cbranch_scc1 ar7
s_or_b32 s33, s3, 0x80
v_mov_b32 v7, s33
s_mov_b64 exec, 1
buffer_store_byte v7, off, s[8:11], s2 sc1
s_mov_b64 exec, -1
ar7:
s_add_u32 m0, s34, 8192
s_mov_b32 s30, 524288
buffer_load_dwordx4 v8, s[20:23], s30 offen  lds
s_add_u32 m0, s34, 9216
s_mov_b32 s30, 557056
buffer_load_dwordx4 v8, s[20:23], s30 offen  lds
s_add_u32 m0, s34, 10240
s_mov_b32 s30, 589824
buffer_load_dwordx4 v8, s[20:23], s30 offen  lds
s_add_u32 m0, s34, 11264
s_mov_b32 s30, 622592
buffer_load_dwordx4 v8, s[20:23], s30 offen  lds
ds_read2st64_b32 v[16:17], v10 offset0:0 offset1:2
ds_read2st64_b32 v[18:19], v10 offset0:8 offset1:10
ds_read2st64_b32 v[20:21], v10 offset0:4 offset1:6
ds_read2st64_b32 v[22:23], v10 offset0:12 offset1:14
ds_read2st64_b32 v[24:25], v11 offset0:0 offset1:2
ds_read2st64_b32 v[26:27], v11 offset0:8 offset1:10
ds_read2st64_b32 v[28:29], v11 offset0:4 offset1:6
ds_read2st64_b32 v[30:31], v11 offset0:12 offset1:14
s_waitcnt lgkmcnt(4)
v_perm_b32 v32, v17, v16, s31
v_perm_b32 v33, v19, v18, s31
v_perm_b32 v34, v21, v20, s31
v_perm_b32 v35, v23, v22, s31
v_perm_b32 v36, v17, v16, s32
v_perm_b32 v37, v19, v18, s32
v_perm_b32 v38, v21, v20, s32
v_perm_b32 v39, v23, v22, s32
v_accvgpr_write_b32 a24, v32
v_accvgpr_write_b32 a25, v33
v_accvgpr_write_b32 a26, v34
v_accvgpr_write_b32 a27, v35
v_accvgpr_write_b32 a32, v36
v_accvgpr_write_b32 a33, v37
v_accvgpr_write_b32 a34, v38
v_accvgpr_write_b32 a35, v39
s_waitcnt lgkmcnt(0)
v_perm_b32 v32, v25, v24, s31
v_perm_b32 v33, v27, v26, s31
v_perm_b32 v34, v29, v28, s31
v_perm_b32 v35, v31, v30, s31
v_perm_b32 v36, v25, v24, s32
v_perm_b32 v37, v27, v26, s32
v_perm_b32 v38, v29, v28, s32
v_perm_b32 v39, v31, v30, s32
v_accvgpr_write_b32 a28, v32
v_accvgpr_write_b32 a29, v33
v_accvgpr_write_b32 a30, v34
v_accvgpr_write_b32 a31, v35
v_accvgpr_write_b32 a36, v36
v_accvgpr_write_b32 a37, v37
v_accvgpr_write_b32 a38, v38
v_accvgpr_write_b32 a39, v39
s_waitcnt vmcnt(4)
s_barrier
s_add_u32 m0, s34, 0
s_mov_b32 s30, 1048576
buffer_load_dwordx4 v8, s[12:15], s30 offen  lds
s_add_u32 m0, s34, 1024
s_mov_b32 s30, 1081344
buffer_load_dwordx4 v8, s[12:15], s30 offen  lds
s_add_u32 m0, s34, 2048
s_mov_b32 s30, 1114112
buffer_load_dwordx4 v8, s[12:15], s30 offen  lds
s_add_u32 m0, s34, 3072
s_mov_b32 s30, 1146880
buffer_load_dwordx4 v8, s[12:15], s30 offen  lds
ds_read2st64_b32 v[16:17], v10 offset0:16 offset1:18
ds_read2st64_b32 v[18:19], v10 offset0:24 offset1:26
ds_read2st64_b32 v[20:21], v10 offset0:20 offset1:22
ds_read2st64_b32 v[22:23], v10 offset0:28 offset1:30
ds_read2st64_b32 v[24:25], v11 offset0:16 offset1:18
ds_read2st64_b32 v[26:27], v11 offset0:24 offset1:26
ds_read2st64_b32 v[28:29], v11 offset0:20 offset1:22
ds_read2st64_b32 v[30:31], v11 offset0:28 offset1:30
s_waitcnt lgkmcnt(4)
v_perm_b32 v32, v17, v16, s31
v_perm_b32 v33, v19, v18, s31
v_perm_b32 v34, v21, v20, s31
v_perm_b32 v35, v23, v22, s31
v_perm_b32 v40, v17, v16, s32
v_perm_b32 v41, v19, v18, s32
v_perm_b32 v42, v21, v20, s32
v_perm_b32 v43, v23, v22, s32
v_accvgpr_write_b32 a40, v32
v_accvgpr_write_b32 a41, v33
v_accvgpr_write_b32 a42, v34
v_accvgpr_write_b32 a43, v35
s_waitcnt lgkmcnt(0)
v_perm_b32 v32, v25, v24, s31
v_perm_b32 v33, v27, v26, s31
v_perm_b32 v34, v29, v28, s31
v_perm_b32 v35, v31, v30, s31
v_perm_b32 v44, v25, v24, s32
v_perm_b32 v45, v27, v26, s32
v_perm_b32 v46, v29, v28, s32
v_perm_b32 v47, v31, v30, s32
v_accvgpr_write_b32 a44, v32
v_accvgpr_write_b32 a45, v33
v_accvgpr_write_b32 a46, v34
v_accvgpr_write_b32 a47, v35
s_waitcnt vmcnt(4)
s_barrier
s_add_u32 m0, s34, 4096
s_mov_b32 s30, 1048576
buffer_load_dwordx4 v8, s[16:19], s30 offen  lds
s_add_u32 m0, s34, 5120
s_mov_b32 s30, 1081344
buffer_load_dwordx4 v8, s[16:19], s30 offen  lds
s_add_u32 m0, s34, 6144
s_mov_b32 s30, 1114112
buffer_load_dwordx4 v8, s[16:19], s30 offen  lds
s_add_u32 m0, s34, 7168
s_mov_b32 s30, 1146880
buffer_load_dwordx4 v8, s[16:19], s30 offen  lds
ds_read2st64_b32 v[16:17], v10 offset0:32 offset1:34
ds_read2st64_b32 v[18:19], v10 offset0:40 offset1:42
ds_read2st64_b32 v[20:21], v10 offset0:36 offset1:38
ds_read2st64_b32 v[22:23], v10 offset0:44 offset1:46
ds_read2st64_b32 v[24:25], v11 offset0:32 offset1:34
ds_read2st64_b32 v[26:27], v11 offset0:40 offset1:42
ds_read2st64_b32 v[28:29], v11 offset0:36 offset1:38
ds_read2st64_b32 v[30:31], v11 offset0:44 offset1:46
s_waitcnt lgkmcnt(4)
v_perm_b32 v32, v17, v16, s31
v_perm_b32 v33, v19, v18, s31
v_perm_b32 v34, v21, v20, s31
v_perm_b32 v35, v23, v22, s31
v_perm_b32 v36, v17, v16, s32
v_perm_b32 v37, v19, v18, s32
v_perm_b32 v38, v21, v20, s32
v_perm_b32 v39, v23, v22, s32
v_accvgpr_write_b32 a48, v32
v_accvgpr_write_b32 a49, v33
v_accvgpr_write_b32 a50, v34
v_accvgpr_write_b32 a51, v35
v_accvgpr_write_b32 a56, v36
v_accvgpr_write_b32 a57, v37
v_accvgpr_write_b32 a58, v38
v_accvgpr_write_b32 a59, v39
s_waitcnt lgkmcnt(0)
v_perm_b32 v32, v25, v24, s31
v_perm_b32 v33, v27, v26, s31
v_perm_b32 v34, v29, v28, s31
v_perm_b32 v35, v31, v30, s31
v_perm_b32 v36, v25, v24, s32
v_perm_b32 v37, v27, v26, s32
v_perm_b32 v38, v29, v28, s32
v_perm_b32 v39, v31, v30, s32
v_accvgpr_write_b32 a52, v32
v_accvgpr_write_b32 a53, v33
v_accvgpr_write_b32 a54, v34
v_accvgpr_write_b32 a55, v35
v_accvgpr_write_b32 a60, v36
v_accvgpr_write_b32 a61, v37
v_accvgpr_write_b32 a62, v38
v_accvgpr_write_b32 a63, v39
s_waitcnt vmcnt(4)
s_barrier
s_add_u32 m0, s34, 8192
s_mov_b32 s30, 1048576
buffer_load_dwordx4 v8, s[20:23], s30 offen  lds
s_add_u32 m0, s34, 9216
s_mov_b32 s30, 1081344
buffer_load_dwordx4 v8, s[20:23], s30 offen  lds
s_add_u32 m0, s34, 10240
s_mov_b32 s30, 1114112
buffer_load_dwordx4 v8, s[20:23], s30 offen  lds
s_add_u32 m0, s34, 11264
s_mov_b32 s30, 1146880
buffer_load_dwordx4 v8, s[20:23], s30 offen  lds
ds_read2st64_b32 v[16:17], v10 offset0:0 offset1:2
ds_read2st64_b32 v[18:19], v10 offset0:8 offset1:10
ds_read2st64_b32 v[20:21], v10 offset0:4 offset1:6
ds_read2st64_b32 v[22:23], v10 offset0:12 offset1:14
ds_read2st64_b32 v[24:25], v11 offset0:0 offset1:2
ds_read2st64_b32 v[26:27], v11 offset0:8 offset1:10
ds_read2st64_b32 v[28:29], v11 offset0:4 offset1:6
ds_read2st64_b32 v[30:31], v11 offset0:12 offset1:14
s_waitcnt lgkmcnt(4)
v_perm_b32 v32, v17, v16, s31
v_perm_b32 v33, v19, v18, s31
v_perm_b32 v34, v21, v20, s31
v_perm_b32 v35, v23, v22, s31
v_perm_b32 v48, v17, v16, s32
v_perm_b32 v49, v19, v18, s32
v_perm_b32 v50, v21, v20, s32
v_perm_b32 v51, v23, v22, s32
v_accvgpr_write_b32 a64, v32
v_accvgpr_write_b32 a65, v33
v_accvgpr_write_b32 a66, v34
v_accvgpr_write_b32 a67, v35
s_waitcnt lgkmcnt(0)
v_perm_b32 v32, v25, v24, s31
v_perm_b32 v33, v27, v26, s31
v_perm_b32 v34, v29, v28, s31
v_perm_b32 v35, v31, v30, s31
v_perm_b32 v52, v25, v24, s32
v_perm_b32 v53, v27, v26, s32
v_perm_b32 v54, v29, v28, s32
v_perm_b32 v55, v31, v30, s32
v_accvgpr_write_b32 a68, v32
v_accvgpr_write_b32 a69, v33
v_accvgpr_write_b32 a70, v34
v_accvgpr_write_b32 a71, v35
s_waitcnt vmcnt(4)
s_barrier
s_add_u32 m0, s34, 0
s_mov_b32 s30, 1572864
buffer_load_dwordx4 v8, s[12:15], s30 offen  lds
s_add_u32 m0, s34, 1024
s_mov_b32 s30, 1605632
buffer_load_dwordx4 v8, s[12:15], s30 offen  lds
s_add_u32 m0, s34, 2048
s_mov_b32 s30, 1638400
buffer_load_dwordx4 v8, s[12:15], s30 offen  lds
s_add_u32 m0, s34, 3072
s_mov_b32 s30, 1671168
buffer_load_dwordx4 v8, s[12:15], s30 offen  lds
ds_read2st64_b32 v[16:17], v10 offset0:16 offset1:18
ds_read2st64_b32 v[18:19], v10 offset0:24 offset1:26
ds_read2st64_b32 v[20:21], v10 offset0:20 offset1:22
ds_read2st64_b32 v[22:23], v10 offset0:28 offset1:30
ds_read2st64_b32 v[24:25], v11 offset0:16 offset1:18
ds_read2st64_b32 v[26:27], v11 offset0:24 offset1:26
ds_read2st64_b32 v[28:29], v11 offset0:20 offset1:22
ds_read2st64_b32 v[30:31], v11 offset0:28 offset1:30
s_lshl_b32 s77, s25, 11
s_add_u32 s77, s77, 2048
s_and_b32 s35, s25, 3
s_lshl_b32 s33, s35, 3
s_sub_u32 s70, s24, s33
s_and_b32 s70, s70, 31
s_lshl_b32 s33, s35, 5
s_add_u32 s70, s70, s33
s_mul_i32 s33, s27, 327680
s_add_u32 s33, s33, 131072
s_mul_i32 s68, s25, 16384
s_lshl_b32 s35, s24, 8
s_add_u32 s68, s68, s35
s_add_u32 s68, s68, s33
s_lshl_b32 s69, s70, 13
s_add_u32 s69, s69, s33
s_lshl_b32 s72, s27, 24
s_lshl_b32 s33, s24, 13
s_add_u32 s72, s72, s33
s_add_u32 s71, s72, 167772160
s_lshl_b32 s33, s25, 11
s_add_u32 s72, s72, s33
s_add_u32 s72, s72, 67108864
s_lshl_b32 s74, s24, 11
s_lshl_b32 s33, s25, 9
s_add_u32 s74, s74, s33
s_lshl_b32 s33, s27, 2
s_add_u32 s74, s74, s33
s_add_u32 s74, s74, 786432
s_lshl_b32 s75, s27, 5
s_add_u32 s75, s75, s24
s_lshl_b32 s75, s75, 7
s_add_u32 s75, s75, 16384
s_lshl_b32 s33, s25, 2
s_add_u32 s75, s75, s33
s_mov_b32 s78, 0x3e0293ee
s_mov_b32 s79, 0x3e0293ee
s_mov_b32 s62, 0
s_mov_b32 s63, 1
s_lshl_b32 s66, s27, 16
s_add_u32 s66, s66, 851968
s_mov_b32 s64, s66
s_add_u32 s65, s66, 16384
s_lshl_b32 s76, s27, 5
s_add_u32 s76, s76, s24
s_lshl_b32 s76, s76, 2
s_add_u32 s76, s76, s25
s_lshl_b32 s76, s76, 13
s_add_u32 s76, s76, 209715200
s_waitcnt lgkmcnt(4)
v_perm_b32 v32, v17, v16, s31
v_perm_b32 v33, v19, v18, s31
v_perm_b32 v34, v21, v20, s31
v_perm_b32 v35, v23, v22, s31
v_perm_b32 v36, v17, v16, s32
v_perm_b32 v37, v19, v18, s32
v_perm_b32 v38, v21, v20, s32
v_perm_b32 v39, v23, v22, s32
v_accvgpr_write_b32 a72, v32
v_accvgpr_write_b32 a73, v33
v_accvgpr_write_b32 a74, v34
v_accvgpr_write_b32 a75, v35
v_accvgpr_write_b32 a80, v36
v_accvgpr_write_b32 a81, v37
v_accvgpr_write_b32 a82, v38
v_accvgpr_write_b32 a83, v39
s_waitcnt lgkmcnt(0)
v_perm_b32 v32, v25, v24, s31
v_perm_b32 v33, v27, v26, s31
v_perm_b32 v34, v29, v28, s31
v_perm_b32 v35, v31, v30, s31
v_perm_b32 v36, v25, v24, s32
v_perm_b32 v37, v27, v26, s32
v_perm_b32 v38, v29, v28, s32
v_perm_b32 v39, v31, v30, s32
v_accvgpr_write_b32 a76, v32
v_accvgpr_write_b32 a77, v33
v_accvgpr_write_b32 a78, v34
v_accvgpr_write_b32 a79, v35
v_accvgpr_write_b32 a84, v36
v_accvgpr_write_b32 a85, v37
v_accvgpr_write_b32 a86, v38
v_accvgpr_write_b32 a87, v39
s_waitcnt vmcnt(4)
s_barrier
s_add_u32 m0, s34, 4096
s_mov_b32 s30, 1572864
buffer_load_dwordx4 v8, s[20:23], s30 offen  lds
s_add_u32 m0, s34, 5120
s_mov_b32 s30, 1605632
buffer_load_dwordx4 v8, s[20:23], s30 offen  lds
s_add_u32 m0, s34, 6144
s_mov_b32 s30, 1638400
buffer_load_dwordx4 v8, s[20:23], s30 offen  lds
s_add_u32 m0, s34, 7168
s_mov_b32 s30, 1671168
buffer_load_dwordx4 v8, s[20:23], s30 offen  lds
ds_read2st64_b32 v[16:17], v10 offset0:32 offset1:34
ds_read2st64_b32 v[18:19], v10 offset0:40 offset1:42
ds_read2st64_b32 v[20:21], v10 offset0:36 offset1:38
ds_read2st64_b32 v[22:23], v10 offset0:44 offset1:46
ds_read2st64_b32 v[24:25], v11 offset0:32 offset1:34
ds_read2st64_b32 v[26:27], v11 offset0:40 offset1:42
ds_read2st64_b32 v[28:29], v11 offset0:36 offset1:38
ds_read2st64_b32 v[30:31], v11 offset0:44 offset1:46
s_waitcnt lgkmcnt(4)
v_perm_b32 v32, v17, v16, s31
v_perm_b32 v33, v19, v18, s31
v_perm_b32 v34, v21, v20, s31
v_perm_b32 v35, v23, v22, s31
v_perm_b32 v56, v17, v16, s32
v_perm_b32 v57, v19, v18, s32
v_perm_b32 v58, v21, v20, s32
v_perm_b32 v59, v23, v22, s32
v_accvgpr_write_b32 a88, v32
v_accvgpr_write_b32 a89, v33
v_accvgpr_write_b32 a90, v34
v_accvgpr_write_b32 a91, v35
s_waitcnt lgkmcnt(0)
v_perm_b32 v32, v25, v24, s31
v_perm_b32 v33, v27, v26, s31
v_perm_b32 v34, v29, v28, s31
v_perm_b32 v35, v31, v30, s31
v_perm_b32 v60, v25, v24, s32
v_perm_b32 v61, v27, v26, s32
v_perm_b32 v62, v29, v28, s32
v_perm_b32 v63, v31, v30, s32
v_accvgpr_write_b32 a92, v32
v_accvgpr_write_b32 a93, v33
v_accvgpr_write_b32 a94, v34
v_accvgpr_write_b32 a95, v35
s_waitcnt vmcnt(4)
s_barrier
s_add_u32 m0, s34, 8192
s_mov_b32 s30, 2097152
buffer_load_dwordx4 v8, s[12:15], s30 offen  lds
s_add_u32 m0, s34, 9216
s_mov_b32 s30, 2129920
buffer_load_dwordx4 v8, s[12:15], s30 offen  lds
s_add_u32 m0, s34, 10240
s_mov_b32 s30, 2162688
buffer_load_dwordx4 v8, s[12:15], s30 offen  lds
s_add_u32 m0, s34, 11264
s_mov_b32 s30, 2195456
buffer_load_dwordx4 v8, s[12:15], s30 offen  lds
ds_read2st64_b32 v[16:17], v10 offset0:0 offset1:2
ds_read2st64_b32 v[18:19], v10 offset0:8 offset1:10
ds_read2st64_b32 v[20:21], v10 offset0:4 offset1:6
ds_read2st64_b32 v[22:23], v10 offset0:12 offset1:14
ds_read2st64_b32 v[24:25], v11 offset0:0 offset1:2
ds_read2st64_b32 v[26:27], v11 offset0:8 offset1:10
ds_read2st64_b32 v[28:29], v11 offset0:4 offset1:6
ds_read2st64_b32 v[30:31], v11 offset0:12 offset1:14
s_waitcnt lgkmcnt(4)
v_perm_b32 v32, v17, v16, s31
v_perm_b32 v33, v19, v18, s31
v_perm_b32 v34, v21, v20, s31
v_perm_b32 v35, v23, v22, s31
v_perm_b32 v36, v17, v16, s32
v_perm_b32 v37, v19, v18, s32
v_perm_b32 v38, v21, v20, s32
v_perm_b32 v39, v23, v22, s32
v_accvgpr_write_b32 a96, v32
v_accvgpr_write_b32 a97, v33
v_accvgpr_write_b32 a98, v34
v_accvgpr_write_b32 a99, v35
v_accvgpr_write_b32 a104, v36
v_accvgpr_write_b32 a105, v37
v_accvgpr_write_b32 a106, v38
v_accvgpr_write_b32 a107, v39
s_waitcnt lgkmcnt(0)
v_perm_b32 v32, v25, v24, s31
v_perm_b32 v33, v27, v26, s31
v_perm_b32 v34, v29, v28, s31
v_perm_b32 v35, v31, v30, s31
v_perm_b32 v36, v25, v24, s32
v_perm_b32 v37, v27, v26, s32
v_perm_b32 v38, v29, v28, s32
v_perm_b32 v39, v31, v30, s32
v_accvgpr_write_b32 a100, v32
v_accvgpr_write_b32 a101, v33
v_accvgpr_write_b32 a102, v34
v_accvgpr_write_b32 a103, v35
v_accvgpr_write_b32 a108, v36
v_accvgpr_write_b32 a109, v37
v_accvgpr_write_b32 a110, v38
v_accvgpr_write_b32 a111, v39
s_waitcnt vmcnt(4)
s_barrier
s_add_u32 m0, s34, 0
s_mov_b32 s30, 2097152
buffer_load_dwordx4 v8, s[20:23], s30 offen  lds
s_add_u32 m0, s34, 1024
s_mov_b32 s30, 2129920
buffer_load_dwordx4 v8, s[20:23], s30 offen  lds
s_add_u32 m0, s34, 2048
s_mov_b32 s30, 2162688
buffer_load_dwordx4 v8, s[20:23], s30 offen  lds
s_add_u32 m0, s34, 3072
s_mov_b32 s30, 2195456
buffer_load_dwordx4 v8, s[20:23], s30 offen  lds
ds_read2st64_b32 v[16:17], v10 offset0:16 offset1:18
ds_read2st64_b32 v[18:19], v10 offset0:24 offset1:26
ds_read2st64_b32 v[20:21], v10 offset0:20 offset1:22
ds_read2st64_b32 v[22:23], v10 offset0:28 offset1:30
ds_read2st64_b32 v[24:25], v11 offset0:16 offset1:18
ds_read2st64_b32 v[26:27], v11 offset0:24 offset1:26
ds_read2st64_b32 v[28:29], v11 offset0:20 offset1:22
ds_read2st64_b32 v[30:31], v11 offset0:28 offset1:30
s_waitcnt lgkmcnt(4)
v_perm_b32 v32, v17, v16, s31
v_perm_b32 v33, v19, v18, s31
v_perm_b32 v34, v21, v20, s31
v_perm_b32 v35, v23, v22, s31
v_perm_b32 v36, v17, v16, s32
v_perm_b32 v37, v19, v18, s32
v_perm_b32 v38, v21, v20, s32
v_perm_b32 v39, v23, v22, s32
v_accvgpr_write_b32 a112, v32
v_accvgpr_write_b32 a113, v33
v_accvgpr_write_b32 a114, v34
v_accvgpr_write_b32 a115, v35
v_accvgpr_write_b32 a120, v36
v_accvgpr_write_b32 a121, v37
v_accvgpr_write_b32 a122, v38
v_accvgpr_write_b32 a123, v39
s_waitcnt lgkmcnt(0)
v_perm_b32 v32, v25, v24, s31
v_perm_b32 v33, v27, v26, s31
v_perm_b32 v34, v29, v28, s31
v_perm_b32 v35, v31, v30, s31
v_perm_b32 v36, v25, v24, s32
v_perm_b32 v37, v27, v26, s32
v_perm_b32 v38, v29, v28, s32
v_perm_b32 v39, v31, v30, s32
v_accvgpr_write_b32 a116, v32
v_accvgpr_write_b32 a117, v33
v_accvgpr_write_b32 a118, v34
v_accvgpr_write_b32 a119, v35
v_accvgpr_write_b32 a124, v36
v_accvgpr_write_b32 a125, v37
v_accvgpr_write_b32 a126, v38
v_accvgpr_write_b32 a127, v39
s_waitcnt vmcnt(4)
s_barrier
s_add_u32 m0, s34, 4096
s_mov_b32 s30, 2621440
buffer_load_dwordx4 v8, s[12:15], s30 offen  lds
s_add_u32 m0, s34, 5120
s_mov_b32 s30, 2654208
buffer_load_dwordx4 v8, s[12:15], s30 offen  lds
s_add_u32 m0, s34, 6144
s_mov_b32 s30, 2686976
buffer_load_dwordx4 v8, s[12:15], s30 offen  lds
s_add_u32 m0, s34, 7168
s_mov_b32 s30, 2719744
buffer_load_dwordx4 v8, s[12:15], s30 offen  lds
ds_read2st64_b32 v[16:17], v10 offset0:32 offset1:34
ds_read2st64_b32 v[18:19], v10 offset0:40 offset1:42
ds_read2st64_b32 v[20:21], v10 offset0:36 offset1:38
ds_read2st64_b32 v[22:23], v10 offset0:44 offset1:46
ds_read2st64_b32 v[24:25], v11 offset0:32 offset1:34
ds_read2st64_b32 v[26:27], v11 offset0:40 offset1:42
ds_read2st64_b32 v[28:29], v11 offset0:36 offset1:38
ds_read2st64_b32 v[30:31], v11 offset0:44 offset1:46
s_waitcnt lgkmcnt(4)
v_perm_b32 v32, v17, v16, s31
v_perm_b32 v33, v19, v18, s31
v_perm_b32 v34, v21, v20, s31
v_perm_b32 v35, v23, v22, s31
v_perm_b32 v72, v17, v16, s32
v_perm_b32 v73, v19, v18, s32
v_perm_b32 v74, v21, v20, s32
v_perm_b32 v75, v23, v22, s32
v_accvgpr_write_b32 a128, v32
v_accvgpr_write_b32 a129, v33
v_accvgpr_write_b32 a130, v34
v_accvgpr_write_b32 a131, v35
s_waitcnt lgkmcnt(0)
v_perm_b32 v32, v25, v24, s31
v_perm_b32 v33, v27, v26, s31
v_perm_b32 v34, v29, v28, s31
v_perm_b32 v35, v31, v30, s31
v_perm_b32 v76, v25, v24, s32
v_perm_b32 v77, v27, v26, s32
v_perm_b32 v78, v29, v28, s32
v_perm_b32 v79, v31, v30, s32
v_accvgpr_write_b32 a132, v32
v_accvgpr_write_b32 a133, v33
v_accvgpr_write_b32 a134, v34
v_accvgpr_write_b32 a135, v35
s_waitcnt vmcnt(4)
s_barrier
s_add_u32 m0, s34, 8192
s_mov_b32 s30, 2621440
buffer_load_dwordx4 v8, s[16:19], s30 offen  lds
s_add_u32 m0, s34, 9216
s_mov_b32 s30, 2654208
buffer_load_dwordx4 v8, s[16:19], s30 offen  lds
s_add_u32 m0, s34, 10240
s_mov_b32 s30, 2686976
buffer_load_dwordx4 v8, s[16:19], s30 offen  lds
s_add_u32 m0, s34, 11264
s_mov_b32 s30, 2719744
buffer_load_dwordx4 v8, s[16:19], s30 offen  lds
ds_read2st64_b32 v[16:17], v10 offset0:0 offset1:2
ds_read2st64_b32 v[18:19], v10 offset0:8 offset1:10
ds_read2st64_b32 v[20:21], v10 offset0:4 offset1:6
ds_read2st64_b32 v[22:23], v10 offset0:12 offset1:14
ds_read2st64_b32 v[24:25], v11 offset0:0 offset1:2
ds_read2st64_b32 v[26:27], v11 offset0:8 offset1:10
ds_read2st64_b32 v[28:29], v11 offset0:4 offset1:6
ds_read2st64_b32 v[30:31], v11 offset0:12 offset1:14
s_waitcnt lgkmcnt(4)
v_perm_b32 v32, v17, v16, s31
v_perm_b32 v33, v19, v18, s31
v_perm_b32 v34, v21, v20, s31
v_perm_b32 v35, v23, v22, s31
v_perm_b32 v80, v17, v16, s32
v_perm_b32 v81, v19, v18, s32
v_perm_b32 v82, v21, v20, s32
v_perm_b32 v83, v23, v22, s32
v_accvgpr_write_b32 a144, v32
v_accvgpr_write_b32 a145, v33
v_accvgpr_write_b32 a146, v34
v_accvgpr_write_b32 a147, v35
s_waitcnt lgkmcnt(0)
v_perm_b32 v32, v25, v24, s31
v_perm_b32 v33, v27, v26, s31
v_perm_b32 v34, v29, v28, s31
v_perm_b32 v35, v31, v30, s31
v_perm_b32 v84, v25, v24, s32
v_perm_b32 v85, v27, v26, s32
v_perm_b32 v86, v29, v28, s32
v_perm_b32 v87, v31, v30, s32
v_accvgpr_write_b32 a148, v32
v_accvgpr_write_b32 a149, v33
v_accvgpr_write_b32 a150, v34
v_accvgpr_write_b32 a151, v35
s_waitcnt vmcnt(4)
s_barrier
s_add_u32 m0, s34, 0
s_mov_b32 s30, 3145728
buffer_load_dwordx4 v8, s[12:15], s30 offen  lds
s_add_u32 m0, s34, 1024
s_mov_b32 s30, 3178496
buffer_load_dwordx4 v8, s[12:15], s30 offen  lds
s_add_u32 m0, s34, 2048
s_mov_b32 s30, 3211264
buffer_load_dwordx4 v8, s[12:15], s30 offen  lds
s_add_u32 m0, s34, 3072
s_mov_b32 s30, 3244032
buffer_load_dwordx4 v8, s[12:15], s30 offen  lds
ds_read2st64_b32 v[16:17], v10 offset0:16 offset1:18
ds_read2st64_b32 v[18:19], v10 offset0:24 offset1:26
ds_read2st64_b32 v[20:21], v10 offset0:20 offset1:22
ds_read2st64_b32 v[22:23], v10 offset0:28 offset1:30
ds_read2st64_b32 v[24:25], v11 offset0:16 offset1:18
ds_read2st64_b32 v[26:27], v11 offset0:24 offset1:26
ds_read2st64_b32 v[28:29], v11 offset0:20 offset1:22
ds_read2st64_b32 v[30:31], v11 offset0:28 offset1:30
s_waitcnt lgkmcnt(4)
v_perm_b32 v32, v17, v16, s31
v_perm_b32 v33, v19, v18, s31
v_perm_b32 v34, v21, v20, s31
v_perm_b32 v35, v23, v22, s31
v_perm_b32 v36, v17, v16, s32
v_perm_b32 v37, v19, v18, s32
v_perm_b32 v38, v21, v20, s32
v_perm_b32 v39, v23, v22, s32
v_accvgpr_write_b32 a152, v32
v_accvgpr_write_b32 a153, v33
v_accvgpr_write_b32 a154, v34
v_accvgpr_write_b32 a155, v35
v_accvgpr_write_b32 a160, v36
v_accvgpr_write_b32 a161, v37
v_accvgpr_write_b32 a162, v38
v_accvgpr_write_b32 a163, v39
s_waitcnt lgkmcnt(0)
v_perm_b32 v32, v25, v24, s31
v_perm_b32 v33, v27, v26, s31
v_perm_b32 v34, v29, v28, s31
v_perm_b32 v35, v31, v30, s31
v_perm_b32 v36, v25, v24, s32
v_perm_b32 v37, v27, v26, s32
v_perm_b32 v38, v29, v28, s32
v_perm_b32 v39, v31, v30, s32
v_accvgpr_write_b32 a156, v32
v_accvgpr_write_b32 a157, v33
v_accvgpr_write_b32 a158, v34
v_accvgpr_write_b32 a159, v35
v_accvgpr_write_b32 a164, v36
v_accvgpr_write_b32 a165, v37
v_accvgpr_write_b32 a166, v38
v_accvgpr_write_b32 a167, v39
s_waitcnt vmcnt(4)
s_barrier
s_add_u32 m0, s34, 4096
s_mov_b32 s30, 3145728
buffer_load_dwordx4 v8, s[16:19], s30 offen  lds
s_add_u32 m0, s34, 5120
s_mov_b32 s30, 3178496
buffer_load_dwordx4 v8, s[16:19], s30 offen  lds
s_add_u32 m0, s34, 6144
s_mov_b32 s30, 3211264
buffer_load_dwordx4 v8, s[16:19], s30 offen  lds
s_add_u32 m0, s34, 7168
s_mov_b32 s30, 3244032
buffer_load_dwordx4 v8, s[16:19], s30 offen  lds
ds_read2st64_b32 v[16:17], v10 offset0:32 offset1:34
ds_read2st64_b32 v[18:19], v10 offset0:40 offset1:42
ds_read2st64_b32 v[20:21], v10 offset0:36 offset1:38
ds_read2st64_b32 v[22:23], v10 offset0:44 offset1:46
ds_read2st64_b32 v[24:25], v11 offset0:32 offset1:34
ds_read2st64_b32 v[26:27], v11 offset0:40 offset1:42
ds_read2st64_b32 v[28:29], v11 offset0:36 offset1:38
ds_read2st64_b32 v[30:31], v11 offset0:44 offset1:46
s_waitcnt lgkmcnt(4)
v_perm_b32 v32, v17, v16, s31
v_perm_b32 v33, v19, v18, s31
v_perm_b32 v34, v21, v20, s31
v_perm_b32 v35, v23, v22, s31
v_perm_b32 v36, v17, v16, s32
v_perm_b32 v37, v19, v18, s32
v_perm_b32 v38, v21, v20, s32
v_perm_b32 v39, v23, v22, s32
v_accvgpr_write_b32 a168, v32
v_accvgpr_write_b32 a169, v33
v_accvgpr_write_b32 a170, v34
v_accvgpr_write_b32 a171, v35
ds_write_b128 v2, v[36:39] offset:12288
s_waitcnt lgkmcnt(1)
v_perm_b32 v32, v25, v24, s31
v_perm_b32 v33, v27, v26, s31
v_perm_b32 v34, v29, v28, s31
v_perm_b32 v35, v31, v30, s31
v_perm_b32 v36, v25, v24, s32
v_perm_b32 v37, v27, v26, s32
v_perm_b32 v38, v29, v28, s32
v_perm_b32 v39, v31, v30, s32
v_accvgpr_write_b32 a172, v32
v_accvgpr_write_b32 a173, v33
v_accvgpr_write_b32 a174, v34
v_accvgpr_write_b32 a175, v35
ds_write_b128 v2, v[36:39] offset:13312
s_waitcnt vmcnt(4)
s_barrier
s_add_u32 m0, s34, 8192
s_mov_b32 s30, 3670016
buffer_load_dwordx4 v8, s[12:15], s30 offen  lds
s_add_u32 m0, s34, 9216
s_mov_b32 s30, 3702784
buffer_load_dwordx4 v8, s[12:15], s30 offen  lds
s_add_u32 m0, s34, 10240
s_mov_b32 s30, 3735552
buffer_load_dwordx4 v8, s[12:15], s30 offen  lds
s_add_u32 m0, s34, 11264
s_mov_b32 s30, 3768320
buffer_load_dwordx4 v8, s[12:15], s30 offen  lds
ds_read2st64_b32 v[16:17], v10 offset0:0 offset1:2
ds_read2st64_b32 v[18:19], v10 offset0:8 offset1:10
ds_read2st64_b32 v[20:21], v10 offset0:4 offset1:6
ds_read2st64_b32 v[22:23], v10 offset0:12 offset1:14
ds_read2st64_b32 v[24:25], v11 offset0:0 offset1:2
ds_read2st64_b32 v[26:27], v11 offset0:8 offset1:10
ds_read2st64_b32 v[28:29], v11 offset0:4 offset1:6
ds_read2st64_b32 v[30:31], v11 offset0:12 offset1:14
s_waitcnt lgkmcnt(4)
v_perm_b32 v32, v17, v16, s31
v_perm_b32 v33, v19, v18, s31
v_perm_b32 v34, v21, v20, s31
v_perm_b32 v35, v23, v22, s31
v_perm_b32 v36, v17, v16, s32
v_perm_b32 v37, v19, v18, s32
v_perm_b32 v38, v21, v20, s32
v_perm_b32 v39, v23, v22, s32
v_accvgpr_write_b32 a184, v32
v_accvgpr_write_b32 a185, v33
v_accvgpr_write_b32 a186, v34
v_accvgpr_write_b32 a187, v35
ds_write_b128 v2, v[36:39] offset:14336
s_waitcnt lgkmcnt(1)
v_perm_b32 v32, v25, v24, s31
v_perm_b32 v33, v27, v26, s31
v_perm_b32 v34, v29, v28, s31
v_perm_b32 v35, v31, v30, s31
v_perm_b32 v36, v25, v24, s32
v_perm_b32 v37, v27, v26, s32
v_perm_b32 v38, v29, v28, s32
v_perm_b32 v39, v31, v30, s32
v_accvgpr_write_b32 a188, v32
v_accvgpr_write_b32 a189, v33
v_accvgpr_write_b32 a190, v34
v_accvgpr_write_b32 a191, v35
ds_write_b128 v2, v[36:39] offset:15360
s_waitcnt vmcnt(4)
s_barrier
s_add_u32 m0, s34, 0
s_mov_b32 s30, 3670016
buffer_load_dwordx4 v8, s[16:19], s30 offen  lds
s_add_u32 m0, s34, 1024
s_mov_b32 s30, 3702784
buffer_load_dwordx4 v8, s[16:19], s30 offen  lds
s_add_u32 m0, s34, 2048
s_mov_b32 s30, 3735552
buffer_load_dwordx4 v8, s[16:19], s30 offen  lds
s_add_u32 m0, s34, 3072
s_mov_b32 s30, 3768320
buffer_load_dwordx4 v8, s[16:19], s30 offen  lds
ds_read2st64_b32 v[16:17], v10 offset0:16 offset1:18
ds_read2st64_b32 v[18:19], v10 offset0:24 offset1:26
ds_read2st64_b32 v[20:21], v10 offset0:20 offset1:22
ds_read2st64_b32 v[22:23], v10 offset0:28 offset1:30
ds_read2st64_b32 v[24:25], v11 offset0:16 offset1:18
ds_read2st64_b32 v[26:27], v11 offset0:24 offset1:26
ds_read2st64_b32 v[28:29], v11 offset0:20 offset1:22
ds_read2st64_b32 v[30:31], v11 offset0:28 offset1:30
s_waitcnt lgkmcnt(4)
v_perm_b32 v32, v17, v16, s31
v_perm_b32 v33, v19, v18, s31
v_perm_b32 v34, v21, v20, s31
v_perm_b32 v35, v23, v22, s31
v_perm_b32 v36, v17, v16, s32
v_perm_b32 v37, v19, v18, s32
v_perm_b32 v38, v21, v20, s32
v_perm_b32 v39, v23, v22, s32
v_accvgpr_write_b32 a192, v32
v_accvgpr_write_b32 a193, v33
v_accvgpr_write_b32 a194, v34
v_accvgpr_write_b32 a195, v35
v_accvgpr_write_b32 a200, v36
v_accvgpr_write_b32 a201, v37
v_accvgpr_write_b32 a202, v38
v_accvgpr_write_b32 a203, v39
s_waitcnt lgkmcnt(0)
v_perm_b32 v32, v25, v24, s31
v_perm_b32 v33, v27, v26, s31
v_perm_b32 v34, v29, v28, s31
v_perm_b32 v35, v31, v30, s31
v_perm_b32 v36, v25, v24, s32
v_perm_b32 v37, v27, v26, s32
v_perm_b32 v38, v29, v28, s32
v_perm_b32 v39, v31, v30, s32
v_accvgpr_write_b32 a196, v32
v_accvgpr_write_b32 a197, v33
v_accvgpr_write_b32 a198, v34
v_accvgpr_write_b32 a199, v35
v_accvgpr_write_b32 a204, v36
v_accvgpr_write_b32 a205, v37
v_accvgpr_write_b32 a206, v38
v_accvgpr_write_b32 a207, v39
s_waitcnt vmcnt(4)
s_barrier
s_add_u32 m0, s34, 4096
s_mov_b32 s30, 3670016
buffer_load_dwordx4 v8, s[20:23], s30 offen  lds
s_add_u32 m0, s34, 5120
s_mov_b32 s30, 3702784
buffer_load_dwordx4 v8, s[20:23], s30 offen  lds
s_add_u32 m0, s34, 6144
s_mov_b32 s30, 3735552
buffer_load_dwordx4 v8, s[20:23], s30 offen  lds
s_add_u32 m0, s34, 7168
s_mov_b32 s30, 3768320
buffer_load_dwordx4 v8, s[20:23], s30 offen  lds
ds_read2st64_b32 v[16:17], v10 offset0:32 offset1:34
ds_read2st64_b32 v[18:19], v10 offset0:40 offset1:42
ds_read2st64_b32 v[20:21], v10 offset0:36 offset1:38
ds_read2st64_b32 v[22:23], v10 offset0:44 offset1:46
ds_read2st64_b32 v[24:25], v11 offset0:32 offset1:34
ds_read2st64_b32 v[26:27], v11 offset0:40 offset1:42
ds_read2st64_b32 v[28:29], v11 offset0:36 offset1:38
ds_read2st64_b32 v[30:31], v11 offset0:44 offset1:46
s_waitcnt lgkmcnt(4)
v_perm_b32 v32, v17, v16, s31
v_perm_b32 v33, v19, v18, s31
v_perm_b32 v34, v21, v20, s31
v_perm_b32 v35, v23, v22, s31
v_perm_b32 v36, v17, v16, s32
v_perm_b32 v37, v19, v18, s32
v_perm_b32 v38, v21, v20, s32
v_perm_b32 v39, v23, v22, s32
ds_write_b128 v2, v[32:35] offset:16384
v_accvgpr_write_b32 a216, v36
v_accvgpr_write_b32 a217, v37
v_accvgpr_write_b32 a218, v38
v_accvgpr_write_b32 a219, v39
s_waitcnt lgkmcnt(1)
v_perm_b32 v32, v25, v24, s31
v_perm_b32 v33, v27, v26, s31
v_perm_b32 v34, v29, v28, s31
v_perm_b32 v35, v31, v30, s31
v_perm_b32 v36, v25, v24, s32
v_perm_b32 v37, v27, v26, s32
v_perm_b32 v38, v29, v28, s32
v_perm_b32 v39, v31, v30, s32
ds_write_b128 v2, v[32:35] offset:17408
v_accvgpr_write_b32 a220, v36
v_accvgpr_write_b32 a221, v37
v_accvgpr_write_b32 a222, v38
v_accvgpr_write_b32 a223, v39
s_waitcnt vmcnt(4)
s_barrier
s_add_u32 m0, s34, 8192
s_mov_b32 s30, 4194304
buffer_load_dwordx4 v8, s[16:19], s30 offen  lds
s_add_u32 m0, s34, 9216
s_mov_b32 s30, 4227072
buffer_load_dwordx4 v8, s[16:19], s30 offen  lds
s_add_u32 m0, s34, 10240
s_mov_b32 s30, 4259840
buffer_load_dwordx4 v8, s[16:19], s30 offen  lds
s_add_u32 m0, s34, 11264
s_mov_b32 s30, 4292608
buffer_load_dwordx4 v8, s[16:19], s30 offen  lds
ds_read2st64_b32 v[16:17], v10 offset0:0 offset1:2
ds_read2st64_b32 v[18:19], v10 offset0:8 offset1:10
ds_read2st64_b32 v[20:21], v10 offset0:4 offset1:6
ds_read2st64_b32 v[22:23], v10 offset0:12 offset1:14
ds_read2st64_b32 v[24:25], v11 offset0:0 offset1:2
ds_read2st64_b32 v[26:27], v11 offset0:8 offset1:10
ds_read2st64_b32 v[28:29], v11 offset0:4 offset1:6
ds_read2st64_b32 v[30:31], v11 offset0:12 offset1:14
s_waitcnt lgkmcnt(4)
v_perm_b32 v32, v17, v16, s31
v_perm_b32 v33, v19, v18, s31
v_perm_b32 v34, v21, v20, s31
v_perm_b32 v35, v23, v22, s31
v_perm_b32 v36, v17, v16, s32
v_perm_b32 v37, v19, v18, s32
v_perm_b32 v38, v21, v20, s32
v_perm_b32 v39, v23, v22, s32
v_accvgpr_write_b32 a224, v32
v_accvgpr_write_b32 a225, v33
v_accvgpr_write_b32 a226, v34
v_accvgpr_write_b32 a227, v35
v_accvgpr_write_b32 a232, v36
v_accvgpr_write_b32 a233, v37
v_accvgpr_write_b32 a234, v38
v_accvgpr_write_b32 a235, v39
s_waitcnt lgkmcnt(0)
v_perm_b32 v32, v25, v24, s31
v_perm_b32 v33, v27, v26, s31
v_perm_b32 v34, v29, v28, s31
v_perm_b32 v35, v31, v30, s31
v_perm_b32 v36, v25, v24, s32
v_perm_b32 v37, v27, v26, s32
v_perm_b32 v38, v29, v28, s32
v_perm_b32 v39, v31, v30, s32
v_accvgpr_write_b32 a228, v32
v_accvgpr_write_b32 a229, v33
v_accvgpr_write_b32 a230, v34
v_accvgpr_write_b32 a231, v35
v_accvgpr_write_b32 a236, v36
v_accvgpr_write_b32 a237, v37
v_accvgpr_write_b32 a238, v38
v_accvgpr_write_b32 a239, v39
s_waitcnt vmcnt(4)
s_barrier
s_add_u32 m0, s34, 0
s_mov_b32 s30, 4194304
buffer_load_dwordx4 v8, s[20:23], s30 offen  lds
s_add_u32 m0, s34, 1024
s_mov_b32 s30, 4227072
buffer_load_dwordx4 v8, s[20:23], s30 offen  lds
s_add_u32 m0, s34, 2048
s_mov_b32 s30, 4259840
buffer_load_dwordx4 v8, s[20:23], s30 offen  lds
s_add_u32 m0, s34, 3072
s_mov_b32 s30, 4292608
buffer_load_dwordx4 v8, s[20:23], s30 offen  lds
ds_read2st64_b32 v[16:17], v10 offset0:16 offset1:18
ds_read2st64_b32 v[18:19], v10 offset0:24 offset1:26
ds_read2st64_b32 v[20:21], v10 offset0:20 offset1:22
ds_read2st64_b32 v[22:23], v10 offset0:28 offset1:30
ds_read2st64_b32 v[24:25], v11 offset0:16 offset1:18
ds_read2st64_b32 v[26:27], v11 offset0:24 offset1:26
ds_read2st64_b32 v[28:29], v11 offset0:20 offset1:22
ds_read2st64_b32 v[30:31], v11 offset0:28 offset1:30
s_waitcnt lgkmcnt(4)
v_perm_b32 v32, v17, v16, s31
v_perm_b32 v33, v19, v18, s31
v_perm_b32 v34, v21, v20, s31
v_perm_b32 v35, v23, v22, s31
v_perm_b32 v36, v17, v16, s32
v_perm_b32 v37, v19, v18, s32
v_perm_b32 v38, v21, v20, s32
v_perm_b32 v39, v23, v22, s32
ds_write_b128 v2, v[32:35] offset:18432
v_accvgpr_write_b32 a240, v36
v_accvgpr_write_b32 a241, v37
v_accvgpr_write_b32 a242, v38
v_accvgpr_write_b32 a243, v39
s_waitcnt lgkmcnt(1)
v_perm_b32 v32, v25, v24, s31
v_perm_b32 v33, v27, v26, s31
v_perm_b32 v34, v29, v28, s31
v_perm_b32 v35, v31, v30, s31
v_perm_b32 v36, v25, v24, s32
v_perm_b32 v37, v27, v26, s32
v_perm_b32 v38, v29, v28, s32
v_perm_b32 v39, v31, v30, s32
ds_write_b128 v2, v[32:35] offset:19456
v_accvgpr_write_b32 a244, v36
v_accvgpr_write_b32 a245, v37
v_accvgpr_write_b32 a246, v38
v_accvgpr_write_b32 a247, v39
s_waitcnt vmcnt(4)
s_barrier
s_add_u32 m0, s34, 4096
s_mov_b32 s30, 4718592
buffer_load_dwordx4 v8, s[16:19], s30 offen  lds
s_add_u32 m0, s34, 5120
s_mov_b32 s30, 4751360
buffer_load_dwordx4 v8, s[16:19], s30 offen  lds
s_add_u32 m0, s34, 6144
s_mov_b32 s30, 4784128
buffer_load_dwordx4 v8, s[16:19], s30 offen  lds
s_add_u32 m0, s34, 7168
s_mov_b32 s30, 4816896
buffer_load_dwordx4 v8, s[16:19], s30 offen  lds
ds_read2st64_b32 v[16:17], v10 offset0:32 offset1:34
ds_read2st64_b32 v[18:19], v10 offset0:40 offset1:42
ds_read2st64_b32 v[20:21], v10 offset0:36 offset1:38
ds_read2st64_b32 v[22:23], v10 offset0:44 offset1:46
ds_read2st64_b32 v[24:25], v11 offset0:32 offset1:34
ds_read2st64_b32 v[26:27], v11 offset0:40 offset1:42
ds_read2st64_b32 v[28:29], v11 offset0:36 offset1:38
ds_read2st64_b32 v[30:31], v11 offset0:44 offset1:46
s_waitcnt lgkmcnt(4)
v_perm_b32 v32, v17, v16, s31
v_perm_b32 v33, v19, v18, s31
v_perm_b32 v34, v21, v20, s31
v_perm_b32 v35, v23, v22, s31
v_perm_b32 v96, v17, v16, s32
v_perm_b32 v97, v19, v18, s32
v_perm_b32 v98, v21, v20, s32
v_perm_b32 v99, v23, v22, s32
ds_write_b128 v2, v[32:35] offset:20480
s_waitcnt lgkmcnt(1)
v_perm_b32 v32, v25, v24, s31
v_perm_b32 v33, v27, v26, s31
v_perm_b32 v34, v29, v28, s31
v_perm_b32 v35, v31, v30, s31
v_perm_b32 v100, v25, v24, s32
v_perm_b32 v101, v27, v26, s32
v_perm_b32 v102, v29, v28, s32
v_perm_b32 v103, v31, v30, s32
ds_write_b128 v2, v[32:35] offset:21504
s_waitcnt vmcnt(4)
s_barrier
s_add_u32 m0, s34, 8192
s_mov_b32 s30, 4718592
buffer_load_dwordx4 v8, s[20:23], s30 offen  lds
s_add_u32 m0, s34, 9216
s_mov_b32 s30, 4751360
buffer_load_dwordx4 v8, s[20:23], s30 offen  lds
s_add_u32 m0, s34, 10240
s_mov_b32 s30, 4784128
buffer_load_dwordx4 v8, s[20:23], s30 offen  lds
s_add_u32 m0, s34, 11264
s_mov_b32 s30, 4816896
buffer_load_dwordx4 v8, s[20:23], s30 offen  lds
ds_read2st64_b32 v[16:17], v10 offset0:0 offset1:2
ds_read2st64_b32 v[18:19], v10 offset0:8 offset1:10
ds_read2st64_b32 v[20:21], v10 offset0:4 offset1:6
ds_read2st64_b32 v[22:23], v10 offset0:12 offset1:14
ds_read2st64_b32 v[24:25], v11 offset0:0 offset1:2
ds_read2st64_b32 v[26:27], v11 offset0:8 offset1:10
ds_read2st64_b32 v[28:29], v11 offset0:4 offset1:6
ds_read2st64_b32 v[30:31], v11 offset0:12 offset1:14
s_waitcnt lgkmcnt(4)
v_perm_b32 v104, v17, v16, s31
v_perm_b32 v105, v19, v18, s31
v_perm_b32 v106, v21, v20, s31
v_perm_b32 v107, v23, v22, s31
v_perm_b32 v112, v17, v16, s32
v_perm_b32 v113, v19, v18, s32
v_perm_b32 v114, v21, v20, s32
v_perm_b32 v115, v23, v22, s32
s_waitcnt lgkmcnt(0)
v_perm_b32 v108, v25, v24, s31
v_perm_b32 v109, v27, v26, s31
v_perm_b32 v110, v29, v28, s31
v_perm_b32 v111, v31, v30, s31
v_perm_b32 v116, v25, v24, s32
v_perm_b32 v117, v27, v26, s32
v_perm_b32 v118, v29, v28, s32
v_perm_b32 v119, v31, v30, s32
s_waitcnt vmcnt(4)
s_barrier
s_add_u32 m0, s34, 0
s_mov_b32 s30, 0
buffer_load_dwordx4 v9, s[96:99], s30 offen  lds
s_add_u32 m0, s34, 1024
s_mov_b32 s30, 5120
buffer_load_dwordx4 v9, s[96:99], s30 offen  lds
s_add_u32 m0, s34, 2048
s_mov_b32 s30, 10240
buffer_load_dwordx4 v9, s[96:99], s30 offen  lds
s_add_u32 m0, s34, 3072
s_mov_b32 s30, 15360
buffer_load_dwordx4 v9, s[96:99], s30 offen  lds
ds_read2st64_b32 v[16:17], v10 offset0:16 offset1:18
ds_read2st64_b32 v[18:19], v10 offset0:24 offset1:26
ds_read2st64_b32 v[20:21], v10 offset0:20 offset1:22
ds_read2st64_b32 v[22:23], v10 offset0:28 offset1:30
ds_read2st64_b32 v[24:25], v11 offset0:16 offset1:18
ds_read2st64_b32 v[26:27], v11 offset0:24 offset1:26
ds_read2st64_b32 v[28:29], v11 offset0:20 offset1:22
ds_read2st64_b32 v[30:31], v11 offset0:28 offset1:30
v_and_b32 v92, 63, v0
v_lshlrev_b32 v92, 2, v92
buffer_load_dword v93, v92, s[8:11], 0 offen sc1
s_waitcnt lgkmcnt(4)
v_perm_b32 v120, v17, v16, s31
v_perm_b32 v121, v19, v18, s31
v_perm_b32 v122, v21, v20, s31
v_perm_b32 v123, v23, v22, s31
v_perm_b32 v128, v17, v16, s32
v_perm_b32 v129, v19, v18, s32
v_perm_b32 v130, v21, v20, s32
v_perm_b32 v131, v23, v22, s32
s_waitcnt lgkmcnt(0)
v_perm_b32 v124, v25, v24, s31
v_perm_b32 v125, v27, v26, s31
v_perm_b32 v126, v29, v28, s31
v_perm_b32 v127, v31, v30, s31
v_perm_b32 v132, v25, v24, s32
v_perm_b32 v133, v27, v26, s32
v_perm_b32 v134, v29, v28, s32
v_perm_b32 v135, v31, v30, s32
s_waitcnt vmcnt(5)
s_barrier
s_add_u32 m0, s34, 4096
s_mov_b32 s30, 256
buffer_load_dwordx4 v9, s[96:99], s30 offen  lds
s_add_u32 m0, s34, 5120
s_mov_b32 s30, 5376
buffer_load_dwordx4 v9, s[96:99], s30 offen  lds
s_add_u32 m0, s34, 6144
s_mov_b32 s30, 10496
buffer_load_dwordx4 v9, s[96:99], s30 offen  lds
s_add_u32 m0, s34, 7168
s_mov_b32 s30, 15616
buffer_load_dwordx4 v9, s[96:99], s30 offen  lds
ds_read2st64_b32 v[16:17], v10 offset0:32 offset1:34
ds_read2st64_b32 v[18:19], v10 offset0:40 offset1:42
ds_read2st64_b32 v[20:21], v10 offset0:36 offset1:38
ds_read2st64_b32 v[22:23], v10 offset0:44 offset1:46
ds_read2st64_b32 v[24:25], v11 offset0:32 offset1:34
ds_read2st64_b32 v[26:27], v11 offset0:40 offset1:42
ds_read2st64_b32 v[28:29], v11 offset0:36 offset1:38
ds_read2st64_b32 v[30:31], v11 offset0:44 offset1:46
s_waitcnt lgkmcnt(4)
v_perm_b32 v32, v17, v16, s31
v_perm_b32 v33, v19, v18, s31
v_perm_b32 v34, v21, v20, s31
v_perm_b32 v35, v23, v22, s31
v_perm_b32 v136, v17, v16, s32
v_perm_b32 v137, v19, v18, s32
v_perm_b32 v138, v21, v20, s32
v_perm_b32 v139, v23, v22, s32
ds_write_b128 v2, v[32:35] offset:24576
s_waitcnt lgkmcnt(1)
v_perm_b32 v32, v25, v24, s31
v_perm_b32 v33, v27, v26, s31
v_perm_b32 v34, v29, v28, s31
v_perm_b32 v35, v31, v30, s31
v_perm_b32 v140, v25, v24, s32
v_perm_b32 v141, v27, v26, s32
v_perm_b32 v142, v29, v28, s32
v_perm_b32 v143, v31, v30, s32
ds_write_b128 v2, v[32:35] offset:25600
s_waitcnt vmcnt(5)
s_barrier
s_add_u32 m0, s34, 8192
s_mov_b32 s30, 512
buffer_load_dwordx4 v9, s[96:99], s30 offen  lds
s_add_u32 m0, s34, 9216
s_mov_b32 s30, 5632
buffer_load_dwordx4 v9, s[96:99], s30 offen  lds
s_add_u32 m0, s34, 10240
s_mov_b32 s30, 10752
buffer_load_dwordx4 v9, s[96:99], s30 offen  lds
s_add_u32 m0, s34, 11264
s_mov_b32 s30, 15872
buffer_load_dwordx4 v9, s[96:99], s30 offen  lds
ds_read2st64_b32 v[16:17], v12 offset0:0 offset1:1
ds_read2st64_b32 v[18:19], v12 offset0:8 offset1:9
ds_read2st64_b32 v[20:21], v12 offset0:2 offset1:3
ds_read2st64_b32 v[22:23], v12 offset0:10 offset1:11
ds_read2st64_b32 v[24:25], v13 offset0:0 offset1:1
ds_read2st64_b32 v[26:27], v13 offset0:8 offset1:9
ds_read2st64_b32 v[28:29], v13 offset0:2 offset1:3
ds_read2st64_b32 v[30:31], v13 offset0:10 offset1:11
s_waitcnt lgkmcnt(4)
v_perm_b32 v32, v17, v16, s31
v_perm_b32 v33, v19, v18, s31
v_perm_b32 v34, v21, v20, s31
v_perm_b32 v35, v23, v22, s31
v_perm_b32 v144, v17, v16, s32
v_perm_b32 v145, v19, v18, s32
v_perm_b32 v146, v21, v20, s32
v_perm_b32 v147, v23, v22, s32
ds_write_b128 v2, v[32:35] offset:26624
s_waitcnt lgkmcnt(1)
v_perm_b32 v32, v25, v24, s31
v_perm_b32 v33, v27, v26, s31
v_perm_b32 v34, v29, v28, s31
v_perm_b32 v35, v31, v30, s31
v_perm_b32 v148, v25, v24, s32
v_perm_b32 v149, v27, v26, s32
v_perm_b32 v150, v29, v28, s32
v_perm_b32 v151, v31, v30, s32
ds_write_b128 v2, v[32:35] offset:27648
s_waitcnt vmcnt(4)
s_barrier
s_add_u32 m0, s34, 0
s_mov_b32 s30, 768
buffer_load_dwordx4 v9, s[96:99], s30 offen  lds
s_add_u32 m0, s34, 1024
s_mov_b32 s30, 5888
buffer_load_dwordx4 v9, s[96:99], s30 offen  lds
s_add_u32 m0, s34, 2048
s_mov_b32 s30, 11008
buffer_load_dwordx4 v9, s[96:99], s30 offen  lds
s_add_u32 m0, s34, 3072
s_mov_b32 s30, 16128
buffer_load_dwordx4 v9, s[96:99], s30 offen  lds
ds_read2st64_b32 v[16:17], v12 offset0:16 offset1:17
ds_read2st64_b32 v[18:19], v12 offset0:24 offset1:25
ds_read2st64_b32 v[20:21], v12 offset0:18 offset1:19
ds_read2st64_b32 v[22:23], v12 offset0:26 offset1:27
ds_read2st64_b32 v[24:25], v13 offset0:16 offset1:17
ds_read2st64_b32 v[26:27], v13 offset0:24 offset1:25
ds_read2st64_b32 v[28:29], v13 offset0:18 offset1:19
ds_read2st64_b32 v[30:31], v13 offset0:26 offset1:27
s_waitcnt lgkmcnt(4)
v_perm_b32 v32, v17, v16, s31
v_perm_b32 v33, v19, v18, s31
v_perm_b32 v34, v21, v20, s31
v_perm_b32 v35, v23, v22, s31
v_perm_b32 v168, v17, v16, s32
v_perm_b32 v169, v19, v18, s32
v_perm_b32 v170, v21, v20, s32
v_perm_b32 v171, v23, v22, s32
ds_write_b128 v2, v[32:35] offset:28672
s_waitcnt lgkmcnt(1)
v_perm_b32 v32, v25, v24, s31
v_perm_b32 v33, v27, v26, s31
v_perm_b32 v34, v29, v28, s31
v_perm_b32 v35, v31, v30, s31
v_perm_b32 v172, v25, v24, s32
v_perm_b32 v173, v27, v26, s32
v_perm_b32 v174, v29, v28, s32
v_perm_b32 v175, v31, v30, s32
ds_write_b128 v2, v[32:35] offset:29696
s_waitcnt vmcnt(4)
s_barrier
s_add_u32 m0, s34, 4096
s_mov_b32 s30, 1024
buffer_load_dwordx4 v9, s[96:99], s30 offen  lds
s_add_u32 m0, s34, 5120
s_mov_b32 s30, 6144
buffer_load_dwordx4 v9, s[96:99], s30 offen  lds
s_add_u32 m0, s34, 6144
s_mov_b32 s30, 11264
buffer_load_dwordx4 v9, s[96:99], s30 offen  lds
s_add_u32 m0, s34, 7168
s_mov_b32 s30, 16384
buffer_load_dwordx4 v9, s[96:99], s30 offen  lds
ds_read2st64_b32 v[16:17], v12 offset0:32 offset1:33
ds_read2st64_b32 v[18:19], v12 offset0:40 offset1:41
ds_read2st64_b32 v[20:21], v12 offset0:34 offset1:35
ds_read2st64_b32 v[22:23], v12 offset0:42 offset1:43
ds_read2st64_b32 v[24:25], v13 offset0:32 offset1:33
ds_read2st64_b32 v[26:27], v13 offset0:40 offset1:41
ds_read2st64_b32 v[28:29], v13 offset0:34 offset1:35
ds_read2st64_b32 v[30:31], v13 offset0:42 offset1:43
s_waitcnt lgkmcnt(4)
v_perm_b32 v32, v17, v16, s31
v_perm_b32 v33, v19, v18, s31
v_perm_b32 v34, v21, v20, s31
v_perm_b32 v35, v23, v22, s31
v_perm_b32 v192, v17, v16, s32
v_perm_b32 v193, v19, v18, s32
v_perm_b32 v194, v21, v20, s32
v_perm_b32 v195, v23, v22, s32
ds_write_b128 v2, v[32:35] offset:30720
s_waitcnt lgkmcnt(1)
v_perm_b32 v32, v25, v24, s31
v_perm_b32 v33, v27, v26, s31
v_perm_b32 v34, v29, v28, s31
v_perm_b32 v35, v31, v30, s31
v_perm_b32 v196, v25, v24, s32
v_perm_b32 v197, v27, v26, s32
v_perm_b32 v198, v29, v28, s32
v_perm_b32 v199, v31, v30, s32
ds_write_b128 v2, v[32:35] offset:31744
s_waitcnt vmcnt(4)
s_barrier
s_add_u32 m0, s34, 8192
s_mov_b32 s30, 81920
buffer_load_dwordx4 v9, s[96:99], s30 offen  lds
s_add_u32 m0, s34, 9216
s_mov_b32 s30, 87040
buffer_load_dwordx4 v9, s[96:99], s30 offen  lds
s_add_u32 m0, s34, 10240
s_mov_b32 s30, 92160
buffer_load_dwordx4 v9, s[96:99], s30 offen  lds
s_add_u32 m0, s34, 11264
s_mov_b32 s30, 97280
buffer_load_dwordx4 v9, s[96:99], s30 offen  lds
ds_read2st64_b32 v[16:17], v12 offset0:0 offset1:1
ds_read2st64_b32 v[18:19], v12 offset0:8 offset1:9
ds_read2st64_b32 v[20:21], v12 offset0:2 offset1:3
ds_read2st64_b32 v[22:23], v12 offset0:10 offset1:11
ds_read2st64_b32 v[24:25], v13 offset0:0 offset1:1
ds_read2st64_b32 v[26:27], v13 offset0:8 offset1:9
ds_read2st64_b32 v[28:29], v13 offset0:2 offset1:3
ds_read2st64_b32 v[30:31], v13 offset0:10 offset1:11
s_mov_b32 s28, 0
s_mov_b32 s30, 0x80808080
s_branch sy11
sy8:
buffer_load_dword v93, v92, s[8:11], 0 offen sc1
s_waitcnt vmcnt(0)
sy11:
v_and_b32 v94, s30, v93
v_cmp_ne_u32 vcc, s30, v94
s_cbranch_vccz sy9
s_sleep 2
s_add_u32 s28, s28, 1
s_cmp_lt_u32 s28, 524288
s_cbranch_scc1 sy8
s_mov_b32 s29, 1
s_branch L_abort
sy9:
s_cmp_lg_u32 s26, 0
s_cbranch_scc1 sy10
v_mov_b32 v95, 0
v_bfe_u32 v94, v93, 0, 3
v_lshlrev_b32 v94, v94, 1
v_or_b32 v95, v95, v94
v_bfe_u32 v94, v93, 8, 3
v_lshlrev_b32 v94, v94, 1
v_or_b32 v95, v95, v94
v_bfe_u32 v94, v93, 16, 3
v_lshlrev_b32 v94, v94, 1
v_or_b32 v95, v95, v94
v_bfe_u32 v94, v93, 24, 3
v_lshlrev_b32 v94, v94, 1
v_or_b32 v95, v95, v94
s_nop 1
v_mov_b32 v94, v95 quad_perm:[1,0,3,2] row_mask:0xf bank_mask:0xf
v_or_b32 v95, v95, v94
v_cmp_ne_u32 vcc, 0xff, v95
s_cbranch_vccnz L_rank
s_mov_b32 s26, 1
sy10:
v_and_b32 v88, 128, v6
buffer_load_dword v88, v88, s[4:7], s74 offen sc1
buffer_load_dword v89, off, s[4:7], s95 sc1
s_getpc_b64 s[84:85]
L_Rpc:
s_add_u32 s84, s84, L_Rsetup-L_Rpc
s_addc_u32 s85, s85, 0
v_lshlrev_b32 v7, 6, v0
v_min_u32 v7, L_R_slow-L_Rsetup, v7
global_load_dword v3, v7, s[84:85]
s_mul_i32 s33, s27, 327680
s_mul_i32 s35, s24, 10240
s_add_u32 s33, s33, s35
s_add_u32 s33, s33, 131072
v_min_u32 v7, 79, v0
v_lshlrev_b32 v7, 7, v7
buffer_load_dword v4, v7, s[4:7], s33 offen sc1
s_waitcnt lgkmcnt(4)
v_perm_b32 v32, v17, v16, s31
v_perm_b32 v33, v19, v18, s31
v_perm_b32 v34, v21, v20, s31
v_perm_b32 v35, v23, v22, s31
v_perm_b32 v216, v17, v16, s32
v_perm_b32 v217, v19, v18, s32
v_perm_b32 v218, v21, v20, s32
v_perm_b32 v219, v23, v22, s32
ds_write_b128 v2, v[32:35] offset:32768
s_waitcnt lgkmcnt(1)
v_perm_b32 v32, v25, v24, s31
v_perm_b32 v33, v27, v26, s31
v_perm_b32 v34, v29, v28, s31
v_perm_b32 v35, v31, v30, s31
v_perm_b32 v220, v25, v24, s32
v_perm_b32 v221, v27, v26, s32
v_perm_b32 v222, v29, v28, s32
v_perm_b32 v223, v31, v30, s32
ds_write_b128 v2, v[32:35] offset:33792
s_waitcnt vmcnt(8)
s_barrier
s_add_u32 m0, s34, 0
s_mov_b32 s30, 82176
buffer_load_dwordx4 v9, s[96:99], s30 offen  lds
s_add_u32 m0, s34, 1024
s_mov_b32 s30, 87296
buffer_load_dwordx4 v9, s[96:99], s30 offen  lds
s_add_u32 m0, s34, 2048
s_mov_b32 s30, 92416
buffer_load_dwordx4 v9, s[96:99], s30 offen  lds
s_add_u32 m0, s34, 3072
s_mov_b32 s30, 97536
buffer_load_dwordx4 v9, s[96:99], s30 offen  lds
ds_read2st64_b32 v[16:17], v12 offset0:16 offset1:17
ds_read2st64_b32 v[18:19], v12 offset0:24 offset1:25
ds_read2st64_b32 v[20:21], v12 offset0:18 offset1:19
ds_read2st64_b32 v[22:23], v12 offset0:26 offset1:27
ds_read2st64_b32 v[24:25], v13 offset0:16 offset1:17
ds_read2st64_b32 v[26:27], v13 offset0:24 offset1:25
ds_read2st64_b32 v[28:29], v13 offset0:18 offset1:19
ds_read2st64_b32 v[30:31], v13 offset0:26 offset1:27
s_waitcnt lgkmcnt(4)
v_perm_b32 v232, v17, v16, s31
v_perm_b32 v233, v19, v18, s31
v_perm_b32 v234, v21, v20, s31
v_perm_b32 v235, v23, v22, s31
v_perm_b32 v240, v17, v16, s32
v_perm_b32 v241, v19, v18, s32
v_perm_b32 v242, v21, v20, s32
v_perm_b32 v243, v23, v22, s32
s_waitcnt lgkmcnt(0)
v_perm_b32 v236, v25, v24, s31
v_perm_b32 v237, v27, v26, s31
v_perm_b32 v238, v29, v28, s31
v_perm_b32 v239, v31, v30, s31
v_perm_b32 v244, v25, v24, s32
v_perm_b32 v245, v27, v26, s32
v_perm_b32 v246, v29, v28, s32
v_perm_b32 v247, v31, v30, s32
s_waitcnt vmcnt(8)
s_barrier
s_add_u32 m0, s34, 4096
s_mov_b32 s30, 82432
buffer_load_dwordx4 v9, s[96:99], s30 offen  lds
s_add_u32 m0, s34, 5120
s_mov_b32 s30, 87552
buffer_load_dwordx4 v9, s[96:99], s30 offen  lds
s_add_u32 m0, s34, 6144
s_mov_b32 s30, 92672
buffer_load_dwordx4 v9, s[96:99], s30 offen  lds
s_add_u32 m0, s34, 7168
s_mov_b32 s30, 97792
buffer_load_dwordx4 v9, s[96:99], s30 offen  lds
ds_read2st64_b32 v[16:17], v12 offset0:32 offset1:33
ds_read2st64_b32 v[18:19], v12 offset0:40 offset1:41
ds_read2st64_b32 v[20:21], v12 offset0:34 offset1:35
ds_read2st64_b32 v[22:23], v12 offset0:42 offset1:43
ds_read2st64_b32 v[24:25], v13 offset0:32 offset1:33
ds_read2st64_b32 v[26:27], v13 offset0:40 offset1:41
ds_read2st64_b32 v[28:29], v13 offset0:34 offset1:35
ds_read2st64_b32 v[30:31], v13 offset0:42 offset1:43
s_waitcnt lgkmcnt(4)
v_perm_b32 v152, v17, v16, s31
v_perm_b32 v153, v19, v18, s31
v_perm_b32 v154, v21, v20, s31
v_perm_b32 v155, v23, v22, s31
v_perm_b32 v160, v17, v16, s32
v_perm_b32 v161, v19, v18, s32
v_perm_b32 v162, v21, v20, s32
v_perm_b32 v163, v23, v22, s32
s_waitcnt lgkmcnt(0)
v_perm_b32 v156, v25, v24, s31
v_perm_b32 v157, v27, v26, s31
v_perm_b32 v158, v29, v28, s31
v_perm_b32 v159, v31, v30, s31
v_perm_b32 v164, v25, v24, s32
v_perm_b32 v165, v27, v26, s32
v_perm_b32 v166, v29, v28, s32
v_perm_b32 v167, v31, v30, s32
s_waitcnt vmcnt(4)
s_barrier
s_add_u32 m0, s34, 8192
s_mov_b32 s30, 82688
buffer_load_dwordx4 v9, s[96:99], s30 offen  lds
s_add_u32 m0, s34, 9216
s_mov_b32 s30, 87808
buffer_load_dwordx4 v9, s[96:99], s30 offen  lds
s_add_u32 m0, s34, 10240
s_mov_b32 s30, 92928
buffer_load_dwordx4 v9, s[96:99], s30 offen  lds
s_add_u32 m0, s34, 11264
s_mov_b32 s30, 98048
buffer_load_dwordx4 v9, s[96:99], s30 offen  lds
ds_read2st64_b32 v[16:17], v12 offset0:0 offset1:1
ds_read2st64_b32 v[18:19], v12 offset0:8 offset1:9
ds_read2st64_b32 v[20:21], v12 offset0:2 offset1:3
ds_read2st64_b32 v[22:23], v12 offset0:10 offset1:11
ds_read2st64_b32 v[24:25], v13 offset0:0 offset1:1
ds_read2st64_b32 v[26:27], v13 offset0:8 offset1:9
ds_read2st64_b32 v[28:29], v13 offset0:2 offset1:3
ds_read2st64_b32 v[30:31], v13 offset0:10 offset1:11
s_waitcnt lgkmcnt(4)
v_perm_b32 v176, v17, v16, s31
v_perm_b32 v177, v19, v18, s31
v_perm_b32 v178, v21, v20, s31
v_perm_b32 v179, v23, v22, s31
v_perm_b32 v184, v17, v16, s32
v_perm_b32 v185, v19, v18, s32
v_perm_b32 v186, v21, v20, s32
v_perm_b32 v187, v23, v22, s32
s_waitcnt lgkmcnt(0)
v_perm_b32 v180, v25, v24, s31
v_perm_b32 v181, v27, v26, s31
v_perm_b32 v182, v29, v28, s31
v_perm_b32 v183, v31, v30, s31
v_perm_b32 v188, v25, v24, s32
v_perm_b32 v189, v27, v26, s32
v_perm_b32 v190, v29, v28, s32
v_perm_b32 v191, v31, v30, s32
s_waitcnt vmcnt(4)
s_barrier
s_add_u32 m0, s34, 0
s_mov_b32 s30, 82944
buffer_load_dwordx4 v9, s[96:99], s30 offen  lds
s_add_u32 m0, s34, 1024
s_mov_b32 s30, 88064
buffer_load_dwordx4 v9, s[96:99], s30 offen  lds
s_add_u32 m0, s34, 2048
s_mov_b32 s30, 93184
buffer_load_dwordx4 v9, s[96:99], s30 offen  lds
s_add_u32 m0, s34, 3072
s_mov_b32 s30, 98304
buffer_load_dwordx4 v9, s[96:99], s30 offen  lds
ds_read2st64_b32 v[16:17], v12 offset0:16 offset1:17
ds_read2st64_b32 v[18:19], v12 offset0:24 offset1:25
ds_read2st64_b32 v[20:21], v12 offset0:18 offset1:19
ds_read2st64_b32 v[22:23], v12 offset0:26 offset1:27
ds_read2st64_b32 v[24:25], v13 offset0:16 offset1:17
ds_read2st64_b32 v[26:27], v13 offset0:24 offset1:25
ds_read2st64_b32 v[28:29], v13 offset0:18 offset1:19
ds_read2st64_b32 v[30:31], v13 offset0:26 offset1:27
s_mov_b32 s28, 0
r12:
v_cmp_eq_u32 vcc, 1, v89
s_cbranch_vccnz r13
buffer_load_dword v89, off, s[4:7], s95 sc1
s_waitcnt vmcnt(0)
s_add_u32 s28, s28, 1
s_cmp_lt_u32 s28, 524288
s_cbranch_scc1 r12
s_mov_b32 s29, 7
s_branch L_abort
r13:
s_add_u32 s33, s93, 0
buffer_load_dwordx4 a[0:3], v6, s[4:7], s33 offen sc1
s_add_u32 s33, s93, 1024
buffer_load_dwordx4 a[4:7], v6, s[4:7], s33 offen sc1
s_add_u32 s33, s93, 2048
buffer_load_dwordx4 a[8:11], v6, s[4:7], s33 offen sc1
s_add_u32 s33, s93, 3072
buffer_load_dwordx4 a[12:15], v6, s[4:7], s33 offen sc1
s_add_u32 s33, s93, 4096
buffer_load_dwordx4 a[16:19], v6, s[4:7], s33 offen sc1
s_add_u32 s33, s93, 5120
buffer_load_dwordx4 a[20:23], v6, s[4:7], s33 offen sc1
s_add_u32 s33, s93, 6144
buffer_load_dwordx4 v[64:67], v6, s[4:7], s33 offen sc1
s_add_u32 s33, s93, 7168
buffer_load_dwordx4 v[68:71], v6, s[4:7], s33 offen sc1
s_add_u32 s33, s93, 8192
buffer_load_dwordx4 a[136:139], v6, s[4:7], s33 offen sc1
s_add_u32 s33, s93, 9216
buffer_load_dwordx4 a[140:143], v6, s[4:7], s33 offen sc1
s_add_u32 s33, s93, 10240
buffer_load_dwordx4 a[176:179], v6, s[4:7], s33 offen sc1
s_add_u32 s33, s93, 11264
buffer_load_dwordx4 a[180:183], v6, s[4:7], s33 offen sc1
s_add_u32 s33, s93, 12288
buffer_load_dwordx4 a[208:211], v6, s[4:7], s33 offen sc1
s_add_u32 s33, s93, 13312
buffer_load_dwordx4 a[212:215], v6, s[4:7], s33 offen sc1
s_add_u32 s33, s93, 14336
buffer_load_dwordx4 a[248:251], v6, s[4:7], s33 offen sc1
s_add_u32 s33, s93, 15360
buffer_load_dwordx4 a[252:255], v6, s[4:7], s33 offen sc1
s_add_u32 s33, s93, 16384
s_add_u32 m0, s34, 22528
s_nop 0
buffer_load_dwordx4 v6, s[4:7], s33 offen sc1 lds
s_add_u32 s33, s93, 17408
s_add_u32 m0, s34, 23552
s_nop 0
buffer_load_dwordx4 v6, s[4:7], s33 offen sc1 lds
v_lshlrev_b32 v90, 3, v6
s_add_u32 s33, s67, 10240
buffer_load_dword v91, v90, s[4:7], s33 offen sc1
s_add_u32 s33, s67, 6144
buffer_load_dword v92, v90, s[4:7], s33 offen sc1
s_waitcnt lgkmcnt(4)
v_perm_b32 v200, v17, v16, s31
v_perm_b32 v201, v19, v18, s31
v_perm_b32 v202, v21, v20, s31
v_perm_b32 v203, v23, v22, s31
v_perm_b32 v208, v17, v16, s32
v_perm_b32 v209, v19, v18, s32
v_perm_b32 v210, v21, v20, s32
v_perm_b32 v211, v23, v22, s32
s_waitcnt lgkmcnt(0)
v_perm_b32 v204, v25, v24, s31
v_perm_b32 v205, v27, v26, s31
v_perm_b32 v206, v29, v28, s31
v_perm_b32 v207, v31, v30, s31
v_perm_b32 v212, v25, v24, s32
v_perm_b32 v213, v27, v26, s32
v_perm_b32 v214, v29, v28, s32
v_perm_b32 v215, v31, v30, s32
s_waitcnt vmcnt(24)
s_barrier
ds_read2st64_b32 v[16:17], v12 offset0:32 offset1:33
ds_read2st64_b32 v[18:19], v12 offset0:40 offset1:41
ds_read2st64_b32 v[20:21], v12 offset0:34 offset1:35
ds_read2st64_b32 v[22:23], v12 offset0:42 offset1:43
ds_read2st64_b32 v[24:25], v13 offset0:32 offset1:33
ds_read2st64_b32 v[26:27], v13 offset0:40 offset1:41
ds_read2st64_b32 v[28:29], v13 offset0:34 offset1:35
ds_read2st64_b32 v[30:31], v13 offset0:42 offset1:43
s_waitcnt lgkmcnt(4)
v_perm_b32 v224, v17, v16, s31
v_perm_b32 v225, v19, v18, s31
v_perm_b32 v226, v21, v20, s31
v_perm_b32 v227, v23, v22, s31
v_perm_b32 v36, v17, v16, s32
v_perm_b32 v37, v19, v18, s32
v_perm_b32 v38, v21, v20, s32
v_perm_b32 v39, v23, v22, s32
ds_write_b128 v2, v[36:39] offset:34816
s_waitcnt lgkmcnt(1)
v_perm_b32 v228, v25, v24, s31
v_perm_b32 v229, v27, v26, s31
v_perm_b32 v230, v29, v28, s31
v_perm_b32 v231, v31, v30, s31
v_perm_b32 v36, v25, v24, s32
v_perm_b32 v37, v27, v26, s32
v_perm_b32 v38, v29, v28, s32
v_perm_b32 v39, v31, v30, s32
ds_write_b128 v2, v[36:39] offset:35840
s_waitcnt vmcnt(20)
s_barrier
ds_read2st64_b32 v[16:17], v12 offset0:0 offset1:1
ds_read2st64_b32 v[18:19], v12 offset0:8 offset1:9
ds_read2st64_b32 v[20:21], v12 offset0:2 offset1:3
ds_read2st64_b32 v[22:23], v12 offset0:10 offset1:11
ds_read2st64_b32 v[24:25], v13 offset0:0 offset1:1
ds_read2st64_b32 v[26:27], v13 offset0:8 offset1:9
ds_read2st64_b32 v[28:29], v13 offset0:2 offset1:3
ds_read2st64_b32 v[30:31], v13 offset0:10 offset1:11
s_waitcnt lgkmcnt(4)
v_perm_b32 v32, v17, v16, s31
v_perm_b32 v33, v19, v18, s31
v_perm_b32 v34, v21, v20, s31
v_perm_b32 v35, v23, v22, s31
v_perm_b32 v248, v17, v16, s32
v_perm_b32 v249, v19, v18, s32
v_perm_b32 v250, v21, v20, s32
v_perm_b32 v251, v23, v22, s32
ds_write_b128 v2, v[32:35] offset:36864
s_waitcnt lgkmcnt(1)
v_perm_b32 v32, v25, v24, s31
v_perm_b32 v33, v27, v26, s31
v_perm_b32 v34, v29, v28, s31
v_perm_b32 v35, v31, v30, s31
v_perm_b32 v252, v25, v24, s32
v_perm_b32 v253, v27, v26, s32
v_perm_b32 v254, v29, v28, s32
v_perm_b32 v255, v31, v30, s32
ds_write_b128 v2, v[32:35] offset:37888
s_waitcnt vmcnt(0) lgkmcnt(0)
s_barrier
L_Rsetup:
v_mov_b32 v0, v6
v_mov_b32 v6, v88
s_nop 0
v_readlane_b32 s73, v6, 0
v_readlane_b32 s29, v6, 8
s_nop 0
s_min_u32 s73, s73, s29
s_cmp_ge_u32 s73, 1
s_cbranch_scc0 r14
buffer_load_dwordx4 v[16:19], v0, s[4:7], s72 offen offset:0 sc1
buffer_load_dwordx4 v[20:23], v0, s[4:7], s72 offen offset:1024 sc1
s_add_u32 s33, s72, 33554432
buffer_load_dwordx4 v[24:27], v0, s[4:7], s33 offen offset:0 sc1
buffer_load_dwordx4 v[28:31], v0, s[4:7], s33 offen offset:1024 sc1
r14:
ds_write_b128 v2, v[40:43] offset:0
ds_write_b128 v2, v[44:47] offset:1024
ds_write_b128 v2, v[48:51] offset:2048
ds_write_b128 v2, v[52:55] offset:3072
ds_write_b128 v2, v[56:59] offset:4096
ds_write_b128 v2, v[60:63] offset:5120
ds_write_b128 v2, v[64:67] offset:6144
ds_write_b128 v2, v[68:71] offset:7168
ds_write_b128 v2, v[72:75] offset:8192
ds_write_b128 v2, v[76:79] offset:9216
ds_write_b128 v2, v[80:83] offset:10240
ds_write_b128 v2, v[84:87] offset:11264
s_mov_b32 s80, 0xff00ff
s_mov_b32 s81, 0xff00ff
s_mov_b32 s92, 0xff00ff00
s_mov_b32 s93, 0xff00ff00
s_mov_b32 s82, 0xffffffff
s_mov_b32 s83, 0x0
v_lshrrev_b32 v6, 4, v0
v_lshrrev_b32 v7, 4, v6
v_and_b32 v32, 7, v6
v_mov_b32 v33, 0x4444
v_mov_b32 v34, 0xeeee
v_cndmask_b32 v1, v34, v33, s[80:81]
v_lshlrev_b32 v8, 7, v7
v_lshl_add_u32 v8, v32, 4, v8
v_and_b32 v34, 8, v6
v_add_u32 v9, v34, v8
v_lshl_add_u32 v9, s25, 9, v9
v_lshl_add_u32 v3, s25, 10, v0
v_lshrrev_b32 v5, 1, v3
v_or_b32 v4, 32, v6
v_lshlrev_b32 v4, 3, v4
v_lshrrev_b32 v38, 5, v6
v_lshlrev_b32 v10, 13, v38
v_and_b32 v39, 31, v6
v_lshl_add_u32 v10, v39, 3, v10
v_bfe_u32 v33, v6, 4, 1
v_bfe_u32 v34, v6, 3, 1
v_and_b32 v36, 3, v6
v_bfe_u32 v37, v6, 2, 1
v_lshl_add_u32 v35, v36, 1, v33
v_lshlrev_b32 v11, 7, v34
v_lshl_add_u32 v11, v35, 4, v11
v_lshl_add_u32 v11, v37, 3, v11
s_add_u32 s12, s67, 0
s_add_u32 s13, s67, 4096
s_add_u32 s14, s67, 8192
s_add_u32 s15, s67, 12288
s_add_u32 s16, s67, 16384
s_add_u32 s17, s67, 20480
s_lshl_b32 s33, s25, 10
s_add_u32 s23, s71, s33
s_lshr_b32 s33, s33, 1
s_add_u32 s71, s71, s33
s_add_u32 s71, s71, 4096
s_lshl_b32 s96, s70, 8
s_add_u32 s97, s66, 49152
s_lshl_b32 s99, s25, 11
s_add_u32 s99, s99, 8192
s_cmp_eq_u32 s25, 0
s_cselect_b32 s99, 0, s99
s_mul_i32 s99, s99, 1
s_add_u32 s98, s69, 4096
s_add_u32 s18, s68, 0
s_add_u32 s19, s68, 65536
s_add_u32 s20, s68, 131072
s_add_u32 s21, s68, 196608
s_add_u32 s22, s68, 262144
s_mov_b32 s84, 0x300003
s_mov_b32 s85, 0x300003
s_mov_b32 s86, 0xc0000c
s_mov_b32 s87, 0xc0000c
s_mov_b32 s88, 0x30000300
s_mov_b32 s89, 0x30000300
s_mov_b32 s90, 0xc0000c00
s_mov_b32 s91, 0xc0000c00
v_and_b32 v7, 16, v0
v_mov_b32 v12, 0x3f80
v_lshlrev_b32 v7, v7, v12
v_cndmask_b32 v12, 0, v7, s[84:85]
v_cndmask_b32 v13, 0, v7, s[86:87]
v_cndmask_b32 v14, 0, v7, s[88:89]
v_cndmask_b32 v15, 0, v7, s[90:91]
s_mov_b32 s84, 0x30003
s_mov_b32 s85, 0x30003
s_mov_b32 s86, 0xc000c
s_mov_b32 s87, 0xc000c
s_mov_b32 s88, 0x300030
s_mov_b32 s89, 0x300030
s_mov_b32 s90, 0xc000c0
s_mov_b32 s91, 0xc000c0
s_waitcnt lgkmcnt(0)
buffer_load_dwordx4 v[32:35], v0, s[4:7], s12 offen offset:0 sc1
buffer_load_dwordx4 v[36:39], v0, s[4:7], s12 offen offset:1024 sc1
buffer_load_dwordx4 v[40:43], v0, s[4:7], s12 offen offset:2048 sc1
buffer_load_dwordx4 v[44:47], v0, s[4:7], s12 offen offset:3072 sc1
buffer_load_dwordx4 v[48:51], v0, s[4:7], s13 offen offset:0 sc1
buffer_load_dwordx4 v[52:55], v0, s[4:7], s13 offen offset:1024 sc1
s_cmp_ge_u32 s73, 1
s_cbranch_scc1 r15
s_mov_b32 s35, 1
s_cmp_ge_u32 s73, s35
s_cbranch_scc1 r17
s_mov_b32 s28, 0
r16:
v_and_b32 v6, 128, v0
buffer_load_dword v6, v6, s[4:7], s74 offen sc1
s_waitcnt vmcnt(0)
v_readlane_b32 s73, v6, 0
v_readlane_b32 s29, v6, 8
s_nop 0
s_min_u32 s73, s73, s29
s_cmp_ge_u32 s73, s35
s_cbranch_scc1 r17
s_add_u32 s28, s28, 1
s_cmp_lt_u32 s28, 524288
s_cbranch_scc1 r16
s_mov_b32 s29, 2
s_branch L_abort
r17:
buffer_load_dwordx4 v[16:19], v0, s[4:7], s72 offen offset:0 sc1
buffer_load_dwordx4 v[20:23], v0, s[4:7], s72 offen offset:1024 sc1
s_add_u32 s33, s72, 33554432
buffer_load_dwordx4 v[24:27], v0, s[4:7], s33 offen offset:0 sc1
buffer_load_dwordx4 v[28:31], v0, s[4:7], s33 offen offset:1024 sc1
r15:
s_add_u32 s34, s64, s77
s_add_u32 s32, s64, s99
s_mov_b32 s28, 0
s_mov_b32 s44, 1
s_lshl_b32 s94, s24, 2
s_add_u32 s94, s94, s25
s_lshl_b32 s94, s94, 7
s_add_u32 s41, s74, 128
s_mov_b32 s42, 0
s_mov_b32 s43, 0
s_cmp_eq_u32 s26, 1
s_cbranch_scc0 L_R_slow
.p2align 6
s_nop 0
s_nop 0
L_Rftop:
buffer_load_dwordx4 v[64:67], v0, s[4:7], s32 offen offset:0 sc1
buffer_load_dwordx4 v[68:71], v0, s[4:7], s32 offen offset:1024 sc1
buffer_load_dwordx4 v[56:59], v0, s[4:7], s34 offen offset:0 sc1
buffer_load_dwordx4 v[60:63], v0, s[4:7], s34 offen offset:1024 sc1
v_mov_b64 v[72:73], 0
v_mov_b64 v[74:75], 0
v_mov_b64 v[76:77], 0
v_mov_b64 v[78:79], 0
v_mov_b64 v[80:81], 0
v_mov_b64 v[82:83], 0
v_mov_b64 v[84:85], 0
v_mov_b64 v[86:87], 0
v_mov_b64 v[88:89], 0
v_mov_b64 v[90:91], 0
v_mov_b64 v[92:93], 0
v_mov_b64 v[94:95], 0
v_lshl_add_u32 v7, s25, 11, v0
s_waitcnt vmcnt(2)
v_max3_u32 v6, v64, v65, v66
v_max3_u32 v6, v6, v67, v68
v_max3_u32 v6, v6, v69, v70
v_max_u32 v6, v6, v71
v_cmp_eq_u32 vcc, -1, v6
s_cbranch_vccnz r18r
r18:
v_smfmac_f32_16x16x64_bf16 v[80:83], v[64:67], v[32:39], v1
buffer_load_dwordx4 v[32:35], v0, s[4:7], s13 offen offset:2048 sc1
buffer_load_dwordx4 v[36:39], v0, s[4:7], s13 offen offset:3072 sc1
s_waitcnt vmcnt(2)
v_max3_u32 v6, v56, v57, v58
v_max3_u32 v6, v6, v59, v60
v_smfmac_f32_16x16x64_bf16 v[84:87], v[64:67], a[0:7], v1
v_max3_u32 v6, v6, v61, v62
v_max_u32 v6, v6, v63
v_smfmac_f32_16x16x64_bf16 v[88:91], v[64:67], v[40:47], v1
buffer_load_dwordx4 v[40:43], v0, s[4:7], s14 offen offset:0 sc1
buffer_load_dwordx4 v[44:47], v0, s[4:7], s14 offen offset:1024 sc1
v_cmp_eq_u32 vcc, -1, v6
s_cbranch_vccnz r19r
r19:
ds_write_b128 v7, v[56:59]
v_smfmac_f32_16x16x64_bf16 v[92:95], v[64:67], a[8:15], v1
ds_write_b128 v7, v[60:63] offset:1024
ds_read_b128 v[56:59], v2 offset:0
ds_read_b128 v[60:63], v2 offset:1024
v_smfmac_f32_16x16x64_bf16 v[72:75], v[64:67], v[48:55], v1
buffer_load_dwordx4 v[48:51], v0, s[4:7], s14 offen offset:2048 sc1
buffer_load_dwordx4 v[52:55], v0, s[4:7], s14 offen offset:3072 sc1
v_smfmac_f32_16x16x64_bf16 v[76:79], v[64:67], a[16:23], v1
v_smfmac_f32_16x16x64_bf16 v[80:83], v[68:71], a[24:31], v1
v_smfmac_f32_16x16x64_bf16 v[84:87], v[68:71], a[32:39], v1
s_waitcnt lgkmcnt(2)
s_barrier
ds_read_b128 v[64:67], v0 offset:0
v_smfmac_f32_16x16x64_bf16 v[88:91], v[68:71], a[40:47], v1
s_waitcnt lgkmcnt(1)
v_smfmac_f32_16x16x64_bf16 v[92:95], v[68:71], v[56:63], v1
ds_read_b128 v[56:59], v2 offset:2048
ds_read_b128 v[60:63], v2 offset:3072
v_smfmac_f32_16x16x64_bf16 v[72:75], v[68:71], a[48:55], v1
v_smfmac_f32_16x16x64_bf16 v[76:79], v[68:71], a[56:63], v1
ds_read_b128 v[68:71], v0 offset:1024
s_waitcnt lgkmcnt(3)
v_smfmac_f32_16x16x64_bf16 v[80:83], v[64:67], a[64:71], v1
s_waitcnt lgkmcnt(1)
v_smfmac_f32_16x16x64_bf16 v[84:87], v[64:67], v[56:63], v1
ds_read_b128 v[56:59], v2 offset:4096
ds_read_b128 v[60:63], v2 offset:5120
v_smfmac_f32_16x16x64_bf16 v[88:91], v[64:67], a[72:79], v1
v_smfmac_f32_16x16x64_bf16 v[92:95], v[64:67], a[80:87], v1
v_smfmac_f32_16x16x64_bf16 v[72:75], v[64:67], a[88:95], v1
s_waitcnt lgkmcnt(0)
v_smfmac_f32_16x16x64_bf16 v[76:79], v[64:67], v[56:63], v1
ds_read_b128 v[56:59], v2 offset:6144
ds_read_b128 v[60:63], v2 offset:7168
ds_read_b128 v[64:67], v0 offset:2048
v_smfmac_f32_16x16x64_bf16 v[80:83], v[68:71], a[96:103], v1
v_smfmac_f32_16x16x64_bf16 v[84:87], v[68:71], a[104:111], v1
s_waitcnt vmcnt(4)
v_smfmac_f32_16x16x64_bf16 v[88:91], v[68:71], v[32:39], v1
buffer_load_dwordx4 v[32:35], v0, s[4:7], s15 offen offset:0 sc1
buffer_load_dwordx4 v[36:39], v0, s[4:7], s15 offen offset:1024 sc1
s_waitcnt lgkmcnt(1)
v_smfmac_f32_16x16x64_bf16 v[92:95], v[68:71], v[56:63], v1
ds_read_b128 v[56:59], v2 offset:8192
ds_read_b128 v[60:63], v2 offset:9216
v_smfmac_f32_16x16x64_bf16 v[72:75], v[68:71], a[112:119], v1
v_smfmac_f32_16x16x64_bf16 v[76:79], v[68:71], a[120:127], v1
ds_read_b128 v[68:71], v0 offset:3072
s_waitcnt lgkmcnt(3)
v_smfmac_f32_16x16x64_bf16 v[80:83], v[64:67], a[128:135], v1
s_waitcnt lgkmcnt(1)
v_smfmac_f32_16x16x64_bf16 v[84:87], v[64:67], v[56:63], v1
ds_read_b128 v[56:59], v2 offset:10240
ds_read_b128 v[60:63], v2 offset:11264
v_smfmac_f32_16x16x64_bf16 v[88:91], v[64:67], a[136:143], v1
s_waitcnt vmcnt(4)
v_smfmac_f32_16x16x64_bf16 v[92:95], v[64:67], v[40:47], v1
buffer_load_dwordx4 v[40:43], v0, s[4:7], s15 offen offset:2048 sc1
buffer_load_dwordx4 v[44:47], v0, s[4:7], s15 offen offset:3072 sc1
v_smfmac_f32_16x16x64_bf16 v[72:75], v[64:67], a[144:151], v1
s_waitcnt lgkmcnt(0)
v_smfmac_f32_16x16x64_bf16 v[76:79], v[64:67], v[56:63], v1
ds_read_b128 v[56:59], v2 offset:12288
ds_read_b128 v[60:63], v2 offset:13312
ds_read_b128 v[64:67], v0 offset:4096
v_smfmac_f32_16x16x64_bf16 v[80:83], v[68:71], a[152:159], v1
v_smfmac_f32_16x16x64_bf16 v[84:87], v[68:71], a[160:167], v1
v_smfmac_f32_16x16x64_bf16 v[88:91], v[68:71], a[168:175], v1
s_waitcnt lgkmcnt(1)
v_smfmac_f32_16x16x64_bf16 v[92:95], v[68:71], v[56:63], v1
ds_read_b128 v[56:59], v2 offset:14336
ds_read_b128 v[60:63], v2 offset:15360
s_waitcnt vmcnt(4)
v_smfmac_f32_16x16x64_bf16 v[72:75], v[68:71], v[48:55], v1
buffer_load_dwordx4 v[48:51], v0, s[4:7], s16 offen offset:0 sc1
buffer_load_dwordx4 v[52:55], v0, s[4:7], s16 offen offset:1024 sc1
v_smfmac_f32_16x16x64_bf16 v[76:79], v[68:71], a[176:183], v1
ds_read_b128 v[68:71], v0 offset:5120
s_waitcnt lgkmcnt(3)
v_smfmac_f32_16x16x64_bf16 v[80:83], v[64:67], a[184:191], v1
s_waitcnt lgkmcnt(1)
v_smfmac_f32_16x16x64_bf16 v[84:87], v[64:67], v[56:63], v1
ds_read_b128 v[56:59], v2 offset:16384
ds_read_b128 v[60:63], v2 offset:17408
v_smfmac_f32_16x16x64_bf16 v[88:91], v[64:67], a[192:199], v1
v_smfmac_f32_16x16x64_bf16 v[92:95], v[64:67], a[200:207], v1
v_smfmac_f32_16x16x64_bf16 v[72:75], v[64:67], a[208:215], v1
s_waitcnt vmcnt(4)
v_smfmac_f32_16x16x64_bf16 v[76:79], v[64:67], v[32:39], v1
buffer_load_dwordx4 v[32:35], v0, s[4:7], s12 offen offset:0 sc1
buffer_load_dwordx4 v[36:39], v0, s[4:7], s12 offen offset:1024 sc1
ds_read_b128 v[64:67], v0 offset:6144
s_waitcnt lgkmcnt(1)
v_smfmac_f32_16x16x64_bf16 v[80:83], v[68:71], v[56:63], v1
ds_read_b128 v[56:59], v2 offset:18432
ds_read_b128 v[60:63], v2 offset:19456
v_smfmac_f32_16x16x64_bf16 v[84:87], v[68:71], a[216:223], v1
v_smfmac_f32_16x16x64_bf16 v[88:91], v[68:71], a[224:231], v1
v_smfmac_f32_16x16x64_bf16 v[92:95], v[68:71], a[232:239], v1
s_waitcnt lgkmcnt(0)
v_smfmac_f32_16x16x64_bf16 v[72:75], v[68:71], v[56:63], v1
ds_read_b128 v[56:59], v2 offset:20480
ds_read_b128 v[60:63], v2 offset:21504
v_smfmac_f32_16x16x64_bf16 v[76:79], v[68:71], a[240:247], v1
ds_read_b128 v[68:71], v0 offset:7168
s_waitcnt vmcnt(4)
v_smfmac_f32_16x16x64_bf16 v[80:83], v[64:67], v[40:47], v1
buffer_load_dwordx4 v[40:43], v0, s[4:7], s12 offen offset:2048 sc1
buffer_load_dwordx4 v[44:47], v0, s[4:7], s12 offen offset:3072 sc1
v_smfmac_f32_16x16x64_bf16 v[84:87], v[64:67], a[248:255], v1
s_waitcnt lgkmcnt(1)
v_smfmac_f32_16x16x64_bf16 v[88:91], v[64:67], v[56:63], v1
ds_read_b128 v[56:59], v2 offset:22528
ds_read_b128 v[60:63], v2 offset:23552
s_barrier
v_smfmac_f32_16x16x64_bf16 v[92:95], v[64:67], v[96:103], v1
v_smfmac_f32_16x16x64_bf16 v[72:75], v[64:67], v[104:111], v1
v_smfmac_f32_16x16x64_bf16 v[76:79], v[64:67], v[112:119], v1
s_waitcnt lgkmcnt(0)
v_smfmac_f32_16x16x64_bf16 v[80:83], v[68:71], v[56:63], v1
ds_read_b128 v[56:59], v2 offset:24576
ds_read_b128 v[60:63], v2 offset:25600
s_waitcnt vmcnt(4)
v_smfmac_f32_16x16x64_bf16 v[84:87], v[68:71], v[48:55], v1
buffer_load_dwordx4 v[48:51], v0, s[4:7], s13 offen offset:0 sc1
buffer_load_dwordx4 v[52:55], v0, s[4:7], s13 offen offset:1024 sc1
v_smfmac_f32_16x16x64_bf16 v[88:91], v[68:71], v[120:127], v1
v_smfmac_f32_16x16x64_bf16 v[92:95], v[68:71], v[128:135], v1
s_waitcnt lgkmcnt(0)
v_smfmac_f32_16x16x64_bf16 v[72:75], v[68:71], v[56:63], v1
ds_read_b128 v[56:59], v2 offset:26624
ds_read_b128 v[60:63], v2 offset:27648
v_smfmac_f32_16x16x64_bf16 v[76:79], v[68:71], v[136:143], v1
v_cvt_pk_bf16_f32 v80, v80, v81
v_cvt_pk_bf16_f32 v81, v82, v83
v_cvt_pk_bf16_f32 v82, v88, v89
v_cvt_pk_bf16_f32 v83, v90, v91
v_cvt_pk_bf16_f32 v84, v84, v85
v_cvt_pk_bf16_f32 v85, v86, v87
v_cvt_pk_bf16_f32 v86, v92, v93
v_cvt_pk_bf16_f32 v87, v94, v95
v_mfma_f32_16x16x32_bf16 v[88:91], v[80:83], v[12:15], 0
v_mov_b32 v7, s62
v_mfma_f32_16x16x32_bf16 v[92:95], v[84:87], v[12:15], 0
v_cvt_pk_bf16_f32 v64, v72, v73
v_cvt_pk_bf16_f32 v65, v74, v75
v_cvt_pk_bf16_f32 v66, v76, v77
v_cvt_pk_bf16_f32 v67, v78, v79
buffer_store_dwordx4 v[64:67], v0, s[4:7], s23 offen sc1
s_nop 2
v_cvt_pk_bf16_f32 v80, v88, v92
v_cvt_pk_bf16_f32 v81, v89, v93
v_cvt_pk_bf16_f32 v82, v90, v94
v_cvt_pk_bf16_f32 v83, v91, v95
s_add_u32 s35, s62, 2
s_min_u32 s35, s35, 64
v_mfma_f32_16x16x32_bf16 v[88:91], v[20:23], v[80:83], 0
v_mfma_f32_16x16x32_bf16 v[84:87], v[16:19], v[80:83], 0
v_mfma_f32_16x16x32_bf16 v[92:95], v[80:83], v[80:83], 0
s_mov_b64 exec, s[92:93]
buffer_store_dwordx4 v[80:83], v8, s[4:7], s71 offen sc1
s_mov_b64 exec, -1
s_cmp_eq_u32 s62, 63
s_cbranch_scc1 L_Rflast
s_add_u32 s72, s72, 262144
s_nop 0
v_mov_b32 v84, v88 row_shr:8 row_mask:0xf bank_mask:0xc
v_mov_b32 v85, v89 row_shr:8 row_mask:0xf bank_mask:0xc
v_mov_b32 v86, v90 row_shr:8 row_mask:0xf bank_mask:0xc
v_mov_b32 v87, v91 row_shr:8 row_mask:0xf bank_mask:0xc
ds_write_b128 v3, v[84:87]
v_mov_b32 v92, v94 row_shr:8 row_mask:0xf bank_mask:0xc
v_mov_b32 v93, v95 row_shr:8 row_mask:0xf bank_mask:0xc
ds_write_b64 v5, v[92:93] offset:4096
s_cmp_ge_u32 s73, s35
s_cbranch_scc1 r21
s_mov_b32 s28, 0
r20:
v_and_b32 v6, 128, v0
buffer_load_dword v6, v6, s[4:7], s74 offen sc1
s_waitcnt vmcnt(0)
v_readlane_b32 s73, v6, 0
v_readlane_b32 s29, v6, 8
s_nop 0
s_min_u32 s73, s73, s29
s_cmp_ge_u32 s73, s35
s_cbranch_scc1 r21
s_add_u32 s28, s28, 1
s_cmp_lt_u32 s28, 524288
s_cbranch_scc1 r20
s_mov_b32 s29, 4
s_branch L_abort
r21:
buffer_load_dwordx4 v[16:19], v0, s[4:7], s72 offen offset:0 sc1
buffer_load_dwordx4 v[20:23], v0, s[4:7], s72 offen offset:1024 sc1
s_waitcnt lgkmcnt(0)
s_barrier
ds_read_b128 v[80:83], v0 offset:0
ds_read_b128 v[84:87], v0 offset:1024
ds_read2st64_b64 v[72:75], v4 offset0:8 offset1:9
ds_read_b128 v[88:91], v0 offset:2048
ds_read_b128 v[92:95], v0 offset:3072
ds_read2st64_b64 v[76:79], v4 offset0:10 offset1:11
s_add_u32 s62, s62, 1
s_add_u32 s71, s71, 262144
s_add_u32 s23, s23, 262144
s_mov_b32 s31, s64
s_mov_b32 s64, s65
s_add_u32 s65, s65, 16384
s_waitcnt lgkmcnt(3)
v_pk_add_f32 v[80:81], v[80:81], v[84:85]
v_pk_add_f32 v[82:83], v[82:83], v[86:87]
v_pk_add_f32 v[72:73], v[72:73], v[74:75]
s_waitcnt lgkmcnt(0)
v_pk_add_f32 v[88:89], v[88:89], v[92:93]
v_pk_add_f32 v[90:91], v[90:91], v[94:95]
v_pk_add_f32 v[76:77], v[76:77], v[78:79]
v_pk_add_f32 v[80:81], v[80:81], v[88:89]
v_pk_add_f32 v[82:83], v[82:83], v[90:91]
v_pk_add_f32 v[84:85], v[72:73], v[76:77]
v_max3_f32 v86, v80, v81, v82
v_max3_f32 v87, v83, v84, v85
v_max_f32 v86, v86, v87
s_cmp_eq_u32 s65, s97
s_cselect_b32 s65, s66, s65
s_add_u32 s31, s31, s96
v_max_f32 v86, v86, v86 row_ror:8 row_mask:0xf bank_mask:0xf
v_mov_b32 v87, v86
s_add_u32 s30, s96, s64
s_add_u32 s34, s64, s77
v_permlane32_swap_b32 v86, v87
v_max_f32 v86, v86, v87
v_mov_b32 v87, v86
s_add_u32 s32, s64, s99
s_add_u32 s33, s72, 33554432
v_permlane16_swap_b32 v86, v87
v_max_f32 v86, v86, v87
v_mul_f32 v86, s78, v86
v_pk_fma_f32 v[80:81], v[80:81], s[78:79], v[86:87] op_sel_hi:[1,1,0] neg_lo:[0,0,1] neg_hi:[0,0,1]
v_pk_fma_f32 v[82:83], v[82:83], s[78:79], v[86:87] op_sel_hi:[1,1,0] neg_lo:[0,0,1] neg_hi:[0,0,1]
v_pk_fma_f32 v[84:85], v[84:85], s[78:79], v[86:87] op_sel_hi:[1,1,0] neg_lo:[0,0,1] neg_hi:[0,0,1]
v_exp_f32 v80, v80
v_exp_f32 v81, v81
v_exp_f32 v82, v82
v_exp_f32 v83, v83
v_exp_f32 v84, v84
v_exp_f32 v85, v85
v_cvt_pk_bf16_f32 v72, v80, v81
v_cvt_pk_bf16_f32 v73, v82, v83
v_cvt_pk_bf16_f32 v76, v84, v85
v_mov_b32 v74, v72 row_ror:8 row_mask:0xf bank_mask:0xf
v_mov_b32 v75, v73 row_ror:8 row_mask:0xf bank_mask:0xf
v_mov_b32 v77, v76 row_ror:8 row_mask:0xf bank_mask:0xf
v_add_f32 v84, v84, v85
v_mfma_f32_16x16x32_bf16 v[88:91], v[24:27], v[72:75], 0
v_add_f32 v80, v80, v81
v_add_f32 v82, v82, v83
v_mfma_f32_16x16x32_bf16 v[92:95], v[28:31], v[72:75], 0
v_fma_f32 v80, v84, 0.5, v80
v_add_f32 v86, v80, v82
v_mfma_f32_16x16x16_bf16 v[88:91], v[64:65], v[76:77], v[88:91]
s_nop 0
v_add_f32 v86, v86, v86 row_ror:8 row_mask:0xf bank_mask:0xf
v_mov_b32 v87, v86
v_mfma_f32_16x16x16_bf16 v[92:95], v[66:67], v[76:77], v[92:95]
s_nop 0
v_permlane32_swap_b32 v86, v87
v_add_f32 v86, v86, v87
v_mov_b32 v87, v86
s_mov_b32 s28, 0
s_nop 0
v_permlane16_swap_b32 v86, v87
v_add_f32 v86, v86, v87
v_rcp_f32 v86, v86
s_nop 0
v_pk_mul_f32 v[88:89], v[88:89], v[86:87] op_sel_hi:[1,0]
v_pk_mul_f32 v[90:91], v[90:91], v[86:87] op_sel_hi:[1,0]
v_pk_mul_f32 v[92:93], v[92:93], v[86:87] op_sel_hi:[1,0]
v_pk_mul_f32 v[94:95], v[94:95], v[86:87] op_sel_hi:[1,0]
v_cvt_pk_bf16_f32 v82, v90, v94
v_cvt_pk_bf16_f32 v83, v91, v95
v_cvt_pk_bf16_f32 v80, v88, v92
v_cvt_pk_bf16_f32 v81, v89, v93
s_nop 0
v_mov_b32 v80, v82 row_shr:8 row_mask:0xf bank_mask:0xc
v_mov_b32 v81, v83 row_shr:8 row_mask:0xf bank_mask:0xc
ds_write_b64 v9, v[80:81] offset:6144
buffer_load_dwordx4 v[24:27], v0, s[4:7], s33 offen offset:0 sc1
buffer_load_dwordx4 v[28:31], v0, s[4:7], s33 offen offset:1024 sc1
v_mov_b64 v[72:73], 0
v_mov_b64 v[74:75], 0
v_mov_b64 v[76:77], 0
v_mov_b64 v[78:79], 0
s_waitcnt lgkmcnt(0)
s_barrier
ds_read_b128 v[64:67], v0 offset:6144
ds_read_b128 v[68:71], v0 offset:7168
v_and_b32 v6, 128, v0
buffer_load_dword v6, v6, s[4:7], s74 offen sc1
v_mov_b64 v[80:81], 0
v_mov_b64 v[82:83], 0
v_mov_b64 v[84:85], 0
v_mov_b64 v[86:87], 0
v_mov_b64 v[88:89], 0
v_mov_b64 v[90:91], 0
v_mov_b64 v[92:93], 0
v_mov_b64 v[94:95], 0
s_waitcnt lgkmcnt(1)
v_smfmac_f32_16x16x64_bf16 v[72:75], v[64:67], v[56:63], v1
ds_read_b128 v[56:59], v2 offset:28672
ds_read_b128 v[60:63], v2 offset:29696
v_smfmac_f32_16x16x64_bf16 v[76:79], v[64:67], v[144:151], v1
s_waitcnt lgkmcnt(2)
v_smfmac_f32_16x16x64_bf16 v[72:75], v[68:71], v[152:159], v1
v_smfmac_f32_16x16x64_bf16 v[76:79], v[68:71], v[160:167], v1
s_waitcnt lgkmcnt(0)
v_smfmac_f32_16x16x64_bf16 v[88:91], v[64:67], v[56:63], v1
ds_read_b128 v[56:59], v2 offset:30720
ds_read_b128 v[60:63], v2 offset:31744
v_smfmac_f32_16x16x64_bf16 v[92:95], v[64:67], v[168:175], v1
v_smfmac_f32_16x16x64_bf16 v[88:91], v[68:71], v[176:183], v1
v_cvt_pk_bf16_f32 v72, v72, v73
v_cvt_pk_bf16_f32 v73, v74, v75
v_cvt_pk_bf16_f32 v74, v76, v77
v_cvt_pk_bf16_f32 v75, v78, v79
v_smfmac_f32_16x16x64_bf16 v[92:95], v[68:71], v[184:191], v1
s_nop 0
v_mfma_f32_16x16x32_bf16 v[76:79], v[72:75], v[12:15], 0
s_waitcnt lgkmcnt(0)
v_smfmac_f32_16x16x64_bf16 v[80:83], v[64:67], v[56:63], v1
ds_read_b128 v[56:59], v2 offset:32768
ds_read_b128 v[60:63], v2 offset:33792
v_mov_b64 v[72:73], 0
v_mov_b64 v[74:75], 0
v_smfmac_f32_16x16x64_bf16 v[84:87], v[64:67], v[192:199], v1
v_smfmac_f32_16x16x64_bf16 v[80:83], v[68:71], v[200:207], v1
v_cvt_pk_bf16_f32 v76, v76, v77
v_cvt_pk_bf16_f32 v77, v78, v79
v_and_or_b32 v76, v76, -2, s63
buffer_store_dwordx2 v[76:77], v10, s[4:7], s18 offen
v_mov_b64 v[76:77], 0
v_mov_b64 v[78:79], 0
v_cvt_pk_bf16_f32 v88, v88, v89
v_cvt_pk_bf16_f32 v89, v90, v91
v_cvt_pk_bf16_f32 v90, v92, v93
v_cvt_pk_bf16_f32 v91, v94, v95
v_smfmac_f32_16x16x64_bf16 v[84:87], v[68:71], v[208:215], v1
s_nop 0
v_mfma_f32_16x16x32_bf16 v[92:95], v[88:91], v[12:15], 0
s_waitcnt lgkmcnt(0)
v_smfmac_f32_16x16x64_bf16 v[72:75], v[64:67], v[56:63], v1
ds_read_b128 v[56:59], v2 offset:34816
ds_read_b128 v[60:63], v2 offset:35840
v_mov_b64 v[88:89], 0
v_mov_b64 v[90:91], 0
v_smfmac_f32_16x16x64_bf16 v[76:79], v[64:67], v[216:223], v1
v_smfmac_f32_16x16x64_bf16 v[72:75], v[68:71], v[224:231], v1
v_cvt_pk_bf16_f32 v92, v92, v93
v_cvt_pk_bf16_f32 v93, v94, v95
v_and_or_b32 v92, v92, -2, s63
buffer_store_dwordx2 v[92:93], v10, s[4:7], s19 offen
v_mov_b64 v[92:93], 0
v_mov_b64 v[94:95], 0
v_cvt_pk_bf16_f32 v80, v80, v81
v_cvt_pk_bf16_f32 v81, v82, v83
v_cvt_pk_bf16_f32 v82, v84, v85
v_cvt_pk_bf16_f32 v83, v86, v87
s_waitcnt lgkmcnt(0)
v_smfmac_f32_16x16x64_bf16 v[76:79], v[68:71], v[56:63], v1
ds_read_b128 v[56:59], v2 offset:36864
ds_read_b128 v[60:63], v2 offset:37888
v_mfma_f32_16x16x32_bf16 v[84:87], v[80:83], v[12:15], 0
v_smfmac_f32_16x16x64_bf16 v[88:91], v[64:67], v[232:239], v1
v_smfmac_f32_16x16x64_bf16 v[92:95], v[64:67], v[240:247], v1
s_waitcnt lgkmcnt(0)
v_smfmac_f32_16x16x64_bf16 v[88:91], v[68:71], v[56:63], v1
v_cvt_pk_bf16_f32 v84, v84, v85
v_cvt_pk_bf16_f32 v85, v86, v87
v_and_or_b32 v84, v84, -2, s63
buffer_store_dwordx2 v[84:85], v10, s[4:7], s20 offen
v_cvt_pk_bf16_f32 v72, v72, v73
v_cvt_pk_bf16_f32 v73, v74, v75
v_cvt_pk_bf16_f32 v74, v76, v77
v_cvt_pk_bf16_f32 v75, v78, v79
v_smfmac_f32_16x16x64_bf16 v[92:95], v[68:71], v[248:255], v1
s_nop 0
v_mfma_f32_16x16x32_bf16 v[76:79], v[72:75], v[12:15], 0
v_and_b32 v60, 16, v0
v_mov_b32 v56, 0x3f80
v_lshlrev_b32 v60, v60, v56
v_cndmask_b32 v56, 0, v60, s[84:85]
v_cndmask_b32 v57, 0, v60, s[86:87]
v_cndmask_b32 v58, 0, v60, s[88:89]
v_cndmask_b32 v59, 0, v60, s[90:91]
v_cvt_pk_bf16_f32 v88, v88, v89
v_cvt_pk_bf16_f32 v89, v90, v91
v_cvt_pk_bf16_f32 v90, v92, v93
v_cvt_pk_bf16_f32 v91, v94, v95
s_nop 1
v_mfma_f32_16x16x32_bf16 v[92:95], v[88:91], v[12:15], 0
v_cvt_pk_bf16_f32 v76, v76, v77
v_cvt_pk_bf16_f32 v77, v78, v79
v_and_or_b32 v76, v76, -2, s63
buffer_store_dwordx2 v[76:77], v10, s[4:7], s21 offen
s_nop 3
v_cvt_pk_bf16_f32 v92, v92, v93
v_cvt_pk_bf16_f32 v93, v94, v95
v_and_or_b32 v92, v92, -2, s63
buffer_store_dwordx2 v[92:93], v10, s[4:7], s22 offen
s_cmp_ge_u32 s70, 40
s_cbranch_scc1 r22
s_waitcnt vmcnt(0)
s_atomic_add s44, s[60:61], s75
r23:
buffer_load_dwordx4 v[64:67], v0, s[4:7], s69 offen offset:0 sc1
buffer_load_dwordx4 v[68:71], v0, s[4:7], s69 offen offset:1024 sc1
buffer_load_dwordx4 v[72:75], v0, s[4:7], s69 offen offset:2048 sc1
buffer_load_dwordx4 v[76:79], v0, s[4:7], s69 offen offset:3072 sc1
buffer_load_dwordx4 v[80:83], v0, s[4:7], s98 offen offset:0 sc1
buffer_load_dwordx4 v[84:87], v0, s[4:7], s98 offen offset:1024 sc1
buffer_load_dwordx4 v[88:91], v0, s[4:7], s98 offen offset:2048 sc1
buffer_load_dwordx4 v[92:95], v0, s[4:7], s98 offen offset:3072 sc1
s_waitcnt vmcnt(7)
v_mfma_f32_16x16x32_bf16 v[60:63], v[56:59], v[64:67], 0
v_bitop3_b32 v64, v64, v66, s63 bitop3:0x7e
s_waitcnt vmcnt(6)
v_mfma_f32_16x16x32_bf16 v[60:63], v[56:59], v[68:71], v[60:63]
v_bitop3_b32 v68, v68, v70, s63 bitop3:0x7e
s_waitcnt vmcnt(5)
v_mfma_f32_16x16x32_bf16 v[60:63], v[56:59], v[72:75], v[60:63]
v_bitop3_b32 v72, v72, v74, s63 bitop3:0x7e
v_or3_b32 v64, v64, v68, v72
s_waitcnt vmcnt(4)
v_mfma_f32_16x16x32_bf16 v[60:63], v[56:59], v[76:79], v[60:63]
v_bitop3_b32 v76, v76, v78, s63 bitop3:0x7e
s_waitcnt vmcnt(3)
v_mfma_f32_16x16x32_bf16 v[60:63], v[56:59], v[80:83], v[60:63]
v_bitop3_b32 v80, v80, v82, s63 bitop3:0x7e
v_or3_b32 v64, v64, v76, v80
s_waitcnt vmcnt(2)
v_mfma_f32_16x16x32_bf16 v[60:63], v[56:59], v[84:87], v[60:63]
v_bitop3_b32 v84, v84, v86, s63 bitop3:0x7e
s_waitcnt vmcnt(1)
v_mfma_f32_16x16x32_bf16 v[60:63], v[56:59], v[88:91], v[60:63]
v_bitop3_b32 v88, v88, v90, s63 bitop3:0x7e
v_or3_b32 v64, v64, v84, v88
s_waitcnt vmcnt(0)
v_mfma_f32_16x16x32_bf16 v[60:63], v[56:59], v[92:95], v[60:63]
v_bitop3_b32 v92, v92, v94, s63 bitop3:0x7e
v_or_b32 v64, v64, v92
v_and_b32 v64, 1, v64
v_cmp_ne_u32 vcc, 0, v64
v_mov_b64 v[66:67], -1
s_cbranch_vccnz r23r
s_mov_b64 exec, s[82:83]
s_nop 0
v_cvt_pk_bf16_f32 v64, v60, v61
v_cvt_pk_bf16_f32 v65, v62, v63
v_min_u32 v64, -2, v64
v_min_u32 v65, -2, v65
buffer_store_dwordx2 v[64:65], v11, s[4:7], s30 offen
s_cmp_lt_u32 s70, 8
s_cbranch_scc1 r25r
r25:
buffer_store_dwordx2 v[66:67], v11, s[4:7], s31 offen
s_mov_b64 exec, -1
s_branch r24
r22:
s_waitcnt vmcnt(0)
s_atomic_add s44, s[60:61], s75
r24:
v_readlane_b32 s73, v6, 0
v_readlane_b32 s29, v6, 8
s_nop 0
s_min_u32 s73, s73, s29
s_xor_b32 s63, s63, 1
s_mov_b32 s28, 0
s_barrier
s_branch L_Rftop
r18r:
buffer_load_dwordx4 v[64:67], v0, s[4:7], s32 offen offset:0 sc1
buffer_load_dwordx4 v[68:71], v0, s[4:7], s32 offen offset:1024 sc1
buffer_load_dwordx4 v[56:59], v0, s[4:7], s34 offen offset:0 sc1
buffer_load_dwordx4 v[60:63], v0, s[4:7], s34 offen offset:1024 sc1
s_waitcnt vmcnt(2)
v_max3_u32 v6, v64, v65, v66
v_max3_u32 v6, v6, v67, v68
v_max3_u32 v6, v6, v69, v70
v_max_u32 v6, v6, v71
v_cmp_eq_u32 vcc, -1, v6
s_cbranch_vccz r18
s_add_u32 s28, s28, 1
s_cmp_lt_u32 s28, 524288
s_cbranch_scc1 r18r
s_mov_b32 s29, 3
s_branch L_abort
r19r:
buffer_load_dwordx4 v[56:59], v0, s[4:7], s34 offen offset:0 sc1
buffer_load_dwordx4 v[60:63], v0, s[4:7], s34 offen offset:1024 sc1
s_waitcnt vmcnt(0)
v_max3_u32 v6, v56, v57, v58
v_max3_u32 v6, v6, v59, v60
v_max3_u32 v6, v6, v61, v62
v_max_u32 v6, v6, v63
v_cmp_eq_u32 vcc, -1, v6
s_cbranch_vccz r19
s_add_u32 s28, s28, 1
s_cmp_lt_u32 s28, 524288
s_cbranch_scc1 r19r
s_mov_b32 s29, 6
s_branch L_abort
r25r:
s_add_u32 s30, s30, 10240
s_add_u32 s33, s30, 4096
buffer_store_dwordx2 v[64:65], v11, s[4:7], s30 offen offset:0
buffer_store_dwordx2 v[64:65], v11, s[4:7], s30 offen offset:2048
buffer_store_dwordx2 v[64:65], v11, s[4:7], s33 offen offset:0
s_add_u32 s30, s31, 10240
s_add_u32 s33, s30, 4096
buffer_store_dwordx2 v[66:67], v11, s[4:7], s30 offen offset:0
buffer_store_dwordx2 v[66:67], v11, s[4:7], s30 offen offset:2048
buffer_store_dwordx2 v[66:67], v11, s[4:7], s33 offen offset:0
s_branch r25
r23r:
s_add_u32 s28, s28, 1
s_cmp_lt_u32 s28, 524288
s_cbranch_scc1 r23
s_mov_b32 s29, 5
s_branch L_abort
L_Rflast:
s_mov_b64 exec, -1
s_waitcnt vmcnt(0) lgkmcnt(0)
v_mov_b32 v6, 64
buffer_store_dword v6, off, s[4:7], s75 sc1
s_branch L_wb
L_R_slow:
.p2align 6
s_nop 0
s_nop 0
L_Rstop:
buffer_load_dwordx4 v[64:67], v0, s[4:7], s32 offen offset:0 sc1
buffer_load_dwordx4 v[68:71], v0, s[4:7], s32 offen offset:1024 sc1
buffer_load_dwordx4 v[56:59], v0, s[4:7], s34 offen offset:0 sc1
buffer_load_dwordx4 v[60:63], v0, s[4:7], s34 offen offset:1024 sc1
v_mov_b64 v[72:73], 0
v_mov_b64 v[74:75], 0
v_mov_b64 v[76:77], 0
v_mov_b64 v[78:79], 0
v_mov_b64 v[80:81], 0
v_mov_b64 v[82:83], 0
v_mov_b64 v[84:85], 0
v_mov_b64 v[86:87], 0
v_mov_b64 v[88:89], 0
v_mov_b64 v[90:91], 0
v_mov_b64 v[92:93], 0
v_mov_b64 v[94:95], 0
v_lshl_add_u32 v7, s25, 11, v0
s_waitcnt vmcnt(2)
v_max3_u32 v6, v64, v65, v66
v_max3_u32 v6, v6, v67, v68
v_max3_u32 v6, v6, v69, v70
v_max_u32 v6, v6, v71
v_cmp_eq_u32 vcc, -1, v6
s_cbranch_vccnz r26r
r26:
v_smfmac_f32_16x16x64_bf16 v[80:83], v[64:67], v[32:39], v1
buffer_load_dwordx4 v[32:35], v0, s[4:7], s13 offen offset:2048 sc1
buffer_load_dwordx4 v[36:39], v0, s[4:7], s13 offen offset:3072 sc1
s_waitcnt vmcnt(2)
v_max3_u32 v6, v56, v57, v58
v_max3_u32 v6, v6, v59, v60
v_smfmac_f32_16x16x64_bf16 v[84:87], v[64:67], a[0:7], v1
v_max3_u32 v6, v6, v61, v62
v_max_u32 v6, v6, v63
v_smfmac_f32_16x16x64_bf16 v[88:91], v[64:67], v[40:47], v1
buffer_load_dwordx4 v[40:43], v0, s[4:7], s14 offen offset:0 sc1
buffer_load_dwordx4 v[44:47], v0, s[4:7], s14 offen offset:1024 sc1
v_cmp_eq_u32 vcc, -1, v6
s_cbranch_vccnz r27r
r27:
ds_write_b128 v7, v[56:59]
v_smfmac_f32_16x16x64_bf16 v[92:95], v[64:67], a[8:15], v1
ds_write_b128 v7, v[60:63] offset:1024
ds_read_b128 v[56:59], v2 offset:0
ds_read_b128 v[60:63], v2 offset:1024
v_smfmac_f32_16x16x64_bf16 v[72:75], v[64:67], v[48:55], v1
buffer_load_dwordx4 v[48:51], v0, s[4:7], s14 offen offset:2048 sc1
buffer_load_dwordx4 v[52:55], v0, s[4:7], s14 offen offset:3072 sc1
v_smfmac_f32_16x16x64_bf16 v[76:79], v[64:67], a[16:23], v1
v_smfmac_f32_16x16x64_bf16 v[80:83], v[68:71], a[24:31], v1
v_smfmac_f32_16x16x64_bf16 v[84:87], v[68:71], a[32:39], v1
s_waitcnt lgkmcnt(2)
s_barrier
ds_read_b128 v[64:67], v0 offset:0
v_smfmac_f32_16x16x64_bf16 v[88:91], v[68:71], a[40:47], v1
s_waitcnt lgkmcnt(1)
v_smfmac_f32_16x16x64_bf16 v[92:95], v[68:71], v[56:63], v1
ds_read_b128 v[56:59], v2 offset:2048
ds_read_b128 v[60:63], v2 offset:3072
v_smfmac_f32_16x16x64_bf16 v[72:75], v[68:71], a[48:55], v1
v_smfmac_f32_16x16x64_bf16 v[76:79], v[68:71], a[56:63], v1
ds_read_b128 v[68:71], v0 offset:1024
s_waitcnt lgkmcnt(3)
v_smfmac_f32_16x16x64_bf16 v[80:83], v[64:67], a[64:71], v1
s_waitcnt lgkmcnt(1)
v_smfmac_f32_16x16x64_bf16 v[84:87], v[64:67], v[56:63], v1
ds_read_b128 v[56:59], v2 offset:4096
ds_read_b128 v[60:63], v2 offset:5120
v_smfmac_f32_16x16x64_bf16 v[88:91], v[64:67], a[72:79], v1
v_smfmac_f32_16x16x64_bf16 v[92:95], v[64:67], a[80:87], v1
v_smfmac_f32_16x16x64_bf16 v[72:75], v[64:67], a[88:95], v1
s_waitcnt lgkmcnt(0)
v_smfmac_f32_16x16x64_bf16 v[76:79], v[64:67], v[56:63], v1
ds_read_b128 v[56:59], v2 offset:6144
ds_read_b128 v[60:63], v2 offset:7168
ds_read_b128 v[64:67], v0 offset:2048
v_smfmac_f32_16x16x64_bf16 v[80:83], v[68:71], a[96:103], v1
v_smfmac_f32_16x16x64_bf16 v[84:87], v[68:71], a[104:111], v1
s_waitcnt vmcnt(4)
v_smfmac_f32_16x16x64_bf16 v[88:91], v[68:71], v[32:39], v1
buffer_load_dwordx4 v[32:35], v0, s[4:7], s15 offen offset:0 sc1
buffer_load_dwordx4 v[36:39], v0, s[4:7], s15 offen offset:1024 sc1
s_waitcnt lgkmcnt(1)
v_smfmac_f32_16x16x64_bf16 v[92:95], v[68:71], v[56:63], v1
ds_read_b128 v[56:59], v2 offset:8192
ds_read_b128 v[60:63], v2 offset:9216
v_smfmac_f32_16x16x64_bf16 v[72:75], v[68:71], a[112:119], v1
v_smfmac_f32_16x16x64_bf16 v[76:79], v[68:71], a[120:127], v1
ds_read_b128 v[68:71], v0 offset:3072
s_waitcnt lgkmcnt(3)
v_smfmac_f32_16x16x64_bf16 v[80:83], v[64:67], a[128:135], v1
s_waitcnt lgkmcnt(1)
v_smfmac_f32_16x16x64_bf16 v[84:87], v[64:67], v[56:63], v1
ds_read_b128 v[56:59], v2 offset:10240
ds_read_b128 v[60:63], v2 offset:11264
v_smfmac_f32_16x16x64_bf16 v[88:91], v[64:67], a[136:143], v1
s_waitcnt vmcnt(4)
v_smfmac_f32_16x16x64_bf16 v[92:95], v[64:67], v[40:47], v1
buffer_load_dwordx4 v[40:43], v0, s[4:7], s15 offen offset:2048 sc1
buffer_load_dwordx4 v[44:47], v0, s[4:7], s15 offen offset:3072 sc1
v_smfmac_f32_16x16x64_bf16 v[72:75], v[64:67], a[144:151], v1
s_waitcnt lgkmcnt(0)
v_smfmac_f32_16x16x64_bf16 v[76:79], v[64:67], v[56:63], v1
ds_read_b128 v[56:59], v2 offset:12288
ds_read_b128 v[60:63], v2 offset:13312
ds_read_b128 v[64:67], v0 offset:4096
v_smfmac_f32_16x16x64_bf16 v[80:83], v[68:71], a[152:159], v1
v_smfmac_f32_16x16x64_bf16 v[84:87], v[68:71], a[160:167], v1
v_smfmac_f32_16x16x64_bf16 v[88:91], v[68:71], a[168:175], v1
s_waitcnt lgkmcnt(1)
v_smfmac_f32_16x16x64_bf16 v[92:95], v[68:71], v[56:63], v1
ds_read_b128 v[56:59], v2 offset:14336
ds_read_b128 v[60:63], v2 offset:15360
s_waitcnt vmcnt(4)
v_smfmac_f32_16x16x64_bf16 v[72:75], v[68:71], v[48:55], v1
buffer_load_dwordx4 v[48:51], v0, s[4:7], s16 offen offset:0 sc1
buffer_load_dwordx4 v[52:55], v0, s[4:7], s16 offen offset:1024 sc1
v_smfmac_f32_16x16x64_bf16 v[76:79], v[68:71], a[176:183], v1
ds_read_b128 v[68:71], v0 offset:5120
s_waitcnt lgkmcnt(3)
v_smfmac_f32_16x16x64_bf16 v[80:83], v[64:67], a[184:191], v1
s_waitcnt lgkmcnt(1)
v_smfmac_f32_16x16x64_bf16 v[84:87], v[64:67], v[56:63], v1
ds_read_b128 v[56:59], v2 offset:16384
ds_read_b128 v[60:63], v2 offset:17408
v_smfmac_f32_16x16x64_bf16 v[88:91], v[64:67], a[192:199], v1
v_smfmac_f32_16x16x64_bf16 v[92:95], v[64:67], a[200:207], v1
v_smfmac_f32_16x16x64_bf16 v[72:75], v[64:67], a[208:215], v1
s_waitcnt vmcnt(4)
v_smfmac_f32_16x16x64_bf16 v[76:79], v[64:67], v[32:39], v1
buffer_load_dwordx4 v[32:35], v0, s[4:7], s12 offen offset:0 sc1
buffer_load_dwordx4 v[36:39], v0, s[4:7], s12 offen offset:1024 sc1
ds_read_b128 v[64:67], v0 offset:6144
s_waitcnt lgkmcnt(1)
v_smfmac_f32_16x16x64_bf16 v[80:83], v[68:71], v[56:63], v1
ds_read_b128 v[56:59], v2 offset:18432
ds_read_b128 v[60:63], v2 offset:19456
v_smfmac_f32_16x16x64_bf16 v[84:87], v[68:71], a[216:223], v1
v_smfmac_f32_16x16x64_bf16 v[88:91], v[68:71], a[224:231], v1
v_smfmac_f32_16x16x64_bf16 v[92:95], v[68:71], a[232:239], v1
s_waitcnt lgkmcnt(0)
v_smfmac_f32_16x16x64_bf16 v[72:75], v[68:71], v[56:63], v1
ds_read_b128 v[56:59], v2 offset:20480
ds_read_b128 v[60:63], v2 offset:21504
v_smfmac_f32_16x16x64_bf16 v[76:79], v[68:71], a[240:247], v1
ds_read_b128 v[68:71], v0 offset:7168
s_waitcnt vmcnt(4)
v_smfmac_f32_16x16x64_bf16 v[80:83], v[64:67], v[40:47], v1
buffer_load_dwordx4 v[40:43], v0, s[4:7], s12 offen offset:2048 sc1
buffer_load_dwordx4 v[44:47], v0, s[4:7], s12 offen offset:3072 sc1
v_smfmac_f32_16x16x64_bf16 v[84:87], v[64:67], a[248:255], v1
s_waitcnt lgkmcnt(1)
v_smfmac_f32_16x16x64_bf16 v[88:91], v[64:67], v[56:63], v1
ds_read_b128 v[56:59], v2 offset:22528
ds_read_b128 v[60:63], v2 offset:23552
s_barrier
v_smfmac_f32_16x16x64_bf16 v[92:95], v[64:67], v[96:103], v1
v_smfmac_f32_16x16x64_bf16 v[72:75], v[64:67], v[104:111], v1
v_smfmac_f32_16x16x64_bf16 v[76:79], v[64:67], v[112:119], v1
s_waitcnt lgkmcnt(0)
v_smfmac_f32_16x16x64_bf16 v[80:83], v[68:71], v[56:63], v1
ds_read_b128 v[56:59], v2 offset:24576
ds_read_b128 v[60:63], v2 offset:25600
s_waitcnt vmcnt(4)
v_smfmac_f32_16x16x64_bf16 v[84:87], v[68:71], v[48:55], v1
buffer_load_dwordx4 v[48:51], v0, s[4:7], s13 offen offset:0 sc1
buffer_load_dwordx4 v[52:55], v0, s[4:7], s13 offen offset:1024 sc1
v_smfmac_f32_16x16x64_bf16 v[88:91], v[68:71], v[120:127], v1
v_smfmac_f32_16x16x64_bf16 v[92:95], v[68:71], v[128:135], v1
s_waitcnt lgkmcnt(0)
v_smfmac_f32_16x16x64_bf16 v[72:75], v[68:71], v[56:63], v1
ds_read_b128 v[56:59], v2 offset:26624
ds_read_b128 v[60:63], v2 offset:27648
v_smfmac_f32_16x16x64_bf16 v[76:79], v[68:71], v[136:143], v1
v_cvt_pk_bf16_f32 v80, v80, v81
v_cvt_pk_bf16_f32 v81, v82, v83
v_cvt_pk_bf16_f32 v82, v88, v89
v_cvt_pk_bf16_f32 v83, v90, v91
v_cvt_pk_bf16_f32 v84, v84, v85
v_cvt_pk_bf16_f32 v85, v86, v87
v_cvt_pk_bf16_f32 v86, v92, v93
v_cvt_pk_bf16_f32 v87, v94, v95
v_mfma_f32_16x16x32_bf16 v[88:91], v[80:83], v[12:15], 0
v_mov_b32 v7, s62
v_mfma_f32_16x16x32_bf16 v[92:95], v[84:87], v[12:15], 0
v_cvt_pk_bf16_f32 v64, v72, v73
v_cvt_pk_bf16_f32 v65, v74, v75
v_cvt_pk_bf16_f32 v66, v76, v77
v_cvt_pk_bf16_f32 v67, v78, v79
buffer_store_dwordx4 v[64:67], v0, s[4:7], s23 offen sc1
s_nop 2
v_cvt_pk_bf16_f32 v80, v88, v92
v_cvt_pk_bf16_f32 v81, v89, v93
v_cvt_pk_bf16_f32 v82, v90, v94
v_cvt_pk_bf16_f32 v83, v91, v95
s_add_u32 s35, s62, 2
s_min_u32 s35, s35, 64
v_mfma_f32_16x16x32_bf16 v[88:91], v[20:23], v[80:83], 0
v_mfma_f32_16x16x32_bf16 v[84:87], v[16:19], v[80:83], 0
v_mfma_f32_16x16x32_bf16 v[92:95], v[80:83], v[80:83], 0
s_mov_b64 exec, s[92:93]
buffer_store_dwordx4 v[80:83], v8, s[4:7], s71 offen sc1
s_mov_b64 exec, -1
s_cmp_eq_u32 s62, 63
s_cbranch_scc1 L_Rslast
s_add_u32 s72, s72, 262144
s_nop 0
v_mov_b32 v84, v88 row_shr:8 row_mask:0xf bank_mask:0xc
v_mov_b32 v85, v89 row_shr:8 row_mask:0xf bank_mask:0xc
v_mov_b32 v86, v90 row_shr:8 row_mask:0xf bank_mask:0xc
v_mov_b32 v87, v91 row_shr:8 row_mask:0xf bank_mask:0xc
ds_write_b128 v3, v[84:87]
v_mov_b32 v92, v94 row_shr:8 row_mask:0xf bank_mask:0xc
v_mov_b32 v93, v95 row_shr:8 row_mask:0xf bank_mask:0xc
ds_write_b64 v5, v[92:93] offset:4096
s_cmp_ge_u32 s73, s35
s_cbranch_scc1 r29
s_mov_b32 s28, 0
r28:
v_and_b32 v6, 128, v0
buffer_load_dword v6, v6, s[4:7], s74 offen sc1
s_waitcnt vmcnt(0)
v_readlane_b32 s73, v6, 0
v_readlane_b32 s29, v6, 8
s_nop 0
s_min_u32 s73, s73, s29
s_cmp_ge_u32 s73, s35
s_cbranch_scc1 r29
s_add_u32 s28, s28, 1
s_cmp_lt_u32 s28, 524288
s_cbranch_scc1 r28
s_mov_b32 s29, 4
s_branch L_abort
r29:
buffer_load_dwordx4 v[16:19], v0, s[4:7], s72 offen offset:0 sc1
buffer_load_dwordx4 v[20:23], v0, s[4:7], s72 offen offset:1024 sc1
s_waitcnt lgkmcnt(0)
s_barrier
ds_read_b128 v[80:83], v0 offset:0
ds_read_b128 v[84:87], v0 offset:1024
ds_read2st64_b64 v[72:75], v4 offset0:8 offset1:9
ds_read_b128 v[88:91], v0 offset:2048
ds_read_b128 v[92:95], v0 offset:3072
ds_read2st64_b64 v[76:79], v4 offset0:10 offset1:11
s_add_u32 s62, s62, 1
s_add_u32 s71, s71, 262144
s_add_u32 s23, s23, 262144
s_mov_b32 s31, s64
s_mov_b32 s64, s65
s_add_u32 s65, s65, 16384
s_waitcnt lgkmcnt(3)
v_pk_add_f32 v[80:81], v[80:81], v[84:85]
v_pk_add_f32 v[82:83], v[82:83], v[86:87]
v_pk_add_f32 v[72:73], v[72:73], v[74:75]
s_waitcnt lgkmcnt(0)
v_pk_add_f32 v[88:89], v[88:89], v[92:93]
v_pk_add_f32 v[90:91], v[90:91], v[94:95]
v_pk_add_f32 v[76:77], v[76:77], v[78:79]
v_pk_add_f32 v[80:81], v[80:81], v[88:89]
v_pk_add_f32 v[82:83], v[82:83], v[90:91]
v_pk_add_f32 v[84:85], v[72:73], v[76:77]
v_max3_f32 v86, v80, v81, v82
v_max3_f32 v87, v83, v84, v85
v_max_f32 v86, v86, v87
s_cmp_eq_u32 s65, s97
s_cselect_b32 s65, s66, s65
s_add_u32 s31, s31, s96
v_max_f32 v86, v86, v86 row_ror:8 row_mask:0xf bank_mask:0xf
v_mov_b32 v87, v86
s_add_u32 s30, s96, s64
s_add_u32 s34, s64, s77
v_permlane32_swap_b32 v86, v87
v_max_f32 v86, v86, v87
v_mov_b32 v87, v86
s_add_u32 s32, s64, s99
s_add_u32 s33, s72, 33554432
v_permlane16_swap_b32 v86, v87
v_max_f32 v86, v86, v87
v_mul_f32 v86, s78, v86
v_pk_fma_f32 v[80:81], v[80:81], s[78:79], v[86:87] op_sel_hi:[1,1,0] neg_lo:[0,0,1] neg_hi:[0,0,1]
v_pk_fma_f32 v[82:83], v[82:83], s[78:79], v[86:87] op_sel_hi:[1,1,0] neg_lo:[0,0,1] neg_hi:[0,0,1]
v_pk_fma_f32 v[84:85], v[84:85], s[78:79], v[86:87] op_sel_hi:[1,1,0] neg_lo:[0,0,1] neg_hi:[0,0,1]
v_exp_f32 v80, v80
v_exp_f32 v81, v81
v_exp_f32 v82, v82
v_exp_f32 v83, v83
v_exp_f32 v84, v84
v_exp_f32 v85, v85
v_cvt_pk_bf16_f32 v72, v80, v81
v_cvt_pk_bf16_f32 v73, v82, v83
v_cvt_pk_bf16_f32 v76, v84, v85
v_mov_b32 v74, v72 row_ror:8 row_mask:0xf bank_mask:0xf
v_mov_b32 v75, v73 row_ror:8 row_mask:0xf bank_mask:0xf
v_mov_b32 v77, v76 row_ror:8 row_mask:0xf bank_mask:0xf
v_add_f32 v84, v84, v85
v_mfma_f32_16x16x32_bf16 v[88:91], v[24:27], v[72:75], 0
v_add_f32 v80, v80, v81
v_add_f32 v82, v82, v83
v_mfma_f32_16x16x32_bf16 v[92:95], v[28:31], v[72:75], 0
v_fma_f32 v80, v84, 0.5, v80
v_add_f32 v86, v80, v82
v_mfma_f32_16x16x16_bf16 v[88:91], v[64:65], v[76:77], v[88:91]
s_nop 0
v_add_f32 v86, v86, v86 row_ror:8 row_mask:0xf bank_mask:0xf
v_mov_b32 v87, v86
v_mfma_f32_16x16x16_bf16 v[92:95], v[66:67], v[76:77], v[92:95]
s_nop 0
v_permlane32_swap_b32 v86, v87
v_add_f32 v86, v86, v87
v_mov_b32 v87, v86
s_mov_b32 s28, 0
s_nop 0
v_permlane16_swap_b32 v86, v87
v_add_f32 v86, v86, v87
v_rcp_f32 v86, v86
s_nop 0
v_pk_mul_f32 v[88:89], v[88:89], v[86:87] op_sel_hi:[1,0]
v_pk_mul_f32 v[90:91], v[90:91], v[86:87] op_sel_hi:[1,0]
v_pk_mul_f32 v[92:93], v[92:93], v[86:87] op_sel_hi:[1,0]
v_pk_mul_f32 v[94:95], v[94:95], v[86:87] op_sel_hi:[1,0]
v_cvt_pk_bf16_f32 v82, v90, v94
v_cvt_pk_bf16_f32 v83, v91, v95
v_cvt_pk_bf16_f32 v80, v88, v92
v_cvt_pk_bf16_f32 v81, v89, v93
s_nop 0
v_mov_b32 v80, v82 row_shr:8 row_mask:0xf bank_mask:0xc
v_mov_b32 v81, v83 row_shr:8 row_mask:0xf bank_mask:0xc
ds_write_b64 v9, v[80:81] offset:6144
buffer_load_dwordx4 v[24:27], v0, s[4:7], s33 offen offset:0 sc1
buffer_load_dwordx4 v[28:31], v0, s[4:7], s33 offen offset:1024 sc1
v_mov_b64 v[72:73], 0
v_mov_b64 v[74:75], 0
v_mov_b64 v[76:77], 0
v_mov_b64 v[78:79], 0
s_waitcnt lgkmcnt(0)
s_barrier
ds_read_b128 v[64:67], v0 offset:6144
ds_read_b128 v[68:71], v0 offset:7168
v_and_b32 v6, 128, v0
buffer_load_dword v6, v6, s[4:7], s74 offen sc1
v_mov_b64 v[80:81], 0
v_mov_b64 v[82:83], 0
v_mov_b64 v[84:85], 0
v_mov_b64 v[86:87], 0
v_mov_b64 v[88:89], 0
v_mov_b64 v[90:91], 0
v_mov_b64 v[92:93], 0
v_mov_b64 v[94:95], 0
s_waitcnt lgkmcnt(1)
v_smfmac_f32_16x16x64_bf16 v[72:75], v[64:67], v[56:63], v1
ds_read_b128 v[56:59], v2 offset:28672
ds_read_b128 v[60:63], v2 offset:29696
v_smfmac_f32_16x16x64_bf16 v[76:79], v[64:67], v[144:151], v1
s_waitcnt lgkmcnt(2)
v_smfmac_f32_16x16x64_bf16 v[72:75], v[68:71], v[152:159], v1
v_smfmac_f32_16x16x64_bf16 v[76:79], v[68:71], v[160:167], v1
s_waitcnt lgkmcnt(0)
v_smfmac_f32_16x16x64_bf16 v[88:91], v[64:67], v[56:63], v1
ds_read_b128 v[56:59], v2 offset:30720
ds_read_b128 v[60:63], v2 offset:31744
v_smfmac_f32_16x16x64_bf16 v[92:95], v[64:67], v[168:175], v1
v_smfmac_f32_16x16x64_bf16 v[88:91], v[68:71], v[176:183], v1
v_cvt_pk_bf16_f32 v72, v72, v73
v_cvt_pk_bf16_f32 v73, v74, v75
v_cvt_pk_bf16_f32 v74, v76, v77
v_cvt_pk_bf16_f32 v75, v78, v79
v_smfmac_f32_16x16x64_bf16 v[92:95], v[68:71], v[184:191], v1
s_nop 0
v_mfma_f32_16x16x32_bf16 v[76:79], v[72:75], v[12:15], 0
s_waitcnt lgkmcnt(0)
v_smfmac_f32_16x16x64_bf16 v[80:83], v[64:67], v[56:63], v1
ds_read_b128 v[56:59], v2 offset:32768
ds_read_b128 v[60:63], v2 offset:33792
v_mov_b64 v[72:73], 0
v_mov_b64 v[74:75], 0
v_smfmac_f32_16x16x64_bf16 v[84:87], v[64:67], v[192:199], v1
v_smfmac_f32_16x16x64_bf16 v[80:83], v[68:71], v[200:207], v1
v_cvt_pk_bf16_f32 v76, v76, v77
v_cvt_pk_bf16_f32 v77, v78, v79
v_and_or_b32 v76, v76, -2, s63
buffer_store_dwordx2 v[76:77], v10, s[4:7], s18 offen sc1
v_mov_b64 v[76:77], 0
v_mov_b64 v[78:79], 0
v_cvt_pk_bf16_f32 v88, v88, v89
v_cvt_pk_bf16_f32 v89, v90, v91
v_cvt_pk_bf16_f32 v90, v92, v93
v_cvt_pk_bf16_f32 v91, v94, v95
v_smfmac_f32_16x16x64_bf16 v[84:87], v[68:71], v[208:215], v1
s_nop 0
v_mfma_f32_16x16x32_bf16 v[92:95], v[88:91], v[12:15], 0
s_waitcnt lgkmcnt(0)
v_smfmac_f32_16x16x64_bf16 v[72:75], v[64:67], v[56:63], v1
ds_read_b128 v[56:59], v2 offset:34816
ds_read_b128 v[60:63], v2 offset:35840
v_mov_b64 v[88:89], 0
v_mov_b64 v[90:91], 0
v_smfmac_f32_16x16x64_bf16 v[76:79], v[64:67], v[216:223], v1
v_smfmac_f32_16x16x64_bf16 v[72:75], v[68:71], v[224:231], v1
v_cvt_pk_bf16_f32 v92, v92, v93
v_cvt_pk_bf16_f32 v93, v94, v95
v_and_or_b32 v92, v92, -2, s63
buffer_store_dwordx2 v[92:93], v10, s[4:7], s19 offen sc1
v_mov_b64 v[92:93], 0
v_mov_b64 v[94:95], 0
v_cvt_pk_bf16_f32 v80, v80, v81
v_cvt_pk_bf16_f32 v81, v82, v83
v_cvt_pk_bf16_f32 v82, v84, v85
v_cvt_pk_bf16_f32 v83, v86, v87
s_waitcnt lgkmcnt(0)
v_smfmac_f32_16x16x64_bf16 v[76:79], v[68:71], v[56:63], v1
ds_read_b128 v[56:59], v2 offset:36864
ds_read_b128 v[60:63], v2 offset:37888
v_mfma_f32_16x16x32_bf16 v[84:87], v[80:83], v[12:15], 0
v_smfmac_f32_16x16x64_bf16 v[88:91], v[64:67], v[232:239], v1
v_smfmac_f32_16x16x64_bf16 v[92:95], v[64:67], v[240:247], v1
s_waitcnt lgkmcnt(0)
v_smfmac_f32_16x16x64_bf16 v[88:91], v[68:71], v[56:63], v1
v_cvt_pk_bf16_f32 v84, v84, v85
v_cvt_pk_bf16_f32 v85, v86, v87
v_and_or_b32 v84, v84, -2, s63
buffer_store_dwordx2 v[84:85], v10, s[4:7], s20 offen sc1
v_cvt_pk_bf16_f32 v72, v72, v73
v_cvt_pk_bf16_f32 v73, v74, v75
v_cvt_pk_bf16_f32 v74, v76, v77
v_cvt_pk_bf16_f32 v75, v78, v79
v_smfmac_f32_16x16x64_bf16 v[92:95], v[68:71], v[248:255], v1
s_nop 0
v_mfma_f32_16x16x32_bf16 v[76:79], v[72:75], v[12:15], 0
v_and_b32 v60, 16, v0
v_mov_b32 v56, 0x3f80
v_lshlrev_b32 v60, v60, v56
v_cndmask_b32 v56, 0, v60, s[84:85]
v_cndmask_b32 v57, 0, v60, s[86:87]
v_cndmask_b32 v58, 0, v60, s[88:89]
v_cndmask_b32 v59, 0, v60, s[90:91]
v_cvt_pk_bf16_f32 v88, v88, v89
v_cvt_pk_bf16_f32 v89, v90, v91
v_cvt_pk_bf16_f32 v90, v92, v93
v_cvt_pk_bf16_f32 v91, v94, v95
s_nop 1
v_mfma_f32_16x16x32_bf16 v[92:95], v[88:91], v[12:15], 0
v_cvt_pk_bf16_f32 v76, v76, v77
v_cvt_pk_bf16_f32 v77, v78, v79
v_and_or_b32 v76, v76, -2, s63
buffer_store_dwordx2 v[76:77], v10, s[4:7], s21 offen sc1
s_nop 3
v_cvt_pk_bf16_f32 v92, v92, v93
v_cvt_pk_bf16_f32 v93, v94, v95
v_and_or_b32 v92, v92, -2, s63
buffer_store_dwordx2 v[92:93], v10, s[4:7], s22 offen sc1
s_cmp_ge_u32 s70, 40
s_cbranch_scc1 r30
s_waitcnt vmcnt(0)
s_atomic_add s44, s[60:61], s75
r31:
buffer_load_dwordx4 v[64:67], v0, s[4:7], s69 offen offset:0 sc1
buffer_load_dwordx4 v[68:71], v0, s[4:7], s69 offen offset:1024 sc1
buffer_load_dwordx4 v[72:75], v0, s[4:7], s69 offen offset:2048 sc1
buffer_load_dwordx4 v[76:79], v0, s[4:7], s69 offen offset:3072 sc1
buffer_load_dwordx4 v[80:83], v0, s[4:7], s98 offen offset:0 sc1
buffer_load_dwordx4 v[84:87], v0, s[4:7], s98 offen offset:1024 sc1
buffer_load_dwordx4 v[88:91], v0, s[4:7], s98 offen offset:2048 sc1
buffer_load_dwordx4 v[92:95], v0, s[4:7], s98 offen offset:3072 sc1
s_waitcnt vmcnt(7)
v_mfma_f32_16x16x32_bf16 v[60:63], v[56:59], v[64:67], 0
v_bitop3_b32 v64, v64, v66, s63 bitop3:0x7e
s_waitcnt vmcnt(6)
v_mfma_f32_16x16x32_bf16 v[60:63], v[56:59], v[68:71], v[60:63]
v_bitop3_b32 v68, v68, v70, s63 bitop3:0x7e
s_waitcnt vmcnt(5)
v_mfma_f32_16x16x32_bf16 v[60:63], v[56:59], v[72:75], v[60:63]
v_bitop3_b32 v72, v72, v74, s63 bitop3:0x7e
v_or3_b32 v64, v64, v68, v72
s_waitcnt vmcnt(4)
v_mfma_f32_16x16x32_bf16 v[60:63], v[56:59], v[76:79], v[60:63]
v_bitop3_b32 v76, v76, v78, s63 bitop3:0x7e
s_waitcnt vmcnt(3)
v_mfma_f32_16x16x32_bf16 v[60:63], v[56:59], v[80:83], v[60:63]
v_bitop3_b32 v80, v80, v82, s63 bitop3:0x7e
v_or3_b32 v64, v64, v76, v80
s_waitcnt vmcnt(2)
v_mfma_f32_16x16x32_bf16 v[60:63], v[56:59], v[84:87], v[60:63]
v_bitop3_b32 v84, v84, v86, s63 bitop3:0x7e
s_waitcnt vmcnt(1)
v_mfma_f32_16x16x32_bf16 v[60:63], v[56:59], v[88:91], v[60:63]
v_bitop3_b32 v88, v88, v90, s63 bitop3:0x7e
v_or3_b32 v64, v64, v84, v88
s_waitcnt vmcnt(0)
v_mfma_f32_16x16x32_bf16 v[60:63], v[56:59], v[92:95], v[60:63]
v_bitop3_b32 v92, v92, v94, s63 bitop3:0x7e
v_or_b32 v64, v64, v92
v_and_b32 v64, 1, v64
v_cmp_ne_u32 vcc, 0, v64
v_mov_b64 v[66:67], -1
s_cbranch_vccnz r31r
s_mov_b64 exec, s[82:83]
s_nop 0
v_cvt_pk_bf16_f32 v64, v60, v61
v_cvt_pk_bf16_f32 v65, v62, v63
v_min_u32 v64, -2, v64
v_min_u32 v65, -2, v65
buffer_store_dwordx2 v[64:65], v11, s[4:7], s30 offen sc1
s_cmp_lt_u32 s70, 8
s_cbranch_scc1 r33r
r33:
buffer_store_dwordx2 v[66:67], v11, s[4:7], s31 offen sc1
s_mov_b64 exec, -1
s_branch r32
r30:
s_waitcnt vmcnt(0)
s_atomic_add s44, s[60:61], s75
r32:
v_readlane_b32 s73, v6, 0
v_readlane_b32 s29, v6, 8
s_nop 0
s_min_u32 s73, s73, s29
s_xor_b32 s63, s63, 1
s_mov_b32 s28, 0
s_barrier
s_branch L_Rstop
r26r:
buffer_load_dwordx4 v[64:67], v0, s[4:7], s32 offen offset:0 sc1
buffer_load_dwordx4 v[68:71], v0, s[4:7], s32 offen offset:1024 sc1
buffer_load_dwordx4 v[56:59], v0, s[4:7], s34 offen offset:0 sc1
buffer_load_dwordx4 v[60:63], v0, s[4:7], s34 offen offset:1024 sc1
s_waitcnt vmcnt(2)
v_max3_u32 v6, v64, v65, v66
v_max3_u32 v6, v6, v67, v68
v_max3_u32 v6, v6, v69, v70
v_max_u32 v6, v6, v71
v_cmp_eq_u32 vcc, -1, v6
s_cbranch_vccz r26
s_add_u32 s28, s28, 1
s_cmp_lt_u32 s28, 524288
s_cbranch_scc1 r26r
s_mov_b32 s29, 3
s_branch L_abort
r27r:
buffer_load_dwordx4 v[56:59], v0, s[4:7], s34 offen offset:0 sc1
buffer_load_dwordx4 v[60:63], v0, s[4:7], s34 offen offset:1024 sc1
s_waitcnt vmcnt(0)
v_max3_u32 v6, v56, v57, v58
v_max3_u32 v6, v6, v59, v60
v_max3_u32 v6, v6, v61, v62
v_max_u32 v6, v6, v63
v_cmp_eq_u32 vcc, -1, v6
s_cbranch_vccz r27
s_add_u32 s28, s28, 1
s_cmp_lt_u32 s28, 524288
s_cbranch_scc1 r27r
s_mov_b32 s29, 6
s_branch L_abort
r33r:
s_add_u32 s30, s30, 10240
s_add_u32 s33, s30, 4096
buffer_store_dwordx2 v[64:65], v11, s[4:7], s30 offen offset:0 sc1
buffer_store_dwordx2 v[64:65], v11, s[4:7], s30 offen offset:2048 sc1
buffer_store_dwordx2 v[64:65], v11, s[4:7], s33 offen offset:0 sc1
s_add_u32 s30, s31, 10240
s_add_u32 s33, s30, 4096
buffer_store_dwordx2 v[66:67], v11, s[4:7], s30 offen offset:0 sc1
buffer_store_dwordx2 v[66:67], v11, s[4:7], s30 offen offset:2048 sc1
buffer_store_dwordx2 v[66:67], v11, s[4:7], s33 offen offset:0 sc1
s_branch r33
r31r:
s_add_u32 s28, s28, 1
s_cmp_lt_u32 s28, 524288
s_cbranch_scc1 r31
s_mov_b32 s29, 5
s_branch L_abort
L_Rslast:
s_mov_b64 exec, -1
s_waitcnt vmcnt(0) lgkmcnt(0)
v_mov_b32 v6, 64
buffer_store_dword v6, off, s[4:7], s75 sc1
s_branch L_wb
L_roleLN:
v_and_b32 v1, 63, v0
v_lshlrev_b32 v2, 4, v1
v_lshlrev_b32 v8, 2, v1
s_mul_i32 s33, s25, 10752
s_add_u32 s33, s33, 0
v_lshrrev_b32 v10, 3, v1
v_and_b32 v11, 7, v1
v_mul_u32_u24 v100, 336, v10
v_lshl_add_u32 v100, v11, 4, v100
v_add_u32 v100, s33, v100
v_mul_u32_u24 v102, 20480, v10
v_lshl_add_u32 v102, v11, 4, v102
v_lshrrev_b32 v10, 2, v1
v_and_b32 v11, 3, v1
v_mul_u32_u24 v101, 336, v10
v_lshl_add_u32 v101, v11, 4, v101
v_add_u32 v101, s33, v101
v_mul_u32_u24 v103, 20480, v10
v_lshl_add_u32 v103, v11, 4, v103
v_lshrrev_b32 v10, 4, v1
v_and_b32 v11, 15, v1
v_and_b32 v6, 31, v1
v_mul_u32_u24 v104, 336, v6
v_lshrrev_b32 v6, 5, v1
v_lshl_add_u32 v104, v6, 4, v104
v_add_u32 v104, s33, v104
v_mul_u32_u24 v105, 1280, v10
v_lshl_add_u32 v105, v11, 4, v105
v_mov_b32 v106, v105
v_mov_b32 v6, 0x40000000
s_and_b32 s33, s25, 1
s_lshl_b32 s33, s33, 3
v_add_u32 v7, s33, v10
v_cmp_gt_u32 vcc, 14, v7
s_nop 1
v_cndmask_b32 v105, v6, v105, vcc
v_add_u32 v7, 4, v7
v_cmp_gt_u32 vcc, 14, v7
s_nop 1
v_cndmask_b32 v106, v6, v106, vcc
v_lshrrev_b32 v7, 5, v1
v_and_b32 v10, 1, v10
v_lshlrev_b32 v107, 8, v7
v_lshl_add_u32 v107, v11, 4, v107
v_lshl_add_u32 v107, v10, 3, v107
v_cmp_gt_u32 vcc, 32, v1
s_nop 1
v_cndmask_b32 v108, v6, v107, vcc
s_lshr_b32 s33, s25, 1
s_mul_i32 s34, s33, 3072
s_add_u32 s34, s34, 0
v_add_u32 v109, s34, v2
s_lshl_b32 s72, s70, 1
s_add_u32 s72, s72, s33
s_lshl_b32 s74, s71, 8
s_add_u32 s74, s74, 8192
s_lshl_b32 s75, s70, 4
s_lshl_b32 s33, s25, 2
s_add_u32 s75, s75, s33
s_add_u32 s75, s75, s74
s_mul_i32 s76, s71, 1310720
s_add_u32 s76, s76, 35651584
s_add_u32 s77, s76, 655360
s_mul_i32 s78, s70, 1280
s_mul_i32 s33, s25, 320
s_add_u32 s78, s78, s33
s_mul_i32 s79, s72, 20480
s_and_b32 s33, s25, 1
s_mul_i32 s33, s33, 10240
s_add_u32 s79, s79, s33
s_mov_b32 s101, 0x3acccccd
s_mov_b32 s84, 0x30003
s_mov_b32 s85, 0x30003
s_mov_b32 s86, 0xc000c
s_mov_b32 s87, 0xc000c
s_mov_b32 s88, 0x300030
s_mov_b32 s89, 0x300030
s_mov_b32 s90, 0xc000c0
s_mov_b32 s91, 0xc000c0
v_and_b32 v10, 16, v2
v_mov_b32 v112, 0x3f80
v_lshlrev_b32 v10, v10, v112
v_cndmask_b32 v112, 0, v10, s[84:85]
v_cndmask_b32 v113, 0, v10, s[86:87]
v_cndmask_b32 v114, 0, v10, s[88:89]
v_cndmask_b32 v115, 0, v10, s[90:91]
s_mov_b32 s84, 0x3000300
s_mov_b32 s85, 0x3000300
s_mov_b32 s86, 0xc000c00
s_mov_b32 s87, 0xc000c00
s_mov_b32 s88, 0x30003000
s_mov_b32 s89, 0x30003000
s_mov_b32 s90, 0xc000c000
s_mov_b32 s91, 0xc000c000
v_and_b32 v10, 16, v2
v_mov_b32 v116, 0x3f80
v_lshlrev_b32 v10, v10, v116
v_cndmask_b32 v116, 0, v10, s[84:85]
v_cndmask_b32 v117, 0, v10, s[86:87]
v_cndmask_b32 v118, 0, v10, s[88:89]
v_cndmask_b32 v119, 0, v10, s[90:91]
s_mov_b32 s20, s36
s_mov_b32 s21, s37
s_mov_b32 s22, 2621440
s_mov_b32 s23, 0x20000
s_sub_u32 s62, s27, 5
s_lshl_b32 s62, s62, 4
s_add_u32 s62, s62, s70
s_lshl_b32 s62, s62, 2
s_add_u32 s62, s62, s25
s_and_b32 s34, s62, 31
s_mul_i32 s30, s62, 1280
buffer_load_dwordx2 v[128:129], v107, s[20:23], s30 offen offset:0 sc1
buffer_load_dwordx2 v[130:131], v107, s[20:23], s30 offen offset:512 sc1
buffer_load_dwordx2 v[132:133], v108, s[20:23], s30 offen offset:1024 sc1
s_add_u32 s30, s30, 245760
buffer_load_dwordx2 v[134:135], v107, s[20:23], s30 offen offset:0 sc1
buffer_load_dwordx2 v[136:137], v107, s[20:23], s30 offen offset:512 sc1
buffer_load_dwordx2 v[138:139], v108, s[20:23], s30 offen offset:1024 sc1
s_add_u32 s30, s30, 245760
buffer_load_dwordx2 v[140:141], v107, s[20:23], s30 offen offset:0 sc1
buffer_load_dwordx2 v[142:143], v107, s[20:23], s30 offen offset:512 sc1
buffer_load_dwordx2 v[144:145], v108, s[20:23], s30 offen offset:1024 sc1
s_add_u32 s30, s30, 245760
buffer_load_dwordx2 v[146:147], v107, s[20:23], s30 offen offset:0 sc1
buffer_load_dwordx2 v[148:149], v107, s[20:23], s30 offen offset:512 sc1
buffer_load_dwordx2 v[150:151], v108, s[20:23], s30 offen offset:1024 sc1
s_add_u32 s30, s30, 245760
buffer_load_dwordx2 v[152:153], v107, s[20:23], s30 offen offset:0 sc1
buffer_load_dwordx2 v[154:155], v107, s[20:23], s30 offen offset:512 sc1
buffer_load_dwordx2 v[156:157], v108, s[20:23], s30 offen offset:1024 sc1
s_add_u32 s30, s30, 245760
buffer_load_dwordx2 v[158:159], v107, s[20:23], s30 offen offset:0 sc1
buffer_load_dwordx2 v[160:161], v107, s[20:23], s30 offen offset:512 sc1
buffer_load_dwordx2 v[162:163], v108, s[20:23], s30 offen offset:1024 sc1
s_add_u32 s30, s30, 245760
buffer_load_dwordx2 v[164:165], v107, s[20:23], s30 offen offset:0 sc1
buffer_load_dwordx2 v[166:167], v107, s[20:23], s30 offen offset:512 sc1
buffer_load_dwordx2 v[168:169], v108, s[20:23], s30 offen offset:1024 sc1
s_add_u32 s30, s30, 245760
buffer_load_dwordx2 v[170:171], v107, s[20:23], s30 offen offset:0 sc1
buffer_load_dwordx2 v[172:173], v107, s[20:23], s30 offen offset:512 sc1
buffer_load_dwordx2 v[174:175], v108, s[20:23], s30 offen offset:1024 sc1
s_add_u32 s30, s30, 245760
buffer_load_dwordx2 v[176:177], v107, s[20:23], s30 offen offset:0 sc1
buffer_load_dwordx2 v[178:179], v107, s[20:23], s30 offen offset:512 sc1
buffer_load_dwordx2 v[180:181], v108, s[20:23], s30 offen offset:1024 sc1
s_add_u32 s30, s30, 245760
buffer_load_dwordx2 v[182:183], v107, s[20:23], s30 offen offset:0 sc1
buffer_load_dwordx2 v[184:185], v107, s[20:23], s30 offen offset:512 sc1
buffer_load_dwordx2 v[186:187], v108, s[20:23], s30 offen offset:1024 sc1
s_add_u32 s30, s30, 245760
buffer_load_dwordx2 v[188:189], v107, s[20:23], s30 offen offset:0 sc1
buffer_load_dwordx2 v[190:191], v107, s[20:23], s30 offen offset:512 sc1
buffer_load_dwordx2 v[192:193], v108, s[20:23], s30 offen offset:1024 sc1
s_add_u32 s30, s30, 245760
v_bfe_u32 v10, v1, 4, 1
v_lshrrev_b32 v11, 5, v1
v_lshl_add_u32 v10, v10, 1, v11
v_and_b32 v11, 15, v1
v_lshlrev_b32 v97, 4, v11
v_lshl_add_u32 v96, v10, 8, v97
v_add_u32 v97, 1024, v97
s_bfe_u32 s33, s34, 0x30001
v_and_b32 v11, 7, v1
v_xor_b32 v11, s33, v11
v_lshlrev_b32 v111, 4, v11
v_bfe_u32 v11, v1, 3, 1
v_lshl_add_u32 v111, v11, 10, v111
v_lshl_add_u32 v110, v10, 11, v111
v_add_u32 v111, 8192, v111
v_mov_b32 v10, 0x40000000
v_cmp_gt_u32 vcc, 16, v1
s_nop 1
v_cndmask_b32 v97, v10, v97, vcc
v_cndmask_b32 v111, v10, v111, vcc
s_lshr_b32 s73, s34, 3
s_mul_i32 s73, s73, 10240
s_and_b32 s33, s34, 7
s_lshl_b32 s33, s33, 7
s_add_u32 s73, s73, s33
s_mov_b32 s12, s38
s_mov_b32 s13, s39
s_mov_b32 s14, 10240
s_mov_b32 s15, 0x20000
v_bfe_u32 v81, v1, 4, 1
v_bfe_u32 v82, v1, 3, 1
v_and_b32 v84, 3, v1
v_bfe_u32 v85, v1, 2, 1
v_lshl_add_u32 v83, v84, 1, v81
v_lshlrev_b32 v80, 7, v82
v_lshl_add_u32 v80, v83, 4, v80
v_lshl_add_u32 v80, v85, 3, v80
v_mul_u32_u24 v86, 1280, v83
v_lshl_add_u32 v86, v82, 4, v86
v_lshl_add_u32 v86, v85, 1, v86
s_lshl_b32 s33, s62, 5
buffer_load_ushort v88, v86, s[12:15], s33 offen offset:0
buffer_load_ushort v89, v86, s[12:15], s33 offen offset:8
buffer_load_ushort v90, v86, s[12:15], s33 offen offset:4
buffer_load_ushort v91, v86, s[12:15], s33 offen offset:12
s_lshr_b32 s64, s62, 5
s_mul_i32 s64, s64, 40960
s_add_u32 s64, s64, 3145728
s_lshr_b32 s65, s62, 5
s_lshl_b32 s65, s65, 7
s_add_u32 s65, s65, 1048576
s_mov_b32 s63, 1
s_waitcnt vmcnt(34)
s_barrier
s_cmp_lg_u32 s25, 0
s_cbranch_scc1 ar34
s_or_b32 s33, s3, 0x80
v_mov_b32 v7, s33
s_mov_b64 exec, 1
buffer_store_byte v7, off, s[8:11], s2 sc1
s_mov_b64 exec, -1
ar34:
v_lshlrev_b32 v40, 16, v128
v_and_b32 v41, 0xffff0000, v128
v_lshlrev_b32 v42, 16, v129
v_and_b32 v43, 0xffff0000, v129
v_lshlrev_b32 v44, 16, v130
v_and_b32 v45, 0xffff0000, v130
v_lshlrev_b32 v46, 16, v131
v_and_b32 v47, 0xffff0000, v131
v_lshlrev_b32 v48, 16, v132
v_and_b32 v49, 0xffff0000, v132
v_lshlrev_b32 v50, 16, v133
v_and_b32 v51, 0xffff0000, v133
v_pk_add_f32 v[52:53], v[40:41], v[42:43]
v_pk_mul_f32 v[54:55], v[40:41], v[40:41]
v_pk_fma_f32 v[54:55], v[42:43], v[42:43], v[54:55]
v_pk_add_f32 v[52:53], v[52:53], v[44:45]
v_pk_fma_f32 v[54:55], v[44:45], v[44:45], v[54:55]
v_pk_add_f32 v[52:53], v[52:53], v[46:47]
v_pk_fma_f32 v[54:55], v[46:47], v[46:47], v[54:55]
v_pk_add_f32 v[52:53], v[52:53], v[48:49]
v_pk_fma_f32 v[54:55], v[48:49], v[48:49], v[54:55]
v_pk_add_f32 v[52:53], v[52:53], v[50:51]
v_pk_fma_f32 v[54:55], v[50:51], v[50:51], v[54:55]
v_add_f32 v52, v52, v53
v_add_f32 v54, v54, v55
s_add_u32 s33, s64, s73
v_add_f32 v52, v52, v52 row_ror:8 row_mask:0xf bank_mask:0xf
v_add_f32 v54, v54, v54 row_ror:8 row_mask:0xf bank_mask:0xf
s_nop 0
v_add_f32 v52, v52, v52 row_ror:4 row_mask:0xf bank_mask:0xf
v_add_f32 v54, v54, v54 row_ror:4 row_mask:0xf bank_mask:0xf
s_nop 0
v_add_f32 v52, v52, v52 row_ror:2 row_mask:0xf bank_mask:0xf
v_add_f32 v54, v54, v54 row_ror:2 row_mask:0xf bank_mask:0xf
s_nop 0
v_add_f32 v52, v52, v52 row_ror:1 row_mask:0xf bank_mask:0xf
v_add_f32 v54, v54, v54 row_ror:1 row_mask:0xf bank_mask:0xf
s_nop 0
v_mov_b32 v53, v52
v_mov_b32 v55, v54
s_nop 0
v_permlane32_swap_b32 v52, v53
v_permlane32_swap_b32 v54, v55
v_add_f32 v52, v52, v53
v_add_f32 v54, v54, v55
v_mov_b32 v53, v52
v_mov_b32 v55, v54
s_nop 0
v_permlane16_swap_b32 v52, v53
v_permlane16_swap_b32 v54, v55
v_add_f32 v52, v52, v53
v_add_f32 v54, v54, v55
v_mul_f32 v52, 0xbacccccd, v52
v_mul_f32 v53, v52, v52
v_fma_f32 v54, v54, s101, -v53
v_max_f32 v54, 0, v54
v_add_f32 v54, 0x3727c5ac, v54
v_rsq_f32 v54, v54
s_nop 0
v_mul_f32 v52, v52, v54
v_pk_fma_f32 v[40:41], v[40:41], v[54:55], v[52:53] op_sel_hi:[1,0,0]
v_cvt_pk_bf16_f32 v40, v40, v41
v_pk_fma_f32 v[42:43], v[42:43], v[54:55], v[52:53] op_sel_hi:[1,0,0]
v_cvt_pk_bf16_f32 v41, v42, v43
v_pk_fma_f32 v[44:45], v[44:45], v[54:55], v[52:53] op_sel_hi:[1,0,0]
v_cvt_pk_bf16_f32 v42, v44, v45
v_pk_fma_f32 v[46:47], v[46:47], v[54:55], v[52:53] op_sel_hi:[1,0,0]
v_cvt_pk_bf16_f32 v43, v46, v47
v_pk_fma_f32 v[48:49], v[48:49], v[54:55], v[52:53] op_sel_hi:[1,0,0]
v_cvt_pk_bf16_f32 v44, v48, v49
v_pk_fma_f32 v[50:51], v[50:51], v[54:55], v[52:53] op_sel_hi:[1,0,0]
v_cvt_pk_bf16_f32 v45, v50, v51
v_mov_b32 v46, v44
v_mov_b32 v47, v45
v_permlane16_swap_b32 v40, v42
v_permlane16_swap_b32 v41, v43
v_permlane16_swap_b32 v44, v46
v_permlane16_swap_b32 v45, v47
buffer_store_dwordx4 v[40:43], v110, s[4:7], s33 offen sc1
buffer_store_dwordx4 v[44:47], v111, s[4:7], s33 offen sc1
s_add_u32 s64, s64, 245760
s_waitcnt vmcnt(33)
v_lshlrev_b32 v56, 16, v134
v_and_b32 v57, 0xffff0000, v134
v_lshlrev_b32 v58, 16, v135
v_and_b32 v59, 0xffff0000, v135
v_lshlrev_b32 v60, 16, v136
v_and_b32 v61, 0xffff0000, v136
v_lshlrev_b32 v62, 16, v137
v_and_b32 v63, 0xffff0000, v137
v_lshlrev_b32 v64, 16, v138
v_and_b32 v65, 0xffff0000, v138
v_lshlrev_b32 v66, 16, v139
v_and_b32 v67, 0xffff0000, v139
v_pk_add_f32 v[68:69], v[56:57], v[58:59]
v_pk_mul_f32 v[70:71], v[56:57], v[56:57]
v_pk_fma_f32 v[70:71], v[58:59], v[58:59], v[70:71]
v_pk_add_f32 v[68:69], v[68:69], v[60:61]
v_pk_fma_f32 v[70:71], v[60:61], v[60:61], v[70:71]
v_pk_add_f32 v[68:69], v[68:69], v[62:63]
v_pk_fma_f32 v[70:71], v[62:63], v[62:63], v[70:71]
v_pk_add_f32 v[68:69], v[68:69], v[64:65]
v_pk_fma_f32 v[70:71], v[64:65], v[64:65], v[70:71]
v_pk_add_f32 v[68:69], v[68:69], v[66:67]
v_pk_fma_f32 v[70:71], v[66:67], v[66:67], v[70:71]
v_add_f32 v68, v68, v69
v_add_f32 v70, v70, v71
s_add_u32 s33, s64, s73
v_add_f32 v68, v68, v68 row_ror:8 row_mask:0xf bank_mask:0xf
v_add_f32 v70, v70, v70 row_ror:8 row_mask:0xf bank_mask:0xf
s_nop 0
v_add_f32 v68, v68, v68 row_ror:4 row_mask:0xf bank_mask:0xf
v_add_f32 v70, v70, v70 row_ror:4 row_mask:0xf bank_mask:0xf
s_nop 0
v_add_f32 v68, v68, v68 row_ror:2 row_mask:0xf bank_mask:0xf
v_add_f32 v70, v70, v70 row_ror:2 row_mask:0xf bank_mask:0xf
s_nop 0
v_add_f32 v68, v68, v68 row_ror:1 row_mask:0xf bank_mask:0xf
v_add_f32 v70, v70, v70 row_ror:1 row_mask:0xf bank_mask:0xf
s_nop 0
v_mov_b32 v69, v68
v_mov_b32 v71, v70
s_nop 0
v_permlane32_swap_b32 v68, v69
v_permlane32_swap_b32 v70, v71
v_add_f32 v68, v68, v69
v_add_f32 v70, v70, v71
v_mov_b32 v69, v68
v_mov_b32 v71, v70
s_nop 0
v_permlane16_swap_b32 v68, v69
v_permlane16_swap_b32 v70, v71
v_add_f32 v68, v68, v69
v_add_f32 v70, v70, v71
v_mul_f32 v68, 0xbacccccd, v68
v_mul_f32 v69, v68, v68
v_fma_f32 v70, v70, s101, -v69
v_max_f32 v70, 0, v70
v_add_f32 v70, 0x3727c5ac, v70
v_rsq_f32 v70, v70
s_nop 0
v_mul_f32 v68, v68, v70
v_pk_fma_f32 v[56:57], v[56:57], v[70:71], v[68:69] op_sel_hi:[1,0,0]
v_cvt_pk_bf16_f32 v56, v56, v57
v_pk_fma_f32 v[58:59], v[58:59], v[70:71], v[68:69] op_sel_hi:[1,0,0]
v_cvt_pk_bf16_f32 v57, v58, v59
v_pk_fma_f32 v[60:61], v[60:61], v[70:71], v[68:69] op_sel_hi:[1,0,0]
v_cvt_pk_bf16_f32 v58, v60, v61
v_pk_fma_f32 v[62:63], v[62:63], v[70:71], v[68:69] op_sel_hi:[1,0,0]
v_cvt_pk_bf16_f32 v59, v62, v63
v_pk_fma_f32 v[64:65], v[64:65], v[70:71], v[68:69] op_sel_hi:[1,0,0]
v_cvt_pk_bf16_f32 v60, v64, v65
v_pk_fma_f32 v[66:67], v[66:67], v[70:71], v[68:69] op_sel_hi:[1,0,0]
v_cvt_pk_bf16_f32 v61, v66, v67
v_mov_b32 v62, v60
v_mov_b32 v63, v61
v_permlane16_swap_b32 v56, v58
v_permlane16_swap_b32 v57, v59
v_permlane16_swap_b32 v60, v62
v_permlane16_swap_b32 v61, v63
buffer_store_dwordx4 v[56:59], v110, s[4:7], s33 offen sc1
buffer_store_dwordx4 v[60:63], v111, s[4:7], s33 offen sc1
s_add_u32 s64, s64, 245760
s_waitcnt vmcnt(32)
v_lshlrev_b32 v40, 16, v140
v_and_b32 v41, 0xffff0000, v140
v_lshlrev_b32 v42, 16, v141
v_and_b32 v43, 0xffff0000, v141
v_lshlrev_b32 v44, 16, v142
v_and_b32 v45, 0xffff0000, v142
v_lshlrev_b32 v46, 16, v143
v_and_b32 v47, 0xffff0000, v143
v_lshlrev_b32 v48, 16, v144
v_and_b32 v49, 0xffff0000, v144
v_lshlrev_b32 v50, 16, v145
v_and_b32 v51, 0xffff0000, v145
v_pk_add_f32 v[52:53], v[40:41], v[42:43]
v_pk_mul_f32 v[54:55], v[40:41], v[40:41]
v_pk_fma_f32 v[54:55], v[42:43], v[42:43], v[54:55]
v_pk_add_f32 v[52:53], v[52:53], v[44:45]
v_pk_fma_f32 v[54:55], v[44:45], v[44:45], v[54:55]
v_pk_add_f32 v[52:53], v[52:53], v[46:47]
v_pk_fma_f32 v[54:55], v[46:47], v[46:47], v[54:55]
v_pk_add_f32 v[52:53], v[52:53], v[48:49]
v_pk_fma_f32 v[54:55], v[48:49], v[48:49], v[54:55]
v_pk_add_f32 v[52:53], v[52:53], v[50:51]
v_pk_fma_f32 v[54:55], v[50:51], v[50:51], v[54:55]
v_add_f32 v52, v52, v53
v_add_f32 v54, v54, v55
s_add_u32 s33, s64, s73
v_add_f32 v52, v52, v52 row_ror:8 row_mask:0xf bank_mask:0xf
v_add_f32 v54, v54, v54 row_ror:8 row_mask:0xf bank_mask:0xf
s_nop 0
v_add_f32 v52, v52, v52 row_ror:4 row_mask:0xf bank_mask:0xf
v_add_f32 v54, v54, v54 row_ror:4 row_mask:0xf bank_mask:0xf
s_nop 0
v_add_f32 v52, v52, v52 row_ror:2 row_mask:0xf bank_mask:0xf
v_add_f32 v54, v54, v54 row_ror:2 row_mask:0xf bank_mask:0xf
s_nop 0
v_add_f32 v52, v52, v52 row_ror:1 row_mask:0xf bank_mask:0xf
v_add_f32 v54, v54, v54 row_ror:1 row_mask:0xf bank_mask:0xf
s_nop 0
v_mov_b32 v53, v52
v_mov_b32 v55, v54
s_nop 0
v_permlane32_swap_b32 v52, v53
v_permlane32_swap_b32 v54, v55
v_add_f32 v52, v52, v53
v_add_f32 v54, v54, v55
v_mov_b32 v53, v52
v_mov_b32 v55, v54
s_nop 0
v_permlane16_swap_b32 v52, v53
v_permlane16_swap_b32 v54, v55
v_add_f32 v52, v52, v53
v_add_f32 v54, v54, v55
v_mul_f32 v52, 0xbacccccd, v52
v_mul_f32 v53, v52, v52
v_fma_f32 v54, v54, s101, -v53
v_max_f32 v54, 0, v54
v_add_f32 v54, 0x3727c5ac, v54
v_rsq_f32 v54, v54
s_nop 0
v_mul_f32 v52, v52, v54
v_pk_fma_f32 v[40:41], v[40:41], v[54:55], v[52:53] op_sel_hi:[1,0,0]
v_cvt_pk_bf16_f32 v40, v40, v41
v_pk_fma_f32 v[42:43], v[42:43], v[54:55], v[52:53] op_sel_hi:[1,0,0]
v_cvt_pk_bf16_f32 v41, v42, v43
v_pk_fma_f32 v[44:45], v[44:45], v[54:55], v[52:53] op_sel_hi:[1,0,0]
v_cvt_pk_bf16_f32 v42, v44, v45
v_pk_fma_f32 v[46:47], v[46:47], v[54:55], v[52:53] op_sel_hi:[1,0,0]
v_cvt_pk_bf16_f32 v43, v46, v47
v_pk_fma_f32 v[48:49], v[48:49], v[54:55], v[52:53] op_sel_hi:[1,0,0]
v_cvt_pk_bf16_f32 v44, v48, v49
v_pk_fma_f32 v[50:51], v[50:51], v[54:55], v[52:53] op_sel_hi:[1,0,0]
v_cvt_pk_bf16_f32 v45, v50, v51
v_mov_b32 v46, v44
v_mov_b32 v47, v45
v_permlane16_swap_b32 v40, v42
v_permlane16_swap_b32 v41, v43
v_permlane16_swap_b32 v44, v46
v_permlane16_swap_b32 v45, v47
buffer_store_dwordx4 v[40:43], v110, s[4:7], s33 offen sc1
buffer_store_dwordx4 v[44:47], v111, s[4:7], s33 offen sc1
s_add_u32 s64, s64, 245760
s_waitcnt vmcnt(31)
v_lshlrev_b32 v56, 16, v146
v_and_b32 v57, 0xffff0000, v146
v_lshlrev_b32 v58, 16, v147
v_and_b32 v59, 0xffff0000, v147
v_lshlrev_b32 v60, 16, v148
v_and_b32 v61, 0xffff0000, v148
v_lshlrev_b32 v62, 16, v149
v_and_b32 v63, 0xffff0000, v149
v_lshlrev_b32 v64, 16, v150
v_and_b32 v65, 0xffff0000, v150
v_lshlrev_b32 v66, 16, v151
v_and_b32 v67, 0xffff0000, v151
v_pk_add_f32 v[68:69], v[56:57], v[58:59]
v_pk_mul_f32 v[70:71], v[56:57], v[56:57]
v_pk_fma_f32 v[70:71], v[58:59], v[58:59], v[70:71]
v_pk_add_f32 v[68:69], v[68:69], v[60:61]
v_pk_fma_f32 v[70:71], v[60:61], v[60:61], v[70:71]
v_pk_add_f32 v[68:69], v[68:69], v[62:63]
v_pk_fma_f32 v[70:71], v[62:63], v[62:63], v[70:71]
v_pk_add_f32 v[68:69], v[68:69], v[64:65]
v_pk_fma_f32 v[70:71], v[64:65], v[64:65], v[70:71]
v_pk_add_f32 v[68:69], v[68:69], v[66:67]
v_pk_fma_f32 v[70:71], v[66:67], v[66:67], v[70:71]
v_add_f32 v68, v68, v69
v_add_f32 v70, v70, v71
s_add_u32 s33, s64, s73
v_add_f32 v68, v68, v68 row_ror:8 row_mask:0xf bank_mask:0xf
v_add_f32 v70, v70, v70 row_ror:8 row_mask:0xf bank_mask:0xf
s_nop 0
v_add_f32 v68, v68, v68 row_ror:4 row_mask:0xf bank_mask:0xf
v_add_f32 v70, v70, v70 row_ror:4 row_mask:0xf bank_mask:0xf
s_nop 0
v_add_f32 v68, v68, v68 row_ror:2 row_mask:0xf bank_mask:0xf
v_add_f32 v70, v70, v70 row_ror:2 row_mask:0xf bank_mask:0xf
s_nop 0
v_add_f32 v68, v68, v68 row_ror:1 row_mask:0xf bank_mask:0xf
v_add_f32 v70, v70, v70 row_ror:1 row_mask:0xf bank_mask:0xf
s_nop 0
v_mov_b32 v69, v68
v_mov_b32 v71, v70
s_nop 0
v_permlane32_swap_b32 v68, v69
v_permlane32_swap_b32 v70, v71
v_add_f32 v68, v68, v69
v_add_f32 v70, v70, v71
v_mov_b32 v69, v68
v_mov_b32 v71, v70
s_nop 0
v_permlane16_swap_b32 v68, v69
v_permlane16_swap_b32 v70, v71
v_add_f32 v68, v68, v69
v_add_f32 v70, v70, v71
v_mul_f32 v68, 0xbacccccd, v68
v_mul_f32 v69, v68, v68
v_fma_f32 v70, v70, s101, -v69
v_max_f32 v70, 0, v70
v_add_f32 v70, 0x3727c5ac, v70
v_rsq_f32 v70, v70
s_nop 0
v_mul_f32 v68, v68, v70
v_pk_fma_f32 v[56:57], v[56:57], v[70:71], v[68:69] op_sel_hi:[1,0,0]
v_cvt_pk_bf16_f32 v56, v56, v57
v_pk_fma_f32 v[58:59], v[58:59], v[70:71], v[68:69] op_sel_hi:[1,0,0]
v_cvt_pk_bf16_f32 v57, v58, v59
v_pk_fma_f32 v[60:61], v[60:61], v[70:71], v[68:69] op_sel_hi:[1,0,0]
v_cvt_pk_bf16_f32 v58, v60, v61
v_pk_fma_f32 v[62:63], v[62:63], v[70:71], v[68:69] op_sel_hi:[1,0,0]
v_cvt_pk_bf16_f32 v59, v62, v63
v_pk_fma_f32 v[64:65], v[64:65], v[70:71], v[68:69] op_sel_hi:[1,0,0]
v_cvt_pk_bf16_f32 v60, v64, v65
v_pk_fma_f32 v[66:67], v[66:67], v[70:71], v[68:69] op_sel_hi:[1,0,0]
v_cvt_pk_bf16_f32 v61, v66, v67
v_mov_b32 v62, v60
v_mov_b32 v63, v61
v_permlane16_swap_b32 v56, v58
v_permlane16_swap_b32 v57, v59
v_permlane16_swap_b32 v60, v62
v_permlane16_swap_b32 v61, v63
buffer_store_dwordx4 v[56:59], v110, s[4:7], s33 offen sc1
buffer_store_dwordx4 v[60:63], v111, s[4:7], s33 offen sc1
s_add_u32 s64, s64, 245760
s_waitcnt vmcnt(30)
v_lshlrev_b32 v40, 16, v152
v_and_b32 v41, 0xffff0000, v152
v_lshlrev_b32 v42, 16, v153
v_and_b32 v43, 0xffff0000, v153
v_lshlrev_b32 v44, 16, v154
v_and_b32 v45, 0xffff0000, v154
v_lshlrev_b32 v46, 16, v155
v_and_b32 v47, 0xffff0000, v155
v_lshlrev_b32 v48, 16, v156
v_and_b32 v49, 0xffff0000, v156
v_lshlrev_b32 v50, 16, v157
v_and_b32 v51, 0xffff0000, v157
v_pk_add_f32 v[52:53], v[40:41], v[42:43]
v_pk_mul_f32 v[54:55], v[40:41], v[40:41]
v_pk_fma_f32 v[54:55], v[42:43], v[42:43], v[54:55]
v_pk_add_f32 v[52:53], v[52:53], v[44:45]
v_pk_fma_f32 v[54:55], v[44:45], v[44:45], v[54:55]
v_pk_add_f32 v[52:53], v[52:53], v[46:47]
v_pk_fma_f32 v[54:55], v[46:47], v[46:47], v[54:55]
v_pk_add_f32 v[52:53], v[52:53], v[48:49]
v_pk_fma_f32 v[54:55], v[48:49], v[48:49], v[54:55]
v_pk_add_f32 v[52:53], v[52:53], v[50:51]
v_pk_fma_f32 v[54:55], v[50:51], v[50:51], v[54:55]
v_add_f32 v52, v52, v53
v_add_f32 v54, v54, v55
s_add_u32 s33, s64, s73
v_add_f32 v52, v52, v52 row_ror:8 row_mask:0xf bank_mask:0xf
v_add_f32 v54, v54, v54 row_ror:8 row_mask:0xf bank_mask:0xf
s_nop 0
v_add_f32 v52, v52, v52 row_ror:4 row_mask:0xf bank_mask:0xf
v_add_f32 v54, v54, v54 row_ror:4 row_mask:0xf bank_mask:0xf
s_nop 0
v_add_f32 v52, v52, v52 row_ror:2 row_mask:0xf bank_mask:0xf
v_add_f32 v54, v54, v54 row_ror:2 row_mask:0xf bank_mask:0xf
s_nop 0
v_add_f32 v52, v52, v52 row_ror:1 row_mask:0xf bank_mask:0xf
v_add_f32 v54, v54, v54 row_ror:1 row_mask:0xf bank_mask:0xf
s_nop 0
v_mov_b32 v53, v52
v_mov_b32 v55, v54
s_nop 0
v_permlane32_swap_b32 v52, v53
v_permlane32_swap_b32 v54, v55
v_add_f32 v52, v52, v53
v_add_f32 v54, v54, v55
v_mov_b32 v53, v52
v_mov_b32 v55, v54
s_nop 0
v_permlane16_swap_b32 v52, v53
v_permlane16_swap_b32 v54, v55
v_add_f32 v52, v52, v53
v_add_f32 v54, v54, v55
v_mul_f32 v52, 0xbacccccd, v52
v_mul_f32 v53, v52, v52
v_fma_f32 v54, v54, s101, -v53
v_max_f32 v54, 0, v54
v_add_f32 v54, 0x3727c5ac, v54
v_rsq_f32 v54, v54
s_nop 0
v_mul_f32 v52, v52, v54
v_pk_fma_f32 v[40:41], v[40:41], v[54:55], v[52:53] op_sel_hi:[1,0,0]
v_cvt_pk_bf16_f32 v40, v40, v41
v_pk_fma_f32 v[42:43], v[42:43], v[54:55], v[52:53] op_sel_hi:[1,0,0]
v_cvt_pk_bf16_f32 v41, v42, v43
v_pk_fma_f32 v[44:45], v[44:45], v[54:55], v[52:53] op_sel_hi:[1,0,0]
v_cvt_pk_bf16_f32 v42, v44, v45
v_pk_fma_f32 v[46:47], v[46:47], v[54:55], v[52:53] op_sel_hi:[1,0,0]
v_cvt_pk_bf16_f32 v43, v46, v47
v_pk_fma_f32 v[48:49], v[48:49], v[54:55], v[52:53] op_sel_hi:[1,0,0]
v_cvt_pk_bf16_f32 v44, v48, v49
v_pk_fma_f32 v[50:51], v[50:51], v[54:55], v[52:53] op_sel_hi:[1,0,0]
v_cvt_pk_bf16_f32 v45, v50, v51
v_mov_b32 v46, v44
v_mov_b32 v47, v45
v_permlane16_swap_b32 v40, v42
v_permlane16_swap_b32 v41, v43
v_permlane16_swap_b32 v44, v46
v_permlane16_swap_b32 v45, v47
buffer_store_dwordx4 v[40:43], v110, s[4:7], s33 offen sc1
buffer_store_dwordx4 v[44:47], v111, s[4:7], s33 offen sc1
s_add_u32 s64, s64, 245760
s_waitcnt vmcnt(29)
v_lshlrev_b32 v56, 16, v158
v_and_b32 v57, 0xffff0000, v158
v_lshlrev_b32 v58, 16, v159
v_and_b32 v59, 0xffff0000, v159
v_lshlrev_b32 v60, 16, v160
v_and_b32 v61, 0xffff0000, v160
v_lshlrev_b32 v62, 16, v161
v_and_b32 v63, 0xffff0000, v161
v_lshlrev_b32 v64, 16, v162
v_and_b32 v65, 0xffff0000, v162
v_lshlrev_b32 v66, 16, v163
v_and_b32 v67, 0xffff0000, v163
v_pk_add_f32 v[68:69], v[56:57], v[58:59]
v_pk_mul_f32 v[70:71], v[56:57], v[56:57]
v_pk_fma_f32 v[70:71], v[58:59], v[58:59], v[70:71]
v_pk_add_f32 v[68:69], v[68:69], v[60:61]
v_pk_fma_f32 v[70:71], v[60:61], v[60:61], v[70:71]
v_pk_add_f32 v[68:69], v[68:69], v[62:63]
v_pk_fma_f32 v[70:71], v[62:63], v[62:63], v[70:71]
v_pk_add_f32 v[68:69], v[68:69], v[64:65]
v_pk_fma_f32 v[70:71], v[64:65], v[64:65], v[70:71]
v_pk_add_f32 v[68:69], v[68:69], v[66:67]
v_pk_fma_f32 v[70:71], v[66:67], v[66:67], v[70:71]
v_add_f32 v68, v68, v69
v_add_f32 v70, v70, v71
s_add_u32 s33, s64, s73
v_add_f32 v68, v68, v68 row_ror:8 row_mask:0xf bank_mask:0xf
v_add_f32 v70, v70, v70 row_ror:8 row_mask:0xf bank_mask:0xf
s_nop 0
v_add_f32 v68, v68, v68 row_ror:4 row_mask:0xf bank_mask:0xf
v_add_f32 v70, v70, v70 row_ror:4 row_mask:0xf bank_mask:0xf
s_nop 0
v_add_f32 v68, v68, v68 row_ror:2 row_mask:0xf bank_mask:0xf
v_add_f32 v70, v70, v70 row_ror:2 row_mask:0xf bank_mask:0xf
s_nop 0
v_add_f32 v68, v68, v68 row_ror:1 row_mask:0xf bank_mask:0xf
v_add_f32 v70, v70, v70 row_ror:1 row_mask:0xf bank_mask:0xf
s_nop 0
v_mov_b32 v69, v68
v_mov_b32 v71, v70
s_nop 0
v_permlane32_swap_b32 v68, v69
v_permlane32_swap_b32 v70, v71
v_add_f32 v68, v68, v69
v_add_f32 v70, v70, v71
v_mov_b32 v69, v68
v_mov_b32 v71, v70
s_nop 0
v_permlane16_swap_b32 v68, v69
v_permlane16_swap_b32 v70, v71
v_add_f32 v68, v68, v69
v_add_f32 v70, v70, v71
v_mul_f32 v68, 0xbacccccd, v68
v_mul_f32 v69, v68, v68
v_fma_f32 v70, v70, s101, -v69
v_max_f32 v70, 0, v70
v_add_f32 v70, 0x3727c5ac, v70
v_rsq_f32 v70, v70
s_nop 0
v_mul_f32 v68, v68, v70
v_pk_fma_f32 v[56:57], v[56:57], v[70:71], v[68:69] op_sel_hi:[1,0,0]
v_cvt_pk_bf16_f32 v56, v56, v57
v_pk_fma_f32 v[58:59], v[58:59], v[70:71], v[68:69] op_sel_hi:[1,0,0]
v_cvt_pk_bf16_f32 v57, v58, v59
v_pk_fma_f32 v[60:61], v[60:61], v[70:71], v[68:69] op_sel_hi:[1,0,0]
v_cvt_pk_bf16_f32 v58, v60, v61
v_pk_fma_f32 v[62:63], v[62:63], v[70:71], v[68:69] op_sel_hi:[1,0,0]
v_cvt_pk_bf16_f32 v59, v62, v63
v_pk_fma_f32 v[64:65], v[64:65], v[70:71], v[68:69] op_sel_hi:[1,0,0]
v_cvt_pk_bf16_f32 v60, v64, v65
v_pk_fma_f32 v[66:67], v[66:67], v[70:71], v[68:69] op_sel_hi:[1,0,0]
v_cvt_pk_bf16_f32 v61, v66, v67
v_mov_b32 v62, v60
v_mov_b32 v63, v61
v_permlane16_swap_b32 v56, v58
v_permlane16_swap_b32 v57, v59
v_permlane16_swap_b32 v60, v62
v_permlane16_swap_b32 v61, v63
buffer_store_dwordx4 v[56:59], v110, s[4:7], s33 offen sc1
buffer_store_dwordx4 v[60:63], v111, s[4:7], s33 offen sc1
s_add_u32 s64, s64, 245760
s_waitcnt vmcnt(28)
v_lshlrev_b32 v40, 16, v164
v_and_b32 v41, 0xffff0000, v164
v_lshlrev_b32 v42, 16, v165
v_and_b32 v43, 0xffff0000, v165
v_lshlrev_b32 v44, 16, v166
v_and_b32 v45, 0xffff0000, v166
v_lshlrev_b32 v46, 16, v167
v_and_b32 v47, 0xffff0000, v167
v_lshlrev_b32 v48, 16, v168
v_and_b32 v49, 0xffff0000, v168
v_lshlrev_b32 v50, 16, v169
v_and_b32 v51, 0xffff0000, v169
v_pk_add_f32 v[52:53], v[40:41], v[42:43]
v_pk_mul_f32 v[54:55], v[40:41], v[40:41]
v_pk_fma_f32 v[54:55], v[42:43], v[42:43], v[54:55]
v_pk_add_f32 v[52:53], v[52:53], v[44:45]
v_pk_fma_f32 v[54:55], v[44:45], v[44:45], v[54:55]
v_pk_add_f32 v[52:53], v[52:53], v[46:47]
v_pk_fma_f32 v[54:55], v[46:47], v[46:47], v[54:55]
v_pk_add_f32 v[52:53], v[52:53], v[48:49]
v_pk_fma_f32 v[54:55], v[48:49], v[48:49], v[54:55]
v_pk_add_f32 v[52:53], v[52:53], v[50:51]
v_pk_fma_f32 v[54:55], v[50:51], v[50:51], v[54:55]
v_add_f32 v52, v52, v53
v_add_f32 v54, v54, v55
s_add_u32 s33, s64, s73
v_add_f32 v52, v52, v52 row_ror:8 row_mask:0xf bank_mask:0xf
v_add_f32 v54, v54, v54 row_ror:8 row_mask:0xf bank_mask:0xf
s_nop 0
v_add_f32 v52, v52, v52 row_ror:4 row_mask:0xf bank_mask:0xf
v_add_f32 v54, v54, v54 row_ror:4 row_mask:0xf bank_mask:0xf
s_nop 0
v_add_f32 v52, v52, v52 row_ror:2 row_mask:0xf bank_mask:0xf
v_add_f32 v54, v54, v54 row_ror:2 row_mask:0xf bank_mask:0xf
s_nop 0
v_add_f32 v52, v52, v52 row_ror:1 row_mask:0xf bank_mask:0xf
v_add_f32 v54, v54, v54 row_ror:1 row_mask:0xf bank_mask:0xf
s_nop 0
v_mov_b32 v53, v52
v_mov_b32 v55, v54
s_nop 0
v_permlane32_swap_b32 v52, v53
v_permlane32_swap_b32 v54, v55
v_add_f32 v52, v52, v53
v_add_f32 v54, v54, v55
v_mov_b32 v53, v52
v_mov_b32 v55, v54
s_nop 0
v_permlane16_swap_b32 v52, v53
v_permlane16_swap_b32 v54, v55
v_add_f32 v52, v52, v53
v_add_f32 v54, v54, v55
v_mul_f32 v52, 0xbacccccd, v52
v_mul_f32 v53, v52, v52
v_fma_f32 v54, v54, s101, -v53
v_max_f32 v54, 0, v54
v_add_f32 v54, 0x3727c5ac, v54
v_rsq_f32 v54, v54
s_nop 0
v_mul_f32 v52, v52, v54
v_pk_fma_f32 v[40:41], v[40:41], v[54:55], v[52:53] op_sel_hi:[1,0,0]
v_cvt_pk_bf16_f32 v40, v40, v41
v_pk_fma_f32 v[42:43], v[42:43], v[54:55], v[52:53] op_sel_hi:[1,0,0]
v_cvt_pk_bf16_f32 v41, v42, v43
v_pk_fma_f32 v[44:45], v[44:45], v[54:55], v[52:53] op_sel_hi:[1,0,0]
v_cvt_pk_bf16_f32 v42, v44, v45
v_pk_fma_f32 v[46:47], v[46:47], v[54:55], v[52:53] op_sel_hi:[1,0,0]
v_cvt_pk_bf16_f32 v43, v46, v47
v_pk_fma_f32 v[48:49], v[48:49], v[54:55], v[52:53] op_sel_hi:[1,0,0]
v_cvt_pk_bf16_f32 v44, v48, v49
v_pk_fma_f32 v[50:51], v[50:51], v[54:55], v[52:53] op_sel_hi:[1,0,0]
v_cvt_pk_bf16_f32 v45, v50, v51
v_mov_b32 v46, v44
v_mov_b32 v47, v45
v_permlane16_swap_b32 v40, v42
v_permlane16_swap_b32 v41, v43
v_permlane16_swap_b32 v44, v46
v_permlane16_swap_b32 v45, v47
buffer_store_dwordx4 v[40:43], v110, s[4:7], s33 offen sc1
buffer_store_dwordx4 v[44:47], v111, s[4:7], s33 offen sc1
s_add_u32 s64, s64, 245760
s_waitcnt vmcnt(27)
v_lshlrev_b32 v56, 16, v170
v_and_b32 v57, 0xffff0000, v170
v_lshlrev_b32 v58, 16, v171
v_and_b32 v59, 0xffff0000, v171
v_lshlrev_b32 v60, 16, v172
v_and_b32 v61, 0xffff0000, v172
v_lshlrev_b32 v62, 16, v173
v_and_b32 v63, 0xffff0000, v173
v_lshlrev_b32 v64, 16, v174
v_and_b32 v65, 0xffff0000, v174
v_lshlrev_b32 v66, 16, v175
v_and_b32 v67, 0xffff0000, v175
v_pk_add_f32 v[68:69], v[56:57], v[58:59]
v_pk_mul_f32 v[70:71], v[56:57], v[56:57]
v_pk_fma_f32 v[70:71], v[58:59], v[58:59], v[70:71]
v_pk_add_f32 v[68:69], v[68:69], v[60:61]
v_pk_fma_f32 v[70:71], v[60:61], v[60:61], v[70:71]
v_pk_add_f32 v[68:69], v[68:69], v[62:63]
v_pk_fma_f32 v[70:71], v[62:63], v[62:63], v[70:71]
v_pk_add_f32 v[68:69], v[68:69], v[64:65]
v_pk_fma_f32 v[70:71], v[64:65], v[64:65], v[70:71]
v_pk_add_f32 v[68:69], v[68:69], v[66:67]
v_pk_fma_f32 v[70:71], v[66:67], v[66:67], v[70:71]
v_add_f32 v68, v68, v69
v_add_f32 v70, v70, v71
s_add_u32 s33, s64, s73
v_add_f32 v68, v68, v68 row_ror:8 row_mask:0xf bank_mask:0xf
v_add_f32 v70, v70, v70 row_ror:8 row_mask:0xf bank_mask:0xf
s_nop 0
v_add_f32 v68, v68, v68 row_ror:4 row_mask:0xf bank_mask:0xf
v_add_f32 v70, v70, v70 row_ror:4 row_mask:0xf bank_mask:0xf
s_nop 0
v_add_f32 v68, v68, v68 row_ror:2 row_mask:0xf bank_mask:0xf
v_add_f32 v70, v70, v70 row_ror:2 row_mask:0xf bank_mask:0xf
s_nop 0
v_add_f32 v68, v68, v68 row_ror:1 row_mask:0xf bank_mask:0xf
v_add_f32 v70, v70, v70 row_ror:1 row_mask:0xf bank_mask:0xf
s_nop 0
v_mov_b32 v69, v68
v_mov_b32 v71, v70
s_nop 0
v_permlane32_swap_b32 v68, v69
v_permlane32_swap_b32 v70, v71
v_add_f32 v68, v68, v69
v_add_f32 v70, v70, v71
v_mov_b32 v69, v68
v_mov_b32 v71, v70
s_nop 0
v_permlane16_swap_b32 v68, v69
v_permlane16_swap_b32 v70, v71
v_add_f32 v68, v68, v69
v_add_f32 v70, v70, v71
v_mul_f32 v68, 0xbacccccd, v68
v_mul_f32 v69, v68, v68
v_fma_f32 v70, v70, s101, -v69
v_max_f32 v70, 0, v70
v_add_f32 v70, 0x3727c5ac, v70
v_rsq_f32 v70, v70
s_nop 0
v_mul_f32 v68, v68, v70
v_pk_fma_f32 v[56:57], v[56:57], v[70:71], v[68:69] op_sel_hi:[1,0,0]
v_cvt_pk_bf16_f32 v56, v56, v57
v_pk_fma_f32 v[58:59], v[58:59], v[70:71], v[68:69] op_sel_hi:[1,0,0]
v_cvt_pk_bf16_f32 v57, v58, v59
v_pk_fma_f32 v[60:61], v[60:61], v[70:71], v[68:69] op_sel_hi:[1,0,0]
v_cvt_pk_bf16_f32 v58, v60, v61
v_pk_fma_f32 v[62:63], v[62:63], v[70:71], v[68:69] op_sel_hi:[1,0,0]
v_cvt_pk_bf16_f32 v59, v62, v63
v_pk_fma_f32 v[64:65], v[64:65], v[70:71], v[68:69] op_sel_hi:[1,0,0]
v_cvt_pk_bf16_f32 v60, v64, v65
v_pk_fma_f32 v[66:67], v[66:67], v[70:71], v[68:69] op_sel_hi:[1,0,0]
v_cvt_pk_bf16_f32 v61, v66, v67
v_mov_b32 v62, v60
v_mov_b32 v63, v61
v_permlane16_swap_b32 v56, v58
v_permlane16_swap_b32 v57, v59
v_permlane16_swap_b32 v60, v62
v_permlane16_swap_b32 v61, v63
buffer_store_dwordx4 v[56:59], v110, s[4:7], s33 offen sc1
buffer_store_dwordx4 v[60:63], v111, s[4:7], s33 offen sc1
s_add_u32 s64, s64, 245760
s_waitcnt vmcnt(26)
v_lshlrev_b32 v40, 16, v176
v_and_b32 v41, 0xffff0000, v176
v_lshlrev_b32 v42, 16, v177
v_and_b32 v43, 0xffff0000, v177
v_lshlrev_b32 v44, 16, v178
v_and_b32 v45, 0xffff0000, v178
v_lshlrev_b32 v46, 16, v179
v_and_b32 v47, 0xffff0000, v179
v_lshlrev_b32 v48, 16, v180
v_and_b32 v49, 0xffff0000, v180
v_lshlrev_b32 v50, 16, v181
v_and_b32 v51, 0xffff0000, v181
v_pk_add_f32 v[52:53], v[40:41], v[42:43]
v_pk_mul_f32 v[54:55], v[40:41], v[40:41]
v_pk_fma_f32 v[54:55], v[42:43], v[42:43], v[54:55]
v_pk_add_f32 v[52:53], v[52:53], v[44:45]
v_pk_fma_f32 v[54:55], v[44:45], v[44:45], v[54:55]
v_pk_add_f32 v[52:53], v[52:53], v[46:47]
v_pk_fma_f32 v[54:55], v[46:47], v[46:47], v[54:55]
v_pk_add_f32 v[52:53], v[52:53], v[48:49]
v_pk_fma_f32 v[54:55], v[48:49], v[48:49], v[54:55]
v_pk_add_f32 v[52:53], v[52:53], v[50:51]
v_pk_fma_f32 v[54:55], v[50:51], v[50:51], v[54:55]
v_add_f32 v52, v52, v53
v_add_f32 v54, v54, v55
s_add_u32 s33, s64, s73
v_add_f32 v52, v52, v52 row_ror:8 row_mask:0xf bank_mask:0xf
v_add_f32 v54, v54, v54 row_ror:8 row_mask:0xf bank_mask:0xf
s_nop 0
v_add_f32 v52, v52, v52 row_ror:4 row_mask:0xf bank_mask:0xf
v_add_f32 v54, v54, v54 row_ror:4 row_mask:0xf bank_mask:0xf
s_nop 0
v_add_f32 v52, v52, v52 row_ror:2 row_mask:0xf bank_mask:0xf
v_add_f32 v54, v54, v54 row_ror:2 row_mask:0xf bank_mask:0xf
s_nop 0
v_add_f32 v52, v52, v52 row_ror:1 row_mask:0xf bank_mask:0xf
v_add_f32 v54, v54, v54 row_ror:1 row_mask:0xf bank_mask:0xf
s_nop 0
v_mov_b32 v53, v52
v_mov_b32 v55, v54
s_nop 0
v_permlane32_swap_b32 v52, v53
v_permlane32_swap_b32 v54, v55
v_add_f32 v52, v52, v53
v_add_f32 v54, v54, v55
v_mov_b32 v53, v52
v_mov_b32 v55, v54
s_nop 0
v_permlane16_swap_b32 v52, v53
v_permlane16_swap_b32 v54, v55
v_add_f32 v52, v52, v53
v_add_f32 v54, v54, v55
v_mul_f32 v52, 0xbacccccd, v52
v_mul_f32 v53, v52, v52
v_fma_f32 v54, v54, s101, -v53
v_max_f32 v54, 0, v54
v_add_f32 v54, 0x3727c5ac, v54
v_rsq_f32 v54, v54
s_nop 0
v_mul_f32 v52, v52, v54
v_pk_fma_f32 v[40:41], v[40:41], v[54:55], v[52:53] op_sel_hi:[1,0,0]
v_cvt_pk_bf16_f32 v40, v40, v41
v_pk_fma_f32 v[42:43], v[42:43], v[54:55], v[52:53] op_sel_hi:[1,0,0]
v_cvt_pk_bf16_f32 v41, v42, v43
v_pk_fma_f32 v[44:45], v[44:45], v[54:55], v[52:53] op_sel_hi:[1,0,0]
v_cvt_pk_bf16_f32 v42, v44, v45
v_pk_fma_f32 v[46:47], v[46:47], v[54:55], v[52:53] op_sel_hi:[1,0,0]
v_cvt_pk_bf16_f32 v43, v46, v47
v_pk_fma_f32 v[48:49], v[48:49], v[54:55], v[52:53] op_sel_hi:[1,0,0]
v_cvt_pk_bf16_f32 v44, v48, v49
v_pk_fma_f32 v[50:51], v[50:51], v[54:55], v[52:53] op_sel_hi:[1,0,0]
v_cvt_pk_bf16_f32 v45, v50, v51
v_mov_b32 v46, v44
v_mov_b32 v47, v45
v_permlane16_swap_b32 v40, v42
v_permlane16_swap_b32 v41, v43
v_permlane16_swap_b32 v44, v46
v_permlane16_swap_b32 v45, v47
buffer_store_dwordx4 v[40:43], v110, s[4:7], s33 offen sc1
buffer_store_dwordx4 v[44:47], v111, s[4:7], s33 offen sc1
s_add_u32 s64, s64, 245760
s_waitcnt vmcnt(25)
v_lshlrev_b32 v56, 16, v182
v_and_b32 v57, 0xffff0000, v182
v_lshlrev_b32 v58, 16, v183
v_and_b32 v59, 0xffff0000, v183
v_lshlrev_b32 v60, 16, v184
v_and_b32 v61, 0xffff0000, v184
v_lshlrev_b32 v62, 16, v185
v_and_b32 v63, 0xffff0000, v185
v_lshlrev_b32 v64, 16, v186
v_and_b32 v65, 0xffff0000, v186
v_lshlrev_b32 v66, 16, v187
v_and_b32 v67, 0xffff0000, v187
v_pk_add_f32 v[68:69], v[56:57], v[58:59]
v_pk_mul_f32 v[70:71], v[56:57], v[56:57]
v_pk_fma_f32 v[70:71], v[58:59], v[58:59], v[70:71]
v_pk_add_f32 v[68:69], v[68:69], v[60:61]
v_pk_fma_f32 v[70:71], v[60:61], v[60:61], v[70:71]
v_pk_add_f32 v[68:69], v[68:69], v[62:63]
v_pk_fma_f32 v[70:71], v[62:63], v[62:63], v[70:71]
v_pk_add_f32 v[68:69], v[68:69], v[64:65]
v_pk_fma_f32 v[70:71], v[64:65], v[64:65], v[70:71]
v_pk_add_f32 v[68:69], v[68:69], v[66:67]
v_pk_fma_f32 v[70:71], v[66:67], v[66:67], v[70:71]
v_add_f32 v68, v68, v69
v_add_f32 v70, v70, v71
s_add_u32 s33, s64, s73
v_add_f32 v68, v68, v68 row_ror:8 row_mask:0xf bank_mask:0xf
v_add_f32 v70, v70, v70 row_ror:8 row_mask:0xf bank_mask:0xf
s_nop 0
v_add_f32 v68, v68, v68 row_ror:4 row_mask:0xf bank_mask:0xf
v_add_f32 v70, v70, v70 row_ror:4 row_mask:0xf bank_mask:0xf
s_nop 0
v_add_f32 v68, v68, v68 row_ror:2 row_mask:0xf bank_mask:0xf
v_add_f32 v70, v70, v70 row_ror:2 row_mask:0xf bank_mask:0xf
s_nop 0
v_add_f32 v68, v68, v68 row_ror:1 row_mask:0xf bank_mask:0xf
v_add_f32 v70, v70, v70 row_ror:1 row_mask:0xf bank_mask:0xf
s_nop 0
v_mov_b32 v69, v68
v_mov_b32 v71, v70
s_nop 0
v_permlane32_swap_b32 v68, v69
v_permlane32_swap_b32 v70, v71
v_add_f32 v68, v68, v69
v_add_f32 v70, v70, v71
v_mov_b32 v69, v68
v_mov_b32 v71, v70
s_nop 0
v_permlane16_swap_b32 v68, v69
v_permlane16_swap_b32 v70, v71
v_add_f32 v68, v68, v69
v_add_f32 v70, v70, v71
v_mul_f32 v68, 0xbacccccd, v68
v_mul_f32 v69, v68, v68
v_fma_f32 v70, v70, s101, -v69
v_max_f32 v70, 0, v70
v_add_f32 v70, 0x3727c5ac, v70
v_rsq_f32 v70, v70
s_nop 0
v_mul_f32 v68, v68, v70
v_pk_fma_f32 v[56:57], v[56:57], v[70:71], v[68:69] op_sel_hi:[1,0,0]
v_cvt_pk_bf16_f32 v56, v56, v57
v_pk_fma_f32 v[58:59], v[58:59], v[70:71], v[68:69] op_sel_hi:[1,0,0]
v_cvt_pk_bf16_f32 v57, v58, v59
v_pk_fma_f32 v[60:61], v[60:61], v[70:71], v[68:69] op_sel_hi:[1,0,0]
v_cvt_pk_bf16_f32 v58, v60, v61
v_pk_fma_f32 v[62:63], v[62:63], v[70:71], v[68:69] op_sel_hi:[1,0,0]
v_cvt_pk_bf16_f32 v59, v62, v63
v_pk_fma_f32 v[64:65], v[64:65], v[70:71], v[68:69] op_sel_hi:[1,0,0]
v_cvt_pk_bf16_f32 v60, v64, v65
v_pk_fma_f32 v[66:67], v[66:67], v[70:71], v[68:69] op_sel_hi:[1,0,0]
v_cvt_pk_bf16_f32 v61, v66, v67
v_mov_b32 v62, v60
v_mov_b32 v63, v61
v_permlane16_swap_b32 v56, v58
v_permlane16_swap_b32 v57, v59
v_permlane16_swap_b32 v60, v62
v_permlane16_swap_b32 v61, v63
buffer_store_dwordx4 v[56:59], v110, s[4:7], s33 offen sc1
buffer_store_dwordx4 v[60:63], v111, s[4:7], s33 offen sc1
s_add_u32 s64, s64, 245760
s_cmp_ge_u32 s62, 128
s_cbranch_scc1 n35
s_waitcnt vmcnt(24)
v_lshlrev_b32 v40, 16, v188
v_and_b32 v41, 0xffff0000, v188
v_lshlrev_b32 v42, 16, v189
v_and_b32 v43, 0xffff0000, v189
v_lshlrev_b32 v44, 16, v190
v_and_b32 v45, 0xffff0000, v190
v_lshlrev_b32 v46, 16, v191
v_and_b32 v47, 0xffff0000, v191
v_lshlrev_b32 v48, 16, v192
v_and_b32 v49, 0xffff0000, v192
v_lshlrev_b32 v50, 16, v193
v_and_b32 v51, 0xffff0000, v193
v_pk_add_f32 v[52:53], v[40:41], v[42:43]
v_pk_mul_f32 v[54:55], v[40:41], v[40:41]
v_pk_fma_f32 v[54:55], v[42:43], v[42:43], v[54:55]
v_pk_add_f32 v[52:53], v[52:53], v[44:45]
v_pk_fma_f32 v[54:55], v[44:45], v[44:45], v[54:55]
v_pk_add_f32 v[52:53], v[52:53], v[46:47]
v_pk_fma_f32 v[54:55], v[46:47], v[46:47], v[54:55]
v_pk_add_f32 v[52:53], v[52:53], v[48:49]
v_pk_fma_f32 v[54:55], v[48:49], v[48:49], v[54:55]
v_pk_add_f32 v[52:53], v[52:53], v[50:51]
v_pk_fma_f32 v[54:55], v[50:51], v[50:51], v[54:55]
v_add_f32 v52, v52, v53
v_add_f32 v54, v54, v55
s_add_u32 s33, s64, s73
v_add_f32 v52, v52, v52 row_ror:8 row_mask:0xf bank_mask:0xf
v_add_f32 v54, v54, v54 row_ror:8 row_mask:0xf bank_mask:0xf
s_nop 0
v_add_f32 v52, v52, v52 row_ror:4 row_mask:0xf bank_mask:0xf
v_add_f32 v54, v54, v54 row_ror:4 row_mask:0xf bank_mask:0xf
s_nop 0
v_add_f32 v52, v52, v52 row_ror:2 row_mask:0xf bank_mask:0xf
v_add_f32 v54, v54, v54 row_ror:2 row_mask:0xf bank_mask:0xf
s_nop 0
v_add_f32 v52, v52, v52 row_ror:1 row_mask:0xf bank_mask:0xf
v_add_f32 v54, v54, v54 row_ror:1 row_mask:0xf bank_mask:0xf
s_nop 0
v_mov_b32 v53, v52
v_mov_b32 v55, v54
s_nop 0
v_permlane32_swap_b32 v52, v53
v_permlane32_swap_b32 v54, v55
v_add_f32 v52, v52, v53
v_add_f32 v54, v54, v55
v_mov_b32 v53, v52
v_mov_b32 v55, v54
s_nop 0
v_permlane16_swap_b32 v52, v53
v_permlane16_swap_b32 v54, v55
v_add_f32 v52, v52, v53
v_add_f32 v54, v54, v55
v_mul_f32 v52, 0xbacccccd, v52
v_mul_f32 v53, v52, v52
v_fma_f32 v54, v54, s101, -v53
v_max_f32 v54, 0, v54
v_add_f32 v54, 0x3727c5ac, v54
v_rsq_f32 v54, v54
s_nop 0
v_mul_f32 v52, v52, v54
v_pk_fma_f32 v[40:41], v[40:41], v[54:55], v[52:53] op_sel_hi:[1,0,0]
v_cvt_pk_bf16_f32 v40, v40, v41
v_pk_fma_f32 v[42:43], v[42:43], v[54:55], v[52:53] op_sel_hi:[1,0,0]
v_cvt_pk_bf16_f32 v41, v42, v43
v_pk_fma_f32 v[44:45], v[44:45], v[54:55], v[52:53] op_sel_hi:[1,0,0]
v_cvt_pk_bf16_f32 v42, v44, v45
v_pk_fma_f32 v[46:47], v[46:47], v[54:55], v[52:53] op_sel_hi:[1,0,0]
v_cvt_pk_bf16_f32 v43, v46, v47
v_pk_fma_f32 v[48:49], v[48:49], v[54:55], v[52:53] op_sel_hi:[1,0,0]
v_cvt_pk_bf16_f32 v44, v48, v49
v_pk_fma_f32 v[50:51], v[50:51], v[54:55], v[52:53] op_sel_hi:[1,0,0]
v_cvt_pk_bf16_f32 v45, v50, v51
v_mov_b32 v46, v44
v_mov_b32 v47, v45
v_permlane16_swap_b32 v40, v42
v_permlane16_swap_b32 v41, v43
v_permlane16_swap_b32 v44, v46
v_permlane16_swap_b32 v45, v47
buffer_store_dwordx4 v[40:43], v110, s[4:7], s33 offen sc1
buffer_store_dwordx4 v[44:47], v111, s[4:7], s33 offen sc1
s_add_u32 s64, s64, 245760
n35:
s_mov_b32 s28, 0
s_mov_b32 s30, 0x80808080
v_and_b32 v12, 63, v0
v_lshlrev_b32 v12, 2, v12
sy36:
buffer_load_dword v13, v12, s[8:11], 0 offen sc1
s_waitcnt vmcnt(0)
sy39:
v_and_b32 v14, s30, v13
v_cmp_ne_u32 vcc, s30, v14
s_cbranch_vccz sy37
s_sleep 2
s_add_u32 s28, s28, 1
s_cmp_lt_u32 s28, 524288
s_cbranch_scc1 sy36
s_mov_b32 s29, 1
s_branch L_abort
sy37:
s_cmp_lg_u32 s26, 0
s_cbranch_scc1 sy38
v_mov_b32 v15, 0
v_bfe_u32 v14, v13, 0, 3
v_lshlrev_b32 v14, v14, 1
v_or_b32 v15, v15, v14
v_bfe_u32 v14, v13, 8, 3
v_lshlrev_b32 v14, v14, 1
v_or_b32 v15, v15, v14
v_bfe_u32 v14, v13, 16, 3
v_lshlrev_b32 v14, v14, 1
v_or_b32 v15, v15, v14
v_bfe_u32 v14, v13, 24, 3
v_lshlrev_b32 v14, v14, 1
v_or_b32 v15, v15, v14
s_nop 1
v_mov_b32 v14, v15 quad_perm:[1,0,3,2] row_mask:0xf bank_mask:0xf
v_or_b32 v15, v15, v14
v_cmp_ne_u32 vcc, 0xff, v15
s_cbranch_vccnz L_rank
s_mov_b32 s26, 1
sy38:
s_atomic_add s63, s[60:61], s65
s_add_u32 s65, s65, 768
s_atomic_add s63, s[60:61], s65
s_add_u32 s65, s65, 768
s_atomic_add s63, s[60:61], s65
s_add_u32 s65, s65, 768
s_atomic_add s63, s[60:61], s65
s_add_u32 s65, s65, 768
s_atomic_add s63, s[60:61], s65
s_add_u32 s65, s65, 768
s_atomic_add s63, s[60:61], s65
s_add_u32 s65, s65, 768
s_atomic_add s63, s[60:61], s65
s_add_u32 s65, s65, 768
s_atomic_add s63, s[60:61], s65
s_add_u32 s65, s65, 768
s_atomic_add s63, s[60:61], s65
s_add_u32 s65, s65, 768
s_atomic_add s63, s[60:61], s65
s_add_u32 s65, s65, 768
s_cmp_ge_u32 s62, 128
s_cbranch_scc1 n41
s_atomic_add s63, s[60:61], s65
s_add_u32 s65, s65, 768
n41:
v_lshl_or_b32 v88, v90, 16, v88
v_lshl_or_b32 v89, v91, 16, v89
v_min_u32 v88, -2, v88
v_min_u32 v89, -2, v89
s_cmp_ge_u32 s62, 40
s_cbranch_scc1 n40
s_lshl_b32 s33, s62, 8
s_mov_b32 exec_hi, 0
s_add_u32 s35, s33, 851968
buffer_store_dwordx2 v[88:89], v80, s[4:7], s35 offen sc1
s_add_u32 s35, s33, 917504
buffer_store_dwordx2 v[88:89], v80, s[4:7], s35 offen sc1
s_cmp_ge_u32 s62, 8
s_cbranch_scc1 n40
s_add_u32 s35, s33, 862208
buffer_store_dwordx2 v[88:89], v80, s[4:7], s35 offen sc1
s_add_u32 s35, s33, 864256
buffer_store_dwordx2 v[88:89], v80, s[4:7], s35 offen sc1
s_add_u32 s35, s33, 866304
buffer_store_dwordx2 v[88:89], v80, s[4:7], s35 offen sc1
s_add_u32 s35, s33, 927744
buffer_store_dwordx2 v[88:89], v80, s[4:7], s35 offen sc1
s_add_u32 s35, s33, 929792
buffer_store_dwordx2 v[88:89], v80, s[4:7], s35 offen sc1
s_add_u32 s35, s33, 931840
buffer_store_dwordx2 v[88:89], v80, s[4:7], s35 offen sc1
n40:
s_mov_b32 exec_hi, -1
s_waitcnt lgkmcnt(0)
s_cmp_lt_u32 s71, 3
s_cbranch_scc1 L_roleA
s_branch L_roleF
L_roleF:
v_and_b32 v1, 63, v0
v_lshlrev_b32 v2, 4, v1
v_lshlrev_b32 v8, 2, v1
s_mov_b32 s12, s52
s_mov_b32 s13, s53
s_mov_b32 s14, 2211840
s_mov_b32 s15, 0x20000
s_mov_b32 s16, s54
s_mov_b32 s17, s55
s_mov_b32 s18, 2211840
s_mov_b32 s19, 0x20000
s_mov_b32 s96, s56
s_mov_b32 s97, s57
s_mov_b32 s98, 2621440
s_mov_b32 s99, 0x20000
s_cmp_lt_u32 s70, 14
s_cbranch_scc1 f42
s_waitcnt vmcnt(0)
s_barrier
s_cmp_lg_u32 s25, 0
s_cbranch_scc1 ar44
s_or_b32 s33, s3, 0x80
v_mov_b32 v7, s33
s_mov_b64 exec, 1
buffer_store_byte v7, off, s[8:11], s2 sc1
s_mov_b64 exec, -1
ar44:
s_branch f43
f42:
s_lshl_b32 s33, s70, 8
v_lshrrev_b32 v16, 4, v1
s_lshl_b32 s30, s25, 4
v_add_u32 v16, s30, v16
v_mul_u32_u24 v16, 3456, v16
v_and_b32 v40, 15, v1
v_lshl_add_u32 v16, v40, 4, v16
v_add_u32 v16, s33, v16
v_and_b32 v18, 19, v1
v_bfe_u32 v19, v1, 2, 1
v_lshl_add_u32 v18, v19, 3, v18
v_bfe_u32 v19, v1, 3, 1
v_lshl_add_u32 v18, v19, 2, v18
v_and_b32 v19, 1, v18
v_mul_u32_u24 v19, 0x0202, v19
v_mul_u32_u24 v19, 0x10001, v19
v_add_u32 v19, 0x05040100, v19
v_lshrrev_b32 v18, 1, v18
v_lshlrev_b32 v18, 2, v18
v_lshrrev_b32 v40, 5, v1
v_mul_u32_u24 v40, 2048, v40
v_add_u32 v18, v18, v40
s_mul_i32 s30, s25, 64
v_add_u32 v18, s30, v18
s_mul_i32 s34, s25, 12288
s_add_u32 m0, s34, 0
s_mov_b32 s30, 0
buffer_load_dwordx4 v16, s[12:15], s30 offen lds
s_add_u32 m0, s34, 1024
s_mov_b32 s30, 13824
buffer_load_dwordx4 v16, s[12:15], s30 offen lds
s_add_u32 m0, s34, 2048
s_mov_b32 s30, 27648
buffer_load_dwordx4 v16, s[12:15], s30 offen lds
s_add_u32 m0, s34, 3072
s_mov_b32 s30, 41472
buffer_load_dwordx4 v16, s[12:15], s30 offen lds
s_add_u32 m0, s34, 4096
s_mov_b32 s30, 221184
buffer_load_dwordx4 v16, s[12:15], s30 offen lds
s_add_u32 m0, s34, 5120
s_mov_b32 s30, 235008
buffer_load_dwordx4 v16, s[12:15], s30 offen lds
s_add_u32 m0, s34, 6144
s_mov_b32 s30, 248832
buffer_load_dwordx4 v16, s[12:15], s30 offen lds
s_add_u32 m0, s34, 7168
s_mov_b32 s30, 262656
buffer_load_dwordx4 v16, s[12:15], s30 offen lds
s_waitcnt vmcnt(4)
s_barrier
s_cmp_lg_u32 s25, 0
s_cbranch_scc1 ar45
s_or_b32 s33, s3, 0x80
v_mov_b32 v7, s33
s_mov_b64 exec, 1
buffer_store_byte v7, off, s[8:11], s2 sc1
s_mov_b64 exec, -1
ar45:
s_add_u32 m0, s34, 8192
s_mov_b32 s30, 442368
buffer_load_dwordx4 v16, s[12:15], s30 offen lds
s_add_u32 m0, s34, 9216
s_mov_b32 s30, 456192
buffer_load_dwordx4 v16, s[12:15], s30 offen lds
s_add_u32 m0, s34, 10240
s_mov_b32 s30, 470016
buffer_load_dwordx4 v16, s[12:15], s30 offen lds
s_add_u32 m0, s34, 11264
s_mov_b32 s30, 483840
buffer_load_dwordx4 v16, s[12:15], s30 offen lds
ds_read2st64_b32 v[24:25], v18 offset0:0 offset1:1
ds_read2st64_b32 v[26:27], v18 offset0:2 offset1:3
ds_read2st64_b32 v[28:29], v18 offset0:4 offset1:5
ds_read2st64_b32 v[30:31], v18 offset0:6 offset1:7
ds_read2st64_b32 v[32:33], v18 offset0:48 offset1:49
ds_read2st64_b32 v[34:35], v18 offset0:50 offset1:51
ds_read2st64_b32 v[36:37], v18 offset0:52 offset1:53
ds_read2st64_b32 v[38:39], v18 offset0:54 offset1:55
s_waitcnt lgkmcnt(4)
v_perm_b32 v40, v25, v24, v19
v_perm_b32 v41, v27, v26, v19
v_perm_b32 v42, v29, v28, v19
v_perm_b32 v43, v31, v30, v19
ds_read2st64_b32 v[24:25], v18 offset0:96 offset1:97
ds_read2st64_b32 v[26:27], v18 offset0:98 offset1:99
ds_read2st64_b32 v[28:29], v18 offset0:100 offset1:101
ds_read2st64_b32 v[30:31], v18 offset0:102 offset1:103
v_accvgpr_write_b32 a0, v40
v_accvgpr_write_b32 a1, v41
v_accvgpr_write_b32 a2, v42
v_accvgpr_write_b32 a3, v43
s_waitcnt lgkmcnt(4)
v_perm_b32 v40, v33, v32, v19
v_perm_b32 v41, v35, v34, v19
v_perm_b32 v42, v37, v36, v19
v_perm_b32 v43, v39, v38, v19
ds_read2st64_b32 v[32:33], v18 offset0:144 offset1:145
ds_read2st64_b32 v[34:35], v18 offset0:146 offset1:147
ds_read2st64_b32 v[36:37], v18 offset0:148 offset1:149
ds_read2st64_b32 v[38:39], v18 offset0:150 offset1:151
v_accvgpr_write_b32 a4, v40
v_accvgpr_write_b32 a5, v41
v_accvgpr_write_b32 a6, v42
v_accvgpr_write_b32 a7, v43
s_waitcnt lgkmcnt(4)
v_perm_b32 v40, v25, v24, v19
v_perm_b32 v41, v27, v26, v19
v_perm_b32 v42, v29, v28, v19
v_perm_b32 v43, v31, v30, v19
v_accvgpr_write_b32 a8, v40
v_accvgpr_write_b32 a9, v41
v_accvgpr_write_b32 a10, v42
v_accvgpr_write_b32 a11, v43
s_waitcnt lgkmcnt(0)
v_perm_b32 v40, v33, v32, v19
v_perm_b32 v41, v35, v34, v19
v_perm_b32 v42, v37, v36, v19
v_perm_b32 v43, v39, v38, v19
v_accvgpr_write_b32 a12, v40
v_accvgpr_write_b32 a13, v41
v_accvgpr_write_b32 a14, v42
v_accvgpr_write_b32 a15, v43
s_waitcnt vmcnt(4)
s_barrier
s_add_u32 m0, s34, 0
s_mov_b32 s30, 663552
buffer_load_dwordx4 v16, s[12:15], s30 offen lds
s_add_u32 m0, s34, 1024
s_mov_b32 s30, 677376
buffer_load_dwordx4 v16, s[12:15], s30 offen lds
s_add_u32 m0, s34, 2048
s_mov_b32 s30, 691200
buffer_load_dwordx4 v16, s[12:15], s30 offen lds
s_add_u32 m0, s34, 3072
s_mov_b32 s30, 705024
buffer_load_dwordx4 v16, s[12:15], s30 offen lds
ds_read2st64_b32 v[24:25], v18 offset0:16 offset1:17
ds_read2st64_b32 v[26:27], v18 offset0:18 offset1:19
ds_read2st64_b32 v[28:29], v18 offset0:20 offset1:21
ds_read2st64_b32 v[30:31], v18 offset0:22 offset1:23
ds_read2st64_b32 v[32:33], v18 offset0:64 offset1:65
ds_read2st64_b32 v[34:35], v18 offset0:66 offset1:67
ds_read2st64_b32 v[36:37], v18 offset0:68 offset1:69
ds_read2st64_b32 v[38:39], v18 offset0:70 offset1:71
s_waitcnt lgkmcnt(4)
v_perm_b32 v40, v25, v24, v19
v_perm_b32 v41, v27, v26, v19
v_perm_b32 v42, v29, v28, v19
v_perm_b32 v43, v31, v30, v19
ds_read2st64_b32 v[24:25], v18 offset0:112 offset1:113
ds_read2st64_b32 v[26:27], v18 offset0:114 offset1:115
ds_read2st64_b32 v[28:29], v18 offset0:116 offset1:117
ds_read2st64_b32 v[30:31], v18 offset0:118 offset1:119
v_accvgpr_write_b32 a16, v40
v_accvgpr_write_b32 a17, v41
v_accvgpr_write_b32 a18, v42
v_accvgpr_write_b32 a19, v43
s_waitcnt lgkmcnt(4)
v_perm_b32 v40, v33, v32, v19
v_perm_b32 v41, v35, v34, v19
v_perm_b32 v42, v37, v36, v19
v_perm_b32 v43, v39, v38, v19
ds_read2st64_b32 v[32:33], v18 offset0:160 offset1:161
ds_read2st64_b32 v[34:35], v18 offset0:162 offset1:163
ds_read2st64_b32 v[36:37], v18 offset0:164 offset1:165
ds_read2st64_b32 v[38:39], v18 offset0:166 offset1:167
v_accvgpr_write_b32 a20, v40
v_accvgpr_write_b32 a21, v41
v_accvgpr_write_b32 a22, v42
v_accvgpr_write_b32 a23, v43
s_waitcnt lgkmcnt(4)
v_perm_b32 v40, v25, v24, v19
v_perm_b32 v41, v27, v26, v19
v_perm_b32 v42, v29, v28, v19
v_perm_b32 v43, v31, v30, v19
v_accvgpr_write_b32 a24, v40
v_accvgpr_write_b32 a25, v41
v_accvgpr_write_b32 a26, v42
v_accvgpr_write_b32 a27, v43
s_waitcnt lgkmcnt(0)
v_perm_b32 v40, v33, v32, v19
v_perm_b32 v41, v35, v34, v19
v_perm_b32 v42, v37, v36, v19
v_perm_b32 v43, v39, v38, v19
v_accvgpr_write_b32 a28, v40
v_accvgpr_write_b32 a29, v41
v_accvgpr_write_b32 a30, v42
v_accvgpr_write_b32 a31, v43
s_waitcnt vmcnt(4)
s_barrier
s_add_u32 m0, s34, 4096
s_mov_b32 s30, 884736
buffer_load_dwordx4 v16, s[12:15], s30 offen lds
s_add_u32 m0, s34, 5120
s_mov_b32 s30, 898560
buffer_load_dwordx4 v16, s[12:15], s30 offen lds
s_add_u32 m0, s34, 6144
s_mov_b32 s30, 912384
buffer_load_dwordx4 v16, s[12:15], s30 offen lds
s_add_u32 m0, s34, 7168
s_mov_b32 s30, 926208
buffer_load_dwordx4 v16, s[12:15], s30 offen lds
ds_read2st64_b32 v[24:25], v18 offset0:32 offset1:33
ds_read2st64_b32 v[26:27], v18 offset0:34 offset1:35
ds_read2st64_b32 v[28:29], v18 offset0:36 offset1:37
ds_read2st64_b32 v[30:31], v18 offset0:38 offset1:39
ds_read2st64_b32 v[32:33], v18 offset0:80 offset1:81
ds_read2st64_b32 v[34:35], v18 offset0:82 offset1:83
ds_read2st64_b32 v[36:37], v18 offset0:84 offset1:85
ds_read2st64_b32 v[38:39], v18 offset0:86 offset1:87
s_waitcnt lgkmcnt(4)
v_perm_b32 v40, v25, v24, v19
v_perm_b32 v41, v27, v26, v19
v_perm_b32 v42, v29, v28, v19
v_perm_b32 v43, v31, v30, v19
ds_read2st64_b32 v[24:25], v18 offset0:128 offset1:129
ds_read2st64_b32 v[26:27], v18 offset0:130 offset1:131
ds_read2st64_b32 v[28:29], v18 offset0:132 offset1:133
ds_read2st64_b32 v[30:31], v18 offset0:134 offset1:135
v_accvgpr_write_b32 a32, v40
v_accvgpr_write_b32 a33, v41
v_accvgpr_write_b32 a34, v42
v_accvgpr_write_b32 a35, v43
s_waitcnt lgkmcnt(4)
v_perm_b32 v40, v33, v32, v19
v_perm_b32 v41, v35, v34, v19
v_perm_b32 v42, v37, v36, v19
v_perm_b32 v43, v39, v38, v19
ds_read2st64_b32 v[32:33], v18 offset0:176 offset1:177
ds_read2st64_b32 v[34:35], v18 offset0:178 offset1:179
ds_read2st64_b32 v[36:37], v18 offset0:180 offset1:181
ds_read2st64_b32 v[38:39], v18 offset0:182 offset1:183
v_accvgpr_write_b32 a36, v40
v_accvgpr_write_b32 a37, v41
v_accvgpr_write_b32 a38, v42
v_accvgpr_write_b32 a39, v43
s_waitcnt lgkmcnt(4)
v_perm_b32 v40, v25, v24, v19
v_perm_b32 v41, v27, v26, v19
v_perm_b32 v42, v29, v28, v19
v_perm_b32 v43, v31, v30, v19
v_accvgpr_write_b32 a40, v40
v_accvgpr_write_b32 a41, v41
v_accvgpr_write_b32 a42, v42
v_accvgpr_write_b32 a43, v43
s_waitcnt lgkmcnt(0)
v_perm_b32 v40, v33, v32, v19
v_perm_b32 v41, v35, v34, v19
v_perm_b32 v42, v37, v36, v19
v_perm_b32 v43, v39, v38, v19
v_accvgpr_write_b32 a44, v40
v_accvgpr_write_b32 a45, v41
v_accvgpr_write_b32 a46, v42
v_accvgpr_write_b32 a47, v43
s_waitcnt vmcnt(4)
s_barrier
s_add_u32 m0, s34, 8192
s_mov_b32 s30, 1105920
buffer_load_dwordx4 v16, s[12:15], s30 offen lds
s_add_u32 m0, s34, 9216
s_mov_b32 s30, 1119744
buffer_load_dwordx4 v16, s[12:15], s30 offen lds
s_add_u32 m0, s34, 10240
s_mov_b32 s30, 1133568
buffer_load_dwordx4 v16, s[12:15], s30 offen lds
s_add_u32 m0, s34, 11264
s_mov_b32 s30, 1147392
buffer_load_dwordx4 v16, s[12:15], s30 offen lds
ds_read2st64_b32 v[24:25], v18 offset0:0 offset1:1
ds_read2st64_b32 v[26:27], v18 offset0:2 offset1:3
ds_read2st64_b32 v[28:29], v18 offset0:4 offset1:5
ds_read2st64_b32 v[30:31], v18 offset0:6 offset1:7
ds_read2st64_b32 v[32:33], v18 offset0:48 offset1:49
ds_read2st64_b32 v[34:35], v18 offset0:50 offset1:51
ds_read2st64_b32 v[36:37], v18 offset0:52 offset1:53
ds_read2st64_b32 v[38:39], v18 offset0:54 offset1:55
s_waitcnt lgkmcnt(4)
v_perm_b32 v40, v25, v24, v19
v_perm_b32 v41, v27, v26, v19
v_perm_b32 v42, v29, v28, v19
v_perm_b32 v43, v31, v30, v19
ds_read2st64_b32 v[24:25], v18 offset0:96 offset1:97
ds_read2st64_b32 v[26:27], v18 offset0:98 offset1:99
ds_read2st64_b32 v[28:29], v18 offset0:100 offset1:101
ds_read2st64_b32 v[30:31], v18 offset0:102 offset1:103
v_accvgpr_write_b32 a48, v40
v_accvgpr_write_b32 a49, v41
v_accvgpr_write_b32 a50, v42
v_accvgpr_write_b32 a51, v43
s_waitcnt lgkmcnt(4)
v_perm_b32 v40, v33, v32, v19
v_perm_b32 v41, v35, v34, v19
v_perm_b32 v42, v37, v36, v19
v_perm_b32 v43, v39, v38, v19
ds_read2st64_b32 v[32:33], v18 offset0:144 offset1:145
ds_read2st64_b32 v[34:35], v18 offset0:146 offset1:147
ds_read2st64_b32 v[36:37], v18 offset0:148 offset1:149
ds_read2st64_b32 v[38:39], v18 offset0:150 offset1:151
v_accvgpr_write_b32 a52, v40
v_accvgpr_write_b32 a53, v41
v_accvgpr_write_b32 a54, v42
v_accvgpr_write_b32 a55, v43
s_waitcnt lgkmcnt(4)
v_perm_b32 v40, v25, v24, v19
v_perm_b32 v41, v27, v26, v19
v_perm_b32 v42, v29, v28, v19
v_perm_b32 v43, v31, v30, v19
v_accvgpr_write_b32 a56, v40
v_accvgpr_write_b32 a57, v41
v_accvgpr_write_b32 a58, v42
v_accvgpr_write_b32 a59, v43
s_waitcnt lgkmcnt(0)
v_perm_b32 v40, v33, v32, v19
v_perm_b32 v41, v35, v34, v19
v_perm_b32 v42, v37, v36, v19
v_perm_b32 v43, v39, v38, v19
v_accvgpr_write_b32 a60, v40
v_accvgpr_write_b32 a61, v41
v_accvgpr_write_b32 a62, v42
v_accvgpr_write_b32 a63, v43
s_waitcnt vmcnt(4)
s_barrier
s_add_u32 m0, s34, 0
s_mov_b32 s30, 1327104
buffer_load_dwordx4 v16, s[12:15], s30 offen lds
s_add_u32 m0, s34, 1024
s_mov_b32 s30, 1340928
buffer_load_dwordx4 v16, s[12:15], s30 offen lds
s_add_u32 m0, s34, 2048
s_mov_b32 s30, 1354752
buffer_load_dwordx4 v16, s[12:15], s30 offen lds
s_add_u32 m0, s34, 3072
s_mov_b32 s30, 1368576
buffer_load_dwordx4 v16, s[12:15], s30 offen lds
ds_read2st64_b32 v[24:25], v18 offset0:16 offset1:17
ds_read2st64_b32 v[26:27], v18 offset0:18 offset1:19
ds_read2st64_b32 v[28:29], v18 offset0:20 offset1:21
ds_read2st64_b32 v[30:31], v18 offset0:22 offset1:23
ds_read2st64_b32 v[32:33], v18 offset0:64 offset1:65
ds_read2st64_b32 v[34:35], v18 offset0:66 offset1:67
ds_read2st64_b32 v[36:37], v18 offset0:68 offset1:69
ds_read2st64_b32 v[38:39], v18 offset0:70 offset1:71
s_waitcnt lgkmcnt(4)
v_perm_b32 v40, v25, v24, v19
v_perm_b32 v41, v27, v26, v19
v_perm_b32 v42, v29, v28, v19
v_perm_b32 v43, v31, v30, v19
ds_read2st64_b32 v[24:25], v18 offset0:112 offset1:113
ds_read2st64_b32 v[26:27], v18 offset0:114 offset1:115
ds_read2st64_b32 v[28:29], v18 offset0:116 offset1:117
ds_read2st64_b32 v[30:31], v18 offset0:118 offset1:119
v_accvgpr_write_b32 a64, v40
v_accvgpr_write_b32 a65, v41
v_accvgpr_write_b32 a66, v42
v_accvgpr_write_b32 a67, v43
s_waitcnt lgkmcnt(4)
v_perm_b32 v40, v33, v32, v19
v_perm_b32 v41, v35, v34, v19
v_perm_b32 v42, v37, v36, v19
v_perm_b32 v43, v39, v38, v19
ds_read2st64_b32 v[32:33], v18 offset0:160 offset1:161
ds_read2st64_b32 v[34:35], v18 offset0:162 offset1:163
ds_read2st64_b32 v[36:37], v18 offset0:164 offset1:165
ds_read2st64_b32 v[38:39], v18 offset0:166 offset1:167
v_accvgpr_write_b32 a68, v40
v_accvgpr_write_b32 a69, v41
v_accvgpr_write_b32 a70, v42
v_accvgpr_write_b32 a71, v43
s_waitcnt lgkmcnt(4)
v_perm_b32 v40, v25, v24, v19
v_perm_b32 v41, v27, v26, v19
v_perm_b32 v42, v29, v28, v19
v_perm_b32 v43, v31, v30, v19
v_accvgpr_write_b32 a72, v40
v_accvgpr_write_b32 a73, v41
v_accvgpr_write_b32 a74, v42
v_accvgpr_write_b32 a75, v43
s_waitcnt lgkmcnt(0)
v_perm_b32 v40, v33, v32, v19
v_perm_b32 v41, v35, v34, v19
v_perm_b32 v42, v37, v36, v19
v_perm_b32 v43, v39, v38, v19
v_accvgpr_write_b32 a76, v40
v_accvgpr_write_b32 a77, v41
v_accvgpr_write_b32 a78, v42
v_accvgpr_write_b32 a79, v43
s_waitcnt vmcnt(4)
s_barrier
s_add_u32 m0, s34, 4096
s_mov_b32 s30, 1548288
buffer_load_dwordx4 v16, s[12:15], s30 offen lds
s_add_u32 m0, s34, 5120
s_mov_b32 s30, 1562112
buffer_load_dwordx4 v16, s[12:15], s30 offen lds
s_add_u32 m0, s34, 6144
s_mov_b32 s30, 1575936
buffer_load_dwordx4 v16, s[12:15], s30 offen lds
s_add_u32 m0, s34, 7168
s_mov_b32 s30, 1589760
buffer_load_dwordx4 v16, s[12:15], s30 offen lds
ds_read2st64_b32 v[24:25], v18 offset0:32 offset1:33
ds_read2st64_b32 v[26:27], v18 offset0:34 offset1:35
ds_read2st64_b32 v[28:29], v18 offset0:36 offset1:37
ds_read2st64_b32 v[30:31], v18 offset0:38 offset1:39
ds_read2st64_b32 v[32:33], v18 offset0:80 offset1:81
ds_read2st64_b32 v[34:35], v18 offset0:82 offset1:83
ds_read2st64_b32 v[36:37], v18 offset0:84 offset1:85
ds_read2st64_b32 v[38:39], v18 offset0:86 offset1:87
s_waitcnt lgkmcnt(4)
v_perm_b32 v40, v25, v24, v19
v_perm_b32 v41, v27, v26, v19
v_perm_b32 v42, v29, v28, v19
v_perm_b32 v43, v31, v30, v19
ds_read2st64_b32 v[24:25], v18 offset0:128 offset1:129
ds_read2st64_b32 v[26:27], v18 offset0:130 offset1:131
ds_read2st64_b32 v[28:29], v18 offset0:132 offset1:133
ds_read2st64_b32 v[30:31], v18 offset0:134 offset1:135
v_accvgpr_write_b32 a80, v40
v_accvgpr_write_b32 a81, v41
v_accvgpr_write_b32 a82, v42
v_accvgpr_write_b32 a83, v43
s_waitcnt lgkmcnt(4)
v_perm_b32 v40, v33, v32, v19
v_perm_b32 v41, v35, v34, v19
v_perm_b32 v42, v37, v36, v19
v_perm_b32 v43, v39, v38, v19
ds_read2st64_b32 v[32:33], v18 offset0:176 offset1:177
ds_read2st64_b32 v[34:35], v18 offset0:178 offset1:179
ds_read2st64_b32 v[36:37], v18 offset0:180 offset1:181
ds_read2st64_b32 v[38:39], v18 offset0:182 offset1:183
v_accvgpr_write_b32 a84, v40
v_accvgpr_write_b32 a85, v41
v_accvgpr_write_b32 a86, v42
v_accvgpr_write_b32 a87, v43
s_waitcnt lgkmcnt(4)
v_perm_b32 v40, v25, v24, v19
v_perm_b32 v41, v27, v26, v19
v_perm_b32 v42, v29, v28, v19
v_perm_b32 v43, v31, v30, v19
v_accvgpr_write_b32 a88, v40
v_accvgpr_write_b32 a89, v41
v_accvgpr_write_b32 a90, v42
v_accvgpr_write_b32 a91, v43
s_waitcnt lgkmcnt(0)
v_perm_b32 v40, v33, v32, v19
v_perm_b32 v41, v35, v34, v19
v_perm_b32 v42, v37, v36, v19
v_perm_b32 v43, v39, v38, v19
v_accvgpr_write_b32 a92, v40
v_accvgpr_write_b32 a93, v41
v_accvgpr_write_b32 a94, v42
v_accvgpr_write_b32 a95, v43
s_waitcnt vmcnt(4)
s_barrier
s_add_u32 m0, s34, 8192
s_mov_b32 s30, 1769472
buffer_load_dwordx4 v16, s[12:15], s30 offen lds
s_add_u32 m0, s34, 9216
s_mov_b32 s30, 1783296
buffer_load_dwordx4 v16, s[12:15], s30 offen lds
s_add_u32 m0, s34, 10240
s_mov_b32 s30, 1797120
buffer_load_dwordx4 v16, s[12:15], s30 offen lds
s_add_u32 m0, s34, 11264
s_mov_b32 s30, 1810944
buffer_load_dwordx4 v16, s[12:15], s30 offen lds
ds_read2st64_b32 v[24:25], v18 offset0:0 offset1:1
ds_read2st64_b32 v[26:27], v18 offset0:2 offset1:3
ds_read2st64_b32 v[28:29], v18 offset0:4 offset1:5
ds_read2st64_b32 v[30:31], v18 offset0:6 offset1:7
ds_read2st64_b32 v[32:33], v18 offset0:48 offset1:49
ds_read2st64_b32 v[34:35], v18 offset0:50 offset1:51
ds_read2st64_b32 v[36:37], v18 offset0:52 offset1:53
ds_read2st64_b32 v[38:39], v18 offset0:54 offset1:55
s_waitcnt lgkmcnt(4)
v_perm_b32 v40, v25, v24, v19
v_perm_b32 v41, v27, v26, v19
v_perm_b32 v42, v29, v28, v19
v_perm_b32 v43, v31, v30, v19
ds_read2st64_b32 v[24:25], v18 offset0:96 offset1:97
ds_read2st64_b32 v[26:27], v18 offset0:98 offset1:99
ds_read2st64_b32 v[28:29], v18 offset0:100 offset1:101
ds_read2st64_b32 v[30:31], v18 offset0:102 offset1:103
v_accvgpr_write_b32 a96, v40
v_accvgpr_write_b32 a97, v41
v_accvgpr_write_b32 a98, v42
v_accvgpr_write_b32 a99, v43
s_waitcnt lgkmcnt(4)
v_perm_b32 v40, v33, v32, v19
v_perm_b32 v41, v35, v34, v19
v_perm_b32 v42, v37, v36, v19
v_perm_b32 v43, v39, v38, v19
ds_read2st64_b32 v[32:33], v18 offset0:144 offset1:145
ds_read2st64_b32 v[34:35], v18 offset0:146 offset1:147
ds_read2st64_b32 v[36:37], v18 offset0:148 offset1:149
ds_read2st64_b32 v[38:39], v18 offset0:150 offset1:151
v_accvgpr_write_b32 a100, v40
v_accvgpr_write_b32 a101, v41
v_accvgpr_write_b32 a102, v42
v_accvgpr_write_b32 a103, v43
s_waitcnt lgkmcnt(4)
v_perm_b32 v40, v25, v24, v19
v_perm_b32 v41, v27, v26, v19
v_perm_b32 v42, v29, v28, v19
v_perm_b32 v43, v31, v30, v19
v_accvgpr_write_b32 a104, v40
v_accvgpr_write_b32 a105, v41
v_accvgpr_write_b32 a106, v42
v_accvgpr_write_b32 a107, v43
s_waitcnt lgkmcnt(0)
v_perm_b32 v40, v33, v32, v19
v_perm_b32 v41, v35, v34, v19
v_perm_b32 v42, v37, v36, v19
v_perm_b32 v43, v39, v38, v19
v_accvgpr_write_b32 a108, v40
v_accvgpr_write_b32 a109, v41
v_accvgpr_write_b32 a110, v42
v_accvgpr_write_b32 a111, v43
s_waitcnt vmcnt(4)
s_barrier
s_add_u32 m0, s34, 0
s_mov_b32 s30, 1990656
buffer_load_dwordx4 v16, s[12:15], s30 offen lds
s_add_u32 m0, s34, 1024
s_mov_b32 s30, 2004480
buffer_load_dwordx4 v16, s[12:15], s30 offen lds
s_add_u32 m0, s34, 2048
s_mov_b32 s30, 2018304
buffer_load_dwordx4 v16, s[12:15], s30 offen lds
s_add_u32 m0, s34, 3072
s_mov_b32 s30, 2032128
buffer_load_dwordx4 v16, s[12:15], s30 offen lds
ds_read2st64_b32 v[24:25], v18 offset0:16 offset1:17
ds_read2st64_b32 v[26:27], v18 offset0:18 offset1:19
ds_read2st64_b32 v[28:29], v18 offset0:20 offset1:21
ds_read2st64_b32 v[30:31], v18 offset0:22 offset1:23
ds_read2st64_b32 v[32:33], v18 offset0:64 offset1:65
ds_read2st64_b32 v[34:35], v18 offset0:66 offset1:67
ds_read2st64_b32 v[36:37], v18 offset0:68 offset1:69
ds_read2st64_b32 v[38:39], v18 offset0:70 offset1:71
s_waitcnt lgkmcnt(4)
v_perm_b32 v40, v25, v24, v19
v_perm_b32 v41, v27, v26, v19
v_perm_b32 v42, v29, v28, v19
v_perm_b32 v43, v31, v30, v19
ds_read2st64_b32 v[24:25], v18 offset0:112 offset1:113
ds_read2st64_b32 v[26:27], v18 offset0:114 offset1:115
ds_read2st64_b32 v[28:29], v18 offset0:116 offset1:117
ds_read2st64_b32 v[30:31], v18 offset0:118 offset1:119
v_accvgpr_write_b32 a112, v40
v_accvgpr_write_b32 a113, v41
v_accvgpr_write_b32 a114, v42
v_accvgpr_write_b32 a115, v43
s_waitcnt lgkmcnt(4)
v_perm_b32 v40, v33, v32, v19
v_perm_b32 v41, v35, v34, v19
v_perm_b32 v42, v37, v36, v19
v_perm_b32 v43, v39, v38, v19
ds_read2st64_b32 v[32:33], v18 offset0:160 offset1:161
ds_read2st64_b32 v[34:35], v18 offset0:162 offset1:163
ds_read2st64_b32 v[36:37], v18 offset0:164 offset1:165
ds_read2st64_b32 v[38:39], v18 offset0:166 offset1:167
v_accvgpr_write_b32 a116, v40
v_accvgpr_write_b32 a117, v41
v_accvgpr_write_b32 a118, v42
v_accvgpr_write_b32 a119, v43
s_waitcnt lgkmcnt(4)
v_perm_b32 v40, v25, v24, v19
v_perm_b32 v41, v27, v26, v19
v_perm_b32 v42, v29, v28, v19
v_perm_b32 v43, v31, v30, v19
v_accvgpr_write_b32 a120, v40
v_accvgpr_write_b32 a121, v41
v_accvgpr_write_b32 a122, v42
v_accvgpr_write_b32 a123, v43
s_waitcnt lgkmcnt(0)
v_perm_b32 v40, v33, v32, v19
v_perm_b32 v41, v35, v34, v19
v_perm_b32 v42, v37, v36, v19
v_perm_b32 v43, v39, v38, v19
v_accvgpr_write_b32 a124, v40
v_accvgpr_write_b32 a125, v41
v_accvgpr_write_b32 a126, v42
v_accvgpr_write_b32 a127, v43
s_waitcnt vmcnt(4)
s_barrier
ds_read2st64_b32 v[24:25], v18 offset0:32 offset1:33
ds_read2st64_b32 v[26:27], v18 offset0:34 offset1:35
ds_read2st64_b32 v[28:29], v18 offset0:36 offset1:37
ds_read2st64_b32 v[30:31], v18 offset0:38 offset1:39
ds_read2st64_b32 v[32:33], v18 offset0:80 offset1:81
ds_read2st64_b32 v[34:35], v18 offset0:82 offset1:83
ds_read2st64_b32 v[36:37], v18 offset0:84 offset1:85
ds_read2st64_b32 v[38:39], v18 offset0:86 offset1:87
s_waitcnt lgkmcnt(4)
v_perm_b32 v40, v25, v24, v19
v_perm_b32 v41, v27, v26, v19
v_perm_b32 v42, v29, v28, v19
v_perm_b32 v43, v31, v30, v19
ds_read2st64_b32 v[24:25], v18 offset0:128 offset1:129
ds_read2st64_b32 v[26:27], v18 offset0:130 offset1:131
ds_read2st64_b32 v[28:29], v18 offset0:132 offset1:133
ds_read2st64_b32 v[30:31], v18 offset0:134 offset1:135
v_accvgpr_write_b32 a128, v40
v_accvgpr_write_b32 a129, v41
v_accvgpr_write_b32 a130, v42
v_accvgpr_write_b32 a131, v43
s_waitcnt lgkmcnt(4)
v_perm_b32 v40, v33, v32, v19
v_perm_b32 v41, v35, v34, v19
v_perm_b32 v42, v37, v36, v19
v_perm_b32 v43, v39, v38, v19
ds_read2st64_b32 v[32:33], v18 offset0:176 offset1:177
ds_read2st64_b32 v[34:35], v18 offset0:178 offset1:179
ds_read2st64_b32 v[36:37], v18 offset0:180 offset1:181
ds_read2st64_b32 v[38:39], v18 offset0:182 offset1:183
v_accvgpr_write_b32 a132, v40
v_accvgpr_write_b32 a133, v41
v_accvgpr_write_b32 a134, v42
v_accvgpr_write_b32 a135, v43
s_waitcnt lgkmcnt(4)
v_perm_b32 v40, v25, v24, v19
v_perm_b32 v41, v27, v26, v19
v_perm_b32 v42, v29, v28, v19
v_perm_b32 v43, v31, v30, v19
v_accvgpr_write_b32 a136, v40
v_accvgpr_write_b32 a137, v41
v_accvgpr_write_b32 a138, v42
v_accvgpr_write_b32 a139, v43
s_waitcnt lgkmcnt(0)
v_perm_b32 v40, v33, v32, v19
v_perm_b32 v41, v35, v34, v19
v_perm_b32 v42, v37, v36, v19
v_perm_b32 v43, v39, v38, v19
v_accvgpr_write_b32 a140, v40
v_accvgpr_write_b32 a141, v41
v_accvgpr_write_b32 a142, v42
v_accvgpr_write_b32 a143, v43
s_waitcnt vmcnt(0)
s_barrier
ds_read2st64_b32 v[24:25], v18 offset0:0 offset1:1
ds_read2st64_b32 v[26:27], v18 offset0:2 offset1:3
ds_read2st64_b32 v[28:29], v18 offset0:4 offset1:5
ds_read2st64_b32 v[30:31], v18 offset0:6 offset1:7
ds_read2st64_b32 v[32:33], v18 offset0:48 offset1:49
ds_read2st64_b32 v[34:35], v18 offset0:50 offset1:51
ds_read2st64_b32 v[36:37], v18 offset0:52 offset1:53
ds_read2st64_b32 v[38:39], v18 offset0:54 offset1:55
s_waitcnt lgkmcnt(4)
v_perm_b32 v40, v25, v24, v19
v_perm_b32 v41, v27, v26, v19
v_perm_b32 v42, v29, v28, v19
v_perm_b32 v43, v31, v30, v19
ds_read2st64_b32 v[24:25], v18 offset0:96 offset1:97
ds_read2st64_b32 v[26:27], v18 offset0:98 offset1:99
ds_read2st64_b32 v[28:29], v18 offset0:100 offset1:101
ds_read2st64_b32 v[30:31], v18 offset0:102 offset1:103
v_accvgpr_write_b32 a144, v40
v_accvgpr_write_b32 a145, v41
v_accvgpr_write_b32 a146, v42
v_accvgpr_write_b32 a147, v43
s_waitcnt lgkmcnt(4)
v_perm_b32 v40, v33, v32, v19
v_perm_b32 v41, v35, v34, v19
v_perm_b32 v42, v37, v36, v19
v_perm_b32 v43, v39, v38, v19
ds_read2st64_b32 v[32:33], v18 offset0:144 offset1:145
ds_read2st64_b32 v[34:35], v18 offset0:146 offset1:147
ds_read2st64_b32 v[36:37], v18 offset0:148 offset1:149
ds_read2st64_b32 v[38:39], v18 offset0:150 offset1:151
v_accvgpr_write_b32 a148, v40
v_accvgpr_write_b32 a149, v41
v_accvgpr_write_b32 a150, v42
v_accvgpr_write_b32 a151, v43
s_waitcnt lgkmcnt(4)
v_perm_b32 v40, v25, v24, v19
v_perm_b32 v41, v27, v26, v19
v_perm_b32 v42, v29, v28, v19
v_perm_b32 v43, v31, v30, v19
v_accvgpr_write_b32 a152, v40
v_accvgpr_write_b32 a153, v41
v_accvgpr_write_b32 a154, v42
v_accvgpr_write_b32 a155, v43
s_waitcnt lgkmcnt(0)
v_perm_b32 v40, v33, v32, v19
v_perm_b32 v41, v35, v34, v19
v_perm_b32 v42, v37, v36, v19
v_perm_b32 v43, v39, v38, v19
v_accvgpr_write_b32 a156, v40
v_accvgpr_write_b32 a157, v41
v_accvgpr_write_b32 a158, v42
v_accvgpr_write_b32 a159, v43
s_waitcnt vmcnt(0) lgkmcnt(0)
s_barrier
s_mul_i32 s62, s70, 163840
v_and_b32 v16, 19, v1
v_bfe_u32 v17, v1, 2, 1
v_lshl_add_u32 v16, v17, 3, v16
v_bfe_u32 v17, v1, 3, 1
v_lshl_add_u32 v16, v17, 2, v16
v_and_b32 v17, 1, v16
v_mul_u32_u24 v17, 0x0202, v17
v_mul_u32_u24 v17, 0x10001, v17
v_add_u32 v17, 0x05040100, v17
v_lshrrev_b32 v16, 1, v16
v_lshlrev_b32 v16, 2, v16
v_lshrrev_b32 v40, 5, v1
v_mul_u32_u24 v40, 10240, v40
v_add_u32 v16, v16, v40
s_mul_i32 s30, s25, 320
v_add_u32 v16, s30, v16
v_lshlrev_b32 v18, 4, v1
s_mul_i32 s34, s25, 10240
s_add_u32 s35, s34, s62
s_add_u32 m0, s34, 0
s_add_u32 s30, s35, 0
buffer_load_dwordx4 v18, s[16:19], s30 offen offset:0 lds
buffer_load_dwordx4 v18, s[16:19], s30 offen offset:1024 lds
buffer_load_dwordx4 v18, s[16:19], s30 offen offset:2048 lds
buffer_load_dwordx4 v18, s[16:19], s30 offen offset:3072 lds
s_add_u32 m0, s34, 4096
s_add_u32 s30, s35, 4096
buffer_load_dwordx4 v18, s[16:19], s30 offen offset:0 lds
buffer_load_dwordx4 v18, s[16:19], s30 offen offset:1024 lds
buffer_load_dwordx4 v18, s[16:19], s30 offen offset:2048 lds
buffer_load_dwordx4 v18, s[16:19], s30 offen offset:3072 lds
s_add_u32 m0, s34, 8192
s_add_u32 s30, s35, 8192
buffer_load_dwordx4 v18, s[16:19], s30 offen offset:0 lds
buffer_load_dwordx4 v18, s[16:19], s30 offen offset:1024 lds
s_add_u32 m0, s34, 40960
s_add_u32 s30, s35, 40960
buffer_load_dwordx4 v18, s[16:19], s30 offen offset:0 lds
buffer_load_dwordx4 v18, s[16:19], s30 offen offset:1024 lds
buffer_load_dwordx4 v18, s[16:19], s30 offen offset:2048 lds
buffer_load_dwordx4 v18, s[16:19], s30 offen offset:3072 lds
s_add_u32 m0, s34, 45056
s_add_u32 s30, s35, 45056
buffer_load_dwordx4 v18, s[16:19], s30 offen offset:0 lds
buffer_load_dwordx4 v18, s[16:19], s30 offen offset:1024 lds
buffer_load_dwordx4 v18, s[16:19], s30 offen offset:2048 lds
buffer_load_dwordx4 v18, s[16:19], s30 offen offset:3072 lds
s_add_u32 m0, s34, 49152
s_add_u32 s30, s35, 49152
buffer_load_dwordx4 v18, s[16:19], s30 offen offset:0 lds
buffer_load_dwordx4 v18, s[16:19], s30 offen offset:1024 lds
s_waitcnt vmcnt(10)
s_barrier
s_add_u32 m0, s34, 81920
s_add_u32 s30, s35, 81920
buffer_load_dwordx4 v18, s[16:19], s30 offen offset:0 lds
buffer_load_dwordx4 v18, s[16:19], s30 offen offset:1024 lds
buffer_load_dwordx4 v18, s[16:19], s30 offen offset:2048 lds
buffer_load_dwordx4 v18, s[16:19], s30 offen offset:3072 lds
s_add_u32 m0, s34, 86016
s_add_u32 s30, s35, 86016
buffer_load_dwordx4 v18, s[16:19], s30 offen offset:0 lds
buffer_load_dwordx4 v18, s[16:19], s30 offen offset:1024 lds
buffer_load_dwordx4 v18, s[16:19], s30 offen offset:2048 lds
buffer_load_dwordx4 v18, s[16:19], s30 offen offset:3072 lds
s_add_u32 m0, s34, 90112
s_add_u32 s30, s35, 90112
buffer_load_dwordx4 v18, s[16:19], s30 offen offset:0 lds
buffer_load_dwordx4 v18, s[16:19], s30 offen offset:1024 lds
v_add_u32 v19, 0, v16
ds_read2st64_b32 v[24:25], v19 offset0:0 offset1:5
ds_read2st64_b32 v[26:27], v19 offset0:10 offset1:15
ds_read2st64_b32 v[28:29], v19 offset0:20 offset1:25
ds_read2st64_b32 v[30:31], v19 offset0:30 offset1:35
ds_read2st64_b32 v[32:33], v19 offset0:80 offset1:85
ds_read2st64_b32 v[34:35], v19 offset0:90 offset1:95
ds_read2st64_b32 v[36:37], v19 offset0:100 offset1:105
ds_read2st64_b32 v[38:39], v19 offset0:110 offset1:115
s_waitcnt lgkmcnt(4)
v_perm_b32 v40, v25, v24, v17
v_perm_b32 v41, v27, v26, v17
v_perm_b32 v42, v29, v28, v17
v_perm_b32 v43, v31, v30, v17
v_add_u32 v19, 64, v16
ds_read2st64_b32 v[24:25], v19 offset0:0 offset1:5
ds_read2st64_b32 v[26:27], v19 offset0:10 offset1:15
ds_read2st64_b32 v[28:29], v19 offset0:20 offset1:25
ds_read2st64_b32 v[30:31], v19 offset0:30 offset1:35
v_accvgpr_write_b32 a160, v40
v_accvgpr_write_b32 a161, v41
v_accvgpr_write_b32 a162, v42
v_accvgpr_write_b32 a163, v43
s_waitcnt lgkmcnt(4)
v_perm_b32 v40, v33, v32, v17
v_perm_b32 v41, v35, v34, v17
v_perm_b32 v42, v37, v36, v17
v_perm_b32 v43, v39, v38, v17
ds_read2st64_b32 v[32:33], v19 offset0:80 offset1:85
ds_read2st64_b32 v[34:35], v19 offset0:90 offset1:95
ds_read2st64_b32 v[36:37], v19 offset0:100 offset1:105
ds_read2st64_b32 v[38:39], v19 offset0:110 offset1:115
v_accvgpr_write_b32 a164, v40
v_accvgpr_write_b32 a165, v41
v_accvgpr_write_b32 a166, v42
v_accvgpr_write_b32 a167, v43
s_waitcnt lgkmcnt(4)
v_perm_b32 v40, v25, v24, v17
v_perm_b32 v41, v27, v26, v17
v_perm_b32 v42, v29, v28, v17
v_perm_b32 v43, v31, v30, v17
v_add_u32 v19, 128, v16
ds_read2st64_b32 v[24:25], v19 offset0:0 offset1:5
ds_read2st64_b32 v[26:27], v19 offset0:10 offset1:15
ds_read2st64_b32 v[28:29], v19 offset0:20 offset1:25
ds_read2st64_b32 v[30:31], v19 offset0:30 offset1:35
v_accvgpr_write_b32 a192, v40
v_accvgpr_write_b32 a193, v41
v_accvgpr_write_b32 a194, v42
v_accvgpr_write_b32 a195, v43
s_waitcnt lgkmcnt(4)
v_perm_b32 v40, v33, v32, v17
v_perm_b32 v41, v35, v34, v17
v_perm_b32 v42, v37, v36, v17
v_perm_b32 v43, v39, v38, v17
ds_read2st64_b32 v[32:33], v19 offset0:80 offset1:85
ds_read2st64_b32 v[34:35], v19 offset0:90 offset1:95
ds_read2st64_b32 v[36:37], v19 offset0:100 offset1:105
ds_read2st64_b32 v[38:39], v19 offset0:110 offset1:115
v_accvgpr_write_b32 a196, v40
v_accvgpr_write_b32 a197, v41
v_accvgpr_write_b32 a198, v42
v_accvgpr_write_b32 a199, v43
s_waitcnt lgkmcnt(4)
v_perm_b32 v40, v25, v24, v17
v_perm_b32 v41, v27, v26, v17
v_perm_b32 v42, v29, v28, v17
v_perm_b32 v43, v31, v30, v17
v_add_u32 v19, 192, v16
ds_read2st64_b32 v[24:25], v19 offset0:0 offset1:5
ds_read2st64_b32 v[26:27], v19 offset0:10 offset1:15
ds_read2st64_b32 v[28:29], v19 offset0:20 offset1:25
ds_read2st64_b32 v[30:31], v19 offset0:30 offset1:35
v_accvgpr_write_b32 a224, v40
v_accvgpr_write_b32 a225, v41
v_accvgpr_write_b32 a226, v42
v_accvgpr_write_b32 a227, v43
s_waitcnt lgkmcnt(4)
v_perm_b32 v40, v33, v32, v17
v_perm_b32 v41, v35, v34, v17
v_perm_b32 v42, v37, v36, v17
v_perm_b32 v43, v39, v38, v17
ds_read2st64_b32 v[32:33], v19 offset0:80 offset1:85
ds_read2st64_b32 v[34:35], v19 offset0:90 offset1:95
ds_read2st64_b32 v[36:37], v19 offset0:100 offset1:105
ds_read2st64_b32 v[38:39], v19 offset0:110 offset1:115
v_accvgpr_write_b32 a228, v40
v_accvgpr_write_b32 a229, v41
v_accvgpr_write_b32 a230, v42
v_accvgpr_write_b32 a231, v43
s_waitcnt lgkmcnt(4)
v_perm_b32 v192, v25, v24, v17
v_perm_b32 v193, v27, v26, v17
v_perm_b32 v194, v29, v28, v17
v_perm_b32 v195, v31, v30, v17
v_add_u32 v19, 256, v16
ds_read2st64_b32 v[24:25], v19 offset0:0 offset1:5
ds_read2st64_b32 v[26:27], v19 offset0:10 offset1:15
ds_read2st64_b32 v[28:29], v19 offset0:20 offset1:25
ds_read2st64_b32 v[30:31], v19 offset0:30 offset1:35
s_waitcnt lgkmcnt(4)
v_perm_b32 v196, v33, v32, v17
v_perm_b32 v197, v35, v34, v17
v_perm_b32 v198, v37, v36, v17
v_perm_b32 v199, v39, v38, v17
ds_read2st64_b32 v[32:33], v19 offset0:80 offset1:85
ds_read2st64_b32 v[34:35], v19 offset0:90 offset1:95
ds_read2st64_b32 v[36:37], v19 offset0:100 offset1:105
ds_read2st64_b32 v[38:39], v19 offset0:110 offset1:115
s_waitcnt lgkmcnt(4)
v_perm_b32 v224, v25, v24, v17
v_perm_b32 v225, v27, v26, v17
v_perm_b32 v226, v29, v28, v17
v_perm_b32 v227, v31, v30, v17
s_waitcnt lgkmcnt(0)
v_perm_b32 v228, v33, v32, v17
v_perm_b32 v229, v35, v34, v17
v_perm_b32 v230, v37, v36, v17
v_perm_b32 v231, v39, v38, v17
s_waitcnt vmcnt(10)
s_barrier
s_add_u32 m0, s34, 0
s_add_u32 s30, s35, 122880
buffer_load_dwordx4 v18, s[16:19], s30 offen offset:0 lds
buffer_load_dwordx4 v18, s[16:19], s30 offen offset:1024 lds
buffer_load_dwordx4 v18, s[16:19], s30 offen offset:2048 lds
buffer_load_dwordx4 v18, s[16:19], s30 offen offset:3072 lds
s_add_u32 m0, s34, 4096
s_add_u32 s30, s35, 126976
buffer_load_dwordx4 v18, s[16:19], s30 offen offset:0 lds
buffer_load_dwordx4 v18, s[16:19], s30 offen offset:1024 lds
buffer_load_dwordx4 v18, s[16:19], s30 offen offset:2048 lds
buffer_load_dwordx4 v18, s[16:19], s30 offen offset:3072 lds
s_add_u32 m0, s34, 8192
s_add_u32 s30, s35, 131072
buffer_load_dwordx4 v18, s[16:19], s30 offen offset:0 lds
buffer_load_dwordx4 v18, s[16:19], s30 offen offset:1024 lds
v_add_u32 v19, 40960, v16
ds_read2st64_b32 v[24:25], v19 offset0:0 offset1:5
ds_read2st64_b32 v[26:27], v19 offset0:10 offset1:15
ds_read2st64_b32 v[28:29], v19 offset0:20 offset1:25
ds_read2st64_b32 v[30:31], v19 offset0:30 offset1:35
ds_read2st64_b32 v[32:33], v19 offset0:80 offset1:85
ds_read2st64_b32 v[34:35], v19 offset0:90 offset1:95
ds_read2st64_b32 v[36:37], v19 offset0:100 offset1:105
ds_read2st64_b32 v[38:39], v19 offset0:110 offset1:115
s_waitcnt lgkmcnt(4)
v_perm_b32 v40, v25, v24, v17
v_perm_b32 v41, v27, v26, v17
v_perm_b32 v42, v29, v28, v17
v_perm_b32 v43, v31, v30, v17
v_add_u32 v19, 41024, v16
ds_read2st64_b32 v[24:25], v19 offset0:0 offset1:5
ds_read2st64_b32 v[26:27], v19 offset0:10 offset1:15
ds_read2st64_b32 v[28:29], v19 offset0:20 offset1:25
ds_read2st64_b32 v[30:31], v19 offset0:30 offset1:35
v_accvgpr_write_b32 a168, v40
v_accvgpr_write_b32 a169, v41
v_accvgpr_write_b32 a170, v42
v_accvgpr_write_b32 a171, v43
s_waitcnt lgkmcnt(4)
v_perm_b32 v40, v33, v32, v17
v_perm_b32 v41, v35, v34, v17
v_perm_b32 v42, v37, v36, v17
v_perm_b32 v43, v39, v38, v17
ds_read2st64_b32 v[32:33], v19 offset0:80 offset1:85
ds_read2st64_b32 v[34:35], v19 offset0:90 offset1:95
ds_read2st64_b32 v[36:37], v19 offset0:100 offset1:105
ds_read2st64_b32 v[38:39], v19 offset0:110 offset1:115
v_accvgpr_write_b32 a172, v40
v_accvgpr_write_b32 a173, v41
v_accvgpr_write_b32 a174, v42
v_accvgpr_write_b32 a175, v43
s_waitcnt lgkmcnt(4)
v_perm_b32 v40, v25, v24, v17
v_perm_b32 v41, v27, v26, v17
v_perm_b32 v42, v29, v28, v17
v_perm_b32 v43, v31, v30, v17
v_add_u32 v19, 41088, v16
ds_read2st64_b32 v[24:25], v19 offset0:0 offset1:5
ds_read2st64_b32 v[26:27], v19 offset0:10 offset1:15
ds_read2st64_b32 v[28:29], v19 offset0:20 offset1:25
ds_read2st64_b32 v[30:31], v19 offset0:30 offset1:35
v_accvgpr_write_b32 a200, v40
v_accvgpr_write_b32 a201, v41
v_accvgpr_write_b32 a202, v42
v_accvgpr_write_b32 a203, v43
s_waitcnt lgkmcnt(4)
v_perm_b32 v40, v33, v32, v17
v_perm_b32 v41, v35, v34, v17
v_perm_b32 v42, v37, v36, v17
v_perm_b32 v43, v39, v38, v17
ds_read2st64_b32 v[32:33], v19 offset0:80 offset1:85
ds_read2st64_b32 v[34:35], v19 offset0:90 offset1:95
ds_read2st64_b32 v[36:37], v19 offset0:100 offset1:105
ds_read2st64_b32 v[38:39], v19 offset0:110 offset1:115
v_accvgpr_write_b32 a204, v40
v_accvgpr_write_b32 a205, v41
v_accvgpr_write_b32 a206, v42
v_accvgpr_write_b32 a207, v43
s_waitcnt lgkmcnt(4)
v_perm_b32 v40, v25, v24, v17
v_perm_b32 v41, v27, v26, v17
v_perm_b32 v42, v29, v28, v17
v_perm_b32 v43, v31, v30, v17
v_add_u32 v19, 41152, v16
ds_read2st64_b32 v[24:25], v19 offset0:0 offset1:5
ds_read2st64_b32 v[26:27], v19 offset0:10 offset1:15
ds_read2st64_b32 v[28:29], v19 offset0:20 offset1:25
ds_read2st64_b32 v[30:31], v19 offset0:30 offset1:35
v_accvgpr_write_b32 a232, v40
v_accvgpr_write_b32 a233, v41
v_accvgpr_write_b32 a234, v42
v_accvgpr_write_b32 a235, v43
s_waitcnt lgkmcnt(4)
v_perm_b32 v40, v33, v32, v17
v_perm_b32 v41, v35, v34, v17
v_perm_b32 v42, v37, v36, v17
v_perm_b32 v43, v39, v38, v17
ds_read2st64_b32 v[32:33], v19 offset0:80 offset1:85
ds_read2st64_b32 v[34:35], v19 offset0:90 offset1:95
ds_read2st64_b32 v[36:37], v19 offset0:100 offset1:105
ds_read2st64_b32 v[38:39], v19 offset0:110 offset1:115
v_accvgpr_write_b32 a236, v40
v_accvgpr_write_b32 a237, v41
v_accvgpr_write_b32 a238, v42
v_accvgpr_write_b32 a239, v43
s_waitcnt lgkmcnt(4)
v_perm_b32 v200, v25, v24, v17
v_perm_b32 v201, v27, v26, v17
v_perm_b32 v202, v29, v28, v17
v_perm_b32 v203, v31, v30, v17
v_add_u32 v19, 41216, v16
ds_read2st64_b32 v[24:25], v19 offset0:0 offset1:5
ds_read2st64_b32 v[26:27], v19 offset0:10 offset1:15
ds_read2st64_b32 v[28:29], v19 offset0:20 offset1:25
ds_read2st64_b32 v[30:31], v19 offset0:30 offset1:35
s_waitcnt lgkmcnt(4)
v_perm_b32 v204, v33, v32, v17
v_perm_b32 v205, v35, v34, v17
v_perm_b32 v206, v37, v36, v17
v_perm_b32 v207, v39, v38, v17
ds_read2st64_b32 v[32:33], v19 offset0:80 offset1:85
ds_read2st64_b32 v[34:35], v19 offset0:90 offset1:95
ds_read2st64_b32 v[36:37], v19 offset0:100 offset1:105
ds_read2st64_b32 v[38:39], v19 offset0:110 offset1:115
s_waitcnt lgkmcnt(4)
v_perm_b32 v232, v25, v24, v17
v_perm_b32 v233, v27, v26, v17
v_perm_b32 v234, v29, v28, v17
v_perm_b32 v235, v31, v30, v17
s_waitcnt lgkmcnt(0)
v_perm_b32 v236, v33, v32, v17
v_perm_b32 v237, v35, v34, v17
v_perm_b32 v238, v37, v36, v17
v_perm_b32 v239, v39, v38, v17
s_waitcnt vmcnt(10)
s_barrier
v_add_u32 v19, 81920, v16
ds_read2st64_b32 v[24:25], v19 offset0:0 offset1:5
ds_read2st64_b32 v[26:27], v19 offset0:10 offset1:15
ds_read2st64_b32 v[28:29], v19 offset0:20 offset1:25
ds_read2st64_b32 v[30:31], v19 offset0:30 offset1:35
ds_read2st64_b32 v[32:33], v19 offset0:80 offset1:85
ds_read2st64_b32 v[34:35], v19 offset0:90 offset1:95
ds_read2st64_b32 v[36:37], v19 offset0:100 offset1:105
ds_read2st64_b32 v[38:39], v19 offset0:110 offset1:115
s_waitcnt lgkmcnt(4)
v_perm_b32 v40, v25, v24, v17
v_perm_b32 v41, v27, v26, v17
v_perm_b32 v42, v29, v28, v17
v_perm_b32 v43, v31, v30, v17
v_add_u32 v19, 81984, v16
ds_read2st64_b32 v[24:25], v19 offset0:0 offset1:5
ds_read2st64_b32 v[26:27], v19 offset0:10 offset1:15
ds_read2st64_b32 v[28:29], v19 offset0:20 offset1:25
ds_read2st64_b32 v[30:31], v19 offset0:30 offset1:35
v_accvgpr_write_b32 a176, v40
v_accvgpr_write_b32 a177, v41
v_accvgpr_write_b32 a178, v42
v_accvgpr_write_b32 a179, v43
s_waitcnt lgkmcnt(4)
v_perm_b32 v40, v33, v32, v17
v_perm_b32 v41, v35, v34, v17
v_perm_b32 v42, v37, v36, v17
v_perm_b32 v43, v39, v38, v17
ds_read2st64_b32 v[32:33], v19 offset0:80 offset1:85
ds_read2st64_b32 v[34:35], v19 offset0:90 offset1:95
ds_read2st64_b32 v[36:37], v19 offset0:100 offset1:105
ds_read2st64_b32 v[38:39], v19 offset0:110 offset1:115
v_accvgpr_write_b32 a180, v40
v_accvgpr_write_b32 a181, v41
v_accvgpr_write_b32 a182, v42
v_accvgpr_write_b32 a183, v43
s_waitcnt lgkmcnt(4)
v_perm_b32 v40, v25, v24, v17
v_perm_b32 v41, v27, v26, v17
v_perm_b32 v42, v29, v28, v17
v_perm_b32 v43, v31, v30, v17
v_add_u32 v19, 82048, v16
ds_read2st64_b32 v[24:25], v19 offset0:0 offset1:5
ds_read2st64_b32 v[26:27], v19 offset0:10 offset1:15
ds_read2st64_b32 v[28:29], v19 offset0:20 offset1:25
ds_read2st64_b32 v[30:31], v19 offset0:30 offset1:35
v_accvgpr_write_b32 a208, v40
v_accvgpr_write_b32 a209, v41
v_accvgpr_write_b32 a210, v42
v_accvgpr_write_b32 a211, v43
s_waitcnt lgkmcnt(4)
v_perm_b32 v40, v33, v32, v17
v_perm_b32 v41, v35, v34, v17
v_perm_b32 v42, v37, v36, v17
v_perm_b32 v43, v39, v38, v17
ds_read2st64_b32 v[32:33], v19 offset0:80 offset1:85
ds_read2st64_b32 v[34:35], v19 offset0:90 offset1:95
ds_read2st64_b32 v[36:37], v19 offset0:100 offset1:105
ds_read2st64_b32 v[38:39], v19 offset0:110 offset1:115
v_accvgpr_write_b32 a212, v40
v_accvgpr_write_b32 a213, v41
v_accvgpr_write_b32 a214, v42
v_accvgpr_write_b32 a215, v43
s_waitcnt lgkmcnt(4)
v_perm_b32 v40, v25, v24, v17
v_perm_b32 v41, v27, v26, v17
v_perm_b32 v42, v29, v28, v17
v_perm_b32 v43, v31, v30, v17
v_add_u32 v19, 82112, v16
ds_read2st64_b32 v[24:25], v19 offset0:0 offset1:5
ds_read2st64_b32 v[26:27], v19 offset0:10 offset1:15
ds_read2st64_b32 v[28:29], v19 offset0:20 offset1:25
ds_read2st64_b32 v[30:31], v19 offset0:30 offset1:35
v_accvgpr_write_b32 a240, v40
v_accvgpr_write_b32 a241, v41
v_accvgpr_write_b32 a242, v42
v_accvgpr_write_b32 a243, v43
s_waitcnt lgkmcnt(4)
v_perm_b32 v40, v33, v32, v17
v_perm_b32 v41, v35, v34, v17
v_perm_b32 v42, v37, v36, v17
v_perm_b32 v43, v39, v38, v17
ds_read2st64_b32 v[32:33], v19 offset0:80 offset1:85
ds_read2st64_b32 v[34:35], v19 offset0:90 offset1:95
ds_read2st64_b32 v[36:37], v19 offset0:100 offset1:105
ds_read2st64_b32 v[38:39], v19 offset0:110 offset1:115
v_accvgpr_write_b32 a244, v40
v_accvgpr_write_b32 a245, v41
v_accvgpr_write_b32 a246, v42
v_accvgpr_write_b32 a247, v43
s_waitcnt lgkmcnt(4)
v_perm_b32 v208, v25, v24, v17
v_perm_b32 v209, v27, v26, v17
v_perm_b32 v210, v29, v28, v17
v_perm_b32 v211, v31, v30, v17
v_add_u32 v19, 82176, v16
ds_read2st64_b32 v[24:25], v19 offset0:0 offset1:5
ds_read2st64_b32 v[26:27], v19 offset0:10 offset1:15
ds_read2st64_b32 v[28:29], v19 offset0:20 offset1:25
ds_read2st64_b32 v[30:31], v19 offset0:30 offset1:35
s_waitcnt lgkmcnt(4)
v_perm_b32 v212, v33, v32, v17
v_perm_b32 v213, v35, v34, v17
v_perm_b32 v214, v37, v36, v17
v_perm_b32 v215, v39, v38, v17
ds_read2st64_b32 v[32:33], v19 offset0:80 offset1:85
ds_read2st64_b32 v[34:35], v19 offset0:90 offset1:95
ds_read2st64_b32 v[36:37], v19 offset0:100 offset1:105
ds_read2st64_b32 v[38:39], v19 offset0:110 offset1:115
s_waitcnt lgkmcnt(4)
v_perm_b32 v240, v25, v24, v17
v_perm_b32 v241, v27, v26, v17
v_perm_b32 v242, v29, v28, v17
v_perm_b32 v243, v31, v30, v17
s_waitcnt lgkmcnt(0)
v_perm_b32 v244, v33, v32, v17
v_perm_b32 v245, v35, v34, v17
v_perm_b32 v246, v37, v36, v17
v_perm_b32 v247, v39, v38, v17
s_waitcnt vmcnt(0)
s_barrier
v_add_u32 v19, 0, v16
ds_read2st64_b32 v[24:25], v19 offset0:0 offset1:5
ds_read2st64_b32 v[26:27], v19 offset0:10 offset1:15
ds_read2st64_b32 v[28:29], v19 offset0:20 offset1:25
ds_read2st64_b32 v[30:31], v19 offset0:30 offset1:35
ds_read2st64_b32 v[32:33], v19 offset0:80 offset1:85
ds_read2st64_b32 v[34:35], v19 offset0:90 offset1:95
ds_read2st64_b32 v[36:37], v19 offset0:100 offset1:105
ds_read2st64_b32 v[38:39], v19 offset0:110 offset1:115
s_waitcnt lgkmcnt(4)
v_perm_b32 v40, v25, v24, v17
v_perm_b32 v41, v27, v26, v17
v_perm_b32 v42, v29, v28, v17
v_perm_b32 v43, v31, v30, v17
v_add_u32 v19, 64, v16
ds_read2st64_b32 v[24:25], v19 offset0:0 offset1:5
ds_read2st64_b32 v[26:27], v19 offset0:10 offset1:15
ds_read2st64_b32 v[28:29], v19 offset0:20 offset1:25
ds_read2st64_b32 v[30:31], v19 offset0:30 offset1:35
v_accvgpr_write_b32 a184, v40
v_accvgpr_write_b32 a185, v41
v_accvgpr_write_b32 a186, v42
v_accvgpr_write_b32 a187, v43
s_waitcnt lgkmcnt(4)
v_perm_b32 v40, v33, v32, v17
v_perm_b32 v41, v35, v34, v17
v_perm_b32 v42, v37, v36, v17
v_perm_b32 v43, v39, v38, v17
ds_read2st64_b32 v[32:33], v19 offset0:80 offset1:85
ds_read2st64_b32 v[34:35], v19 offset0:90 offset1:95
ds_read2st64_b32 v[36:37], v19 offset0:100 offset1:105
ds_read2st64_b32 v[38:39], v19 offset0:110 offset1:115
v_accvgpr_write_b32 a188, v40
v_accvgpr_write_b32 a189, v41
v_accvgpr_write_b32 a190, v42
v_accvgpr_write_b32 a191, v43
s_waitcnt lgkmcnt(4)
v_perm_b32 v40, v25, v24, v17
v_perm_b32 v41, v27, v26, v17
v_perm_b32 v42, v29, v28, v17
v_perm_b32 v43, v31, v30, v17
v_add_u32 v19, 128, v16
ds_read2st64_b32 v[24:25], v19 offset0:0 offset1:5
ds_read2st64_b32 v[26:27], v19 offset0:10 offset1:15
ds_read2st64_b32 v[28:29], v19 offset0:20 offset1:25
ds_read2st64_b32 v[30:31], v19 offset0:30 offset1:35
v_accvgpr_write_b32 a216, v40
v_accvgpr_write_b32 a217, v41
v_accvgpr_write_b32 a218, v42
v_accvgpr_write_b32 a219, v43
s_waitcnt lgkmcnt(4)
v_perm_b32 v40, v33, v32, v17
v_perm_b32 v41, v35, v34, v17
v_perm_b32 v42, v37, v36, v17
v_perm_b32 v43, v39, v38, v17
ds_read2st64_b32 v[32:33], v19 offset0:80 offset1:85
ds_read2st64_b32 v[34:35], v19 offset0:90 offset1:95
ds_read2st64_b32 v[36:37], v19 offset0:100 offset1:105
ds_read2st64_b32 v[38:39], v19 offset0:110 offset1:115
v_accvgpr_write_b32 a220, v40
v_accvgpr_write_b32 a221, v41
v_accvgpr_write_b32 a222, v42
v_accvgpr_write_b32 a223, v43
s_waitcnt lgkmcnt(4)
v_perm_b32 v40, v25, v24, v17
v_perm_b32 v41, v27, v26, v17
v_perm_b32 v42, v29, v28, v17
v_perm_b32 v43, v31, v30, v17
v_add_u32 v19, 192, v16
ds_read2st64_b32 v[24:25], v19 offset0:0 offset1:5
ds_read2st64_b32 v[26:27], v19 offset0:10 offset1:15
ds_read2st64_b32 v[28:29], v19 offset0:20 offset1:25
ds_read2st64_b32 v[30:31], v19 offset0:30 offset1:35
v_accvgpr_write_b32 a248, v40
v_accvgpr_write_b32 a249, v41
v_accvgpr_write_b32 a250, v42
v_accvgpr_write_b32 a251, v43
s_waitcnt lgkmcnt(4)
v_perm_b32 v40, v33, v32, v17
v_perm_b32 v41, v35, v34, v17
v_perm_b32 v42, v37, v36, v17
v_perm_b32 v43, v39, v38, v17
ds_read2st64_b32 v[32:33], v19 offset0:80 offset1:85
ds_read2st64_b32 v[34:35], v19 offset0:90 offset1:95
ds_read2st64_b32 v[36:37], v19 offset0:100 offset1:105
ds_read2st64_b32 v[38:39], v19 offset0:110 offset1:115
v_accvgpr_write_b32 a252, v40
v_accvgpr_write_b32 a253, v41
v_accvgpr_write_b32 a254, v42
v_accvgpr_write_b32 a255, v43
s_waitcnt lgkmcnt(4)
v_perm_b32 v216, v25, v24, v17
v_perm_b32 v217, v27, v26, v17
v_perm_b32 v218, v29, v28, v17
v_perm_b32 v219, v31, v30, v17
v_add_u32 v19, 256, v16
ds_read2st64_b32 v[24:25], v19 offset0:0 offset1:5
ds_read2st64_b32 v[26:27], v19 offset0:10 offset1:15
ds_read2st64_b32 v[28:29], v19 offset0:20 offset1:25
ds_read2st64_b32 v[30:31], v19 offset0:30 offset1:35
s_waitcnt lgkmcnt(4)
v_perm_b32 v220, v33, v32, v17
v_perm_b32 v221, v35, v34, v17
v_perm_b32 v222, v37, v36, v17
v_perm_b32 v223, v39, v38, v17
ds_read2st64_b32 v[32:33], v19 offset0:80 offset1:85
ds_read2st64_b32 v[34:35], v19 offset0:90 offset1:95
ds_read2st64_b32 v[36:37], v19 offset0:100 offset1:105
ds_read2st64_b32 v[38:39], v19 offset0:110 offset1:115
s_waitcnt lgkmcnt(4)
v_perm_b32 v248, v25, v24, v17
v_perm_b32 v249, v27, v26, v17
v_perm_b32 v250, v29, v28, v17
v_perm_b32 v251, v31, v30, v17
s_waitcnt lgkmcnt(0)
v_perm_b32 v252, v33, v32, v17
v_perm_b32 v253, v35, v34, v17
v_perm_b32 v254, v37, v36, v17
v_perm_b32 v255, v39, v38, v17
s_waitcnt vmcnt(0) lgkmcnt(0)
s_barrier
f43:
s_mov_b32 s28, 0
s_mov_b32 s30, 0x80808080
v_and_b32 v12, 63, v0
v_lshlrev_b32 v12, 2, v12
sy46:
buffer_load_dword v13, v12, s[8:11], 0 offen sc1
s_waitcnt vmcnt(0)
sy49:
v_and_b32 v14, s30, v13
v_cmp_ne_u32 vcc, s30, v14
s_cbranch_vccz sy47
s_sleep 2
s_add_u32 s28, s28, 1
s_cmp_lt_u32 s28, 524288
s_cbranch_scc1 sy46
s_mov_b32 s29, 1
s_branch L_abort
sy47:
s_cmp_lg_u32 s26, 0
s_cbranch_scc1 sy48
v_mov_b32 v15, 0
v_bfe_u32 v14, v13, 0, 3
v_lshlrev_b32 v14, v14, 1
v_or_b32 v15, v15, v14
v_bfe_u32 v14, v13, 8, 3
v_lshlrev_b32 v14, v14, 1
v_or_b32 v15, v15, v14
v_bfe_u32 v14, v13, 16, 3
v_lshlrev_b32 v14, v14, 1
v_or_b32 v15, v15, v14
v_bfe_u32 v14, v13, 24, 3
v_lshlrev_b32 v14, v14, 1
v_or_b32 v15, v15, v14
s_nop 1
v_mov_b32 v14, v15 quad_perm:[1,0,3,2] row_mask:0xf bank_mask:0xf
v_or_b32 v15, v15, v14
v_cmp_ne_u32 vcc, 0xff, v15
s_cbranch_vccnz L_rank
s_mov_b32 s26, 1
sy48:
s_mul_i32 s33, s25, 10752
s_add_u32 s33, s33, 65536
v_lshrrev_b32 v10, 3, v1
v_and_b32 v11, 7, v1
v_mul_u32_u24 v100, 336, v10
v_lshl_add_u32 v100, v11, 4, v100
v_add_u32 v100, s33, v100
v_mul_u32_u24 v102, 20480, v10
v_lshl_add_u32 v102, v11, 4, v102
v_lshrrev_b32 v10, 2, v1
v_and_b32 v11, 3, v1
v_mul_u32_u24 v101, 336, v10
v_lshl_add_u32 v101, v11, 4, v101
v_add_u32 v101, s33, v101
v_mul_u32_u24 v103, 20480, v10
v_lshl_add_u32 v103, v11, 4, v103
v_lshrrev_b32 v10, 4, v1
v_and_b32 v11, 15, v1
v_and_b32 v6, 31, v1
v_mul_u32_u24 v104, 336, v6
v_lshrrev_b32 v6, 5, v1
v_lshl_add_u32 v104, v6, 4, v104
v_add_u32 v104, s33, v104
v_mul_u32_u24 v105, 1280, v10
v_lshl_add_u32 v105, v11, 4, v105
v_mov_b32 v106, v105
v_mov_b32 v6, 0x40000000
s_and_b32 s33, s25, 1
s_lshl_b32 s33, s33, 3
v_add_u32 v7, s33, v10
v_cmp_gt_u32 vcc, 14, v7
s_nop 1
v_cndmask_b32 v105, v6, v105, vcc
v_add_u32 v7, 4, v7
v_cmp_gt_u32 vcc, 14, v7
s_nop 1
v_cndmask_b32 v106, v6, v106, vcc
v_lshrrev_b32 v7, 5, v1
v_and_b32 v10, 1, v10
v_lshlrev_b32 v107, 8, v7
v_lshl_add_u32 v107, v11, 4, v107
v_lshl_add_u32 v107, v10, 3, v107
v_cmp_gt_u32 vcc, 32, v1
s_nop 1
v_cndmask_b32 v108, v6, v107, vcc
s_bitcmp1_b32 s25, 0
s_cselect_b32 s33, 0, 0x40000000
v_or_b32 v107, s33, v107
v_or_b32 v108, s33, v108
s_lshr_b32 s33, s25, 1
s_mul_i32 s34, s33, 3072
s_add_u32 s34, s34, 49152
v_add_u32 v109, s34, v2
s_lshl_b32 s72, s70, 1
s_add_u32 s72, s72, s33
s_lshl_b32 s74, s71, 8
s_add_u32 s74, s74, 8192
s_lshl_b32 s75, s70, 4
s_lshl_b32 s33, s25, 2
s_add_u32 s75, s75, s33
s_add_u32 s75, s75, s74
s_mul_i32 s76, s71, 1310720
s_add_u32 s76, s76, 35651584
s_add_u32 s77, s76, 655360
s_mul_i32 s78, s70, 1280
s_mul_i32 s33, s25, 320
s_add_u32 s78, s78, s33
s_mul_i32 s79, s72, 20480
s_and_b32 s33, s25, 1
s_mul_i32 s33, s33, 10240
s_add_u32 s79, s79, s33
s_mov_b32 s101, 0x3acccccd
s_mov_b32 s84, 0x30003
s_mov_b32 s85, 0x30003
s_mov_b32 s86, 0xc000c
s_mov_b32 s87, 0xc000c
s_mov_b32 s88, 0x300030
s_mov_b32 s89, 0x300030
s_mov_b32 s90, 0xc000c0
s_mov_b32 s91, 0xc000c0
v_and_b32 v10, 16, v2
v_mov_b32 v112, 0x3f80
v_lshlrev_b32 v10, v10, v112
v_cndmask_b32 v112, 0, v10, s[84:85]
v_cndmask_b32 v113, 0, v10, s[86:87]
v_cndmask_b32 v114, 0, v10, s[88:89]
v_cndmask_b32 v115, 0, v10, s[90:91]
s_mov_b32 s84, 0x3000300
s_mov_b32 s85, 0x3000300
s_mov_b32 s86, 0xc000c00
s_mov_b32 s87, 0xc000c00
s_mov_b32 s88, 0x30003000
s_mov_b32 s89, 0x30003000
s_mov_b32 s90, 0xc000c000
s_mov_b32 s91, 0xc000c000
v_and_b32 v10, 16, v2
v_mov_b32 v116, 0x3f80
v_lshlrev_b32 v10, v10, v116
v_cndmask_b32 v116, 0, v10, s[84:85]
v_cndmask_b32 v117, 0, v10, s[86:87]
v_cndmask_b32 v118, 0, v10, s[88:89]
v_cndmask_b32 v119, 0, v10, s[90:91]
v_bfe_u32 v10, v1, 4, 1
v_lshrrev_b32 v11, 5, v1
v_lshl_add_u32 v10, v10, 1, v11
v_and_b32 v11, 15, v1
v_lshlrev_b32 v97, 4, v11
v_lshl_add_u32 v96, v10, 8, v97
v_add_u32 v97, 1024, v97
s_bfe_u32 s33, s72, 0x30001
v_and_b32 v11, 7, v1
v_xor_b32 v11, s33, v11
v_lshlrev_b32 v111, 4, v11
v_bfe_u32 v11, v1, 3, 1
v_lshl_add_u32 v111, v11, 10, v111
v_lshl_add_u32 v110, v10, 11, v111
v_add_u32 v111, 8192, v111
v_mov_b32 v10, 0x40000000
v_cmp_gt_u32 vcc, 16, v1
s_nop 1
v_cndmask_b32 v97, v10, v97, vcc
v_cndmask_b32 v111, v10, v111, vcc
s_lshr_b32 s73, s72, 3
s_mul_i32 s73, s73, 10240
s_and_b32 s33, s72, 7
s_lshl_b32 s33, s33, 7
s_add_u32 s73, s73, s33
s_mov_b64 s[86:87], s[60:61]
s_mov_b32 s88, 1
s_mov_b32 s54, 0xaaaaa000
s_mov_b32 s55, 0xaaaaaaaa
s_mov_b32 s56, 0xaaaaaaaa
s_mov_b32 s57, 0xfffaaaaa
s_lshl_b32 s69, s27, 5
s_add_u32 s69, s69, s24
s_lshl_b32 s69, s69, 2
s_add_u32 s69, s69, s25
s_lshl_b32 s69, s69, 13
s_add_u32 s69, s69, 209715200
s_sub_u32 s62, s71, 3
v_bfe_u32 v10, v1, 1, 3
v_lshrrev_b32 v11, 5, v1
v_xor_b32 v10, v10, v11
v_lshlrev_b32 v20, 4, v10
v_and_b32 v10, 7, v1
v_lshl_add_u32 v20, v10, 7, v20
v_bfe_u32 v10, v1, 3, 2
v_mul_u32_u24 v10, 10240, v10
v_add_u32 v20, v20, v10
v_xor_b32 v21, 32, v20
v_xor_b32 v22, 64, v20
v_xor_b32 v23, 96, v20
v_and_b32 v0, 31, v1
v_lshlrev_b32 v0, 7, v0
v_bfe_u32 v10, v1, 4, 1
v_mul_u32_u24 v19, 4096, v10
v_lshrrev_b32 v10, 5, v1
v_lshl_add_u32 v19, v10, 8, v19
v_and_b32 v10, 15, v1
v_lshl_add_u32 v19, v10, 4, v19
s_mov_b32 s80, 0xbfb8aa3b
s_mov_b32 s81, s80
s_mov_b32 s65, 0
s_lshl_b32 s33, s25, 11
v_add_u32 v16, s33, v2
s_lshl_b32 s33, s25, 2
s_add_u32 s33, s33, 57344
v_mov_b32 v18, s33
v_mov_b32 v17, 57344
s_cmp_lt_u32 s62, 64
s_cselect_b64 s[60:61], s[54:55], s[56:57]
s_cselect_b32 s33, 0, 26
s_bfm_b64 s[34:35], s62, 0
s_and_b64 s[34:35], s[34:35], s[60:61]
s_bcnt1_i32_b64 s34, s[34:35]
s_add_u32 s33, s33, s34
s_sub_u32 s34, s62, s33
s_add_u32 s33, s33, 64
s_bitcmp1_b64 s[60:61], s62
s_cselect_b32 s14, s33, s34
s_cmp_ge_u32 s62, 128
s_cselect_b32 s14, s62, s14
s_lshl_b32 s84, s27, 5
s_add_u32 s84, s84, s24
s_lshl_b32 s84, s84, 2
s_add_u32 s84, s84, s25
s_lshl_b32 s84, s84, 2
s_add_u32 s84, s84, 49152
v_mov_b32 v11, 1
ds_write_b32 v18, v11
ds_write_b32 v18, v11 offset:16
s_mov_b32 s66, 0
s_cmp_lt_u32 s70, 14
s_cbranch_scc1 L_Fblock
L_Frtop:
s_mov_b32 s63, s14
s_add_u32 s65, s65, 1
v_mov_b32 v10, s65
s_cmp_eq_u32 s26, 1
s_cbranch_scc0 pb50
buffer_store_dword v10, off, s[4:7], s75
pb51:
s_mov_b32 s28, 0
p53:
buffer_load_dword v10, v8, s[4:7], s74 offen sc1
s_waitcnt vmcnt(0)
v_cmp_gt_u32 vcc, s65, v10
s_nop 0
s_cmp_eq_u64 vcc, 0
s_cbranch_scc1 p54
s_add_u32 s28, s28, 1
s_cmp_lt_u32 s28, 524288
s_cbranch_scc1 p53
s_mov_b32 s29, 33
s_branch L_abort
p54:
g52:
s_cmp_eq_u32 s26, 1
s_cbranch_scc0 gq55
gq56:
s_and_b32 s30, s65, 3
s_lshl_b32 s31, s27, 3
s_add_u32 s30, s30, s31
s_lshl_b32 s30, s30, 5
s_add_u32 s30, s30, s72
s_mul_i32 s30, s30, 1280
s_add_u32 s30, s30, 15728640
buffer_load_dwordx2 v[184:185], v107, s[4:7], s30 offen offset:0 sc1
buffer_load_dwordx2 v[186:187], v107, s[4:7], s30 offen offset:512 sc1
buffer_load_dwordx2 v[188:189], v108, s[4:7], s30 offen offset:1024 sc1
s_and_b32 s17, s63, 63
s_cmp_ge_u32 s63, 128
s_cselect_b32 s17, 64, s17
s_lshl_b32 s16, s17, 5
s_add_u32 s16, s16, s72
s_lshl_b32 s82, s17, 7
s_add_u32 s82, s82, 1056768
s_cmp_ge_u32 s63, 128
s_cselect_b32 s82, s84, s82
s_mul_i32 s16, s16, 1280
s_add_u32 s15, s16, 22020096
s_mul_i32 s17, s17, 40960
s_add_u32 s17, s17, 5767168
s_mov_b32 s45, s63
s_bfe_u32 s13, s63, 0x10006
s_add_u32 s30, s79, s76
s_add_u32 s31, s30, 5120
buffer_load_dwordx4 v[120:123], v105, s[4:7], s30 offen offset:0 sc1
buffer_load_dwordx4 v[124:127], v105, s[4:7], s30 offen offset:256 sc1
buffer_load_dwordx4 v[128:131], v105, s[4:7], s30 offen offset:512 sc1
buffer_load_dwordx4 v[132:135], v105, s[4:7], s30 offen offset:768 sc1
buffer_load_dwordx4 v[136:139], v105, s[4:7], s30 offen offset:1024 sc1
buffer_load_dwordx4 v[140:143], v106, s[4:7], s31 offen offset:0 sc1
buffer_load_dwordx4 v[144:147], v106, s[4:7], s31 offen offset:256 sc1
buffer_load_dwordx4 v[148:151], v106, s[4:7], s31 offen offset:512 sc1
buffer_load_dwordx4 v[152:155], v106, s[4:7], s31 offen offset:768 sc1
buffer_load_dwordx4 v[156:159], v106, s[4:7], s31 offen offset:1024 sc1
s_waitcnt vmcnt(10)
v_lshlrev_b32 v172, 16, v184
v_and_b32 v173, 0xffff0000, v184
v_lshlrev_b32 v174, 16, v185
v_and_b32 v175, 0xffff0000, v185
v_lshlrev_b32 v176, 16, v186
v_and_b32 v177, 0xffff0000, v186
v_lshlrev_b32 v178, 16, v187
v_and_b32 v179, 0xffff0000, v187
v_lshlrev_b32 v180, 16, v188
v_and_b32 v181, 0xffff0000, v188
v_lshlrev_b32 v182, 16, v189
v_and_b32 v183, 0xffff0000, v189
s_waitcnt vmcnt(9)
v_mfma_f32_16x16x32_bf16 v[172:175], v[112:115], v[120:123], v[172:175]
s_waitcnt vmcnt(8)
v_mfma_f32_16x16x32_bf16 v[172:175], v[116:119], v[124:127], v[172:175]
s_waitcnt vmcnt(7)
v_mfma_f32_16x16x32_bf16 v[176:179], v[112:115], v[128:131], v[176:179]
s_waitcnt vmcnt(6)
v_mfma_f32_16x16x32_bf16 v[176:179], v[116:119], v[132:135], v[176:179]
s_waitcnt vmcnt(5)
v_mfma_f32_16x16x32_bf16 v[180:183], v[112:115], v[136:139], v[180:183]
s_waitcnt vmcnt(4)
v_mfma_f32_16x16x32_bf16 v[172:175], v[112:115], v[140:143], v[172:175]
s_waitcnt vmcnt(3)
v_mfma_f32_16x16x32_bf16 v[172:175], v[116:119], v[144:147], v[172:175]
s_waitcnt vmcnt(2)
v_mfma_f32_16x16x32_bf16 v[176:179], v[112:115], v[148:151], v[176:179]
s_waitcnt vmcnt(1)
v_mfma_f32_16x16x32_bf16 v[176:179], v[116:119], v[152:155], v[176:179]
s_waitcnt vmcnt(0)
v_mfma_f32_16x16x32_bf16 v[180:183], v[112:115], v[156:159], v[180:183]
v_mov_b32 v10, s65
s_cmp_eq_u32 s26, 1
s_cbranch_scc0 cs57
buffer_store_dword v10, off, s[4:7], s75 offset:2048
cs58:
s_bitcmp1_b32 s25, 0
s_cbranch_scc0 d59
ds_write_b128 v109, v[172:175] offset:0
ds_write_b128 v109, v[176:179] offset:1024
ds_write_b128 v109, v[180:183] offset:2048
d59:
s_waitcnt lgkmcnt(0)
s_barrier
s_bitcmp1_b32 s25, 0
s_cbranch_scc1 f60
s_cmp_eq_u32 s13, 1
s_cbranch_scc1 f61
ds_read_b128 v[160:163], v109 offset:0
ds_read_b128 v[164:167], v109 offset:1024
ds_read_b128 v[168:171], v109 offset:2048
s_waitcnt lgkmcnt(2)
v_pk_add_f32 v[172:173], v[172:173], v[160:161]
v_pk_add_f32 v[174:175], v[174:175], v[162:163]
s_waitcnt lgkmcnt(1)
v_pk_add_f32 v[176:177], v[176:177], v[164:165]
v_pk_add_f32 v[178:179], v[178:179], v[166:167]
s_waitcnt lgkmcnt(0)
v_pk_add_f32 v[180:181], v[180:181], v[168:169]
v_pk_add_f32 v[182:183], v[182:183], v[170:171]
v_cvt_pk_bf16_f32 v160, v172, v173
v_cvt_pk_bf16_f32 v161, v174, v175
v_cvt_pk_bf16_f32 v162, v176, v177
v_cvt_pk_bf16_f32 v163, v178, v179
v_cvt_pk_bf16_f32 v164, v180, v181
v_cvt_pk_bf16_f32 v165, v182, v183
v_mov_b32 v166, v164
v_mov_b32 v167, v165
v_permlane16_swap_b32 v160, v162
v_permlane16_swap_b32 v161, v163
v_permlane16_swap_b32 v164, v166
v_permlane16_swap_b32 v165, v167
buffer_store_dwordx4 v[160:163], v96, s[4:7], s15 offen sc1
buffer_store_dwordx4 v[164:167], v97, s[4:7], s15 offen sc1
v_pk_add_f32 v[190:191], v[172:173], v[174:175]
v_pk_mul_f32 v[168:169], v[172:173], v[172:173]
v_pk_fma_f32 v[168:169], v[174:175], v[174:175], v[168:169]
v_pk_add_f32 v[190:191], v[190:191], v[176:177]
v_pk_fma_f32 v[168:169], v[176:177], v[176:177], v[168:169]
v_pk_add_f32 v[190:191], v[190:191], v[178:179]
v_pk_fma_f32 v[168:169], v[178:179], v[178:179], v[168:169]
v_pk_add_f32 v[190:191], v[190:191], v[180:181]
v_pk_fma_f32 v[168:169], v[180:181], v[180:181], v[168:169]
v_pk_add_f32 v[190:191], v[190:191], v[182:183]
v_pk_fma_f32 v[168:169], v[182:183], v[182:183], v[168:169]
v_add_f32 v190, v190, v191
v_add_f32 v168, v168, v169
s_add_u32 s18, s17, s73
v_add_f32 v190, v190, v190 row_ror:8 row_mask:0xf bank_mask:0xf
v_add_f32 v168, v168, v168 row_ror:8 row_mask:0xf bank_mask:0xf
s_nop 0
v_add_f32 v190, v190, v190 row_ror:4 row_mask:0xf bank_mask:0xf
v_add_f32 v168, v168, v168 row_ror:4 row_mask:0xf bank_mask:0xf
s_nop 0
v_add_f32 v190, v190, v190 row_ror:2 row_mask:0xf bank_mask:0xf
v_add_f32 v168, v168, v168 row_ror:2 row_mask:0xf bank_mask:0xf
s_nop 0
v_add_f32 v190, v190, v190 row_ror:1 row_mask:0xf bank_mask:0xf
v_add_f32 v168, v168, v168 row_ror:1 row_mask:0xf bank_mask:0xf
s_nop 0
v_mov_b32 v191, v190
v_mov_b32 v169, v168
s_nop 0
v_permlane32_swap_b32 v190, v191
v_permlane32_swap_b32 v168, v169
v_add_f32 v190, v190, v191
v_add_f32 v168, v168, v169
v_mov_b32 v191, v190
v_mov_b32 v169, v168
s_nop 0
v_permlane16_swap_b32 v190, v191
v_permlane16_swap_b32 v168, v169
v_add_f32 v190, v190, v191
v_add_f32 v168, v168, v169
v_mul_f32 v190, 0xbacccccd, v190
v_mul_f32 v191, v190, v190
v_fma_f32 v168, v168, s101, -v191
v_max_f32 v168, 0, v168
v_add_f32 v168, 0x3727c5ac, v168
v_rsq_f32 v168, v168
s_nop 0
v_mul_f32 v190, v190, v168
v_pk_fma_f32 v[172:173], v[172:173], v[168:169], v[190:191] op_sel_hi:[1,0,0]
v_cvt_pk_bf16_f32 v172, v172, v173
v_pk_fma_f32 v[174:175], v[174:175], v[168:169], v[190:191] op_sel_hi:[1,0,0]
v_cvt_pk_bf16_f32 v173, v174, v175
v_pk_fma_f32 v[176:177], v[176:177], v[168:169], v[190:191] op_sel_hi:[1,0,0]
v_cvt_pk_bf16_f32 v174, v176, v177
v_pk_fma_f32 v[178:179], v[178:179], v[168:169], v[190:191] op_sel_hi:[1,0,0]
v_cvt_pk_bf16_f32 v175, v178, v179
v_pk_fma_f32 v[180:181], v[180:181], v[168:169], v[190:191] op_sel_hi:[1,0,0]
v_cvt_pk_bf16_f32 v176, v180, v181
v_pk_fma_f32 v[182:183], v[182:183], v[168:169], v[190:191] op_sel_hi:[1,0,0]
v_cvt_pk_bf16_f32 v177, v182, v183
v_mov_b32 v178, v176
v_mov_b32 v179, v177
v_permlane16_swap_b32 v172, v174
v_permlane16_swap_b32 v173, v175
v_permlane16_swap_b32 v176, v178
v_permlane16_swap_b32 v177, v179
buffer_store_dwordx4 v[172:175], v110, s[4:7], s18 offen sc1
buffer_store_dwordx4 v[176:179], v111, s[4:7], s18 offen sc1
s_waitcnt vmcnt(0)
s_atomic_add s88, s[86:87], s82
s_branch f60
f61:
ds_read_b128 v[160:163], v109 offset:0
ds_read_b128 v[164:167], v109 offset:1024
ds_read_b128 v[168:171], v109 offset:2048
s_waitcnt lgkmcnt(2)
v_pk_add_f32 v[172:173], v[172:173], v[160:161]
v_pk_add_f32 v[174:175], v[174:175], v[162:163]
s_waitcnt lgkmcnt(1)
v_pk_add_f32 v[176:177], v[176:177], v[164:165]
v_pk_add_f32 v[178:179], v[178:179], v[166:167]
s_waitcnt lgkmcnt(0)
v_pk_add_f32 v[180:181], v[180:181], v[168:169]
v_pk_add_f32 v[182:183], v[182:183], v[170:171]
v_cvt_pk_bf16_f32 v160, v172, v173
v_cvt_pk_bf16_f32 v161, v174, v175
v_cvt_pk_bf16_f32 v162, v176, v177
v_cvt_pk_bf16_f32 v163, v178, v179
v_cvt_pk_bf16_f32 v164, v180, v181
v_cvt_pk_bf16_f32 v165, v182, v183
v_mov_b32 v166, v164
v_mov_b32 v167, v165
v_permlane16_swap_b32 v160, v162
v_permlane16_swap_b32 v161, v163
v_permlane16_swap_b32 v164, v166
v_permlane16_swap_b32 v165, v167
buffer_store_dwordx4 v[160:163], v96, s[96:99], s16 offen
buffer_store_dwordx4 v[164:167], v97, s[96:99], s16 offen
f60:
s_barrier
s_add_u32 s62, s62, 3
s_cmp_lt_u32 s62, 64
s_cselect_b64 s[60:61], s[54:55], s[56:57]
s_cselect_b32 s33, 0, 26
s_bfm_b64 s[34:35], s62, 0
s_and_b64 s[34:35], s[34:35], s[60:61]
s_bcnt1_i32_b64 s34, s[34:35]
s_add_u32 s33, s33, s34
s_sub_u32 s34, s62, s33
s_add_u32 s33, s33, 64
s_bitcmp1_b64 s[60:61], s62
s_cselect_b32 s14, s33, s34
s_cmp_ge_u32 s62, 128
s_cselect_b32 s14, s62, s14
s_cmp_lt_u32 s62, 128
s_cbranch_scc1 L_Frtop
s_endpgm
.p2align 5
L_Ftop:
ds_read_b128 v[40:43], v2 offset:40960
ds_read_b128 v[44:47], v2 offset:41984
ds_read_b128 v[48:51], v2 offset:43008
ds_read_b128 v[52:55], v2 offset:44032
s_mov_b32 s63, s14
s_mov_b32 s14, s64
s_add_u32 s62, s62, 3
s_add_u32 s65, s65, 1
s_cmp_eq_u32 s19, 1
s_cbranch_scc1 L_Fb1
s_cmp_eq_u32 s19, 2
s_cbranch_scc1 L_Fb2
s_bitcmp1_b32 s25, 0
s_cbranch_scc1 L_Fb3
s_waitcnt lgkmcnt(3)
v_mfma_f32_32x32x16_bf16 v[120:135], a[160:163], v[40:43], 0
ds_read_b128 v[56:59], v2 offset:45056
ds_read_b128 v[60:63], v2 offset:46080
s_waitcnt lgkmcnt(4)
v_mfma_f32_32x32x16_bf16 v[120:135], a[164:167], v[44:47], v[120:135]
ds_read_b128 v[64:67], v2 offset:47104
ds_read_b128 v[68:71], v2 offset:48128
s_waitcnt lgkmcnt(5)
v_mfma_f32_32x32x16_bf16 v[120:135], a[168:171], v[48:51], v[120:135]
s_waitcnt lgkmcnt(4)
v_mfma_f32_32x32x16_bf16 v[120:135], a[172:175], v[52:55], v[120:135]
s_waitcnt lgkmcnt(3)
v_mfma_f32_32x32x16_bf16 v[120:135], a[176:179], v[56:59], v[120:135]
s_waitcnt lgkmcnt(2)
v_mfma_f32_32x32x16_bf16 v[120:135], a[180:183], v[60:63], v[120:135]
s_waitcnt lgkmcnt(1)
v_mfma_f32_32x32x16_bf16 v[120:135], a[184:187], v[64:67], v[120:135]
s_waitcnt lgkmcnt(0)
v_mfma_f32_32x32x16_bf16 v[120:135], a[188:191], v[68:71], v[120:135]
v_mfma_f32_32x32x16_bf16 v[136:151], a[192:195], v[40:43], 0
buffer_load_dword v10, v8, s[4:7], s74 offen offset:2048 sc1
s_add_u32 s35, s78, s76
v_mfma_f32_32x32x16_bf16 v[136:151], a[196:199], v[44:47], v[136:151]
v_mfma_f32_32x32x16_bf16 v[136:151], a[200:203], v[48:51], v[136:151]
v_cvt_pk_bf16_f32 v72, v120, v121
v_cvt_pk_bf16_f32 v73, v122, v123
v_cvt_pk_bf16_f32 v74, v124, v125
v_cvt_pk_bf16_f32 v75, v126, v127
v_mfma_f32_32x32x16_bf16 v[136:151], a[204:207], v[52:55], v[136:151]
ds_write_b128 v104, v[72:75] offset:0
v_mfma_f32_32x32x16_bf16 v[136:151], a[208:211], v[56:59], v[136:151]
v_cvt_pk_bf16_f32 v76, v128, v129
v_cvt_pk_bf16_f32 v77, v130, v131
v_cvt_pk_bf16_f32 v78, v132, v133
v_cvt_pk_bf16_f32 v79, v134, v135
v_mfma_f32_32x32x16_bf16 v[136:151], a[212:215], v[60:63], v[136:151]
ds_write_b128 v104, v[76:79] offset:32
v_mfma_f32_32x32x16_bf16 v[136:151], a[216:219], v[64:67], v[136:151]
v_mfma_f32_32x32x16_bf16 v[136:151], a[220:223], v[68:71], v[136:151]
v_mfma_f32_32x32x16_bf16 v[120:135], a[224:227], v[40:43], 0
v_mfma_f32_32x32x16_bf16 v[120:135], a[228:231], v[44:47], v[120:135]
v_mfma_f32_32x32x16_bf16 v[120:135], a[232:235], v[48:51], v[120:135]
v_cvt_pk_bf16_f32 v72, v136, v137
v_cvt_pk_bf16_f32 v73, v138, v139
v_cvt_pk_bf16_f32 v74, v140, v141
v_cvt_pk_bf16_f32 v75, v142, v143
v_mfma_f32_32x32x16_bf16 v[120:135], a[236:239], v[52:55], v[120:135]
ds_write_b128 v104, v[72:75] offset:64
v_mfma_f32_32x32x16_bf16 v[120:135], a[240:243], v[56:59], v[120:135]
v_cvt_pk_bf16_f32 v76, v144, v145
v_cvt_pk_bf16_f32 v77, v146, v147
v_cvt_pk_bf16_f32 v78, v148, v149
v_cvt_pk_bf16_f32 v79, v150, v151
v_mfma_f32_32x32x16_bf16 v[120:135], a[244:247], v[60:63], v[120:135]
ds_write_b128 v104, v[76:79] offset:96
ds_read_b128 v[80:83], v100 offset:0
ds_read_b128 v[84:87], v100 offset:2688
v_mfma_f32_32x32x16_bf16 v[120:135], a[248:251], v[64:67], v[120:135]
ds_read_b128 v[88:91], v100 offset:5376
ds_read_b128 v[92:95], v100 offset:8064
v_mfma_f32_32x32x16_bf16 v[120:135], a[252:255], v[68:71], v[120:135]
s_waitcnt vmcnt(0)
v_add_u32 v10, 1, v10
v_cmp_gt_u32 vcc, s65, v10
s_mov_b32 s28, 0
s_cbranch_vccnz sf62
sf63:
v_mfma_f32_32x32x16_bf16 v[136:151], v[192:195], v[40:43], 0
v_mfma_f32_32x32x16_bf16 v[136:151], v[196:199], v[44:47], v[136:151]
s_waitcnt lgkmcnt(3)
s_add_u32 s33, s35, 0
buffer_store_dwordx4 v[80:83], v102, s[4:7], s33 offen offset:0
v_mfma_f32_32x32x16_bf16 v[136:151], v[200:203], v[48:51], v[136:151]
v_cvt_pk_bf16_f32 v72, v120, v121
v_cvt_pk_bf16_f32 v73, v122, v123
v_cvt_pk_bf16_f32 v74, v124, v125
v_cvt_pk_bf16_f32 v75, v126, v127
v_mfma_f32_32x32x16_bf16 v[136:151], v[204:207], v[52:55], v[136:151]
ds_write_b128 v104, v[72:75] offset:128
s_waitcnt lgkmcnt(3)
s_add_u32 s33, s35, 163840
buffer_store_dwordx4 v[84:87], v102, s[4:7], s33 offen offset:0
v_mfma_f32_32x32x16_bf16 v[136:151], v[208:211], v[56:59], v[136:151]
v_cvt_pk_bf16_f32 v76, v128, v129
v_cvt_pk_bf16_f32 v77, v130, v131
v_cvt_pk_bf16_f32 v78, v132, v133
v_cvt_pk_bf16_f32 v79, v134, v135
v_mfma_f32_32x32x16_bf16 v[136:151], v[212:215], v[60:63], v[136:151]
ds_write_b128 v104, v[76:79] offset:160
s_waitcnt lgkmcnt(3)
s_add_u32 s33, s35, 327680
buffer_store_dwordx4 v[88:91], v102, s[4:7], s33 offen offset:0
v_mfma_f32_32x32x16_bf16 v[136:151], v[216:219], v[64:67], v[136:151]
v_mfma_f32_32x32x16_bf16 v[136:151], v[220:223], v[68:71], v[136:151]
s_waitcnt lgkmcnt(2)
s_add_u32 s33, s35, 491520
buffer_store_dwordx4 v[92:95], v102, s[4:7], s33 offen offset:0
v_mfma_f32_32x32x16_bf16 v[120:135], v[224:227], v[40:43], 0
v_mfma_f32_32x32x16_bf16 v[120:135], v[228:231], v[44:47], v[120:135]
v_mfma_f32_32x32x16_bf16 v[120:135], v[232:235], v[48:51], v[120:135]
v_cvt_pk_bf16_f32 v72, v136, v137
v_cvt_pk_bf16_f32 v73, v138, v139
v_cvt_pk_bf16_f32 v74, v140, v141
v_cvt_pk_bf16_f32 v75, v142, v143
v_mfma_f32_32x32x16_bf16 v[120:135], v[236:239], v[52:55], v[120:135]
ds_write_b128 v104, v[72:75] offset:192
v_mfma_f32_32x32x16_bf16 v[120:135], v[240:243], v[56:59], v[120:135]
v_cvt_pk_bf16_f32 v76, v144, v145
v_cvt_pk_bf16_f32 v77, v146, v147
v_cvt_pk_bf16_f32 v78, v148, v149
v_cvt_pk_bf16_f32 v79, v150, v151
v_mfma_f32_32x32x16_bf16 v[120:135], v[244:247], v[60:63], v[120:135]
ds_write_b128 v104, v[76:79] offset:224
ds_read_b128 v[80:83], v100 offset:128
ds_read_b128 v[84:87], v100 offset:2816
v_mfma_f32_32x32x16_bf16 v[120:135], v[248:251], v[64:67], v[120:135]
ds_read_b128 v[88:91], v100 offset:5504
ds_read_b128 v[92:95], v100 offset:8192
v_mfma_f32_32x32x16_bf16 v[120:135], v[252:255], v[68:71], v[120:135]
s_waitcnt lgkmcnt(3)
s_add_u32 s33, s35, 0
buffer_store_dwordx4 v[80:83], v102, s[4:7], s33 offen offset:128
s_waitcnt lgkmcnt(2)
s_add_u32 s33, s35, 163840
buffer_store_dwordx4 v[84:87], v102, s[4:7], s33 offen offset:128
s_waitcnt lgkmcnt(1)
s_add_u32 s33, s35, 327680
buffer_store_dwordx4 v[88:91], v102, s[4:7], s33 offen offset:128
s_waitcnt lgkmcnt(0)
s_add_u32 s33, s35, 491520
buffer_store_dwordx4 v[92:95], v102, s[4:7], s33 offen offset:128
s_branch L_Fjoin
L_Fb1:
s_waitcnt lgkmcnt(3)
v_mfma_f32_32x32x16_bf16 v[120:135], a[160:163], v[40:43], 0
ds_read_b128 v[56:59], v2 offset:45056
ds_read_b128 v[60:63], v2 offset:46080
s_waitcnt lgkmcnt(4)
v_mfma_f32_32x32x16_bf16 v[120:135], a[164:167], v[44:47], v[120:135]
ds_read_b128 v[64:67], v2 offset:47104
ds_read_b128 v[68:71], v2 offset:48128
ds_read_b128 v[160:163], v109 offset:0
ds_read_b128 v[164:167], v109 offset:1024
ds_read_b128 v[168:171], v109 offset:2048
s_waitcnt lgkmcnt(8)
v_mfma_f32_32x32x16_bf16 v[120:135], a[168:171], v[48:51], v[120:135]
s_waitcnt lgkmcnt(7)
v_mfma_f32_32x32x16_bf16 v[120:135], a[172:175], v[52:55], v[120:135]
s_waitcnt lgkmcnt(6)
v_mfma_f32_32x32x16_bf16 v[120:135], a[176:179], v[56:59], v[120:135]
s_waitcnt lgkmcnt(5)
v_mfma_f32_32x32x16_bf16 v[120:135], a[180:183], v[60:63], v[120:135]
s_waitcnt lgkmcnt(2)
v_add_f32 v172, v172, v160
v_add_f32 v173, v173, v161
v_add_f32 v174, v174, v162
v_add_f32 v175, v175, v163
s_waitcnt lgkmcnt(1)
v_add_f32 v176, v176, v164
v_add_f32 v177, v177, v165
v_mfma_f32_32x32x16_bf16 v[120:135], a[184:187], v[64:67], v[120:135]
v_add_f32 v178, v178, v166
v_add_f32 v179, v179, v167
s_waitcnt lgkmcnt(0)
v_add_f32 v180, v180, v168
v_add_f32 v181, v181, v169
v_add_f32 v182, v182, v170
v_add_f32 v183, v183, v171
v_cvt_pk_bf16_f32 v160, v172, v173
v_mfma_f32_32x32x16_bf16 v[120:135], a[188:191], v[68:71], v[120:135]
v_cvt_pk_bf16_f32 v161, v174, v175
v_cvt_pk_bf16_f32 v162, v176, v177
v_cvt_pk_bf16_f32 v163, v178, v179
v_cvt_pk_bf16_f32 v164, v180, v181
v_cvt_pk_bf16_f32 v165, v182, v183
v_mov_b32 v166, v164
v_mov_b32 v167, v165
v_mfma_f32_32x32x16_bf16 v[136:151], a[192:195], v[40:43], 0
buffer_load_dword v10, v8, s[4:7], s74 offen offset:2048 sc1
s_add_u32 s35, s78, s76
v_permlane16_swap_b32 v160, v162
v_permlane16_swap_b32 v161, v163
v_mfma_f32_32x32x16_bf16 v[136:151], a[196:199], v[44:47], v[136:151]
v_permlane16_swap_b32 v164, v166
v_permlane16_swap_b32 v165, v167
v_mfma_f32_32x32x16_bf16 v[136:151], a[200:203], v[48:51], v[136:151]
v_cvt_pk_bf16_f32 v72, v120, v121
v_cvt_pk_bf16_f32 v73, v122, v123
v_cvt_pk_bf16_f32 v74, v124, v125
v_cvt_pk_bf16_f32 v75, v126, v127
v_mfma_f32_32x32x16_bf16 v[136:151], a[204:207], v[52:55], v[136:151]
ds_write_b128 v104, v[72:75] offset:0
v_mfma_f32_32x32x16_bf16 v[136:151], a[208:211], v[56:59], v[136:151]
v_cvt_pk_bf16_f32 v76, v128, v129
v_cvt_pk_bf16_f32 v77, v130, v131
v_cvt_pk_bf16_f32 v78, v132, v133
v_cvt_pk_bf16_f32 v79, v134, v135
v_mfma_f32_32x32x16_bf16 v[136:151], a[212:215], v[60:63], v[136:151]
ds_write_b128 v104, v[76:79] offset:32
v_mfma_f32_32x32x16_bf16 v[136:151], a[216:219], v[64:67], v[136:151]
buffer_store_dwordx4 v[160:163], v96, s[4:7], s15 offen sc1
v_mfma_f32_32x32x16_bf16 v[136:151], a[220:223], v[68:71], v[136:151]
buffer_store_dwordx4 v[164:167], v97, s[4:7], s15 offen sc1
v_add_f32 v190, v172, v174
v_add_f32 v191, v173, v175
v_mfma_f32_32x32x16_bf16 v[120:135], a[224:227], v[40:43], 0
v_mul_f32 v168, v172, v172
v_mul_f32 v169, v173, v173
v_fma_f32 v168, v174, v174, v168
v_fma_f32 v169, v175, v175, v169
v_add_f32 v190, v190, v176
v_add_f32 v191, v191, v177
v_fma_f32 v168, v176, v176, v168
v_fma_f32 v169, v177, v177, v169
v_mfma_f32_32x32x16_bf16 v[120:135], a[228:231], v[44:47], v[120:135]
v_add_f32 v190, v190, v178
v_add_f32 v191, v191, v179
v_fma_f32 v168, v178, v178, v168
v_fma_f32 v169, v179, v179, v169
v_add_f32 v190, v190, v180
v_add_f32 v191, v191, v181
v_fma_f32 v168, v180, v180, v168
v_fma_f32 v169, v181, v181, v169
v_mfma_f32_32x32x16_bf16 v[120:135], a[232:235], v[48:51], v[120:135]
v_cvt_pk_bf16_f32 v72, v136, v137
v_cvt_pk_bf16_f32 v73, v138, v139
v_cvt_pk_bf16_f32 v74, v140, v141
v_cvt_pk_bf16_f32 v75, v142, v143
v_add_f32 v190, v190, v182
v_add_f32 v191, v191, v183
v_fma_f32 v168, v182, v182, v168
v_fma_f32 v169, v183, v183, v169
v_mfma_f32_32x32x16_bf16 v[120:135], a[236:239], v[52:55], v[120:135]
ds_write_b128 v104, v[72:75] offset:64
v_add_f32 v190, v190, v191
v_add_f32 v168, v168, v169
s_add_u32 s18, s17, s73
v_add_f32 v190, v190, v190 row_ror:8 row_mask:0xf bank_mask:0xf
v_mfma_f32_32x32x16_bf16 v[120:135], a[240:243], v[56:59], v[120:135]
v_cvt_pk_bf16_f32 v76, v144, v145
v_cvt_pk_bf16_f32 v77, v146, v147
v_cvt_pk_bf16_f32 v78, v148, v149
v_cvt_pk_bf16_f32 v79, v150, v151
v_add_f32 v168, v168, v168 row_ror:8 row_mask:0xf bank_mask:0xf
s_nop 0
v_add_f32 v190, v190, v190 row_ror:4 row_mask:0xf bank_mask:0xf
v_add_f32 v168, v168, v168 row_ror:4 row_mask:0xf bank_mask:0xf
v_mfma_f32_32x32x16_bf16 v[120:135], a[244:247], v[60:63], v[120:135]
ds_write_b128 v104, v[76:79] offset:96
ds_read_b128 v[80:83], v100 offset:0
ds_read_b128 v[84:87], v100 offset:2688
s_nop 0
v_add_f32 v190, v190, v190 row_ror:2 row_mask:0xf bank_mask:0xf
v_mfma_f32_32x32x16_bf16 v[120:135], a[248:251], v[64:67], v[120:135]
ds_read_b128 v[88:91], v100 offset:5376
ds_read_b128 v[92:95], v100 offset:8064
v_add_f32 v168, v168, v168 row_ror:2 row_mask:0xf bank_mask:0xf
s_nop 0
v_add_f32 v190, v190, v190 row_ror:1 row_mask:0xf bank_mask:0xf
v_add_f32 v168, v168, v168 row_ror:1 row_mask:0xf bank_mask:0xf
s_nop 0
v_mov_b32 v191, v190
v_mfma_f32_32x32x16_bf16 v[120:135], a[252:255], v[68:71], v[120:135]
s_waitcnt vmcnt(2)
v_add_u32 v10, 1, v10
v_cmp_gt_u32 vcc, s65, v10
s_mov_b32 s28, 0
s_cbranch_vccnz sf64
sf65:
v_mov_b32 v169, v168
s_nop 0
v_permlane32_swap_b32 v190, v191
v_mfma_f32_32x32x16_bf16 v[136:151], v[192:195], v[40:43], 0
v_permlane32_swap_b32 v168, v169
v_add_f32 v190, v190, v191
v_add_f32 v168, v168, v169
v_mov_b32 v191, v190
v_mov_b32 v169, v168
s_nop 0
v_mfma_f32_32x32x16_bf16 v[136:151], v[196:199], v[44:47], v[136:151]
s_waitcnt lgkmcnt(3)
s_add_u32 s33, s35, 0
buffer_store_dwordx4 v[80:83], v102, s[4:7], s33 offen offset:0
v_mfma_f32_32x32x16_bf16 v[136:151], v[200:203], v[48:51], v[136:151]
v_cvt_pk_bf16_f32 v72, v120, v121
v_cvt_pk_bf16_f32 v73, v122, v123
v_cvt_pk_bf16_f32 v74, v124, v125
v_cvt_pk_bf16_f32 v75, v126, v127
v_permlane16_swap_b32 v190, v191
v_permlane16_swap_b32 v168, v169
v_mfma_f32_32x32x16_bf16 v[136:151], v[204:207], v[52:55], v[136:151]
ds_write_b128 v104, v[72:75] offset:128
s_waitcnt lgkmcnt(3)
s_add_u32 s33, s35, 163840
buffer_store_dwordx4 v[84:87], v102, s[4:7], s33 offen offset:0
v_mfma_f32_32x32x16_bf16 v[136:151], v[208:211], v[56:59], v[136:151]
v_cvt_pk_bf16_f32 v76, v128, v129
v_cvt_pk_bf16_f32 v77, v130, v131
v_cvt_pk_bf16_f32 v78, v132, v133
v_cvt_pk_bf16_f32 v79, v134, v135
v_add_f32 v190, v190, v191
v_add_f32 v168, v168, v169
v_mul_f32 v190, 0xbacccccd, v190
v_mul_f32 v191, v190, v190
v_mfma_f32_32x32x16_bf16 v[136:151], v[212:215], v[60:63], v[136:151]
ds_write_b128 v104, v[76:79] offset:160
s_waitcnt lgkmcnt(3)
s_add_u32 s33, s35, 327680
buffer_store_dwordx4 v[88:91], v102, s[4:7], s33 offen offset:0
v_mfma_f32_32x32x16_bf16 v[136:151], v[216:219], v[64:67], v[136:151]
v_fma_f32 v168, v168, s101, -v191
v_max_f32 v168, 0, v168
v_add_f32 v168, 0x3727c5ac, v168
v_rsq_f32 v168, v168
s_nop 0
v_mul_f32 v190, v190, v168
v_fma_f32 v172, v172, v168, v190
v_mfma_f32_32x32x16_bf16 v[136:151], v[220:223], v[68:71], v[136:151]
s_waitcnt lgkmcnt(2)
s_add_u32 s33, s35, 491520
buffer_store_dwordx4 v[92:95], v102, s[4:7], s33 offen offset:0
v_fma_f32 v173, v173, v168, v190
v_mfma_f32_32x32x16_bf16 v[120:135], v[224:227], v[40:43], 0
v_cvt_pk_bf16_f32 v172, v172, v173
v_fma_f32 v174, v174, v168, v190
v_fma_f32 v175, v175, v168, v190
v_cvt_pk_bf16_f32 v173, v174, v175
v_fma_f32 v176, v176, v168, v190
v_fma_f32 v177, v177, v168, v190
v_cvt_pk_bf16_f32 v174, v176, v177
v_fma_f32 v178, v178, v168, v190
v_mfma_f32_32x32x16_bf16 v[120:135], v[228:231], v[44:47], v[120:135]
v_fma_f32 v179, v179, v168, v190
v_cvt_pk_bf16_f32 v175, v178, v179
v_fma_f32 v180, v180, v168, v190
v_fma_f32 v181, v181, v168, v190
v_cvt_pk_bf16_f32 v176, v180, v181
v_fma_f32 v182, v182, v168, v190
v_fma_f32 v183, v183, v168, v190
v_cvt_pk_bf16_f32 v177, v182, v183
v_mfma_f32_32x32x16_bf16 v[120:135], v[232:235], v[48:51], v[120:135]
v_cvt_pk_bf16_f32 v72, v136, v137
v_cvt_pk_bf16_f32 v73, v138, v139
v_cvt_pk_bf16_f32 v74, v140, v141
v_cvt_pk_bf16_f32 v75, v142, v143
v_mov_b32 v178, v176
v_mov_b32 v179, v177
v_permlane16_swap_b32 v172, v174
v_mfma_f32_32x32x16_bf16 v[120:135], v[236:239], v[52:55], v[120:135]
ds_write_b128 v104, v[72:75] offset:192
v_permlane16_swap_b32 v173, v175
v_permlane16_swap_b32 v176, v178
v_mfma_f32_32x32x16_bf16 v[120:135], v[240:243], v[56:59], v[120:135]
v_cvt_pk_bf16_f32 v76, v144, v145
v_cvt_pk_bf16_f32 v77, v146, v147
v_cvt_pk_bf16_f32 v78, v148, v149
v_cvt_pk_bf16_f32 v79, v150, v151
v_permlane16_swap_b32 v177, v179
v_mfma_f32_32x32x16_bf16 v[120:135], v[244:247], v[60:63], v[120:135]
ds_write_b128 v104, v[76:79] offset:224
ds_read_b128 v[80:83], v100 offset:128
ds_read_b128 v[84:87], v100 offset:2816
v_mfma_f32_32x32x16_bf16 v[120:135], v[248:251], v[64:67], v[120:135]
ds_read_b128 v[88:91], v100 offset:5504
ds_read_b128 v[92:95], v100 offset:8192
buffer_store_dwordx4 v[172:175], v110, s[4:7], s18 offen sc1
v_mfma_f32_32x32x16_bf16 v[120:135], v[252:255], v[68:71], v[120:135]
buffer_store_dwordx4 v[176:179], v111, s[4:7], s18 offen sc1
s_waitcnt lgkmcnt(3)
s_add_u32 s33, s35, 0
buffer_store_dwordx4 v[80:83], v102, s[4:7], s33 offen offset:128
s_waitcnt lgkmcnt(2)
s_add_u32 s33, s35, 163840
buffer_store_dwordx4 v[84:87], v102, s[4:7], s33 offen offset:128
s_waitcnt lgkmcnt(1)
s_add_u32 s33, s35, 327680
buffer_store_dwordx4 v[88:91], v102, s[4:7], s33 offen offset:128
s_waitcnt lgkmcnt(0)
s_add_u32 s33, s35, 491520
buffer_store_dwordx4 v[92:95], v102, s[4:7], s33 offen offset:128
s_branch L_Fjoin
L_Fb2:
s_waitcnt lgkmcnt(3)
v_mfma_f32_32x32x16_bf16 v[120:135], a[160:163], v[40:43], 0
ds_read_b128 v[56:59], v2 offset:45056
ds_read_b128 v[60:63], v2 offset:46080
s_waitcnt lgkmcnt(4)
v_mfma_f32_32x32x16_bf16 v[120:135], a[164:167], v[44:47], v[120:135]
ds_read_b128 v[64:67], v2 offset:47104
ds_read_b128 v[68:71], v2 offset:48128
ds_read_b128 v[160:163], v109 offset:0
ds_read_b128 v[164:167], v109 offset:1024
ds_read_b128 v[168:171], v109 offset:2048
s_waitcnt lgkmcnt(8)
v_mfma_f32_32x32x16_bf16 v[120:135], a[168:171], v[48:51], v[120:135]
s_waitcnt lgkmcnt(7)
v_mfma_f32_32x32x16_bf16 v[120:135], a[172:175], v[52:55], v[120:135]
s_waitcnt lgkmcnt(6)
v_mfma_f32_32x32x16_bf16 v[120:135], a[176:179], v[56:59], v[120:135]
s_waitcnt lgkmcnt(5)
v_mfma_f32_32x32x16_bf16 v[120:135], a[180:183], v[60:63], v[120:135]
s_waitcnt lgkmcnt(2)
v_add_f32 v172, v172, v160
v_add_f32 v173, v173, v161
v_add_f32 v174, v174, v162
v_add_f32 v175, v175, v163
s_waitcnt lgkmcnt(1)
v_add_f32 v176, v176, v164
v_add_f32 v177, v177, v165
v_mfma_f32_32x32x16_bf16 v[120:135], a[184:187], v[64:67], v[120:135]
v_add_f32 v178, v178, v166
v_add_f32 v179, v179, v167
s_waitcnt lgkmcnt(0)
v_add_f32 v180, v180, v168
v_add_f32 v181, v181, v169
v_add_f32 v182, v182, v170
v_add_f32 v183, v183, v171
v_cvt_pk_bf16_f32 v160, v172, v173
v_mfma_f32_32x32x16_bf16 v[120:135], a[188:191], v[68:71], v[120:135]
v_cvt_pk_bf16_f32 v161, v174, v175
v_cvt_pk_bf16_f32 v162, v176, v177
v_cvt_pk_bf16_f32 v163, v178, v179
v_cvt_pk_bf16_f32 v164, v180, v181
v_cvt_pk_bf16_f32 v165, v182, v183
v_mov_b32 v166, v164
v_mov_b32 v167, v165
v_mfma_f32_32x32x16_bf16 v[136:151], a[192:195], v[40:43], 0
buffer_load_dword v10, v8, s[4:7], s74 offen offset:2048 sc1
s_add_u32 s35, s78, s76
v_permlane16_swap_b32 v160, v162
v_permlane16_swap_b32 v161, v163
v_mfma_f32_32x32x16_bf16 v[136:151], a[196:199], v[44:47], v[136:151]
v_permlane16_swap_b32 v164, v166
v_permlane16_swap_b32 v165, v167
v_mfma_f32_32x32x16_bf16 v[136:151], a[200:203], v[48:51], v[136:151]
v_cvt_pk_bf16_f32 v72, v120, v121
v_cvt_pk_bf16_f32 v73, v122, v123
v_cvt_pk_bf16_f32 v74, v124, v125
v_cvt_pk_bf16_f32 v75, v126, v127
v_mfma_f32_32x32x16_bf16 v[136:151], a[204:207], v[52:55], v[136:151]
ds_write_b128 v104, v[72:75] offset:0
v_mfma_f32_32x32x16_bf16 v[136:151], a[208:211], v[56:59], v[136:151]
v_cvt_pk_bf16_f32 v76, v128, v129
v_cvt_pk_bf16_f32 v77, v130, v131
v_cvt_pk_bf16_f32 v78, v132, v133
v_cvt_pk_bf16_f32 v79, v134, v135
v_mfma_f32_32x32x16_bf16 v[136:151], a[212:215], v[60:63], v[136:151]
ds_write_b128 v104, v[76:79] offset:32
v_mfma_f32_32x32x16_bf16 v[136:151], a[216:219], v[64:67], v[136:151]
buffer_store_dwordx4 v[160:163], v96, s[96:99], s16 offen
v_mfma_f32_32x32x16_bf16 v[136:151], a[220:223], v[68:71], v[136:151]
buffer_store_dwordx4 v[164:167], v97, s[96:99], s16 offen
v_mfma_f32_32x32x16_bf16 v[120:135], a[224:227], v[40:43], 0
v_mfma_f32_32x32x16_bf16 v[120:135], a[228:231], v[44:47], v[120:135]
v_mfma_f32_32x32x16_bf16 v[120:135], a[232:235], v[48:51], v[120:135]
v_cvt_pk_bf16_f32 v72, v136, v137
v_cvt_pk_bf16_f32 v73, v138, v139
v_cvt_pk_bf16_f32 v74, v140, v141
v_cvt_pk_bf16_f32 v75, v142, v143
v_mfma_f32_32x32x16_bf16 v[120:135], a[236:239], v[52:55], v[120:135]
ds_write_b128 v104, v[72:75] offset:64
v_mfma_f32_32x32x16_bf16 v[120:135], a[240:243], v[56:59], v[120:135]
v_cvt_pk_bf16_f32 v76, v144, v145
v_cvt_pk_bf16_f32 v77, v146, v147
v_cvt_pk_bf16_f32 v78, v148, v149
v_cvt_pk_bf16_f32 v79, v150, v151
v_mfma_f32_32x32x16_bf16 v[120:135], a[244:247], v[60:63], v[120:135]
ds_write_b128 v104, v[76:79] offset:96
ds_read_b128 v[80:83], v100 offset:0
ds_read_b128 v[84:87], v100 offset:2688
v_mfma_f32_32x32x16_bf16 v[120:135], a[248:251], v[64:67], v[120:135]
ds_read_b128 v[88:91], v100 offset:5376
ds_read_b128 v[92:95], v100 offset:8064
v_mfma_f32_32x32x16_bf16 v[120:135], a[252:255], v[68:71], v[120:135]
s_waitcnt vmcnt(2)
v_add_u32 v10, 1, v10
v_cmp_gt_u32 vcc, s65, v10
s_mov_b32 s28, 0
s_cbranch_vccnz sf66
sf67:
v_mfma_f32_32x32x16_bf16 v[136:151], v[192:195], v[40:43], 0
v_mfma_f32_32x32x16_bf16 v[136:151], v[196:199], v[44:47], v[136:151]
s_waitcnt lgkmcnt(3)
s_add_u32 s33, s35, 0
buffer_store_dwordx4 v[80:83], v102, s[4:7], s33 offen offset:0
v_mfma_f32_32x32x16_bf16 v[136:151], v[200:203], v[48:51], v[136:151]
v_cvt_pk_bf16_f32 v72, v120, v121
v_cvt_pk_bf16_f32 v73, v122, v123
v_cvt_pk_bf16_f32 v74, v124, v125
v_cvt_pk_bf16_f32 v75, v126, v127
v_mfma_f32_32x32x16_bf16 v[136:151], v[204:207], v[52:55], v[136:151]
ds_write_b128 v104, v[72:75] offset:128
s_waitcnt lgkmcnt(3)
s_add_u32 s33, s35, 163840
buffer_store_dwordx4 v[84:87], v102, s[4:7], s33 offen offset:0
v_mfma_f32_32x32x16_bf16 v[136:151], v[208:211], v[56:59], v[136:151]
v_cvt_pk_bf16_f32 v76, v128, v129
v_cvt_pk_bf16_f32 v77, v130, v131
v_cvt_pk_bf16_f32 v78, v132, v133
v_cvt_pk_bf16_f32 v79, v134, v135
v_mfma_f32_32x32x16_bf16 v[136:151], v[212:215], v[60:63], v[136:151]
ds_write_b128 v104, v[76:79] offset:160
s_waitcnt lgkmcnt(3)
s_add_u32 s33, s35, 327680
buffer_store_dwordx4 v[88:91], v102, s[4:7], s33 offen offset:0
v_mfma_f32_32x32x16_bf16 v[136:151], v[216:219], v[64:67], v[136:151]
v_mfma_f32_32x32x16_bf16 v[136:151], v[220:223], v[68:71], v[136:151]
s_waitcnt lgkmcnt(2)
s_add_u32 s33, s35, 491520
buffer_store_dwordx4 v[92:95], v102, s[4:7], s33 offen offset:0
v_mfma_f32_32x32x16_bf16 v[120:135], v[224:227], v[40:43], 0
v_mfma_f32_32x32x16_bf16 v[120:135], v[228:231], v[44:47], v[120:135]
v_mfma_f32_32x32x16_bf16 v[120:135], v[232:235], v[48:51], v[120:135]
v_cvt_pk_bf16_f32 v72, v136, v137
v_cvt_pk_bf16_f32 v73, v138, v139
v_cvt_pk_bf16_f32 v74, v140, v141
v_cvt_pk_bf16_f32 v75, v142, v143
v_mfma_f32_32x32x16_bf16 v[120:135], v[236:239], v[52:55], v[120:135]
ds_write_b128 v104, v[72:75] offset:192
v_mfma_f32_32x32x16_bf16 v[120:135], v[240:243], v[56:59], v[120:135]
v_cvt_pk_bf16_f32 v76, v144, v145
v_cvt_pk_bf16_f32 v77, v146, v147
v_cvt_pk_bf16_f32 v78, v148, v149
v_cvt_pk_bf16_f32 v79, v150, v151
v_mfma_f32_32x32x16_bf16 v[120:135], v[244:247], v[60:63], v[120:135]
ds_write_b128 v104, v[76:79] offset:224
ds_read_b128 v[80:83], v100 offset:128
ds_read_b128 v[84:87], v100 offset:2816
v_mfma_f32_32x32x16_bf16 v[120:135], v[248:251], v[64:67], v[120:135]
ds_read_b128 v[88:91], v100 offset:5504
ds_read_b128 v[92:95], v100 offset:8192
v_mfma_f32_32x32x16_bf16 v[120:135], v[252:255], v[68:71], v[120:135]
s_waitcnt lgkmcnt(3)
s_add_u32 s33, s35, 0
buffer_store_dwordx4 v[80:83], v102, s[4:7], s33 offen offset:128
s_waitcnt lgkmcnt(2)
s_add_u32 s33, s35, 163840
buffer_store_dwordx4 v[84:87], v102, s[4:7], s33 offen offset:128
s_waitcnt lgkmcnt(1)
s_add_u32 s33, s35, 327680
buffer_store_dwordx4 v[88:91], v102, s[4:7], s33 offen offset:128
s_waitcnt lgkmcnt(0)
s_add_u32 s33, s35, 491520
buffer_store_dwordx4 v[92:95], v102, s[4:7], s33 offen offset:128
s_branch L_Fjoin
L_Fb3:
s_waitcnt lgkmcnt(3)
v_mfma_f32_32x32x16_bf16 v[120:135], a[160:163], v[40:43], 0
s_add_u32 s30, s65, 1
s_and_b32 s67, s30, 3
s_lshl_b32 s68, s27, 3
s_add_u32 s67, s67, s68
s_lshr_b32 s68, s25, 1
s_mul_i32 s68, s68, 20480
s_mul_i32 s67, s67, 40960
s_add_u32 s67, s67, s68
s_add_u32 s67, s67, 9437184
ds_read_b128 v[56:59], v2 offset:45056
ds_read_b128 v[60:63], v2 offset:46080
s_waitcnt lgkmcnt(4)
v_mfma_f32_32x32x16_bf16 v[120:135], a[164:167], v[44:47], v[120:135]
s_mov_b32 m0, s68
s_nop 0
buffer_load_dwordx4 v5, s[4:7], s67 offen offset:0 sc1 lds
ds_read_b128 v[64:67], v2 offset:47104
ds_read_b128 v[68:71], v2 offset:48128
s_waitcnt lgkmcnt(5)
v_mfma_f32_32x32x16_bf16 v[120:135], a[168:171], v[48:51], v[120:135]
buffer_load_dwordx4 v5, s[4:7], s67 offen offset:1024 sc1 lds
s_waitcnt lgkmcnt(4)
v_mfma_f32_32x32x16_bf16 v[120:135], a[172:175], v[52:55], v[120:135]
buffer_load_dwordx4 v5, s[4:7], s67 offen offset:2048 sc1 lds
s_waitcnt lgkmcnt(3)
v_mfma_f32_32x32x16_bf16 v[120:135], a[176:179], v[56:59], v[120:135]
buffer_load_dwordx4 v5, s[4:7], s67 offen offset:3072 sc1 lds
s_waitcnt lgkmcnt(2)
v_mfma_f32_32x32x16_bf16 v[120:135], a[180:183], v[60:63], v[120:135]
s_add_u32 s68, s68, 4096
s_add_u32 s67, s67, 4096
s_mov_b32 m0, s68
s_nop 0
buffer_load_dwordx4 v5, s[4:7], s67 offen offset:0 sc1 lds
s_waitcnt lgkmcnt(1)
v_mfma_f32_32x32x16_bf16 v[120:135], a[184:187], v[64:67], v[120:135]
buffer_load_dwordx4 v5, s[4:7], s67 offen offset:1024 sc1 lds
s_waitcnt lgkmcnt(0)
v_mfma_f32_32x32x16_bf16 v[120:135], a[188:191], v[68:71], v[120:135]
buffer_load_dwordx4 v5, s[4:7], s67 offen offset:2048 sc1 lds
v_mfma_f32_32x32x16_bf16 v[136:151], a[192:195], v[40:43], 0
buffer_load_dwordx4 v5, s[4:7], s67 offen offset:3072 sc1 lds
buffer_load_dword v10, v8, s[4:7], s74 offen offset:2048 sc1
s_add_u32 s35, s78, s76
v_mfma_f32_32x32x16_bf16 v[136:151], a[196:199], v[44:47], v[136:151]
s_add_u32 s68, s68, 4096
s_add_u32 s67, s67, 4096
s_mov_b32 m0, s68
s_nop 0
buffer_load_dwordx4 v5, s[4:7], s67 offen offset:0 sc1 lds
v_mfma_f32_32x32x16_bf16 v[136:151], a[200:203], v[48:51], v[136:151]
buffer_load_dwordx4 v5, s[4:7], s67 offen offset:1024 sc1 lds
v_cvt_pk_bf16_f32 v72, v120, v121
v_cvt_pk_bf16_f32 v73, v122, v123
v_cvt_pk_bf16_f32 v74, v124, v125
v_cvt_pk_bf16_f32 v75, v126, v127
v_mfma_f32_32x32x16_bf16 v[136:151], a[204:207], v[52:55], v[136:151]
buffer_load_dwordx4 v5, s[4:7], s67 offen offset:2048 sc1 lds
ds_write_b128 v104, v[72:75] offset:0
v_mfma_f32_32x32x16_bf16 v[136:151], a[208:211], v[56:59], v[136:151]
buffer_load_dwordx4 v5, s[4:7], s67 offen offset:3072 sc1 lds
v_cvt_pk_bf16_f32 v76, v128, v129
v_cvt_pk_bf16_f32 v77, v130, v131
v_cvt_pk_bf16_f32 v78, v132, v133
v_cvt_pk_bf16_f32 v79, v134, v135
v_mfma_f32_32x32x16_bf16 v[136:151], a[212:215], v[60:63], v[136:151]
s_add_u32 s68, s68, 4096
s_add_u32 s67, s67, 4096
s_mov_b32 m0, s68
s_nop 0
buffer_load_dwordx4 v5, s[4:7], s67 offen offset:0 sc1 lds
ds_write_b128 v104, v[76:79] offset:32
v_mfma_f32_32x32x16_bf16 v[136:151], a[216:219], v[64:67], v[136:151]
buffer_load_dwordx4 v5, s[4:7], s67 offen offset:1024 sc1 lds
v_mfma_f32_32x32x16_bf16 v[136:151], a[220:223], v[68:71], v[136:151]
buffer_load_dwordx4 v5, s[4:7], s67 offen offset:2048 sc1 lds
v_mfma_f32_32x32x16_bf16 v[120:135], a[224:227], v[40:43], 0
buffer_load_dwordx4 v5, s[4:7], s67 offen offset:3072 sc1 lds
v_mfma_f32_32x32x16_bf16 v[120:135], a[228:231], v[44:47], v[120:135]
s_add_u32 s68, s68, 4096
s_add_u32 s67, s67, 4096
s_mov_b32 m0, s68
s_nop 0
buffer_load_dwordx4 v5, s[4:7], s67 offen offset:0 sc1 lds
v_mfma_f32_32x32x16_bf16 v[120:135], a[232:235], v[48:51], v[120:135]
buffer_load_dwordx4 v5, s[4:7], s67 offen offset:1024 sc1 lds
v_cvt_pk_bf16_f32 v72, v136, v137
v_cvt_pk_bf16_f32 v73, v138, v139
v_cvt_pk_bf16_f32 v74, v140, v141
v_cvt_pk_bf16_f32 v75, v142, v143
v_mfma_f32_32x32x16_bf16 v[120:135], a[236:239], v[52:55], v[120:135]
buffer_load_dwordx4 v5, s[4:7], s67 offen offset:2048 sc1 lds
ds_write_b128 v104, v[72:75] offset:64
v_mfma_f32_32x32x16_bf16 v[120:135], a[240:243], v[56:59], v[120:135]
buffer_load_dwordx4 v5, s[4:7], s67 offen offset:3072 sc1 lds
v_cvt_pk_bf16_f32 v76, v144, v145
v_cvt_pk_bf16_f32 v77, v146, v147
v_cvt_pk_bf16_f32 v78, v148, v149
v_cvt_pk_bf16_f32 v79, v150, v151
v_mfma_f32_32x32x16_bf16 v[120:135], a[244:247], v[60:63], v[120:135]
ds_write_b128 v104, v[76:79] offset:96
ds_read_b128 v[80:83], v100 offset:0
ds_read_b128 v[84:87], v100 offset:2688
v_mfma_f32_32x32x16_bf16 v[120:135], a[248:251], v[64:67], v[120:135]
ds_read_b128 v[88:91], v100 offset:5376
ds_read_b128 v[92:95], v100 offset:8064
v_mfma_f32_32x32x16_bf16 v[120:135], a[252:255], v[68:71], v[120:135]
s_waitcnt vmcnt(12)
v_add_u32 v10, 1, v10
v_cmp_gt_u32 vcc, s65, v10
s_mov_b32 s28, 0
s_cbranch_vccnz sf68
sf69:
v_mfma_f32_32x32x16_bf16 v[136:151], v[192:195], v[40:43], 0
v_mfma_f32_32x32x16_bf16 v[136:151], v[196:199], v[44:47], v[136:151]
s_waitcnt lgkmcnt(3)
s_add_u32 s33, s35, 0
buffer_store_dwordx4 v[80:83], v102, s[4:7], s33 offen offset:0
v_mfma_f32_32x32x16_bf16 v[136:151], v[200:203], v[48:51], v[136:151]
v_cvt_pk_bf16_f32 v72, v120, v121
v_cvt_pk_bf16_f32 v73, v122, v123
v_cvt_pk_bf16_f32 v74, v124, v125
v_cvt_pk_bf16_f32 v75, v126, v127
v_mfma_f32_32x32x16_bf16 v[136:151], v[204:207], v[52:55], v[136:151]
ds_write_b128 v104, v[72:75] offset:128
s_waitcnt lgkmcnt(3)
s_add_u32 s33, s35, 163840
buffer_store_dwordx4 v[84:87], v102, s[4:7], s33 offen offset:0
v_mfma_f32_32x32x16_bf16 v[136:151], v[208:211], v[56:59], v[136:151]
v_cvt_pk_bf16_f32 v76, v128, v129
v_cvt_pk_bf16_f32 v77, v130, v131
v_cvt_pk_bf16_f32 v78, v132, v133
v_cvt_pk_bf16_f32 v79, v134, v135
v_mfma_f32_32x32x16_bf16 v[136:151], v[212:215], v[60:63], v[136:151]
ds_write_b128 v104, v[76:79] offset:160
s_waitcnt lgkmcnt(3)
s_add_u32 s33, s35, 327680
buffer_store_dwordx4 v[88:91], v102, s[4:7], s33 offen offset:0
v_mfma_f32_32x32x16_bf16 v[136:151], v[216:219], v[64:67], v[136:151]
v_mfma_f32_32x32x16_bf16 v[136:151], v[220:223], v[68:71], v[136:151]
s_waitcnt lgkmcnt(2)
s_add_u32 s33, s35, 491520
buffer_store_dwordx4 v[92:95], v102, s[4:7], s33 offen offset:0
v_mfma_f32_32x32x16_bf16 v[120:135], v[224:227], v[40:43], 0
v_mfma_f32_32x32x16_bf16 v[120:135], v[228:231], v[44:47], v[120:135]
v_mfma_f32_32x32x16_bf16 v[120:135], v[232:235], v[48:51], v[120:135]
v_cvt_pk_bf16_f32 v72, v136, v137
v_cvt_pk_bf16_f32 v73, v138, v139
v_cvt_pk_bf16_f32 v74, v140, v141
v_cvt_pk_bf16_f32 v75, v142, v143
v_mfma_f32_32x32x16_bf16 v[120:135], v[236:239], v[52:55], v[120:135]
ds_write_b128 v104, v[72:75] offset:192
v_mfma_f32_32x32x16_bf16 v[120:135], v[240:243], v[56:59], v[120:135]
v_cvt_pk_bf16_f32 v76, v144, v145
v_cvt_pk_bf16_f32 v77, v146, v147
v_cvt_pk_bf16_f32 v78, v148, v149
v_cvt_pk_bf16_f32 v79, v150, v151
v_mfma_f32_32x32x16_bf16 v[120:135], v[244:247], v[60:63], v[120:135]
ds_write_b128 v104, v[76:79] offset:224
ds_read_b128 v[80:83], v100 offset:128
ds_read_b128 v[84:87], v100 offset:2816
v_mfma_f32_32x32x16_bf16 v[120:135], v[248:251], v[64:67], v[120:135]
ds_read_b128 v[88:91], v100 offset:5504
ds_read_b128 v[92:95], v100 offset:8192
v_mfma_f32_32x32x16_bf16 v[120:135], v[252:255], v[68:71], v[120:135]
s_waitcnt lgkmcnt(3)
s_add_u32 s33, s35, 0
buffer_store_dwordx4 v[80:83], v102, s[4:7], s33 offen offset:128
s_waitcnt lgkmcnt(2)
s_add_u32 s33, s35, 163840
buffer_store_dwordx4 v[84:87], v102, s[4:7], s33 offen offset:128
s_waitcnt lgkmcnt(1)
s_add_u32 s33, s35, 327680
buffer_store_dwordx4 v[88:91], v102, s[4:7], s33 offen offset:128
s_waitcnt lgkmcnt(0)
s_add_u32 s33, s35, 491520
buffer_store_dwordx4 v[92:95], v102, s[4:7], s33 offen offset:128
s_waitcnt vmcnt(8)
L_Fjoin:
s_barrier
ds_read_b128 v[40:43], v17
v_cvt_pk_bf16_f32 v24, v120, v121
v_cvt_pk_bf16_f32 v25, v122, v123
v_cvt_pk_bf16_f32 v26, v124, v125
v_cvt_pk_bf16_f32 v27, v126, v127
ds_write_b128 v104, v[24:27] offset:256
v_cvt_pk_bf16_f32 v28, v128, v129
v_cvt_pk_bf16_f32 v29, v130, v131
v_cvt_pk_bf16_f32 v30, v132, v133
v_cvt_pk_bf16_f32 v31, v134, v135
ds_write_b128 v104, v[28:31] offset:288
ds_read_b128 v[24:27], v101 offset:256
ds_read_b128 v[28:31], v101 offset:5632
s_waitcnt lgkmcnt(4)
v_and_b32 v40, v40, v41
v_and_b32 v42, v42, v43
v_and_b32 v40, v40, v42
s_nop 0
v_readfirstlane_b32 s30, v40
s_nop 0
s_cmp_eq_u32 s30, 1
v_xor_b32 v17, 16, v17
v_xor_b32 v18, 16, v18
s_cbranch_scc0 f70
ds_read_b128 v[40:43], v20 offset:0
ds_read_b128 v[44:47], v21 offset:0
ds_read_b128 v[48:51], v22 offset:0
ds_read_b128 v[52:55], v23 offset:0
ds_read_b128 v[56:59], v20 offset:1024
ds_read_b128 v[60:63], v21 offset:1024
ds_read_b128 v[64:67], v22 offset:1024
ds_read_b128 v[68:71], v23 offset:1024
s_waitcnt lgkmcnt(9)
s_add_u32 s33, s35, 0
buffer_store_dwordx4 v[24:27], v103, s[4:7], s33 offen offset:256
s_waitcnt lgkmcnt(8)
s_add_u32 s33, s35, 327680
buffer_store_dwordx4 v[28:31], v103, s[4:7], s33 offen offset:256
s_waitcnt lgkmcnt(7)
v_mfma_f32_32x32x16_bf16 v[72:87], a[0:3], v[40:43], 0
ds_read_b128 v[40:43], v20 offset:2048
s_waitcnt lgkmcnt(7)
v_mfma_f32_32x32x16_bf16 v[72:87], a[4:7], v[44:47], v[72:87]
ds_read_b128 v[44:47], v21 offset:2048
s_waitcnt lgkmcnt(7)
v_mfma_f32_32x32x16_bf16 v[72:87], a[8:11], v[48:51], v[72:87]
ds_read_b128 v[48:51], v22 offset:2048
s_add_u32 s32, s62, 3
s_cmp_lt_u32 s32, 64
s_cselect_b64 s[60:61], s[54:55], s[56:57]
s_cselect_b32 s33, 0, 26
s_bfm_b64 s[34:35], s32, 0
s_and_b64 s[34:35], s[34:35], s[60:61]
s_bcnt1_i32_b64 s34, s[34:35]
s_add_u32 s33, s33, s34
s_sub_u32 s34, s32, s33
s_add_u32 s33, s33, 64
s_bitcmp1_b64 s[60:61], s32
s_cselect_b32 s64, s33, s34
s_cmp_ge_u32 s32, 128
s_cselect_b32 s64, s32, s64
s_waitcnt lgkmcnt(7)
v_mfma_f32_32x32x16_bf16 v[72:87], a[12:15], v[52:55], v[72:87]
ds_read_b128 v[52:55], v23 offset:2048
s_waitcnt lgkmcnt(7)
v_mfma_f32_32x32x16_bf16 v[72:87], a[16:19], v[56:59], v[72:87]
ds_read_b128 v[56:59], v20 offset:3072
s_waitcnt lgkmcnt(7)
v_mfma_f32_32x32x16_bf16 v[72:87], a[20:23], v[60:63], v[72:87]
ds_read_b128 v[60:63], v21 offset:3072
s_waitcnt lgkmcnt(7)
v_mfma_f32_32x32x16_bf16 v[72:87], a[24:27], v[64:67], v[72:87]
ds_read_b128 v[64:67], v22 offset:3072
s_waitcnt vmcnt(0)
v_mov_b32 v10, s65
s_cmp_eq_u32 s26, 1
s_cbranch_scc0 pb71
buffer_store_dword v10, off, s[4:7], s75
pb72:
s_cmp_eq_u32 s19, 1
s_cbranch_scc0 f73
s_atomic_add s88, s[86:87], s82
f73:
s_and_b32 s30, s65, 3
s_lshl_b32 s31, s27, 3
s_add_u32 s30, s30, s31
s_lshl_b32 s30, s30, 5
s_add_u32 s30, s30, s72
s_mul_i32 s30, s30, 1280
s_add_u32 s30, s30, 15728640
buffer_load_dwordx2 v[184:185], v107, s[4:7], s30 offen offset:0 sc1
buffer_load_dwordx2 v[186:187], v107, s[4:7], s30 offen offset:512 sc1
buffer_load_dwordx2 v[188:189], v108, s[4:7], s30 offen offset:1024 sc1
s_and_b32 s17, s63, 63
s_cmp_ge_u32 s63, 128
s_cselect_b32 s17, 64, s17
s_lshl_b32 s16, s17, 5
s_add_u32 s16, s16, s72
s_lshl_b32 s82, s17, 7
s_add_u32 s82, s82, 1056768
s_cmp_ge_u32 s63, 128
s_cselect_b32 s82, s84, s82
s_mul_i32 s16, s16, 1280
s_add_u32 s15, s16, 22020096
s_mul_i32 s17, s17, 40960
s_add_u32 s17, s17, 5767168
s_mov_b32 s45, s63
s_bfe_u32 s13, s63, 0x10006
s_waitcnt lgkmcnt(7)
v_mfma_f32_32x32x16_bf16 v[72:87], a[28:31], v[68:71], v[72:87]
ds_read_b128 v[68:71], v23 offset:3072
s_waitcnt lgkmcnt(7)
v_mfma_f32_32x32x16_bf16 v[72:87], a[32:35], v[40:43], v[72:87]
ds_read_b128 v[40:43], v20 offset:4096
s_waitcnt lgkmcnt(7)
v_mfma_f32_32x32x16_bf16 v[72:87], a[36:39], v[44:47], v[72:87]
ds_read_b128 v[44:47], v21 offset:4096
s_waitcnt lgkmcnt(7)
v_mfma_f32_32x32x16_bf16 v[72:87], a[40:43], v[48:51], v[72:87]
ds_read_b128 v[48:51], v22 offset:4096
s_waitcnt lgkmcnt(7)
v_mfma_f32_32x32x16_bf16 v[72:87], a[44:47], v[52:55], v[72:87]
ds_read_b128 v[52:55], v23 offset:4096
s_waitcnt lgkmcnt(7)
v_mfma_f32_32x32x16_bf16 v[72:87], a[48:51], v[56:59], v[72:87]
ds_read_b128 v[56:59], v20 offset:5120
s_waitcnt lgkmcnt(7)
v_mfma_f32_32x32x16_bf16 v[72:87], a[52:55], v[60:63], v[72:87]
ds_read_b128 v[60:63], v21 offset:5120
s_waitcnt lgkmcnt(7)
v_mfma_f32_32x32x16_bf16 v[72:87], a[56:59], v[64:67], v[72:87]
ds_read_b128 v[64:67], v22 offset:5120
s_waitcnt lgkmcnt(7)
v_mfma_f32_32x32x16_bf16 v[72:87], a[60:63], v[68:71], v[72:87]
ds_read_b128 v[68:71], v23 offset:5120
s_waitcnt lgkmcnt(7)
v_mfma_f32_32x32x16_bf16 v[72:87], a[64:67], v[40:43], v[72:87]
ds_read_b128 v[40:43], v20 offset:6144
s_waitcnt lgkmcnt(7)
v_mfma_f32_32x32x16_bf16 v[72:87], a[68:71], v[44:47], v[72:87]
ds_read_b128 v[44:47], v21 offset:6144
s_waitcnt lgkmcnt(7)
v_mfma_f32_32x32x16_bf16 v[72:87], a[72:75], v[48:51], v[72:87]
ds_read_b128 v[48:51], v22 offset:6144
s_waitcnt lgkmcnt(7)
v_mfma_f32_32x32x16_bf16 v[72:87], a[76:79], v[52:55], v[72:87]
ds_read_b128 v[52:55], v23 offset:6144
s_waitcnt lgkmcnt(7)
v_mfma_f32_32x32x16_bf16 v[72:87], a[80:83], v[56:59], v[72:87]
ds_read_b128 v[56:59], v20 offset:7168
s_waitcnt lgkmcnt(7)
v_mfma_f32_32x32x16_bf16 v[72:87], a[84:87], v[60:63], v[72:87]
ds_read_b128 v[60:63], v21 offset:7168
s_waitcnt lgkmcnt(7)
v_mfma_f32_32x32x16_bf16 v[72:87], a[88:91], v[64:67], v[72:87]
ds_read_b128 v[64:67], v22 offset:7168
s_waitcnt lgkmcnt(7)
v_mfma_f32_32x32x16_bf16 v[72:87], a[92:95], v[68:71], v[72:87]
ds_read_b128 v[68:71], v23 offset:7168
s_waitcnt lgkmcnt(7)
v_mfma_f32_32x32x16_bf16 v[72:87], a[96:99], v[40:43], v[72:87]
ds_read_b128 v[40:43], v20 offset:8192
buffer_load_dword v10, v8, s[4:7], s74 offen sc1
s_waitcnt lgkmcnt(7)
v_mfma_f32_32x32x16_bf16 v[72:87], a[100:103], v[44:47], v[72:87]
ds_read_b128 v[44:47], v21 offset:8192
s_waitcnt lgkmcnt(7)
v_mfma_f32_32x32x16_bf16 v[72:87], a[104:107], v[48:51], v[72:87]
ds_read_b128 v[48:51], v22 offset:8192
s_waitcnt lgkmcnt(7)
v_mfma_f32_32x32x16_bf16 v[72:87], a[108:111], v[52:55], v[72:87]
ds_read_b128 v[52:55], v23 offset:8192
s_waitcnt lgkmcnt(7)
v_mfma_f32_32x32x16_bf16 v[72:87], a[112:115], v[56:59], v[72:87]
ds_read_b128 v[56:59], v20 offset:9216
s_waitcnt lgkmcnt(7)
v_mfma_f32_32x32x16_bf16 v[72:87], a[116:119], v[60:63], v[72:87]
ds_read_b128 v[60:63], v21 offset:9216
s_waitcnt lgkmcnt(7)
v_mfma_f32_32x32x16_bf16 v[72:87], a[120:123], v[64:67], v[72:87]
ds_read_b128 v[64:67], v22 offset:9216
s_waitcnt vmcnt(0)
v_cmp_gt_u32 vcc, s65, v10
s_nop 0
s_cmp_eq_u64 vcc, 0
s_cbranch_scc1 g74
s_mov_b32 s28, 0
p75:
buffer_load_dword v10, v8, s[4:7], s74 offen sc1
s_waitcnt vmcnt(0)
v_cmp_gt_u32 vcc, s65, v10
s_nop 0
s_cmp_eq_u64 vcc, 0
s_cbranch_scc1 p76
s_add_u32 s28, s28, 1
s_cmp_lt_u32 s28, 524288
s_cbranch_scc1 p75
s_mov_b32 s29, 31
s_branch L_abort
p76:
g74:
s_cmp_eq_u32 s26, 1
s_cbranch_scc0 gq77
gq78:
s_add_u32 s34, s79, s76
s_add_u32 s35, s34, 5120
s_waitcnt lgkmcnt(7)
v_mfma_f32_32x32x16_bf16 v[72:87], a[124:127], v[68:71], v[72:87]
ds_read_b128 v[68:71], v23 offset:9216
buffer_load_dwordx4 v[120:123], v105, s[4:7], s34 offen offset:0 sc1
s_waitcnt lgkmcnt(7)
v_mfma_f32_32x32x16_bf16 v[72:87], a[128:131], v[40:43], v[72:87]
buffer_load_dwordx4 v[124:127], v105, s[4:7], s34 offen offset:256 sc1
s_waitcnt lgkmcnt(6)
v_mfma_f32_32x32x16_bf16 v[72:87], a[132:135], v[44:47], v[72:87]
buffer_load_dwordx4 v[128:131], v105, s[4:7], s34 offen offset:512 sc1
s_waitcnt lgkmcnt(5)
v_mfma_f32_32x32x16_bf16 v[72:87], a[136:139], v[48:51], v[72:87]
buffer_load_dwordx4 v[132:135], v105, s[4:7], s34 offen offset:768 sc1
s_waitcnt lgkmcnt(4)
v_mfma_f32_32x32x16_bf16 v[72:87], a[140:143], v[52:55], v[72:87]
buffer_load_dwordx4 v[136:139], v105, s[4:7], s34 offen offset:1024 sc1
s_waitcnt lgkmcnt(3)
v_mfma_f32_32x32x16_bf16 v[72:87], a[144:147], v[56:59], v[72:87]
buffer_load_dwordx4 v[140:143], v106, s[4:7], s35 offen offset:0 sc1
s_waitcnt lgkmcnt(2)
v_mfma_f32_32x32x16_bf16 v[72:87], a[148:151], v[60:63], v[72:87]
buffer_load_dwordx4 v[144:147], v106, s[4:7], s35 offen offset:256 sc1
s_waitcnt lgkmcnt(1)
v_mfma_f32_32x32x16_bf16 v[72:87], a[152:155], v[64:67], v[72:87]
buffer_load_dwordx4 v[148:151], v106, s[4:7], s35 offen offset:512 sc1
s_waitcnt lgkmcnt(0)
v_mfma_f32_32x32x16_bf16 v[72:87], a[156:159], v[68:71], v[72:87]
buffer_load_dwordx4 v[152:155], v106, s[4:7], s35 offen offset:768 sc1
s_add_u32 s83, s65, 2
s_and_b32 s31, s83, 3
s_lshl_b32 s30, s27, 3
s_add_u32 s31, s31, s30
s_lshl_b32 s31, s31, 12
s_add_u32 s31, s31, 1572864
buffer_load_dword v9, v0, s[4:7], s31 offen sc1
s_nop 3
v_pk_mul_f32 v[40:41], v[72:73], s[80:81]
v_pk_mul_f32 v[42:43], v[74:75], s[80:81]
v_pk_mul_f32 v[44:45], v[76:77], s[80:81]
v_pk_mul_f32 v[46:47], v[78:79], s[80:81]
v_pk_mul_f32 v[48:49], v[80:81], s[80:81]
v_pk_mul_f32 v[50:51], v[82:83], s[80:81]
v_pk_mul_f32 v[52:53], v[84:85], s[80:81]
v_pk_mul_f32 v[54:55], v[86:87], s[80:81]
v_exp_f32 v40, v40
v_exp_f32 v41, v41
v_exp_f32 v42, v42
v_exp_f32 v43, v43
v_exp_f32 v44, v44
v_exp_f32 v45, v45
v_exp_f32 v46, v46
v_exp_f32 v47, v47
v_exp_f32 v48, v48
v_exp_f32 v49, v49
v_exp_f32 v50, v50
v_exp_f32 v51, v51
v_exp_f32 v52, v52
v_exp_f32 v53, v53
v_exp_f32 v54, v54
v_exp_f32 v55, v55
v_pk_add_f32 v[40:41], v[40:41], 1.0 op_sel_hi:[1,0]
v_pk_add_f32 v[42:43], v[42:43], 1.0 op_sel_hi:[1,0]
v_pk_add_f32 v[44:45], v[44:45], 1.0 op_sel_hi:[1,0]
v_pk_add_f32 v[46:47], v[46:47], 1.0 op_sel_hi:[1,0]
v_pk_add_f32 v[48:49], v[48:49], 1.0 op_sel_hi:[1,0]
v_pk_add_f32 v[50:51], v[50:51], 1.0 op_sel_hi:[1,0]
v_pk_add_f32 v[52:53], v[52:53], 1.0 op_sel_hi:[1,0]
v_pk_add_f32 v[54:55], v[54:55], 1.0 op_sel_hi:[1,0]
v_rcp_f32 v40, v40
v_rcp_f32 v41, v41
v_rcp_f32 v42, v42
v_rcp_f32 v43, v43
v_rcp_f32 v44, v44
v_rcp_f32 v45, v45
v_rcp_f32 v46, v46
v_rcp_f32 v47, v47
v_rcp_f32 v48, v48
v_rcp_f32 v49, v49
v_rcp_f32 v50, v50
v_rcp_f32 v51, v51
v_rcp_f32 v52, v52
v_rcp_f32 v53, v53
v_rcp_f32 v54, v54
v_rcp_f32 v55, v55
v_pk_mul_f32 v[72:73], v[72:73], v[40:41]
v_pk_mul_f32 v[74:75], v[74:75], v[42:43]
v_pk_mul_f32 v[76:77], v[76:77], v[44:45]
v_pk_mul_f32 v[78:79], v[78:79], v[46:47]
v_pk_mul_f32 v[80:81], v[80:81], v[48:49]
v_pk_mul_f32 v[82:83], v[82:83], v[50:51]
v_pk_mul_f32 v[84:85], v[84:85], v[52:53]
v_pk_mul_f32 v[86:87], v[86:87], v[54:55]
v_cvt_pk_bf16_f32 v88, v72, v73
v_cvt_pk_bf16_f32 v89, v74, v75
v_cvt_pk_bf16_f32 v90, v76, v77
v_cvt_pk_bf16_f32 v91, v78, v79
ds_write_b128 v16, v[88:91] offset:40960
v_cvt_pk_bf16_f32 v92, v80, v81
v_cvt_pk_bf16_f32 v93, v82, v83
v_cvt_pk_bf16_f32 v94, v84, v85
v_cvt_pk_bf16_f32 v95, v86, v87
ds_write_b128 v16, v[92:95] offset:41984
buffer_load_dwordx4 v[156:159], v106, s[4:7], s35 offen offset:1024 sc1
v_lshlrev_b32 v172, 16, v184
v_and_b32 v173, 0xffff0000, v184
v_lshlrev_b32 v174, 16, v185
v_and_b32 v175, 0xffff0000, v185
v_lshlrev_b32 v176, 16, v186
v_and_b32 v177, 0xffff0000, v186
v_lshlrev_b32 v178, 16, v187
v_and_b32 v179, 0xffff0000, v187
v_lshlrev_b32 v180, 16, v188
v_and_b32 v181, 0xffff0000, v188
v_lshlrev_b32 v182, 16, v189
v_and_b32 v183, 0xffff0000, v189
s_waitcnt vmcnt(10)
v_mfma_f32_16x16x32_bf16 v[172:175], v[112:115], v[120:123], v[172:175]
s_waitcnt vmcnt(9)
v_mfma_f32_16x16x32_bf16 v[172:175], v[116:119], v[124:127], v[172:175]
s_waitcnt vmcnt(8)
v_mfma_f32_16x16x32_bf16 v[176:179], v[112:115], v[128:131], v[176:179]
s_waitcnt vmcnt(7)
v_mfma_f32_16x16x32_bf16 v[176:179], v[116:119], v[132:135], v[176:179]
s_waitcnt vmcnt(6)
v_mfma_f32_16x16x32_bf16 v[180:183], v[112:115], v[136:139], v[180:183]
s_waitcnt vmcnt(5)
v_mfma_f32_16x16x32_bf16 v[172:175], v[112:115], v[140:143], v[172:175]
s_waitcnt vmcnt(4)
v_mfma_f32_16x16x32_bf16 v[172:175], v[116:119], v[144:147], v[172:175]
s_waitcnt vmcnt(3)
v_mfma_f32_16x16x32_bf16 v[176:179], v[112:115], v[148:151], v[176:179]
s_waitcnt vmcnt(2)
v_mfma_f32_16x16x32_bf16 v[176:179], v[116:119], v[152:155], v[176:179]
s_waitcnt vmcnt(0)
v_mfma_f32_16x16x32_bf16 v[180:183], v[112:115], v[156:159], v[180:183]
v_mov_b32 v10, s65
s_cmp_eq_u32 s26, 1
s_cbranch_scc0 cs79
buffer_store_dword v10, off, s[4:7], s75 offset:2048
cs80:
s_bitcmp1_b32 s25, 0
s_cbranch_scc0 d81
ds_write_b128 v109, v[172:175] offset:0
ds_write_b128 v109, v[176:179] offset:1024
ds_write_b128 v109, v[180:183] offset:2048
d81:
s_bitcmp1_b32 s25, 0
s_cbranch_scc0 f82
v_cmp_gt_u32 vcc, s83, v9
s_nop 0
s_cmp_eq_u32 vcc_lo, 0
s_cselect_b32 s66, 1, 0
s_cmp_ge_u32 s64, 128
s_cselect_b32 s66, 0, s66
s_cmp_eq_u32 s66, 1
s_cselect_b32 s33, 0, 0x40000000
v_or_b32 v5, s33, v2
v_mov_b32 v11, s66
ds_write_b32 v18, v11
f82:
s_waitcnt lgkmcnt(0)
s_barrier
s_add_u32 s19, s13, 1
s_bitcmp1_b32 s25, 0
s_cselect_b32 s19, 0, s19
s_branch L_Ftop
f70:
s_waitcnt lgkmcnt(1)
s_add_u32 s33, s35, 0
buffer_store_dwordx4 v[24:27], v103, s[4:7], s33 offen offset:256
s_waitcnt lgkmcnt(0)
s_add_u32 s33, s35, 327680
buffer_store_dwordx4 v[28:31], v103, s[4:7], s33 offen offset:256
s_waitcnt vmcnt(0)
v_mov_b32 v10, s65
s_cmp_eq_u32 s26, 1
s_cbranch_scc0 pb83
buffer_store_dword v10, off, s[4:7], s75
pb84:
s_cmp_eq_u32 s19, 1
s_cbranch_scc0 f85
s_atomic_add s88, s[86:87], s82
f85:
s_sleep 3
s_mov_b32 s28, 0
p87:
buffer_load_dword v10, v8, s[4:7], s74 offen sc1
s_waitcnt vmcnt(0)
v_cmp_gt_u32 vcc, s65, v10
s_nop 0
s_cmp_eq_u64 vcc, 0
s_cbranch_scc1 p88
s_add_u32 s28, s28, 1
s_cmp_lt_u32 s28, 524288
s_cbranch_scc1 p87
s_mov_b32 s29, 34
s_branch L_abort
p88:
g86:
s_cmp_eq_u32 s26, 1
s_cbranch_scc0 gq89
gq90:
s_and_b32 s30, s65, 3
s_lshl_b32 s31, s27, 3
s_add_u32 s30, s30, s31
s_lshl_b32 s30, s30, 5
s_add_u32 s30, s30, s72
s_mul_i32 s30, s30, 1280
s_add_u32 s30, s30, 15728640
buffer_load_dwordx2 v[184:185], v107, s[4:7], s30 offen offset:0 sc1
buffer_load_dwordx2 v[186:187], v107, s[4:7], s30 offen offset:512 sc1
buffer_load_dwordx2 v[188:189], v108, s[4:7], s30 offen offset:1024 sc1
s_and_b32 s17, s63, 63
s_cmp_ge_u32 s63, 128
s_cselect_b32 s17, 64, s17
s_lshl_b32 s16, s17, 5
s_add_u32 s16, s16, s72
s_lshl_b32 s82, s17, 7
s_add_u32 s82, s82, 1056768
s_cmp_ge_u32 s63, 128
s_cselect_b32 s82, s84, s82
s_mul_i32 s16, s16, 1280
s_add_u32 s15, s16, 22020096
s_mul_i32 s17, s17, 40960
s_add_u32 s17, s17, 5767168
s_mov_b32 s45, s63
s_bfe_u32 s13, s63, 0x10006
s_add_u32 s30, s79, s76
s_add_u32 s31, s30, 5120
buffer_load_dwordx4 v[120:123], v105, s[4:7], s30 offen offset:0 sc1
buffer_load_dwordx4 v[124:127], v105, s[4:7], s30 offen offset:256 sc1
buffer_load_dwordx4 v[128:131], v105, s[4:7], s30 offen offset:512 sc1
buffer_load_dwordx4 v[132:135], v105, s[4:7], s30 offen offset:768 sc1
buffer_load_dwordx4 v[136:139], v105, s[4:7], s30 offen offset:1024 sc1
buffer_load_dwordx4 v[140:143], v106, s[4:7], s31 offen offset:0 sc1
buffer_load_dwordx4 v[144:147], v106, s[4:7], s31 offen offset:256 sc1
buffer_load_dwordx4 v[148:151], v106, s[4:7], s31 offen offset:512 sc1
buffer_load_dwordx4 v[152:155], v106, s[4:7], s31 offen offset:768 sc1
buffer_load_dwordx4 v[156:159], v106, s[4:7], s31 offen offset:1024 sc1
s_waitcnt vmcnt(10)
v_lshlrev_b32 v172, 16, v184
v_and_b32 v173, 0xffff0000, v184
v_lshlrev_b32 v174, 16, v185
v_and_b32 v175, 0xffff0000, v185
v_lshlrev_b32 v176, 16, v186
v_and_b32 v177, 0xffff0000, v186
v_lshlrev_b32 v178, 16, v187
v_and_b32 v179, 0xffff0000, v187
v_lshlrev_b32 v180, 16, v188
v_and_b32 v181, 0xffff0000, v188
v_lshlrev_b32 v182, 16, v189
v_and_b32 v183, 0xffff0000, v189
s_waitcnt vmcnt(9)
v_mfma_f32_16x16x32_bf16 v[172:175], v[112:115], v[120:123], v[172:175]
s_waitcnt vmcnt(8)
v_mfma_f32_16x16x32_bf16 v[172:175], v[116:119], v[124:127], v[172:175]
s_waitcnt vmcnt(7)
v_mfma_f32_16x16x32_bf16 v[176:179], v[112:115], v[128:131], v[176:179]
s_waitcnt vmcnt(6)
v_mfma_f32_16x16x32_bf16 v[176:179], v[116:119], v[132:135], v[176:179]
s_waitcnt vmcnt(5)
v_mfma_f32_16x16x32_bf16 v[180:183], v[112:115], v[136:139], v[180:183]
s_waitcnt vmcnt(4)
v_mfma_f32_16x16x32_bf16 v[172:175], v[112:115], v[140:143], v[172:175]
s_waitcnt vmcnt(3)
v_mfma_f32_16x16x32_bf16 v[172:175], v[116:119], v[144:147], v[172:175]
s_waitcnt vmcnt(2)
v_mfma_f32_16x16x32_bf16 v[176:179], v[112:115], v[148:151], v[176:179]
s_waitcnt vmcnt(1)
v_mfma_f32_16x16x32_bf16 v[176:179], v[116:119], v[152:155], v[176:179]
s_waitcnt vmcnt(0)
v_mfma_f32_16x16x32_bf16 v[180:183], v[112:115], v[156:159], v[180:183]
v_mov_b32 v10, s65
s_cmp_eq_u32 s26, 1
s_cbranch_scc0 cs91
buffer_store_dword v10, off, s[4:7], s75 offset:2048
cs92:
s_bitcmp1_b32 s25, 0
s_cbranch_scc0 d93
ds_write_b128 v109, v[172:175] offset:0
ds_write_b128 v109, v[176:179] offset:1024
ds_write_b128 v109, v[180:183] offset:2048
d93:
s_waitcnt lgkmcnt(0)
s_barrier
s_bitcmp1_b32 s25, 0
s_cbranch_scc1 f94
s_cmp_eq_u32 s13, 1
s_cbranch_scc1 f95
ds_read_b128 v[160:163], v109 offset:0
ds_read_b128 v[164:167], v109 offset:1024
ds_read_b128 v[168:171], v109 offset:2048
s_waitcnt lgkmcnt(2)
v_pk_add_f32 v[172:173], v[172:173], v[160:161]
v_pk_add_f32 v[174:175], v[174:175], v[162:163]
s_waitcnt lgkmcnt(1)
v_pk_add_f32 v[176:177], v[176:177], v[164:165]
v_pk_add_f32 v[178:179], v[178:179], v[166:167]
s_waitcnt lgkmcnt(0)
v_pk_add_f32 v[180:181], v[180:181], v[168:169]
v_pk_add_f32 v[182:183], v[182:183], v[170:171]
v_cvt_pk_bf16_f32 v160, v172, v173
v_cvt_pk_bf16_f32 v161, v174, v175
v_cvt_pk_bf16_f32 v162, v176, v177
v_cvt_pk_bf16_f32 v163, v178, v179
v_cvt_pk_bf16_f32 v164, v180, v181
v_cvt_pk_bf16_f32 v165, v182, v183
v_mov_b32 v166, v164
v_mov_b32 v167, v165
v_permlane16_swap_b32 v160, v162
v_permlane16_swap_b32 v161, v163
v_permlane16_swap_b32 v164, v166
v_permlane16_swap_b32 v165, v167
buffer_store_dwordx4 v[160:163], v96, s[4:7], s15 offen sc1
buffer_store_dwordx4 v[164:167], v97, s[4:7], s15 offen sc1
v_pk_add_f32 v[190:191], v[172:173], v[174:175]
v_pk_mul_f32 v[168:169], v[172:173], v[172:173]
v_pk_fma_f32 v[168:169], v[174:175], v[174:175], v[168:169]
v_pk_add_f32 v[190:191], v[190:191], v[176:177]
v_pk_fma_f32 v[168:169], v[176:177], v[176:177], v[168:169]
v_pk_add_f32 v[190:191], v[190:191], v[178:179]
v_pk_fma_f32 v[168:169], v[178:179], v[178:179], v[168:169]
v_pk_add_f32 v[190:191], v[190:191], v[180:181]
v_pk_fma_f32 v[168:169], v[180:181], v[180:181], v[168:169]
v_pk_add_f32 v[190:191], v[190:191], v[182:183]
v_pk_fma_f32 v[168:169], v[182:183], v[182:183], v[168:169]
v_add_f32 v190, v190, v191
v_add_f32 v168, v168, v169
s_add_u32 s18, s17, s73
v_add_f32 v190, v190, v190 row_ror:8 row_mask:0xf bank_mask:0xf
v_add_f32 v168, v168, v168 row_ror:8 row_mask:0xf bank_mask:0xf
s_nop 0
v_add_f32 v190, v190, v190 row_ror:4 row_mask:0xf bank_mask:0xf
v_add_f32 v168, v168, v168 row_ror:4 row_mask:0xf bank_mask:0xf
s_nop 0
v_add_f32 v190, v190, v190 row_ror:2 row_mask:0xf bank_mask:0xf
v_add_f32 v168, v168, v168 row_ror:2 row_mask:0xf bank_mask:0xf
s_nop 0
v_add_f32 v190, v190, v190 row_ror:1 row_mask:0xf bank_mask:0xf
v_add_f32 v168, v168, v168 row_ror:1 row_mask:0xf bank_mask:0xf
s_nop 0
v_mov_b32 v191, v190
v_mov_b32 v169, v168
s_nop 0
v_permlane32_swap_b32 v190, v191
v_permlane32_swap_b32 v168, v169
v_add_f32 v190, v190, v191
v_add_f32 v168, v168, v169
v_mov_b32 v191, v190
v_mov_b32 v169, v168
s_nop 0
v_permlane16_swap_b32 v190, v191
v_permlane16_swap_b32 v168, v169
v_add_f32 v190, v190, v191
v_add_f32 v168, v168, v169
v_mul_f32 v190, 0xbacccccd, v190
v_mul_f32 v191, v190, v190
v_fma_f32 v168, v168, s101, -v191
v_max_f32 v168, 0, v168
v_add_f32 v168, 0x3727c5ac, v168
v_rsq_f32 v168, v168
s_nop 0
v_mul_f32 v190, v190, v168
v_pk_fma_f32 v[172:173], v[172:173], v[168:169], v[190:191] op_sel_hi:[1,0,0]
v_cvt_pk_bf16_f32 v172, v172, v173
v_pk_fma_f32 v[174:175], v[174:175], v[168:169], v[190:191] op_sel_hi:[1,0,0]
v_cvt_pk_bf16_f32 v173, v174, v175
v_pk_fma_f32 v[176:177], v[176:177], v[168:169], v[190:191] op_sel_hi:[1,0,0]
v_cvt_pk_bf16_f32 v174, v176, v177
v_pk_fma_f32 v[178:179], v[178:179], v[168:169], v[190:191] op_sel_hi:[1,0,0]
v_cvt_pk_bf16_f32 v175, v178, v179
v_pk_fma_f32 v[180:181], v[180:181], v[168:169], v[190:191] op_sel_hi:[1,0,0]
v_cvt_pk_bf16_f32 v176, v180, v181
v_pk_fma_f32 v[182:183], v[182:183], v[168:169], v[190:191] op_sel_hi:[1,0,0]
v_cvt_pk_bf16_f32 v177, v182, v183
v_mov_b32 v178, v176
v_mov_b32 v179, v177
v_permlane16_swap_b32 v172, v174
v_permlane16_swap_b32 v173, v175
v_permlane16_swap_b32 v176, v178
v_permlane16_swap_b32 v177, v179
buffer_store_dwordx4 v[172:175], v110, s[4:7], s18 offen sc1
buffer_store_dwordx4 v[176:179], v111, s[4:7], s18 offen sc1
s_waitcnt vmcnt(0)
s_atomic_add s88, s[86:87], s82
s_branch f94
f95:
ds_read_b128 v[160:163], v109 offset:0
ds_read_b128 v[164:167], v109 offset:1024
ds_read_b128 v[168:171], v109 offset:2048
s_waitcnt lgkmcnt(2)
v_pk_add_f32 v[172:173], v[172:173], v[160:161]
v_pk_add_f32 v[174:175], v[174:175], v[162:163]
s_waitcnt lgkmcnt(1)
v_pk_add_f32 v[176:177], v[176:177], v[164:165]
v_pk_add_f32 v[178:179], v[178:179], v[166:167]
s_waitcnt lgkmcnt(0)
v_pk_add_f32 v[180:181], v[180:181], v[168:169]
v_pk_add_f32 v[182:183], v[182:183], v[170:171]
v_cvt_pk_bf16_f32 v160, v172, v173
v_cvt_pk_bf16_f32 v161, v174, v175
v_cvt_pk_bf16_f32 v162, v176, v177
v_cvt_pk_bf16_f32 v163, v178, v179
v_cvt_pk_bf16_f32 v164, v180, v181
v_cvt_pk_bf16_f32 v165, v182, v183
v_mov_b32 v166, v164
v_mov_b32 v167, v165
v_permlane16_swap_b32 v160, v162
v_permlane16_swap_b32 v161, v163
v_permlane16_swap_b32 v164, v166
v_permlane16_swap_b32 v165, v167
buffer_store_dwordx4 v[160:163], v96, s[96:99], s16 offen
buffer_store_dwordx4 v[164:167], v97, s[96:99], s16 offen
f94:
s_cmp_ge_u32 s14, 128
s_cbranch_scc1 L_end
L_Fblock:
s_bitcmp1_b32 s25, 0
s_cbranch_scc0 f96
s_cmp_eq_u32 s66, 1
s_cbranch_scc1 f97
s_mov_b32 s28, 0
p98:
s_add_u32 s83, s65, 1
s_and_b32 s31, s83, 3
s_lshl_b32 s30, s27, 3
s_add_u32 s31, s31, s30
s_lshl_b32 s31, s31, 12
s_add_u32 s31, s31, 1572864
buffer_load_dword v9, v0, s[4:7], s31 offen sc1
s_waitcnt vmcnt(0)
v_cmp_gt_u32 vcc, s83, v9
s_nop 0
s_cmp_eq_u32 vcc_lo, 0
s_cbranch_scc1 p99
s_sleep 1
s_add_u32 s28, s28, 1
s_cmp_lt_u32 s28, 524288
s_cbranch_scc1 p98
s_mov_b32 s29, 32
s_branch L_abort
p99:
s_add_u32 s30, s65, 1
s_and_b32 s67, s30, 3
s_lshl_b32 s68, s27, 3
s_add_u32 s67, s67, s68
s_lshr_b32 s68, s25, 1
s_mul_i32 s68, s68, 20480
s_mul_i32 s67, s67, 40960
s_add_u32 s67, s67, s68
s_add_u32 s67, s67, 9437184
s_mov_b32 m0, s68
s_nop 0
buffer_load_dwordx4 v2, s[4:7], s67 offen offset:0 sc1 lds
buffer_load_dwordx4 v2, s[4:7], s67 offen offset:1024 sc1 lds
buffer_load_dwordx4 v2, s[4:7], s67 offen offset:2048 sc1 lds
buffer_load_dwordx4 v2, s[4:7], s67 offen offset:3072 sc1 lds
s_add_u32 s68, s68, 4096
s_add_u32 s67, s67, 4096
s_mov_b32 m0, s68
s_nop 0
buffer_load_dwordx4 v2, s[4:7], s67 offen offset:0 sc1 lds
buffer_load_dwordx4 v2, s[4:7], s67 offen offset:1024 sc1 lds
buffer_load_dwordx4 v2, s[4:7], s67 offen offset:2048 sc1 lds
buffer_load_dwordx4 v2, s[4:7], s67 offen offset:3072 sc1 lds
s_add_u32 s68, s68, 4096
s_add_u32 s67, s67, 4096
s_mov_b32 m0, s68
s_nop 0
buffer_load_dwordx4 v2, s[4:7], s67 offen offset:0 sc1 lds
buffer_load_dwordx4 v2, s[4:7], s67 offen offset:1024 sc1 lds
buffer_load_dwordx4 v2, s[4:7], s67 offen offset:2048 sc1 lds
buffer_load_dwordx4 v2, s[4:7], s67 offen offset:3072 sc1 lds
s_add_u32 s68, s68, 4096
s_add_u32 s67, s67, 4096
s_mov_b32 m0, s68
s_nop 0
buffer_load_dwordx4 v2, s[4:7], s67 offen offset:0 sc1 lds
buffer_load_dwordx4 v2, s[4:7], s67 offen offset:1024 sc1 lds
buffer_load_dwordx4 v2, s[4:7], s67 offen offset:2048 sc1 lds
buffer_load_dwordx4 v2, s[4:7], s67 offen offset:3072 sc1 lds
s_add_u32 s68, s68, 4096
s_add_u32 s67, s67, 4096
s_mov_b32 m0, s68
s_nop 0
buffer_load_dwordx4 v2, s[4:7], s67 offen offset:0 sc1 lds
buffer_load_dwordx4 v2, s[4:7], s67 offen offset:1024 sc1 lds
buffer_load_dwordx4 v2, s[4:7], s67 offen offset:2048 sc1 lds
buffer_load_dwordx4 v2, s[4:7], s67 offen offset:3072 sc1 lds
s_waitcnt vmcnt(0)
f97:
f96:
s_barrier
ds_read_b128 v[40:43], v20 offset:0
ds_read_b128 v[44:47], v21 offset:0
ds_read_b128 v[48:51], v22 offset:0
ds_read_b128 v[52:55], v23 offset:0
ds_read_b128 v[56:59], v20 offset:1024
ds_read_b128 v[60:63], v21 offset:1024
ds_read_b128 v[64:67], v22 offset:1024
ds_read_b128 v[68:71], v23 offset:1024
s_waitcnt lgkmcnt(7)
v_mfma_f32_32x32x16_bf16 v[72:87], a[0:3], v[40:43], 0
ds_read_b128 v[40:43], v20 offset:2048
s_waitcnt lgkmcnt(7)
v_mfma_f32_32x32x16_bf16 v[72:87], a[4:7], v[44:47], v[72:87]
ds_read_b128 v[44:47], v21 offset:2048
s_waitcnt lgkmcnt(7)
v_mfma_f32_32x32x16_bf16 v[72:87], a[8:11], v[48:51], v[72:87]
ds_read_b128 v[48:51], v22 offset:2048
s_add_u32 s32, s62, 3
s_cmp_lt_u32 s32, 64
s_cselect_b64 s[60:61], s[54:55], s[56:57]
s_cselect_b32 s33, 0, 26
s_bfm_b64 s[34:35], s32, 0
s_and_b64 s[34:35], s[34:35], s[60:61]
s_bcnt1_i32_b64 s34, s[34:35]
s_add_u32 s33, s33, s34
s_sub_u32 s34, s32, s33
s_add_u32 s33, s33, 64
s_bitcmp1_b64 s[60:61], s32
s_cselect_b32 s64, s33, s34
s_cmp_ge_u32 s32, 128
s_cselect_b32 s64, s32, s64
s_waitcnt lgkmcnt(7)
v_mfma_f32_32x32x16_bf16 v[72:87], a[12:15], v[52:55], v[72:87]
ds_read_b128 v[52:55], v23 offset:2048
s_waitcnt lgkmcnt(7)
v_mfma_f32_32x32x16_bf16 v[72:87], a[16:19], v[56:59], v[72:87]
ds_read_b128 v[56:59], v20 offset:3072
s_waitcnt lgkmcnt(7)
v_mfma_f32_32x32x16_bf16 v[72:87], a[20:23], v[60:63], v[72:87]
ds_read_b128 v[60:63], v21 offset:3072
s_waitcnt lgkmcnt(7)
v_mfma_f32_32x32x16_bf16 v[72:87], a[24:27], v[64:67], v[72:87]
ds_read_b128 v[64:67], v22 offset:3072
s_waitcnt lgkmcnt(7)
v_mfma_f32_32x32x16_bf16 v[72:87], a[28:31], v[68:71], v[72:87]
ds_read_b128 v[68:71], v23 offset:3072
s_waitcnt lgkmcnt(7)
v_mfma_f32_32x32x16_bf16 v[72:87], a[32:35], v[40:43], v[72:87]
ds_read_b128 v[40:43], v20 offset:4096
s_waitcnt lgkmcnt(7)
v_mfma_f32_32x32x16_bf16 v[72:87], a[36:39], v[44:47], v[72:87]
ds_read_b128 v[44:47], v21 offset:4096
s_waitcnt lgkmcnt(7)
v_mfma_f32_32x32x16_bf16 v[72:87], a[40:43], v[48:51], v[72:87]
ds_read_b128 v[48:51], v22 offset:4096
s_waitcnt lgkmcnt(7)
v_mfma_f32_32x32x16_bf16 v[72:87], a[44:47], v[52:55], v[72:87]
ds_read_b128 v[52:55], v23 offset:4096
s_waitcnt lgkmcnt(7)
v_mfma_f32_32x32x16_bf16 v[72:87], a[48:51], v[56:59], v[72:87]
ds_read_b128 v[56:59], v20 offset:5120
s_waitcnt lgkmcnt(7)
v_mfma_f32_32x32x16_bf16 v[72:87], a[52:55], v[60:63], v[72:87]
ds_read_b128 v[60:63], v21 offset:5120
s_waitcnt lgkmcnt(7)
v_mfma_f32_32x32x16_bf16 v[72:87], a[56:59], v[64:67], v[72:87]
ds_read_b128 v[64:67], v22 offset:5120
s_waitcnt lgkmcnt(7)
v_mfma_f32_32x32x16_bf16 v[72:87], a[60:63], v[68:71], v[72:87]
ds_read_b128 v[68:71], v23 offset:5120
s_waitcnt lgkmcnt(7)
v_mfma_f32_32x32x16_bf16 v[72:87], a[64:67], v[40:43], v[72:87]
ds_read_b128 v[40:43], v20 offset:6144
s_waitcnt lgkmcnt(7)
v_mfma_f32_32x32x16_bf16 v[72:87], a[68:71], v[44:47], v[72:87]
ds_read_b128 v[44:47], v21 offset:6144
s_waitcnt lgkmcnt(7)
v_mfma_f32_32x32x16_bf16 v[72:87], a[72:75], v[48:51], v[72:87]
ds_read_b128 v[48:51], v22 offset:6144
s_waitcnt lgkmcnt(7)
v_mfma_f32_32x32x16_bf16 v[72:87], a[76:79], v[52:55], v[72:87]
ds_read_b128 v[52:55], v23 offset:6144
s_waitcnt lgkmcnt(7)
v_mfma_f32_32x32x16_bf16 v[72:87], a[80:83], v[56:59], v[72:87]
ds_read_b128 v[56:59], v20 offset:7168
s_waitcnt lgkmcnt(7)
v_mfma_f32_32x32x16_bf16 v[72:87], a[84:87], v[60:63], v[72:87]
ds_read_b128 v[60:63], v21 offset:7168
s_waitcnt lgkmcnt(7)
v_mfma_f32_32x32x16_bf16 v[72:87], a[88:91], v[64:67], v[72:87]
ds_read_b128 v[64:67], v22 offset:7168
s_waitcnt lgkmcnt(7)
v_mfma_f32_32x32x16_bf16 v[72:87], a[92:95], v[68:71], v[72:87]
ds_read_b128 v[68:71], v23 offset:7168
s_waitcnt lgkmcnt(7)
v_mfma_f32_32x32x16_bf16 v[72:87], a[96:99], v[40:43], v[72:87]
ds_read_b128 v[40:43], v20 offset:8192
s_waitcnt lgkmcnt(7)
v_mfma_f32_32x32x16_bf16 v[72:87], a[100:103], v[44:47], v[72:87]
ds_read_b128 v[44:47], v21 offset:8192
s_waitcnt lgkmcnt(7)
v_mfma_f32_32x32x16_bf16 v[72:87], a[104:107], v[48:51], v[72:87]
ds_read_b128 v[48:51], v22 offset:8192
s_waitcnt lgkmcnt(7)
v_mfma_f32_32x32x16_bf16 v[72:87], a[108:111], v[52:55], v[72:87]
ds_read_b128 v[52:55], v23 offset:8192
s_waitcnt lgkmcnt(7)
v_mfma_f32_32x32x16_bf16 v[72:87], a[112:115], v[56:59], v[72:87]
ds_read_b128 v[56:59], v20 offset:9216
s_waitcnt lgkmcnt(7)
v_mfma_f32_32x32x16_bf16 v[72:87], a[116:119], v[60:63], v[72:87]
ds_read_b128 v[60:63], v21 offset:9216
s_waitcnt lgkmcnt(7)
v_mfma_f32_32x32x16_bf16 v[72:87], a[120:123], v[64:67], v[72:87]
ds_read_b128 v[64:67], v22 offset:9216
s_waitcnt lgkmcnt(7)
v_mfma_f32_32x32x16_bf16 v[72:87], a[124:127], v[68:71], v[72:87]
ds_read_b128 v[68:71], v23 offset:9216
s_waitcnt lgkmcnt(7)
v_mfma_f32_32x32x16_bf16 v[72:87], a[128:131], v[40:43], v[72:87]
s_waitcnt lgkmcnt(6)
v_mfma_f32_32x32x16_bf16 v[72:87], a[132:135], v[44:47], v[72:87]
s_waitcnt lgkmcnt(5)
v_mfma_f32_32x32x16_bf16 v[72:87], a[136:139], v[48:51], v[72:87]
s_waitcnt lgkmcnt(4)
v_mfma_f32_32x32x16_bf16 v[72:87], a[140:143], v[52:55], v[72:87]
s_waitcnt lgkmcnt(3)
v_mfma_f32_32x32x16_bf16 v[72:87], a[144:147], v[56:59], v[72:87]
s_waitcnt lgkmcnt(2)
v_mfma_f32_32x32x16_bf16 v[72:87], a[148:151], v[60:63], v[72:87]
s_waitcnt lgkmcnt(1)
v_mfma_f32_32x32x16_bf16 v[72:87], a[152:155], v[64:67], v[72:87]
s_waitcnt lgkmcnt(0)
v_mfma_f32_32x32x16_bf16 v[72:87], a[156:159], v[68:71], v[72:87]
s_add_u32 s83, s65, 2
s_and_b32 s31, s83, 3
s_lshl_b32 s30, s27, 3
s_add_u32 s31, s31, s30
s_lshl_b32 s31, s31, 12
s_add_u32 s31, s31, 1572864
buffer_load_dword v9, v0, s[4:7], s31 offen sc1
s_nop 4
v_pk_mul_f32 v[40:41], v[72:73], s[80:81]
v_pk_mul_f32 v[42:43], v[74:75], s[80:81]
v_pk_mul_f32 v[44:45], v[76:77], s[80:81]
v_pk_mul_f32 v[46:47], v[78:79], s[80:81]
v_pk_mul_f32 v[48:49], v[80:81], s[80:81]
v_pk_mul_f32 v[50:51], v[82:83], s[80:81]
v_pk_mul_f32 v[52:53], v[84:85], s[80:81]
v_pk_mul_f32 v[54:55], v[86:87], s[80:81]
v_exp_f32 v40, v40
v_exp_f32 v41, v41
v_exp_f32 v42, v42
v_exp_f32 v43, v43
v_exp_f32 v44, v44
v_exp_f32 v45, v45
v_exp_f32 v46, v46
v_exp_f32 v47, v47
v_exp_f32 v48, v48
v_exp_f32 v49, v49
v_exp_f32 v50, v50
v_exp_f32 v51, v51
v_exp_f32 v52, v52
v_exp_f32 v53, v53
v_exp_f32 v54, v54
v_exp_f32 v55, v55
v_pk_add_f32 v[40:41], v[40:41], 1.0 op_sel_hi:[1,0]
v_pk_add_f32 v[42:43], v[42:43], 1.0 op_sel_hi:[1,0]
v_pk_add_f32 v[44:45], v[44:45], 1.0 op_sel_hi:[1,0]
v_pk_add_f32 v[46:47], v[46:47], 1.0 op_sel_hi:[1,0]
v_pk_add_f32 v[48:49], v[48:49], 1.0 op_sel_hi:[1,0]
v_pk_add_f32 v[50:51], v[50:51], 1.0 op_sel_hi:[1,0]
v_pk_add_f32 v[52:53], v[52:53], 1.0 op_sel_hi:[1,0]
v_pk_add_f32 v[54:55], v[54:55], 1.0 op_sel_hi:[1,0]
v_rcp_f32 v40, v40
v_rcp_f32 v41, v41
v_rcp_f32 v42, v42
v_rcp_f32 v43, v43
v_rcp_f32 v44, v44
v_rcp_f32 v45, v45
v_rcp_f32 v46, v46
v_rcp_f32 v47, v47
v_rcp_f32 v48, v48
v_rcp_f32 v49, v49
v_rcp_f32 v50, v50
v_rcp_f32 v51, v51
v_rcp_f32 v52, v52
v_rcp_f32 v53, v53
v_rcp_f32 v54, v54
v_rcp_f32 v55, v55
v_pk_mul_f32 v[72:73], v[72:73], v[40:41]
v_pk_mul_f32 v[74:75], v[74:75], v[42:43]
v_pk_mul_f32 v[76:77], v[76:77], v[44:45]
v_pk_mul_f32 v[78:79], v[78:79], v[46:47]
v_pk_mul_f32 v[80:81], v[80:81], v[48:49]
v_pk_mul_f32 v[82:83], v[82:83], v[50:51]
v_pk_mul_f32 v[84:85], v[84:85], v[52:53]
v_pk_mul_f32 v[86:87], v[86:87], v[54:55]
v_cvt_pk_bf16_f32 v88, v72, v73
v_cvt_pk_bf16_f32 v89, v74, v75
v_cvt_pk_bf16_f32 v90, v76, v77
v_cvt_pk_bf16_f32 v91, v78, v79
ds_write_b128 v16, v[88:91] offset:40960
v_cvt_pk_bf16_f32 v92, v80, v81
v_cvt_pk_bf16_f32 v93, v82, v83
v_cvt_pk_bf16_f32 v94, v84, v85
v_cvt_pk_bf16_f32 v95, v86, v87
ds_write_b128 v16, v[92:95] offset:41984
s_bitcmp1_b32 s25, 0
s_cbranch_scc0 f100
s_waitcnt vmcnt(0)
v_cmp_gt_u32 vcc, s83, v9
s_nop 0
s_cmp_eq_u32 vcc_lo, 0
s_cselect_b32 s66, 1, 0
s_cmp_ge_u32 s64, 128
s_cselect_b32 s66, 0, s66
s_cmp_eq_u32 s66, 1
s_cselect_b32 s33, 0, 0x40000000
v_or_b32 v5, s33, v2
v_mov_b32 v11, s66
ds_write_b32 v18, v11
f100:
s_waitcnt lgkmcnt(0)
s_barrier
s_mov_b32 s19, 0
s_branch L_Ftop
pb50:
buffer_wbl2 sc1
s_waitcnt vmcnt(0)
buffer_store_dword v10, off, s[4:7], s75 sc1
s_branch pb51
gq55:
buffer_inv sc1
s_waitcnt vmcnt(0)
s_branch gq56
cs57:
buffer_store_dword v10, off, s[4:7], s75 offset:2048 sc1
s_branch cs58
sf62:
buffer_load_dword v10, v8, s[4:7], s74 offen offset:2048 sc1
s_waitcnt vmcnt(0)
v_add_u32 v10, 1, v10
v_cmp_gt_u32 vcc, s65, v10
s_cbranch_vccz sf63
s_add_u32 s28, s28, 1
s_cmp_lt_u32 s28, 524288
s_cbranch_scc1 sf62
s_mov_b32 s29, 35
s_branch L_abort
sf64:
buffer_load_dword v10, v8, s[4:7], s74 offen offset:2048 sc1
s_waitcnt vmcnt(0)
v_add_u32 v10, 1, v10
v_cmp_gt_u32 vcc, s65, v10
s_cbranch_vccz sf65
s_add_u32 s28, s28, 1
s_cmp_lt_u32 s28, 524288
s_cbranch_scc1 sf64
s_mov_b32 s29, 35
s_branch L_abort
sf66:
buffer_load_dword v10, v8, s[4:7], s74 offen offset:2048 sc1
s_waitcnt vmcnt(0)
v_add_u32 v10, 1, v10
v_cmp_gt_u32 vcc, s65, v10
s_cbranch_vccz sf67
s_add_u32 s28, s28, 1
s_cmp_lt_u32 s28, 524288
s_cbranch_scc1 sf66
s_mov_b32 s29, 35
s_branch L_abort
sf68:
buffer_load_dword v10, v8, s[4:7], s74 offen offset:2048 sc1
s_waitcnt vmcnt(0)
v_add_u32 v10, 1, v10
v_cmp_gt_u32 vcc, s65, v10
s_cbranch_vccz sf69
s_add_u32 s28, s28, 1
s_cmp_lt_u32 s28, 524288
s_cbranch_scc1 sf68
s_mov_b32 s29, 35
s_branch L_abort
pb71:
buffer_wbl2 sc1
s_waitcnt vmcnt(0)
buffer_store_dword v10, off, s[4:7], s75 sc1
s_branch pb72
gq77:
buffer_inv sc1
s_waitcnt vmcnt(0)
s_branch gq78
cs79:
buffer_store_dword v10, off, s[4:7], s75 offset:2048 sc1
s_branch cs80
pb83:
buffer_wbl2 sc1
s_waitcnt vmcnt(0)
buffer_store_dword v10, off, s[4:7], s75 sc1
s_branch pb84
gq89:
buffer_inv sc1
s_waitcnt vmcnt(0)
s_branch gq90
cs91:
buffer_store_dword v10, off, s[4:7], s75 offset:2048 sc1
s_branch cs92
L_roleK:
v_and_b32 v1, 63, v0
v_lshlrev_b32 v2, 4, v1
v_lshlrev_b32 v8, 2, v1
s_lshl_b32 s33, s24, 8
v_lshrrev_b32 v16, 4, v1
s_lshl_b32 s30, s25, 4
v_add_u32 v16, s30, v16
v_mul_u32_u24 v16, 8192, v16
v_and_b32 v40, 15, v1
v_lshl_add_u32 v16, v40, 4, v16
v_add_u32 v16, s33, v16
s_mov_b32 s12, s42
s_mov_b32 s13, s43
s_mov_b32 s14, 5242880
s_mov_b32 s15, 0x20000
v_bfe_u32 v18, v1, 4, 1
v_mul_u32_u24 v18, 2048, v18
v_bfe_u32 v19, v1, 5, 1
v_mul_u32_u24 v19, 12288, v19
v_add_u32 v18, v18, v19
v_and_b32 v19, 15, v1
v_lshl_add_u32 v18, v19, 2, v18
s_lshl_b32 s30, s25, 6
s_add_u32 s30, s30, 0
v_add_u32 v18, s30, v18
v_add_u32 v19, 24576, v18
s_mov_b32 s31, 0x05040100
s_mov_b32 s32, 0x07060302
s_mul_i32 s34, s25, 12288
s_add_u32 s34, s34, 0
s_add_u32 m0, s34, 0
s_mov_b32 s30, 0
buffer_load_dwordx4 v16, s[12:15], s30 offen  lds
s_add_u32 m0, s34, 1024
s_mov_b32 s30, 32768
buffer_load_dwordx4 v16, s[12:15], s30 offen  lds
s_add_u32 m0, s34, 2048
s_mov_b32 s30, 65536
buffer_load_dwordx4 v16, s[12:15], s30 offen  lds
s_add_u32 m0, s34, 3072
s_mov_b32 s30, 98304
buffer_load_dwordx4 v16, s[12:15], s30 offen  lds
s_add_u32 m0, s34, 4096
s_mov_b32 s30, 524288
buffer_load_dwordx4 v16, s[12:15], s30 offen  lds
s_add_u32 m0, s34, 5120
s_mov_b32 s30, 557056
buffer_load_dwordx4 v16, s[12:15], s30 offen  lds
s_add_u32 m0, s34, 6144
s_mov_b32 s30, 589824
buffer_load_dwordx4 v16, s[12:15], s30 offen  lds
s_add_u32 m0, s34, 7168
s_mov_b32 s30, 622592
buffer_load_dwordx4 v16, s[12:15], s30 offen  lds
s_waitcnt vmcnt(4)
s_barrier
s_cmp_lg_u32 s25, 0
s_cbranch_scc1 ar101
s_or_b32 s33, s3, 0x80
v_mov_b32 v7, s33
s_mov_b64 exec, 1
buffer_store_byte v7, off, s[8:11], s2 sc1
s_mov_b64 exec, -1
ar101:
s_add_u32 m0, s34, 8192
s_mov_b32 s30, 1048576
buffer_load_dwordx4 v16, s[12:15], s30 offen  lds
s_add_u32 m0, s34, 9216
s_mov_b32 s30, 1081344
buffer_load_dwordx4 v16, s[12:15], s30 offen  lds
s_add_u32 m0, s34, 10240
s_mov_b32 s30, 1114112
buffer_load_dwordx4 v16, s[12:15], s30 offen  lds
s_add_u32 m0, s34, 11264
s_mov_b32 s30, 1146880
buffer_load_dwordx4 v16, s[12:15], s30 offen  lds
ds_read2st64_b32 v[24:25], v18 offset0:0 offset1:1
ds_read2st64_b32 v[26:27], v18 offset0:2 offset1:3
ds_read2st64_b32 v[28:29], v18 offset0:4 offset1:5
ds_read2st64_b32 v[30:31], v18 offset0:6 offset1:7
ds_read2st64_b32 v[32:33], v19 offset0:0 offset1:1
ds_read2st64_b32 v[34:35], v19 offset0:2 offset1:3
ds_read2st64_b32 v[36:37], v19 offset0:4 offset1:5
ds_read2st64_b32 v[38:39], v19 offset0:6 offset1:7
s_waitcnt lgkmcnt(4)
v_perm_b32 v96, v25, v24, s31
v_perm_b32 v97, v27, v26, s31
v_perm_b32 v98, v29, v28, s31
v_perm_b32 v99, v31, v30, s31
v_perm_b32 v100, v25, v24, s32
v_perm_b32 v101, v27, v26, s32
v_perm_b32 v102, v29, v28, s32
v_perm_b32 v103, v31, v30, s32
s_waitcnt lgkmcnt(0)
v_perm_b32 v104, v33, v32, s31
v_perm_b32 v105, v35, v34, s31
v_perm_b32 v106, v37, v36, s31
v_perm_b32 v107, v39, v38, s31
v_perm_b32 v108, v33, v32, s32
v_perm_b32 v109, v35, v34, s32
v_perm_b32 v110, v37, v36, s32
v_perm_b32 v111, v39, v38, s32
s_waitcnt vmcnt(4)
s_barrier
s_add_u32 m0, s34, 0
s_mov_b32 s30, 1572864
buffer_load_dwordx4 v16, s[12:15], s30 offen  lds
s_add_u32 m0, s34, 1024
s_mov_b32 s30, 1605632
buffer_load_dwordx4 v16, s[12:15], s30 offen  lds
s_add_u32 m0, s34, 2048
s_mov_b32 s30, 1638400
buffer_load_dwordx4 v16, s[12:15], s30 offen  lds
s_add_u32 m0, s34, 3072
s_mov_b32 s30, 1671168
buffer_load_dwordx4 v16, s[12:15], s30 offen  lds
ds_read2st64_b32 v[24:25], v18 offset0:16 offset1:17
ds_read2st64_b32 v[26:27], v18 offset0:18 offset1:19
ds_read2st64_b32 v[28:29], v18 offset0:20 offset1:21
ds_read2st64_b32 v[30:31], v18 offset0:22 offset1:23
ds_read2st64_b32 v[32:33], v19 offset0:16 offset1:17
ds_read2st64_b32 v[34:35], v19 offset0:18 offset1:19
ds_read2st64_b32 v[36:37], v19 offset0:20 offset1:21
ds_read2st64_b32 v[38:39], v19 offset0:22 offset1:23
s_waitcnt lgkmcnt(4)
v_perm_b32 v112, v25, v24, s31
v_perm_b32 v113, v27, v26, s31
v_perm_b32 v114, v29, v28, s31
v_perm_b32 v115, v31, v30, s31
v_perm_b32 v116, v25, v24, s32
v_perm_b32 v117, v27, v26, s32
v_perm_b32 v118, v29, v28, s32
v_perm_b32 v119, v31, v30, s32
s_waitcnt lgkmcnt(0)
v_perm_b32 v120, v33, v32, s31
v_perm_b32 v121, v35, v34, s31
v_perm_b32 v122, v37, v36, s31
v_perm_b32 v123, v39, v38, s31
v_perm_b32 v124, v33, v32, s32
v_perm_b32 v125, v35, v34, s32
v_perm_b32 v126, v37, v36, s32
v_perm_b32 v127, v39, v38, s32
s_waitcnt vmcnt(4)
s_barrier
s_add_u32 m0, s34, 4096
s_mov_b32 s30, 2097152
buffer_load_dwordx4 v16, s[12:15], s30 offen  lds
s_add_u32 m0, s34, 5120
s_mov_b32 s30, 2129920
buffer_load_dwordx4 v16, s[12:15], s30 offen  lds
s_add_u32 m0, s34, 6144
s_mov_b32 s30, 2162688
buffer_load_dwordx4 v16, s[12:15], s30 offen  lds
s_add_u32 m0, s34, 7168
s_mov_b32 s30, 2195456
buffer_load_dwordx4 v16, s[12:15], s30 offen  lds
ds_read2st64_b32 v[24:25], v18 offset0:32 offset1:33
ds_read2st64_b32 v[26:27], v18 offset0:34 offset1:35
ds_read2st64_b32 v[28:29], v18 offset0:36 offset1:37
ds_read2st64_b32 v[30:31], v18 offset0:38 offset1:39
ds_read2st64_b32 v[32:33], v19 offset0:32 offset1:33
ds_read2st64_b32 v[34:35], v19 offset0:34 offset1:35
ds_read2st64_b32 v[36:37], v19 offset0:36 offset1:37
ds_read2st64_b32 v[38:39], v19 offset0:38 offset1:39
s_waitcnt lgkmcnt(4)
v_perm_b32 v128, v25, v24, s31
v_perm_b32 v129, v27, v26, s31
v_perm_b32 v130, v29, v28, s31
v_perm_b32 v131, v31, v30, s31
v_perm_b32 v132, v25, v24, s32
v_perm_b32 v133, v27, v26, s32
v_perm_b32 v134, v29, v28, s32
v_perm_b32 v135, v31, v30, s32
s_waitcnt lgkmcnt(0)
v_perm_b32 v136, v33, v32, s31
v_perm_b32 v137, v35, v34, s31
v_perm_b32 v138, v37, v36, s31
v_perm_b32 v139, v39, v38, s31
v_perm_b32 v140, v33, v32, s32
v_perm_b32 v141, v35, v34, s32
v_perm_b32 v142, v37, v36, s32
v_perm_b32 v143, v39, v38, s32
s_waitcnt vmcnt(4)
s_barrier
s_add_u32 m0, s34, 8192
s_mov_b32 s30, 2621440
buffer_load_dwordx4 v16, s[12:15], s30 offen  lds
s_add_u32 m0, s34, 9216
s_mov_b32 s30, 2654208
buffer_load_dwordx4 v16, s[12:15], s30 offen  lds
s_add_u32 m0, s34, 10240
s_mov_b32 s30, 2686976
buffer_load_dwordx4 v16, s[12:15], s30 offen  lds
s_add_u32 m0, s34, 11264
s_mov_b32 s30, 2719744
buffer_load_dwordx4 v16, s[12:15], s30 offen  lds
ds_read2st64_b32 v[24:25], v18 offset0:0 offset1:1
ds_read2st64_b32 v[26:27], v18 offset0:2 offset1:3
ds_read2st64_b32 v[28:29], v18 offset0:4 offset1:5
ds_read2st64_b32 v[30:31], v18 offset0:6 offset1:7
ds_read2st64_b32 v[32:33], v19 offset0:0 offset1:1
ds_read2st64_b32 v[34:35], v19 offset0:2 offset1:3
ds_read2st64_b32 v[36:37], v19 offset0:4 offset1:5
ds_read2st64_b32 v[38:39], v19 offset0:6 offset1:7
s_waitcnt lgkmcnt(4)
v_perm_b32 v144, v25, v24, s31
v_perm_b32 v145, v27, v26, s31
v_perm_b32 v146, v29, v28, s31
v_perm_b32 v147, v31, v30, s31
v_perm_b32 v148, v25, v24, s32
v_perm_b32 v149, v27, v26, s32
v_perm_b32 v150, v29, v28, s32
v_perm_b32 v151, v31, v30, s32
s_waitcnt lgkmcnt(0)
v_perm_b32 v152, v33, v32, s31
v_perm_b32 v153, v35, v34, s31
v_perm_b32 v154, v37, v36, s31
v_perm_b32 v155, v39, v38, s31
v_perm_b32 v156, v33, v32, s32
v_perm_b32 v157, v35, v34, s32
v_perm_b32 v158, v37, v36, s32
v_perm_b32 v159, v39, v38, s32
s_waitcnt vmcnt(4)
s_barrier
s_add_u32 m0, s34, 0
s_mov_b32 s30, 3145728
buffer_load_dwordx4 v16, s[12:15], s30 offen  lds
s_add_u32 m0, s34, 1024
s_mov_b32 s30, 3178496
buffer_load_dwordx4 v16, s[12:15], s30 offen  lds
s_add_u32 m0, s34, 2048
s_mov_b32 s30, 3211264
buffer_load_dwordx4 v16, s[12:15], s30 offen  lds
s_add_u32 m0, s34, 3072
s_mov_b32 s30, 3244032
buffer_load_dwordx4 v16, s[12:15], s30 offen  lds
ds_read2st64_b32 v[24:25], v18 offset0:16 offset1:17
ds_read2st64_b32 v[26:27], v18 offset0:18 offset1:19
ds_read2st64_b32 v[28:29], v18 offset0:20 offset1:21
ds_read2st64_b32 v[30:31], v18 offset0:22 offset1:23
ds_read2st64_b32 v[32:33], v19 offset0:16 offset1:17
ds_read2st64_b32 v[34:35], v19 offset0:18 offset1:19
ds_read2st64_b32 v[36:37], v19 offset0:20 offset1:21
ds_read2st64_b32 v[38:39], v19 offset0:22 offset1:23
s_waitcnt lgkmcnt(4)
v_perm_b32 v160, v25, v24, s31
v_perm_b32 v161, v27, v26, s31
v_perm_b32 v162, v29, v28, s31
v_perm_b32 v163, v31, v30, s31
v_perm_b32 v164, v25, v24, s32
v_perm_b32 v165, v27, v26, s32
v_perm_b32 v166, v29, v28, s32
v_perm_b32 v167, v31, v30, s32
s_waitcnt lgkmcnt(0)
v_perm_b32 v168, v33, v32, s31
v_perm_b32 v169, v35, v34, s31
v_perm_b32 v170, v37, v36, s31
v_perm_b32 v171, v39, v38, s31
v_perm_b32 v172, v33, v32, s32
v_perm_b32 v173, v35, v34, s32
v_perm_b32 v174, v37, v36, s32
v_perm_b32 v175, v39, v38, s32
s_waitcnt vmcnt(4)
s_barrier
s_add_u32 m0, s34, 4096
s_mov_b32 s30, 3670016
buffer_load_dwordx4 v16, s[12:15], s30 offen  lds
s_add_u32 m0, s34, 5120
s_mov_b32 s30, 3702784
buffer_load_dwordx4 v16, s[12:15], s30 offen  lds
s_add_u32 m0, s34, 6144
s_mov_b32 s30, 3735552
buffer_load_dwordx4 v16, s[12:15], s30 offen  lds
s_add_u32 m0, s34, 7168
s_mov_b32 s30, 3768320
buffer_load_dwordx4 v16, s[12:15], s30 offen  lds
ds_read2st64_b32 v[24:25], v18 offset0:32 offset1:33
ds_read2st64_b32 v[26:27], v18 offset0:34 offset1:35
ds_read2st64_b32 v[28:29], v18 offset0:36 offset1:37
ds_read2st64_b32 v[30:31], v18 offset0:38 offset1:39
ds_read2st64_b32 v[32:33], v19 offset0:32 offset1:33
ds_read2st64_b32 v[34:35], v19 offset0:34 offset1:35
ds_read2st64_b32 v[36:37], v19 offset0:36 offset1:37
ds_read2st64_b32 v[38:39], v19 offset0:38 offset1:39
s_waitcnt lgkmcnt(4)
v_perm_b32 v176, v25, v24, s31
v_perm_b32 v177, v27, v26, s31
v_perm_b32 v178, v29, v28, s31
v_perm_b32 v179, v31, v30, s31
v_perm_b32 v180, v25, v24, s32
v_perm_b32 v181, v27, v26, s32
v_perm_b32 v182, v29, v28, s32
v_perm_b32 v183, v31, v30, s32
s_waitcnt lgkmcnt(0)
v_perm_b32 v184, v33, v32, s31
v_perm_b32 v185, v35, v34, s31
v_perm_b32 v186, v37, v36, s31
v_perm_b32 v187, v39, v38, s31
v_perm_b32 v188, v33, v32, s32
v_perm_b32 v189, v35, v34, s32
v_perm_b32 v190, v37, v36, s32
v_perm_b32 v191, v39, v38, s32
s_waitcnt vmcnt(4)
s_barrier
s_add_u32 m0, s34, 8192
s_mov_b32 s30, 4194304
buffer_load_dwordx4 v16, s[12:15], s30 offen  lds
s_add_u32 m0, s34, 9216
s_mov_b32 s30, 4227072
buffer_load_dwordx4 v16, s[12:15], s30 offen  lds
s_add_u32 m0, s34, 10240
s_mov_b32 s30, 4259840
buffer_load_dwordx4 v16, s[12:15], s30 offen  lds
s_add_u32 m0, s34, 11264
s_mov_b32 s30, 4292608
buffer_load_dwordx4 v16, s[12:15], s30 offen  lds
ds_read2st64_b32 v[24:25], v18 offset0:0 offset1:1
ds_read2st64_b32 v[26:27], v18 offset0:2 offset1:3
ds_read2st64_b32 v[28:29], v18 offset0:4 offset1:5
ds_read2st64_b32 v[30:31], v18 offset0:6 offset1:7
ds_read2st64_b32 v[32:33], v19 offset0:0 offset1:1
ds_read2st64_b32 v[34:35], v19 offset0:2 offset1:3
ds_read2st64_b32 v[36:37], v19 offset0:4 offset1:5
ds_read2st64_b32 v[38:39], v19 offset0:6 offset1:7
s_waitcnt lgkmcnt(4)
v_perm_b32 v192, v25, v24, s31
v_perm_b32 v193, v27, v26, s31
v_perm_b32 v194, v29, v28, s31
v_perm_b32 v195, v31, v30, s31
v_perm_b32 v196, v25, v24, s32
v_perm_b32 v197, v27, v26, s32
v_perm_b32 v198, v29, v28, s32
v_perm_b32 v199, v31, v30, s32
s_waitcnt lgkmcnt(0)
v_perm_b32 v200, v33, v32, s31
v_perm_b32 v201, v35, v34, s31
v_perm_b32 v202, v37, v36, s31
v_perm_b32 v203, v39, v38, s31
v_perm_b32 v204, v33, v32, s32
v_perm_b32 v205, v35, v34, s32
v_perm_b32 v206, v37, v36, s32
v_perm_b32 v207, v39, v38, s32
s_waitcnt vmcnt(4)
s_barrier
s_add_u32 m0, s34, 0
s_mov_b32 s30, 4718592
buffer_load_dwordx4 v16, s[12:15], s30 offen  lds
s_add_u32 m0, s34, 1024
s_mov_b32 s30, 4751360
buffer_load_dwordx4 v16, s[12:15], s30 offen  lds
s_add_u32 m0, s34, 2048
s_mov_b32 s30, 4784128
buffer_load_dwordx4 v16, s[12:15], s30 offen  lds
s_add_u32 m0, s34, 3072
s_mov_b32 s30, 4816896
buffer_load_dwordx4 v16, s[12:15], s30 offen  lds
ds_read2st64_b32 v[24:25], v18 offset0:16 offset1:17
ds_read2st64_b32 v[26:27], v18 offset0:18 offset1:19
ds_read2st64_b32 v[28:29], v18 offset0:20 offset1:21
ds_read2st64_b32 v[30:31], v18 offset0:22 offset1:23
ds_read2st64_b32 v[32:33], v19 offset0:16 offset1:17
ds_read2st64_b32 v[34:35], v19 offset0:18 offset1:19
ds_read2st64_b32 v[36:37], v19 offset0:20 offset1:21
ds_read2st64_b32 v[38:39], v19 offset0:22 offset1:23
s_waitcnt lgkmcnt(4)
v_perm_b32 v208, v25, v24, s31
v_perm_b32 v209, v27, v26, s31
v_perm_b32 v210, v29, v28, s31
v_perm_b32 v211, v31, v30, s31
v_perm_b32 v212, v25, v24, s32
v_perm_b32 v213, v27, v26, s32
v_perm_b32 v214, v29, v28, s32
v_perm_b32 v215, v31, v30, s32
s_waitcnt lgkmcnt(0)
v_perm_b32 v216, v33, v32, s31
v_perm_b32 v217, v35, v34, s31
v_perm_b32 v218, v37, v36, s31
v_perm_b32 v219, v39, v38, s31
v_perm_b32 v220, v33, v32, s32
v_perm_b32 v221, v35, v34, s32
v_perm_b32 v222, v37, v36, s32
v_perm_b32 v223, v39, v38, s32
s_waitcnt vmcnt(4)
s_barrier
ds_read2st64_b32 v[24:25], v18 offset0:32 offset1:33
ds_read2st64_b32 v[26:27], v18 offset0:34 offset1:35
ds_read2st64_b32 v[28:29], v18 offset0:36 offset1:37
ds_read2st64_b32 v[30:31], v18 offset0:38 offset1:39
ds_read2st64_b32 v[32:33], v19 offset0:32 offset1:33
ds_read2st64_b32 v[34:35], v19 offset0:34 offset1:35
ds_read2st64_b32 v[36:37], v19 offset0:36 offset1:37
ds_read2st64_b32 v[38:39], v19 offset0:38 offset1:39
s_waitcnt lgkmcnt(4)
v_perm_b32 v224, v25, v24, s31
v_perm_b32 v225, v27, v26, s31
v_perm_b32 v226, v29, v28, s31
v_perm_b32 v227, v31, v30, s31
v_perm_b32 v228, v25, v24, s32
v_perm_b32 v229, v27, v26, s32
v_perm_b32 v230, v29, v28, s32
v_perm_b32 v231, v31, v30, s32
s_waitcnt lgkmcnt(0)
v_perm_b32 v232, v33, v32, s31
v_perm_b32 v233, v35, v34, s31
v_perm_b32 v234, v37, v36, s31
v_perm_b32 v235, v39, v38, s31
v_perm_b32 v236, v33, v32, s32
v_perm_b32 v237, v35, v34, s32
v_perm_b32 v238, v37, v36, s32
v_perm_b32 v239, v39, v38, s32
s_waitcnt vmcnt(0)
s_barrier
ds_read2st64_b32 v[24:25], v18 offset0:0 offset1:1
ds_read2st64_b32 v[26:27], v18 offset0:2 offset1:3
ds_read2st64_b32 v[28:29], v18 offset0:4 offset1:5
ds_read2st64_b32 v[30:31], v18 offset0:6 offset1:7
ds_read2st64_b32 v[32:33], v19 offset0:0 offset1:1
ds_read2st64_b32 v[34:35], v19 offset0:2 offset1:3
ds_read2st64_b32 v[36:37], v19 offset0:4 offset1:5
ds_read2st64_b32 v[38:39], v19 offset0:6 offset1:7
s_waitcnt lgkmcnt(4)
v_perm_b32 v240, v25, v24, s31
v_perm_b32 v241, v27, v26, s31
v_perm_b32 v242, v29, v28, s31
v_perm_b32 v243, v31, v30, s31
v_perm_b32 v244, v25, v24, s32
v_perm_b32 v245, v27, v26, s32
v_perm_b32 v246, v29, v28, s32
v_perm_b32 v247, v31, v30, s32
s_waitcnt lgkmcnt(0)
v_perm_b32 v248, v33, v32, s31
v_perm_b32 v249, v35, v34, s31
v_perm_b32 v250, v37, v36, s31
v_perm_b32 v251, v39, v38, s31
v_perm_b32 v252, v33, v32, s32
v_perm_b32 v253, v35, v34, s32
v_perm_b32 v254, v37, v36, s32
v_perm_b32 v255, v39, v38, s32
s_waitcnt vmcnt(0) lgkmcnt(0)
s_barrier
v_bfe_u32 v10, v1, 1, 3
v_lshrrev_b32 v11, 4, v1
v_xor_b32 v10, v10, v11
v_lshlrev_b32 v76, 4, v10
v_and_b32 v10, 7, v1
v_lshl_add_u32 v76, v10, 7, v76
v_bfe_u32 v10, v1, 3, 1
v_mul_u32_u24 v10, 10240, v10
v_add_u32 v76, v76, v10
v_xor_b32 v77, 64, v76
s_mov_b32 s28, 0
s_mov_b32 s30, 0x80808080
v_and_b32 v12, 63, v0
v_lshlrev_b32 v12, 2, v12
sy102:
buffer_load_dword v13, v12, s[8:11], 0 offen sc1
s_waitcnt vmcnt(0)
sy105:
v_and_b32 v14, s30, v13
v_cmp_ne_u32 vcc, s30, v14
s_cbranch_vccz sy103
s_sleep 2
s_add_u32 s28, s28, 1
s_cmp_lt_u32 s28, 524288
s_cbranch_scc1 sy102
s_mov_b32 s29, 1
s_branch L_abort
sy103:
s_cmp_lg_u32 s26, 0
s_cbranch_scc1 sy104
v_mov_b32 v15, 0
v_bfe_u32 v14, v13, 0, 3
v_lshlrev_b32 v14, v14, 1
v_or_b32 v15, v15, v14
v_bfe_u32 v14, v13, 8, 3
v_lshlrev_b32 v14, v14, 1
v_or_b32 v15, v15, v14
v_bfe_u32 v14, v13, 16, 3
v_lshlrev_b32 v14, v14, 1
v_or_b32 v15, v15, v14
v_bfe_u32 v14, v13, 24, 3
v_lshlrev_b32 v14, v14, 1
v_or_b32 v15, v15, v14
s_nop 1
v_mov_b32 v14, v15 quad_perm:[1,0,3,2] row_mask:0xf bank_mask:0xf
v_or_b32 v15, v15, v14
v_cmp_ne_u32 vcc, 0xff, v15
s_cbranch_vccnz L_rank
s_mov_b32 s26, 1
sy104:
s_lshl_b32 s73, s27, 5
s_add_u32 s73, s73, s24
s_lshl_b32 s73, s73, 2
s_add_u32 s73, s73, s25
s_lshl_b32 s73, s73, 13
s_add_u32 s73, s73, 209715200
s_mov_b32 s54, 0xaaa00000
s_mov_b32 s55, 0xaaaaaaaa
s_mov_b32 s56, 0xaaaaaaaa
s_mov_b32 s57, 0xfffffaaa
s_lshl_b32 s68, s24, 11
s_lshl_b32 s33, s25, 9
s_add_u32 s68, s68, s33
s_lshl_b32 s70, s68, 2
s_add_u32 s70, s70, 67108864
s_add_u32 s68, s68, 786432
s_mov_b32 s67, s68
s_mov_b32 s69, 0
s_mov_b32 s62, 0
s_mov_b32 s63, 0
s_mov_b32 s64, 1
s_mov_b32 s65, 0
s_mov_b32 s28, 0
k106:
s_lshl_b32 s31, s63, 7
s_add_u32 s31, s31, 1048576
buffer_load_dword v11, off, s[4:7], s31 sc1
s_waitcnt vmcnt(0)
v_readfirstlane_b32 s76, v11
s_nop 0
s_cmp_ge_u32 s76, 32
s_cbranch_scc1 k107
s_sleep 1
s_add_u32 s28, s28, 1
s_cmp_lt_u32 s28, 524288
s_cbranch_scc1 k106
s_mov_b32 s29, 10
s_branch L_abort
k107:
s_mul_i32 s72, s25, 10240
s_mul_i32 s71, s63, 40960
s_add_u32 s71, s71, s72
s_add_u32 s71, s71, 3145728
s_add_u32 s72, s72, s65
s_mov_b32 m0, s72
s_nop 0
buffer_load_dwordx4 v2, s[4:7], s71 offen offset:0 sc1 lds
buffer_load_dwordx4 v2, s[4:7], s71 offen offset:1024 sc1 lds
buffer_load_dwordx4 v2, s[4:7], s71 offen offset:2048 sc1 lds
buffer_load_dwordx4 v2, s[4:7], s71 offen offset:3072 sc1 lds
s_add_u32 s72, s72, 4096
s_add_u32 s71, s71, 4096
s_mov_b32 m0, s72
s_nop 0
buffer_load_dwordx4 v2, s[4:7], s71 offen offset:0 sc1 lds
buffer_load_dwordx4 v2, s[4:7], s71 offen offset:1024 sc1 lds
buffer_load_dwordx4 v2, s[4:7], s71 offen offset:2048 sc1 lds
buffer_load_dwordx4 v2, s[4:7], s71 offen offset:3072 sc1 lds
s_add_u32 s72, s72, 4096
s_add_u32 s71, s71, 4096
s_mov_b32 m0, s72
s_nop 0
buffer_load_dwordx4 v2, s[4:7], s71 offen offset:0 sc1 lds
buffer_load_dwordx4 v2, s[4:7], s71 offen offset:1024 sc1 lds
s_lshl_b32 s31, s64, 7
s_add_u32 s31, s31, 1048576
buffer_load_dword v9, off, s[4:7], s31 sc1
s_waitcnt vmcnt(0)
.p2align 5
L_Ktop:
v_add_u32 v72, s65, v76
v_add_u32 v73, s65, v77
s_waitcnt vmcnt(3)
s_barrier
ds_read_b128 v[16:19], v72 offset:0
ds_read_b128 v[20:23], v72 offset:20480
ds_read_b128 v[24:27], v73 offset:0
ds_read_b128 v[28:31], v73 offset:20480
ds_read_b128 v[32:35], v72 offset:1024
ds_read_b128 v[36:39], v72 offset:21504
s_lshl_b32 s31, s64, 7
s_add_u32 s31, s31, 1048576
buffer_load_dword v11, off, s[4:7], s31 sc1
v_readfirstlane_b32 s77, v9
s_nop 0
s_cmp_ge_u32 s77, 32
s_cselect_b32 s66, 1, 0
s_cmp_ge_u32 s62, 127
s_cselect_b32 s66, 0, s66
s_cmp_eq_u32 s66, 1
s_cselect_b32 s33, 0, 0x40000000
v_or_b32 v5, s33, v2
s_xor_b32 s65, s65, 40960
s_mul_i32 s72, s25, 10240
s_mul_i32 s71, s64, 40960
s_add_u32 s71, s71, s72
s_add_u32 s71, s71, 3145728
s_add_u32 s72, s72, s65
s_waitcnt lgkmcnt(5)
v_mfma_f32_16x16x32_bf16 v[48:51], v[96:99], v[16:19], 0
s_mov_b32 m0, s72
s_nop 0
buffer_load_dwordx4 v5, s[4:7], s71 offen offset:0 sc1 lds
v_mfma_f32_16x16x32_bf16 v[52:55], v[100:103], v[16:19], 0
ds_read_b128 v[16:19], v73 offset:1024
s_waitcnt lgkmcnt(5)
v_mfma_f32_16x16x32_bf16 v[56:59], v[96:99], v[20:23], 0
buffer_load_dwordx4 v5, s[4:7], s71 offen offset:1024 sc1 lds
v_mfma_f32_16x16x32_bf16 v[60:63], v[100:103], v[20:23], 0
ds_read_b128 v[20:23], v73 offset:21504
s_waitcnt lgkmcnt(5)
v_mfma_f32_16x16x32_bf16 v[48:51], v[104:107], v[24:27], v[48:51]
v_mfma_f32_16x16x32_bf16 v[52:55], v[108:111], v[24:27], v[52:55]
ds_read_b128 v[24:27], v72 offset:2048
s_waitcnt lgkmcnt(5)
v_mfma_f32_16x16x32_bf16 v[56:59], v[104:107], v[28:31], v[56:59]
buffer_load_dwordx4 v5, s[4:7], s71 offen offset:2048 sc1 lds
v_mfma_f32_16x16x32_bf16 v[60:63], v[108:111], v[28:31], v[60:63]
ds_read_b128 v[28:31], v72 offset:22528
s_waitcnt lgkmcnt(5)
v_mfma_f32_16x16x32_bf16 v[48:51], v[112:115], v[32:35], v[48:51]
v_mfma_f32_16x16x32_bf16 v[52:55], v[116:119], v[32:35], v[52:55]
ds_read_b128 v[32:35], v73 offset:2048
s_waitcnt lgkmcnt(5)
v_mfma_f32_16x16x32_bf16 v[56:59], v[112:115], v[36:39], v[56:59]
buffer_load_dwordx4 v5, s[4:7], s71 offen offset:3072 sc1 lds
v_mfma_f32_16x16x32_bf16 v[60:63], v[116:119], v[36:39], v[60:63]
ds_read_b128 v[36:39], v73 offset:22528
s_waitcnt lgkmcnt(5)
v_mfma_f32_16x16x32_bf16 v[48:51], v[120:123], v[16:19], v[48:51]
v_mfma_f32_16x16x32_bf16 v[52:55], v[124:127], v[16:19], v[52:55]
ds_read_b128 v[16:19], v72 offset:3072
s_waitcnt lgkmcnt(5)
v_mfma_f32_16x16x32_bf16 v[56:59], v[120:123], v[20:23], v[56:59]
s_add_u32 s72, s72, 4096
s_add_u32 s71, s71, 4096
s_mov_b32 m0, s72
s_nop 0
buffer_load_dwordx4 v5, s[4:7], s71 offen offset:0 sc1 lds
v_mfma_f32_16x16x32_bf16 v[60:63], v[124:127], v[20:23], v[60:63]
ds_read_b128 v[20:23], v72 offset:23552
s_waitcnt lgkmcnt(5)
v_mfma_f32_16x16x32_bf16 v[48:51], v[128:131], v[24:27], v[48:51]
v_mfma_f32_16x16x32_bf16 v[52:55], v[132:135], v[24:27], v[52:55]
ds_read_b128 v[24:27], v73 offset:3072
s_waitcnt lgkmcnt(5)
v_mfma_f32_16x16x32_bf16 v[56:59], v[128:131], v[28:31], v[56:59]
buffer_load_dwordx4 v5, s[4:7], s71 offen offset:1024 sc1 lds
v_mfma_f32_16x16x32_bf16 v[60:63], v[132:135], v[28:31], v[60:63]
ds_read_b128 v[28:31], v73 offset:23552
s_waitcnt lgkmcnt(5)
v_mfma_f32_16x16x32_bf16 v[48:51], v[136:139], v[32:35], v[48:51]
buffer_load_dwordx4 v5, s[4:7], s71 offen offset:2048 sc1 lds
v_mfma_f32_16x16x32_bf16 v[52:55], v[140:143], v[32:35], v[52:55]
ds_read_b128 v[32:35], v72 offset:4096
s_waitcnt lgkmcnt(5)
v_mfma_f32_16x16x32_bf16 v[56:59], v[136:139], v[36:39], v[56:59]
v_mfma_f32_16x16x32_bf16 v[60:63], v[140:143], v[36:39], v[60:63]
ds_read_b128 v[36:39], v72 offset:24576
s_waitcnt lgkmcnt(5)
v_mfma_f32_16x16x32_bf16 v[48:51], v[144:147], v[16:19], v[48:51]
buffer_load_dwordx4 v5, s[4:7], s71 offen offset:3072 sc1 lds
v_mfma_f32_16x16x32_bf16 v[52:55], v[148:151], v[16:19], v[52:55]
ds_read_b128 v[16:19], v73 offset:4096
s_waitcnt lgkmcnt(5)
v_mfma_f32_16x16x32_bf16 v[56:59], v[144:147], v[20:23], v[56:59]
v_mfma_f32_16x16x32_bf16 v[60:63], v[148:151], v[20:23], v[60:63]
ds_read_b128 v[20:23], v73 offset:24576
s_waitcnt lgkmcnt(5)
v_mfma_f32_16x16x32_bf16 v[48:51], v[152:155], v[24:27], v[48:51]
s_add_u32 s72, s72, 4096
s_add_u32 s71, s71, 4096
s_mov_b32 m0, s72
s_nop 0
buffer_load_dwordx4 v5, s[4:7], s71 offen offset:0 sc1 lds
v_mfma_f32_16x16x32_bf16 v[52:55], v[156:159], v[24:27], v[52:55]
ds_read_b128 v[24:27], v72 offset:5120
s_waitcnt lgkmcnt(5)
v_mfma_f32_16x16x32_bf16 v[56:59], v[152:155], v[28:31], v[56:59]
v_mfma_f32_16x16x32_bf16 v[60:63], v[156:159], v[28:31], v[60:63]
ds_read_b128 v[28:31], v72 offset:25600
s_waitcnt lgkmcnt(5)
v_mfma_f32_16x16x32_bf16 v[48:51], v[160:163], v[32:35], v[48:51]
buffer_load_dwordx4 v5, s[4:7], s71 offen offset:1024 sc1 lds
v_mfma_f32_16x16x32_bf16 v[52:55], v[164:167], v[32:35], v[52:55]
ds_read_b128 v[32:35], v73 offset:5120
s_waitcnt lgkmcnt(5)
v_mfma_f32_16x16x32_bf16 v[56:59], v[160:163], v[36:39], v[56:59]
s_add_u32 s32, s62, 2
s_cmp_lt_u32 s32, 64
s_cselect_b64 s[60:61], s[54:55], s[56:57]
s_cselect_b32 s33, 0, 22
s_bfm_b64 s[34:35], s32, 0
s_and_b64 s[34:35], s[34:35], s[60:61]
s_bcnt1_i32_b64 s34, s[34:35]
s_add_u32 s33, s33, s34
s_sub_u32 s34, s32, s33
s_add_u32 s33, s33, 64
s_bitcmp1_b64 s[60:61], s32
s_cselect_b32 s74, s33, s34
s_cmp_ge_u32 s32, 128
s_cselect_b32 s74, s32, s74
v_mfma_f32_16x16x32_bf16 v[60:63], v[164:167], v[36:39], v[60:63]
ds_read_b128 v[36:39], v73 offset:25600
s_waitcnt lgkmcnt(5)
v_mfma_f32_16x16x32_bf16 v[48:51], v[168:171], v[16:19], v[48:51]
v_mfma_f32_16x16x32_bf16 v[52:55], v[172:175], v[16:19], v[52:55]
ds_read_b128 v[16:19], v72 offset:6144
s_waitcnt lgkmcnt(5)
v_mfma_f32_16x16x32_bf16 v[56:59], v[168:171], v[20:23], v[56:59]
v_mfma_f32_16x16x32_bf16 v[60:63], v[172:175], v[20:23], v[60:63]
ds_read_b128 v[20:23], v72 offset:26624
s_lshl_b32 s31, s74, 7
s_add_u32 s31, s31, 1048576
buffer_load_dword v9, off, s[4:7], s31 sc1
s_cmp_eq_u32 s66, 1
s_cbranch_scc1 k109
s_cmp_ge_u32 s62, 127
s_cbranch_scc1 k109
s_waitcnt vmcnt(11)
v_readfirstlane_b32 s76, v11
s_nop 0
s_cmp_ge_u32 s76, 32
s_cbranch_scc1 k108
k109:
s_waitcnt lgkmcnt(5)
v_mfma_f32_16x16x32_bf16 v[48:51], v[176:179], v[24:27], v[48:51]
v_mfma_f32_16x16x32_bf16 v[52:55], v[180:183], v[24:27], v[52:55]
ds_read_b128 v[24:27], v73 offset:6144
s_waitcnt lgkmcnt(5)
v_mfma_f32_16x16x32_bf16 v[56:59], v[176:179], v[28:31], v[56:59]
v_mfma_f32_16x16x32_bf16 v[60:63], v[180:183], v[28:31], v[60:63]
ds_read_b128 v[28:31], v73 offset:26624
s_waitcnt lgkmcnt(5)
v_mfma_f32_16x16x32_bf16 v[48:51], v[184:187], v[32:35], v[48:51]
v_mfma_f32_16x16x32_bf16 v[52:55], v[188:191], v[32:35], v[52:55]
ds_read_b128 v[32:35], v72 offset:7168
s_waitcnt lgkmcnt(5)
v_mfma_f32_16x16x32_bf16 v[56:59], v[184:187], v[36:39], v[56:59]
s_waitcnt vmcnt(12)
v_mov_b32 v10, s69
buffer_store_dword v10, off, s[4:7], s67 sc1
v_mfma_f32_16x16x32_bf16 v[60:63], v[188:191], v[36:39], v[60:63]
ds_read_b128 v[36:39], v72 offset:27648
s_waitcnt lgkmcnt(5)
v_mfma_f32_16x16x32_bf16 v[48:51], v[192:195], v[16:19], v[48:51]
v_mfma_f32_16x16x32_bf16 v[52:55], v[196:199], v[16:19], v[52:55]
ds_read_b128 v[16:19], v73 offset:7168
s_waitcnt lgkmcnt(5)
v_mfma_f32_16x16x32_bf16 v[56:59], v[192:195], v[20:23], v[56:59]
v_mfma_f32_16x16x32_bf16 v[60:63], v[196:199], v[20:23], v[60:63]
ds_read_b128 v[20:23], v73 offset:27648
s_waitcnt lgkmcnt(5)
v_mfma_f32_16x16x32_bf16 v[48:51], v[200:203], v[24:27], v[48:51]
v_mfma_f32_16x16x32_bf16 v[52:55], v[204:207], v[24:27], v[52:55]
ds_read_b128 v[24:27], v72 offset:8192
s_waitcnt lgkmcnt(5)
v_mfma_f32_16x16x32_bf16 v[56:59], v[200:203], v[28:31], v[56:59]
v_mfma_f32_16x16x32_bf16 v[60:63], v[204:207], v[28:31], v[60:63]
ds_read_b128 v[28:31], v72 offset:28672
s_waitcnt lgkmcnt(5)
v_mfma_f32_16x16x32_bf16 v[48:51], v[208:211], v[32:35], v[48:51]
v_mfma_f32_16x16x32_bf16 v[52:55], v[212:215], v[32:35], v[52:55]
ds_read_b128 v[32:35], v73 offset:8192
s_waitcnt lgkmcnt(5)
v_mfma_f32_16x16x32_bf16 v[56:59], v[208:211], v[36:39], v[56:59]
v_mfma_f32_16x16x32_bf16 v[60:63], v[212:215], v[36:39], v[60:63]
ds_read_b128 v[36:39], v73 offset:28672
s_waitcnt lgkmcnt(5)
v_mfma_f32_16x16x32_bf16 v[48:51], v[216:219], v[16:19], v[48:51]
v_mfma_f32_16x16x32_bf16 v[52:55], v[220:223], v[16:19], v[52:55]
ds_read_b128 v[16:19], v72 offset:9216
s_waitcnt lgkmcnt(5)
v_mfma_f32_16x16x32_bf16 v[56:59], v[216:219], v[20:23], v[56:59]
v_mfma_f32_16x16x32_bf16 v[60:63], v[220:223], v[20:23], v[60:63]
ds_read_b128 v[20:23], v72 offset:29696
s_waitcnt lgkmcnt(5)
v_mfma_f32_16x16x32_bf16 v[48:51], v[224:227], v[24:27], v[48:51]
v_mfma_f32_16x16x32_bf16 v[52:55], v[228:231], v[24:27], v[52:55]
ds_read_b128 v[24:27], v73 offset:9216
s_waitcnt lgkmcnt(5)
v_mfma_f32_16x16x32_bf16 v[56:59], v[224:227], v[28:31], v[56:59]
s_lshl_b32 s34, s63, 18
s_add_u32 s34, s34, s70
s_lshr_b32 s67, s63, 6
s_lshl_b32 s67, s67, 2
v_mfma_f32_16x16x32_bf16 v[60:63], v[228:231], v[28:31], v[60:63]
ds_read_b128 v[28:31], v73 offset:29696
s_waitcnt lgkmcnt(5)
v_mfma_f32_16x16x32_bf16 v[48:51], v[232:235], v[32:35], v[48:51]
s_add_u32 s67, s67, s68
s_and_b32 s69, s63, 63
s_add_u32 s69, s69, 1
s_add_u32 s62, s62, 1
v_mfma_f32_16x16x32_bf16 v[52:55], v[236:239], v[32:35], v[52:55]
s_waitcnt lgkmcnt(4)
v_mfma_f32_16x16x32_bf16 v[56:59], v[232:235], v[36:39], v[56:59]
s_mov_b32 s63, s64
s_mov_b32 s64, s74
v_mfma_f32_16x16x32_bf16 v[60:63], v[236:239], v[36:39], v[60:63]
s_waitcnt lgkmcnt(3)
v_mfma_f32_16x16x32_bf16 v[48:51], v[240:243], v[16:19], v[48:51]
v_mfma_f32_16x16x32_bf16 v[52:55], v[244:247], v[16:19], v[52:55]
s_waitcnt lgkmcnt(2)
v_mfma_f32_16x16x32_bf16 v[56:59], v[240:243], v[20:23], v[56:59]
v_mfma_f32_16x16x32_bf16 v[60:63], v[244:247], v[20:23], v[60:63]
s_waitcnt lgkmcnt(1)
v_mfma_f32_16x16x32_bf16 v[48:51], v[248:251], v[24:27], v[48:51]
v_mfma_f32_16x16x32_bf16 v[52:55], v[252:255], v[24:27], v[52:55]
s_waitcnt lgkmcnt(0)
v_mfma_f32_16x16x32_bf16 v[56:59], v[248:251], v[28:31], v[56:59]
v_mfma_f32_16x16x32_bf16 v[60:63], v[252:255], v[28:31], v[60:63]
s_branch k110
k108:
s_mov_b32 s66, 1
s_mul_i32 s72, s25, 10240
s_mul_i32 s71, s64, 40960
s_add_u32 s71, s71, s72
s_add_u32 s71, s71, 3145728
s_add_u32 s72, s72, s65
s_waitcnt lgkmcnt(5)
v_mfma_f32_16x16x32_bf16 v[48:51], v[176:179], v[24:27], v[48:51]
s_mov_b32 m0, s72
s_nop 0
buffer_load_dwordx4 v2, s[4:7], s71 offen offset:0 sc1 lds
v_mfma_f32_16x16x32_bf16 v[52:55], v[180:183], v[24:27], v[52:55]
ds_read_b128 v[24:27], v73 offset:6144
s_waitcnt lgkmcnt(5)
v_mfma_f32_16x16x32_bf16 v[56:59], v[176:179], v[28:31], v[56:59]
buffer_load_dwordx4 v2, s[4:7], s71 offen offset:1024 sc1 lds
v_mfma_f32_16x16x32_bf16 v[60:63], v[180:183], v[28:31], v[60:63]
ds_read_b128 v[28:31], v73 offset:26624
s_waitcnt lgkmcnt(5)
v_mfma_f32_16x16x32_bf16 v[48:51], v[184:187], v[32:35], v[48:51]
buffer_load_dwordx4 v2, s[4:7], s71 offen offset:2048 sc1 lds
v_mfma_f32_16x16x32_bf16 v[52:55], v[188:191], v[32:35], v[52:55]
ds_read_b128 v[32:35], v72 offset:7168
s_waitcnt lgkmcnt(5)
v_mfma_f32_16x16x32_bf16 v[56:59], v[184:187], v[36:39], v[56:59]
buffer_load_dwordx4 v2, s[4:7], s71 offen offset:3072 sc1 lds
v_mfma_f32_16x16x32_bf16 v[60:63], v[188:191], v[36:39], v[60:63]
ds_read_b128 v[36:39], v72 offset:27648
s_waitcnt lgkmcnt(5)
v_mfma_f32_16x16x32_bf16 v[48:51], v[192:195], v[16:19], v[48:51]
s_add_u32 s72, s72, 4096
s_add_u32 s71, s71, 4096
s_mov_b32 m0, s72
s_nop 0
buffer_load_dwordx4 v2, s[4:7], s71 offen offset:0 sc1 lds
v_mfma_f32_16x16x32_bf16 v[52:55], v[196:199], v[16:19], v[52:55]
ds_read_b128 v[16:19], v73 offset:7168
s_waitcnt lgkmcnt(5)
v_mfma_f32_16x16x32_bf16 v[56:59], v[192:195], v[20:23], v[56:59]
buffer_load_dwordx4 v2, s[4:7], s71 offen offset:1024 sc1 lds
v_mfma_f32_16x16x32_bf16 v[60:63], v[196:199], v[20:23], v[60:63]
ds_read_b128 v[20:23], v73 offset:27648
s_waitcnt lgkmcnt(5)
v_mfma_f32_16x16x32_bf16 v[48:51], v[200:203], v[24:27], v[48:51]
buffer_load_dwordx4 v2, s[4:7], s71 offen offset:2048 sc1 lds
v_mfma_f32_16x16x32_bf16 v[52:55], v[204:207], v[24:27], v[52:55]
ds_read_b128 v[24:27], v72 offset:8192
s_waitcnt lgkmcnt(5)
v_mfma_f32_16x16x32_bf16 v[56:59], v[200:203], v[28:31], v[56:59]
buffer_load_dwordx4 v2, s[4:7], s71 offen offset:3072 sc1 lds
v_mfma_f32_16x16x32_bf16 v[60:63], v[204:207], v[28:31], v[60:63]
ds_read_b128 v[28:31], v72 offset:28672
s_waitcnt lgkmcnt(5)
v_mfma_f32_16x16x32_bf16 v[48:51], v[208:211], v[32:35], v[48:51]
s_add_u32 s72, s72, 4096
s_add_u32 s71, s71, 4096
s_mov_b32 m0, s72
s_nop 0
buffer_load_dwordx4 v2, s[4:7], s71 offen offset:0 sc1 lds
v_mfma_f32_16x16x32_bf16 v[52:55], v[212:215], v[32:35], v[52:55]
ds_read_b128 v[32:35], v73 offset:8192
s_waitcnt lgkmcnt(5)
v_mfma_f32_16x16x32_bf16 v[56:59], v[208:211], v[36:39], v[56:59]
buffer_load_dwordx4 v2, s[4:7], s71 offen offset:1024 sc1 lds
v_mfma_f32_16x16x32_bf16 v[60:63], v[212:215], v[36:39], v[60:63]
ds_read_b128 v[36:39], v73 offset:28672
s_waitcnt lgkmcnt(5)
v_mfma_f32_16x16x32_bf16 v[48:51], v[216:219], v[16:19], v[48:51]
s_waitcnt vmcnt(22)
v_mov_b32 v10, s69
buffer_store_dword v10, off, s[4:7], s67 sc1
v_mfma_f32_16x16x32_bf16 v[52:55], v[220:223], v[16:19], v[52:55]
ds_read_b128 v[16:19], v72 offset:9216
s_waitcnt lgkmcnt(5)
v_mfma_f32_16x16x32_bf16 v[56:59], v[216:219], v[20:23], v[56:59]
v_mfma_f32_16x16x32_bf16 v[60:63], v[220:223], v[20:23], v[60:63]
ds_read_b128 v[20:23], v72 offset:29696
s_waitcnt lgkmcnt(5)
v_mfma_f32_16x16x32_bf16 v[48:51], v[224:227], v[24:27], v[48:51]
v_mfma_f32_16x16x32_bf16 v[52:55], v[228:231], v[24:27], v[52:55]
ds_read_b128 v[24:27], v73 offset:9216
s_waitcnt lgkmcnt(5)
v_mfma_f32_16x16x32_bf16 v[56:59], v[224:227], v[28:31], v[56:59]
s_lshl_b32 s34, s63, 18
s_add_u32 s34, s34, s70
s_lshr_b32 s67, s63, 6
s_lshl_b32 s67, s67, 2
v_mfma_f32_16x16x32_bf16 v[60:63], v[228:231], v[28:31], v[60:63]
ds_read_b128 v[28:31], v73 offset:29696
s_waitcnt lgkmcnt(5)
v_mfma_f32_16x16x32_bf16 v[48:51], v[232:235], v[32:35], v[48:51]
s_add_u32 s67, s67, s68
s_and_b32 s69, s63, 63
s_add_u32 s69, s69, 1
s_add_u32 s62, s62, 1
v_mfma_f32_16x16x32_bf16 v[52:55], v[236:239], v[32:35], v[52:55]
s_waitcnt lgkmcnt(4)
v_mfma_f32_16x16x32_bf16 v[56:59], v[232:235], v[36:39], v[56:59]
s_mov_b32 s63, s64
s_mov_b32 s64, s74
v_mfma_f32_16x16x32_bf16 v[60:63], v[236:239], v[36:39], v[60:63]
s_waitcnt lgkmcnt(3)
v_mfma_f32_16x16x32_bf16 v[48:51], v[240:243], v[16:19], v[48:51]
v_mfma_f32_16x16x32_bf16 v[52:55], v[244:247], v[16:19], v[52:55]
s_waitcnt lgkmcnt(2)
v_mfma_f32_16x16x32_bf16 v[56:59], v[240:243], v[20:23], v[56:59]
v_mfma_f32_16x16x32_bf16 v[60:63], v[244:247], v[20:23], v[60:63]
s_waitcnt lgkmcnt(1)
v_mfma_f32_16x16x32_bf16 v[48:51], v[248:251], v[24:27], v[48:51]
v_mfma_f32_16x16x32_bf16 v[52:55], v[252:255], v[24:27], v[52:55]
s_waitcnt lgkmcnt(0)
v_mfma_f32_16x16x32_bf16 v[56:59], v[248:251], v[28:31], v[56:59]
v_mfma_f32_16x16x32_bf16 v[60:63], v[252:255], v[28:31], v[60:63]
k110:
s_nop 3
v_cvt_pk_bf16_f32 v64, v48, v52
v_cvt_pk_bf16_f32 v65, v49, v53
v_cvt_pk_bf16_f32 v66, v50, v54
v_cvt_pk_bf16_f32 v67, v51, v55
buffer_store_dwordx4 v[64:67], v2, s[4:7], s34 offen offset:0 sc1
v_cvt_pk_bf16_f32 v68, v56, v60
v_cvt_pk_bf16_f32 v69, v57, v61
v_cvt_pk_bf16_f32 v70, v58, v62
v_cvt_pk_bf16_f32 v71, v59, v63
buffer_store_dwordx4 v[68:71], v2, s[4:7], s34 offen offset:1024 sc1
s_cmp_eq_u32 s66, 1
s_cbranch_scc1 L_Ktop
s_waitcnt vmcnt(0)
v_mov_b32 v10, s69
buffer_store_dword v10, off, s[4:7], s67 sc1
s_cmp_ge_u32 s62, 128
s_cbranch_scc1 L_end
s_mov_b32 s28, 0
k111:
s_lshl_b32 s31, s63, 7
s_add_u32 s31, s31, 1048576
buffer_load_dword v11, off, s[4:7], s31 sc1
s_waitcnt vmcnt(0)
v_readfirstlane_b32 s76, v11
s_nop 0
s_cmp_ge_u32 s76, 32
s_cbranch_scc1 k112
s_sleep 1
s_add_u32 s28, s28, 1
s_cmp_lt_u32 s28, 524288
s_cbranch_scc1 k111
s_mov_b32 s29, 11
s_branch L_abort
k112:
s_mul_i32 s72, s25, 10240
s_mul_i32 s71, s63, 40960
s_add_u32 s71, s71, s72
s_add_u32 s71, s71, 3145728
s_add_u32 s72, s72, s65
s_mov_b32 m0, s72
s_nop 0
buffer_load_dwordx4 v2, s[4:7], s71 offen offset:0 sc1 lds
buffer_load_dwordx4 v2, s[4:7], s71 offen offset:1024 sc1 lds
buffer_load_dwordx4 v2, s[4:7], s71 offen offset:2048 sc1 lds
buffer_load_dwordx4 v2, s[4:7], s71 offen offset:3072 sc1 lds
s_add_u32 s72, s72, 4096
s_add_u32 s71, s71, 4096
s_mov_b32 m0, s72
s_nop 0
buffer_load_dwordx4 v2, s[4:7], s71 offen offset:0 sc1 lds
buffer_load_dwordx4 v2, s[4:7], s71 offen offset:1024 sc1 lds
buffer_load_dwordx4 v2, s[4:7], s71 offen offset:2048 sc1 lds
buffer_load_dwordx4 v2, s[4:7], s71 offen offset:3072 sc1 lds
s_add_u32 s72, s72, 4096
s_add_u32 s71, s71, 4096
s_mov_b32 m0, s72
s_nop 0
buffer_load_dwordx4 v2, s[4:7], s71 offen offset:0 sc1 lds
buffer_load_dwordx4 v2, s[4:7], s71 offen offset:1024 sc1 lds
s_lshl_b32 s31, s64, 7
s_add_u32 s31, s31, 1048576
buffer_load_dword v9, off, s[4:7], s31 sc1
s_waitcnt vmcnt(0)
s_branch L_Ktop
L_roleV:
v_and_b32 v1, 63, v0
v_lshlrev_b32 v2, 4, v1
v_lshlrev_b32 v8, 2, v1
s_lshl_b32 s33, s24, 8
v_lshrrev_b32 v16, 4, v1
s_lshl_b32 s30, s25, 4
v_add_u32 v16, s30, v16
v_mul_u32_u24 v16, 8192, v16
v_and_b32 v40, 15, v1
v_lshl_add_u32 v16, v40, 4, v16
v_add_u32 v16, s33, v16
s_mov_b32 s12, s44
s_mov_b32 s13, s45
s_mov_b32 s14, 5242880
s_mov_b32 s15, 0x20000
v_bfe_u32 v18, v1, 4, 1
v_mul_u32_u24 v18, 2048, v18
v_bfe_u32 v19, v1, 5, 1
v_mul_u32_u24 v19, 12288, v19
v_add_u32 v18, v18, v19
v_and_b32 v19, 15, v1
v_lshl_add_u32 v18, v19, 2, v18
s_lshl_b32 s30, s25, 6
s_add_u32 s30, s30, 0
v_add_u32 v18, s30, v18
v_add_u32 v19, 24576, v18
s_mov_b32 s31, 0x05040100
s_mov_b32 s32, 0x07060302
s_mul_i32 s34, s25, 12288
s_add_u32 s34, s34, 0
s_add_u32 m0, s34, 0
s_mov_b32 s30, 0
buffer_load_dwordx4 v16, s[12:15], s30 offen  lds
s_add_u32 m0, s34, 1024
s_mov_b32 s30, 32768
buffer_load_dwordx4 v16, s[12:15], s30 offen  lds
s_add_u32 m0, s34, 2048
s_mov_b32 s30, 65536
buffer_load_dwordx4 v16, s[12:15], s30 offen  lds
s_add_u32 m0, s34, 3072
s_mov_b32 s30, 98304
buffer_load_dwordx4 v16, s[12:15], s30 offen  lds
s_add_u32 m0, s34, 4096
s_mov_b32 s30, 524288
buffer_load_dwordx4 v16, s[12:15], s30 offen  lds
s_add_u32 m0, s34, 5120
s_mov_b32 s30, 557056
buffer_load_dwordx4 v16, s[12:15], s30 offen  lds
s_add_u32 m0, s34, 6144
s_mov_b32 s30, 589824
buffer_load_dwordx4 v16, s[12:15], s30 offen  lds
s_add_u32 m0, s34, 7168
s_mov_b32 s30, 622592
buffer_load_dwordx4 v16, s[12:15], s30 offen  lds
s_waitcnt vmcnt(4)
s_barrier
s_cmp_lg_u32 s25, 0
s_cbranch_scc1 ar113
s_or_b32 s33, s3, 0x80
v_mov_b32 v7, s33
s_mov_b64 exec, 1
buffer_store_byte v7, off, s[8:11], s2 sc1
s_mov_b64 exec, -1
ar113:
s_add_u32 m0, s34, 8192
s_mov_b32 s30, 1048576
buffer_load_dwordx4 v16, s[12:15], s30 offen  lds
s_add_u32 m0, s34, 9216
s_mov_b32 s30, 1081344
buffer_load_dwordx4 v16, s[12:15], s30 offen  lds
s_add_u32 m0, s34, 10240
s_mov_b32 s30, 1114112
buffer_load_dwordx4 v16, s[12:15], s30 offen  lds
s_add_u32 m0, s34, 11264
s_mov_b32 s30, 1146880
buffer_load_dwordx4 v16, s[12:15], s30 offen  lds
ds_read2st64_b32 v[24:25], v18 offset0:0 offset1:1
ds_read2st64_b32 v[26:27], v18 offset0:2 offset1:3
ds_read2st64_b32 v[28:29], v18 offset0:4 offset1:5
ds_read2st64_b32 v[30:31], v18 offset0:6 offset1:7
ds_read2st64_b32 v[32:33], v19 offset0:0 offset1:1
ds_read2st64_b32 v[34:35], v19 offset0:2 offset1:3
ds_read2st64_b32 v[36:37], v19 offset0:4 offset1:5
ds_read2st64_b32 v[38:39], v19 offset0:6 offset1:7
s_waitcnt lgkmcnt(4)
v_perm_b32 v96, v25, v24, s31
v_perm_b32 v97, v27, v26, s31
v_perm_b32 v98, v29, v28, s31
v_perm_b32 v99, v31, v30, s31
v_perm_b32 v100, v25, v24, s32
v_perm_b32 v101, v27, v26, s32
v_perm_b32 v102, v29, v28, s32
v_perm_b32 v103, v31, v30, s32
s_waitcnt lgkmcnt(0)
v_perm_b32 v104, v33, v32, s31
v_perm_b32 v105, v35, v34, s31
v_perm_b32 v106, v37, v36, s31
v_perm_b32 v107, v39, v38, s31
v_perm_b32 v108, v33, v32, s32
v_perm_b32 v109, v35, v34, s32
v_perm_b32 v110, v37, v36, s32
v_perm_b32 v111, v39, v38, s32
s_waitcnt vmcnt(4)
s_barrier
s_add_u32 m0, s34, 0
s_mov_b32 s30, 1572864
buffer_load_dwordx4 v16, s[12:15], s30 offen  lds
s_add_u32 m0, s34, 1024
s_mov_b32 s30, 1605632
buffer_load_dwordx4 v16, s[12:15], s30 offen  lds
s_add_u32 m0, s34, 2048
s_mov_b32 s30, 1638400
buffer_load_dwordx4 v16, s[12:15], s30 offen  lds
s_add_u32 m0, s34, 3072
s_mov_b32 s30, 1671168
buffer_load_dwordx4 v16, s[12:15], s30 offen  lds
ds_read2st64_b32 v[24:25], v18 offset0:16 offset1:17
ds_read2st64_b32 v[26:27], v18 offset0:18 offset1:19
ds_read2st64_b32 v[28:29], v18 offset0:20 offset1:21
ds_read2st64_b32 v[30:31], v18 offset0:22 offset1:23
ds_read2st64_b32 v[32:33], v19 offset0:16 offset1:17
ds_read2st64_b32 v[34:35], v19 offset0:18 offset1:19
ds_read2st64_b32 v[36:37], v19 offset0:20 offset1:21
ds_read2st64_b32 v[38:39], v19 offset0:22 offset1:23
s_waitcnt lgkmcnt(4)
v_perm_b32 v112, v25, v24, s31
v_perm_b32 v113, v27, v26, s31
v_perm_b32 v114, v29, v28, s31
v_perm_b32 v115, v31, v30, s31
v_perm_b32 v116, v25, v24, s32
v_perm_b32 v117, v27, v26, s32
v_perm_b32 v118, v29, v28, s32
v_perm_b32 v119, v31, v30, s32
s_waitcnt lgkmcnt(0)
v_perm_b32 v120, v33, v32, s31
v_perm_b32 v121, v35, v34, s31
v_perm_b32 v122, v37, v36, s31
v_perm_b32 v123, v39, v38, s31
v_perm_b32 v124, v33, v32, s32
v_perm_b32 v125, v35, v34, s32
v_perm_b32 v126, v37, v36, s32
v_perm_b32 v127, v39, v38, s32
s_waitcnt vmcnt(4)
s_barrier
s_add_u32 m0, s34, 4096
s_mov_b32 s30, 2097152
buffer_load_dwordx4 v16, s[12:15], s30 offen  lds
s_add_u32 m0, s34, 5120
s_mov_b32 s30, 2129920
buffer_load_dwordx4 v16, s[12:15], s30 offen  lds
s_add_u32 m0, s34, 6144
s_mov_b32 s30, 2162688
buffer_load_dwordx4 v16, s[12:15], s30 offen  lds
s_add_u32 m0, s34, 7168
s_mov_b32 s30, 2195456
buffer_load_dwordx4 v16, s[12:15], s30 offen  lds
ds_read2st64_b32 v[24:25], v18 offset0:32 offset1:33
ds_read2st64_b32 v[26:27], v18 offset0:34 offset1:35
ds_read2st64_b32 v[28:29], v18 offset0:36 offset1:37
ds_read2st64_b32 v[30:31], v18 offset0:38 offset1:39
ds_read2st64_b32 v[32:33], v19 offset0:32 offset1:33
ds_read2st64_b32 v[34:35], v19 offset0:34 offset1:35
ds_read2st64_b32 v[36:37], v19 offset0:36 offset1:37
ds_read2st64_b32 v[38:39], v19 offset0:38 offset1:39
s_waitcnt lgkmcnt(4)
v_perm_b32 v128, v25, v24, s31
v_perm_b32 v129, v27, v26, s31
v_perm_b32 v130, v29, v28, s31
v_perm_b32 v131, v31, v30, s31
v_perm_b32 v132, v25, v24, s32
v_perm_b32 v133, v27, v26, s32
v_perm_b32 v134, v29, v28, s32
v_perm_b32 v135, v31, v30, s32
s_waitcnt lgkmcnt(0)
v_perm_b32 v136, v33, v32, s31
v_perm_b32 v137, v35, v34, s31
v_perm_b32 v138, v37, v36, s31
v_perm_b32 v139, v39, v38, s31
v_perm_b32 v140, v33, v32, s32
v_perm_b32 v141, v35, v34, s32
v_perm_b32 v142, v37, v36, s32
v_perm_b32 v143, v39, v38, s32
s_waitcnt vmcnt(4)
s_barrier
s_add_u32 m0, s34, 8192
s_mov_b32 s30, 2621440
buffer_load_dwordx4 v16, s[12:15], s30 offen  lds
s_add_u32 m0, s34, 9216
s_mov_b32 s30, 2654208
buffer_load_dwordx4 v16, s[12:15], s30 offen  lds
s_add_u32 m0, s34, 10240
s_mov_b32 s30, 2686976
buffer_load_dwordx4 v16, s[12:15], s30 offen  lds
s_add_u32 m0, s34, 11264
s_mov_b32 s30, 2719744
buffer_load_dwordx4 v16, s[12:15], s30 offen  lds
ds_read2st64_b32 v[24:25], v18 offset0:0 offset1:1
ds_read2st64_b32 v[26:27], v18 offset0:2 offset1:3
ds_read2st64_b32 v[28:29], v18 offset0:4 offset1:5
ds_read2st64_b32 v[30:31], v18 offset0:6 offset1:7
ds_read2st64_b32 v[32:33], v19 offset0:0 offset1:1
ds_read2st64_b32 v[34:35], v19 offset0:2 offset1:3
ds_read2st64_b32 v[36:37], v19 offset0:4 offset1:5
ds_read2st64_b32 v[38:39], v19 offset0:6 offset1:7
s_waitcnt lgkmcnt(4)
v_perm_b32 v144, v25, v24, s31
v_perm_b32 v145, v27, v26, s31
v_perm_b32 v146, v29, v28, s31
v_perm_b32 v147, v31, v30, s31
v_perm_b32 v148, v25, v24, s32
v_perm_b32 v149, v27, v26, s32
v_perm_b32 v150, v29, v28, s32
v_perm_b32 v151, v31, v30, s32
s_waitcnt lgkmcnt(0)
v_perm_b32 v152, v33, v32, s31
v_perm_b32 v153, v35, v34, s31
v_perm_b32 v154, v37, v36, s31
v_perm_b32 v155, v39, v38, s31
v_perm_b32 v156, v33, v32, s32
v_perm_b32 v157, v35, v34, s32
v_perm_b32 v158, v37, v36, s32
v_perm_b32 v159, v39, v38, s32
s_waitcnt vmcnt(4)
s_barrier
s_add_u32 m0, s34, 0
s_mov_b32 s30, 3145728
buffer_load_dwordx4 v16, s[12:15], s30 offen  lds
s_add_u32 m0, s34, 1024
s_mov_b32 s30, 3178496
buffer_load_dwordx4 v16, s[12:15], s30 offen  lds
s_add_u32 m0, s34, 2048
s_mov_b32 s30, 3211264
buffer_load_dwordx4 v16, s[12:15], s30 offen  lds
s_add_u32 m0, s34, 3072
s_mov_b32 s30, 3244032
buffer_load_dwordx4 v16, s[12:15], s30 offen  lds
ds_read2st64_b32 v[24:25], v18 offset0:16 offset1:17
ds_read2st64_b32 v[26:27], v18 offset0:18 offset1:19
ds_read2st64_b32 v[28:29], v18 offset0:20 offset1:21
ds_read2st64_b32 v[30:31], v18 offset0:22 offset1:23
ds_read2st64_b32 v[32:33], v19 offset0:16 offset1:17
ds_read2st64_b32 v[34:35], v19 offset0:18 offset1:19
ds_read2st64_b32 v[36:37], v19 offset0:20 offset1:21
ds_read2st64_b32 v[38:39], v19 offset0:22 offset1:23
s_waitcnt lgkmcnt(4)
v_perm_b32 v160, v25, v24, s31
v_perm_b32 v161, v27, v26, s31
v_perm_b32 v162, v29, v28, s31
v_perm_b32 v163, v31, v30, s31
v_perm_b32 v164, v25, v24, s32
v_perm_b32 v165, v27, v26, s32
v_perm_b32 v166, v29, v28, s32
v_perm_b32 v167, v31, v30, s32
s_waitcnt lgkmcnt(0)
v_perm_b32 v168, v33, v32, s31
v_perm_b32 v169, v35, v34, s31
v_perm_b32 v170, v37, v36, s31
v_perm_b32 v171, v39, v38, s31
v_perm_b32 v172, v33, v32, s32
v_perm_b32 v173, v35, v34, s32
v_perm_b32 v174, v37, v36, s32
v_perm_b32 v175, v39, v38, s32
s_waitcnt vmcnt(4)
s_barrier
s_add_u32 m0, s34, 4096
s_mov_b32 s30, 3670016
buffer_load_dwordx4 v16, s[12:15], s30 offen  lds
s_add_u32 m0, s34, 5120
s_mov_b32 s30, 3702784
buffer_load_dwordx4 v16, s[12:15], s30 offen  lds
s_add_u32 m0, s34, 6144
s_mov_b32 s30, 3735552
buffer_load_dwordx4 v16, s[12:15], s30 offen  lds
s_add_u32 m0, s34, 7168
s_mov_b32 s30, 3768320
buffer_load_dwordx4 v16, s[12:15], s30 offen  lds
ds_read2st64_b32 v[24:25], v18 offset0:32 offset1:33
ds_read2st64_b32 v[26:27], v18 offset0:34 offset1:35
ds_read2st64_b32 v[28:29], v18 offset0:36 offset1:37
ds_read2st64_b32 v[30:31], v18 offset0:38 offset1:39
ds_read2st64_b32 v[32:33], v19 offset0:32 offset1:33
ds_read2st64_b32 v[34:35], v19 offset0:34 offset1:35
ds_read2st64_b32 v[36:37], v19 offset0:36 offset1:37
ds_read2st64_b32 v[38:39], v19 offset0:38 offset1:39
s_waitcnt lgkmcnt(4)
v_perm_b32 v176, v25, v24, s31
v_perm_b32 v177, v27, v26, s31
v_perm_b32 v178, v29, v28, s31
v_perm_b32 v179, v31, v30, s31
v_perm_b32 v180, v25, v24, s32
v_perm_b32 v181, v27, v26, s32
v_perm_b32 v182, v29, v28, s32
v_perm_b32 v183, v31, v30, s32
s_waitcnt lgkmcnt(0)
v_perm_b32 v184, v33, v32, s31
v_perm_b32 v185, v35, v34, s31
v_perm_b32 v186, v37, v36, s31
v_perm_b32 v187, v39, v38, s31
v_perm_b32 v188, v33, v32, s32
v_perm_b32 v189, v35, v34, s32
v_perm_b32 v190, v37, v36, s32
v_perm_b32 v191, v39, v38, s32
s_waitcnt vmcnt(4)
s_barrier
s_add_u32 m0, s34, 8192
s_mov_b32 s30, 4194304
buffer_load_dwordx4 v16, s[12:15], s30 offen  lds
s_add_u32 m0, s34, 9216
s_mov_b32 s30, 4227072
buffer_load_dwordx4 v16, s[12:15], s30 offen  lds
s_add_u32 m0, s34, 10240
s_mov_b32 s30, 4259840
buffer_load_dwordx4 v16, s[12:15], s30 offen  lds
s_add_u32 m0, s34, 11264
s_mov_b32 s30, 4292608
buffer_load_dwordx4 v16, s[12:15], s30 offen  lds
ds_read2st64_b32 v[24:25], v18 offset0:0 offset1:1
ds_read2st64_b32 v[26:27], v18 offset0:2 offset1:3
ds_read2st64_b32 v[28:29], v18 offset0:4 offset1:5
ds_read2st64_b32 v[30:31], v18 offset0:6 offset1:7
ds_read2st64_b32 v[32:33], v19 offset0:0 offset1:1
ds_read2st64_b32 v[34:35], v19 offset0:2 offset1:3
ds_read2st64_b32 v[36:37], v19 offset0:4 offset1:5
ds_read2st64_b32 v[38:39], v19 offset0:6 offset1:7
s_waitcnt lgkmcnt(4)
v_perm_b32 v192, v25, v24, s31
v_perm_b32 v193, v27, v26, s31
v_perm_b32 v194, v29, v28, s31
v_perm_b32 v195, v31, v30, s31
v_perm_b32 v196, v25, v24, s32
v_perm_b32 v197, v27, v26, s32
v_perm_b32 v198, v29, v28, s32
v_perm_b32 v199, v31, v30, s32
s_waitcnt lgkmcnt(0)
v_perm_b32 v200, v33, v32, s31
v_perm_b32 v201, v35, v34, s31
v_perm_b32 v202, v37, v36, s31
v_perm_b32 v203, v39, v38, s31
v_perm_b32 v204, v33, v32, s32
v_perm_b32 v205, v35, v34, s32
v_perm_b32 v206, v37, v36, s32
v_perm_b32 v207, v39, v38, s32
s_waitcnt vmcnt(4)
s_barrier
s_add_u32 m0, s34, 0
s_mov_b32 s30, 4718592
buffer_load_dwordx4 v16, s[12:15], s30 offen  lds
s_add_u32 m0, s34, 1024
s_mov_b32 s30, 4751360
buffer_load_dwordx4 v16, s[12:15], s30 offen  lds
s_add_u32 m0, s34, 2048
s_mov_b32 s30, 4784128
buffer_load_dwordx4 v16, s[12:15], s30 offen  lds
s_add_u32 m0, s34, 3072
s_mov_b32 s30, 4816896
buffer_load_dwordx4 v16, s[12:15], s30 offen  lds
ds_read2st64_b32 v[24:25], v18 offset0:16 offset1:17
ds_read2st64_b32 v[26:27], v18 offset0:18 offset1:19
ds_read2st64_b32 v[28:29], v18 offset0:20 offset1:21
ds_read2st64_b32 v[30:31], v18 offset0:22 offset1:23
ds_read2st64_b32 v[32:33], v19 offset0:16 offset1:17
ds_read2st64_b32 v[34:35], v19 offset0:18 offset1:19
ds_read2st64_b32 v[36:37], v19 offset0:20 offset1:21
ds_read2st64_b32 v[38:39], v19 offset0:22 offset1:23
s_waitcnt lgkmcnt(4)
v_perm_b32 v208, v25, v24, s31
v_perm_b32 v209, v27, v26, s31
v_perm_b32 v210, v29, v28, s31
v_perm_b32 v211, v31, v30, s31
v_perm_b32 v212, v25, v24, s32
v_perm_b32 v213, v27, v26, s32
v_perm_b32 v214, v29, v28, s32
v_perm_b32 v215, v31, v30, s32
s_waitcnt lgkmcnt(0)
v_perm_b32 v216, v33, v32, s31
v_perm_b32 v217, v35, v34, s31
v_perm_b32 v218, v37, v36, s31
v_perm_b32 v219, v39, v38, s31
v_perm_b32 v220, v33, v32, s32
v_perm_b32 v221, v35, v34, s32
v_perm_b32 v222, v37, v36, s32
v_perm_b32 v223, v39, v38, s32
s_waitcnt vmcnt(4)
s_barrier
ds_read2st64_b32 v[24:25], v18 offset0:32 offset1:33
ds_read2st64_b32 v[26:27], v18 offset0:34 offset1:35
ds_read2st64_b32 v[28:29], v18 offset0:36 offset1:37
ds_read2st64_b32 v[30:31], v18 offset0:38 offset1:39
ds_read2st64_b32 v[32:33], v19 offset0:32 offset1:33
ds_read2st64_b32 v[34:35], v19 offset0:34 offset1:35
ds_read2st64_b32 v[36:37], v19 offset0:36 offset1:37
ds_read2st64_b32 v[38:39], v19 offset0:38 offset1:39
s_waitcnt lgkmcnt(4)
v_perm_b32 v224, v25, v24, s31
v_perm_b32 v225, v27, v26, s31
v_perm_b32 v226, v29, v28, s31
v_perm_b32 v227, v31, v30, s31
v_perm_b32 v228, v25, v24, s32
v_perm_b32 v229, v27, v26, s32
v_perm_b32 v230, v29, v28, s32
v_perm_b32 v231, v31, v30, s32
s_waitcnt lgkmcnt(0)
v_perm_b32 v232, v33, v32, s31
v_perm_b32 v233, v35, v34, s31
v_perm_b32 v234, v37, v36, s31
v_perm_b32 v235, v39, v38, s31
v_perm_b32 v236, v33, v32, s32
v_perm_b32 v237, v35, v34, s32
v_perm_b32 v238, v37, v36, s32
v_perm_b32 v239, v39, v38, s32
s_waitcnt vmcnt(0)
s_barrier
ds_read2st64_b32 v[24:25], v18 offset0:0 offset1:1
ds_read2st64_b32 v[26:27], v18 offset0:2 offset1:3
ds_read2st64_b32 v[28:29], v18 offset0:4 offset1:5
ds_read2st64_b32 v[30:31], v18 offset0:6 offset1:7
ds_read2st64_b32 v[32:33], v19 offset0:0 offset1:1
ds_read2st64_b32 v[34:35], v19 offset0:2 offset1:3
ds_read2st64_b32 v[36:37], v19 offset0:4 offset1:5
ds_read2st64_b32 v[38:39], v19 offset0:6 offset1:7
s_waitcnt lgkmcnt(4)
v_perm_b32 v240, v25, v24, s31
v_perm_b32 v241, v27, v26, s31
v_perm_b32 v242, v29, v28, s31
v_perm_b32 v243, v31, v30, s31
v_perm_b32 v244, v25, v24, s32
v_perm_b32 v245, v27, v26, s32
v_perm_b32 v246, v29, v28, s32
v_perm_b32 v247, v31, v30, s32
s_waitcnt lgkmcnt(0)
v_perm_b32 v248, v33, v32, s31
v_perm_b32 v249, v35, v34, s31
v_perm_b32 v250, v37, v36, s31
v_perm_b32 v251, v39, v38, s31
v_perm_b32 v252, v33, v32, s32
v_perm_b32 v253, v35, v34, s32
v_perm_b32 v254, v37, v36, s32
v_perm_b32 v255, v39, v38, s32
s_waitcnt vmcnt(0) lgkmcnt(0)
s_barrier
v_bfe_u32 v10, v1, 1, 3
v_lshrrev_b32 v11, 4, v1
v_xor_b32 v10, v10, v11
v_lshlrev_b32 v76, 4, v10
v_and_b32 v10, 7, v1
v_lshl_add_u32 v76, v10, 7, v76
v_bfe_u32 v10, v1, 3, 1
v_mul_u32_u24 v10, 10240, v10
v_add_u32 v76, v76, v10
v_xor_b32 v77, 64, v76
s_mov_b32 s28, 0
s_mov_b32 s30, 0x80808080
v_and_b32 v12, 63, v0
v_lshlrev_b32 v12, 2, v12
sy114:
buffer_load_dword v13, v12, s[8:11], 0 offen sc1
s_waitcnt vmcnt(0)
sy117:
v_and_b32 v14, s30, v13
v_cmp_ne_u32 vcc, s30, v14
s_cbranch_vccz sy115
s_sleep 2
s_add_u32 s28, s28, 1
s_cmp_lt_u32 s28, 524288
s_cbranch_scc1 sy114
s_mov_b32 s29, 1
s_branch L_abort
sy115:
s_cmp_lg_u32 s26, 0
s_cbranch_scc1 sy116
v_mov_b32 v15, 0
v_bfe_u32 v14, v13, 0, 3
v_lshlrev_b32 v14, v14, 1
v_or_b32 v15, v15, v14
v_bfe_u32 v14, v13, 8, 3
v_lshlrev_b32 v14, v14, 1
v_or_b32 v15, v15, v14
v_bfe_u32 v14, v13, 16, 3
v_lshlrev_b32 v14, v14, 1
v_or_b32 v15, v15, v14
v_bfe_u32 v14, v13, 24, 3
v_lshlrev_b32 v14, v14, 1
v_or_b32 v15, v15, v14
s_nop 1
v_mov_b32 v14, v15 quad_perm:[1,0,3,2] row_mask:0xf bank_mask:0xf
v_or_b32 v15, v15, v14
v_cmp_ne_u32 vcc, 0xff, v15
s_cbranch_vccnz L_rank
s_mov_b32 s26, 1
sy116:
s_lshl_b32 s73, s27, 5
s_add_u32 s73, s73, s24
s_lshl_b32 s73, s73, 2
s_add_u32 s73, s73, s25
s_lshl_b32 s73, s73, 13
s_add_u32 s73, s73, 209715200
s_mov_b32 s54, 0xaaa00000
s_mov_b32 s55, 0xaaaaaaaa
s_mov_b32 s56, 0xaaaaaaaa
s_mov_b32 s57, 0xfffffaaa
s_lshl_b32 s68, s24, 11
s_lshl_b32 s33, s25, 9
s_add_u32 s68, s68, s33
s_lshl_b32 s70, s68, 2
s_add_u32 s70, s70, 100663296
s_add_u32 s68, s68, 786560
s_mov_b32 s67, s68
s_mov_b32 s69, 0
s_mov_b32 s62, 0
s_mov_b32 s63, 0
s_mov_b32 s64, 1
s_mov_b32 s65, 0
s_mov_b32 s28, 0
k118:
s_lshl_b32 s31, s63, 7
s_add_u32 s31, s31, 1048576
buffer_load_dword v11, off, s[4:7], s31 sc1
s_waitcnt vmcnt(0)
v_readfirstlane_b32 s76, v11
s_nop 0
s_cmp_ge_u32 s76, 32
s_cbranch_scc1 k119
s_sleep 1
s_add_u32 s28, s28, 1
s_cmp_lt_u32 s28, 524288
s_cbranch_scc1 k118
s_mov_b32 s29, 10
s_branch L_abort
k119:
s_mul_i32 s72, s25, 10240
s_mul_i32 s71, s63, 40960
s_add_u32 s71, s71, s72
s_add_u32 s71, s71, 3145728
s_add_u32 s72, s72, s65
s_mov_b32 m0, s72
s_nop 0
buffer_load_dwordx4 v2, s[4:7], s71 offen offset:0 sc1 lds
buffer_load_dwordx4 v2, s[4:7], s71 offen offset:1024 sc1 lds
buffer_load_dwordx4 v2, s[4:7], s71 offen offset:2048 sc1 lds
buffer_load_dwordx4 v2, s[4:7], s71 offen offset:3072 sc1 lds
s_add_u32 s72, s72, 4096
s_add_u32 s71, s71, 4096
s_mov_b32 m0, s72
s_nop 0
buffer_load_dwordx4 v2, s[4:7], s71 offen offset:0 sc1 lds
buffer_load_dwordx4 v2, s[4:7], s71 offen offset:1024 sc1 lds
buffer_load_dwordx4 v2, s[4:7], s71 offen offset:2048 sc1 lds
buffer_load_dwordx4 v2, s[4:7], s71 offen offset:3072 sc1 lds
s_add_u32 s72, s72, 4096
s_add_u32 s71, s71, 4096
s_mov_b32 m0, s72
s_nop 0
buffer_load_dwordx4 v2, s[4:7], s71 offen offset:0 sc1 lds
buffer_load_dwordx4 v2, s[4:7], s71 offen offset:1024 sc1 lds
s_lshl_b32 s31, s64, 7
s_add_u32 s31, s31, 1048576
buffer_load_dword v9, off, s[4:7], s31 sc1
s_waitcnt vmcnt(0)
.p2align 5
L_Vtop:
v_add_u32 v72, s65, v76
v_add_u32 v73, s65, v77
s_waitcnt vmcnt(3)
s_barrier
ds_read_b128 v[16:19], v72 offset:0
ds_read_b128 v[20:23], v72 offset:20480
ds_read_b128 v[24:27], v73 offset:0
ds_read_b128 v[28:31], v73 offset:20480
ds_read_b128 v[32:35], v72 offset:1024
ds_read_b128 v[36:39], v72 offset:21504
s_lshl_b32 s31, s64, 7
s_add_u32 s31, s31, 1048576
buffer_load_dword v11, off, s[4:7], s31 sc1
v_readfirstlane_b32 s77, v9
s_nop 0
s_cmp_ge_u32 s77, 32
s_cselect_b32 s66, 1, 0
s_cmp_ge_u32 s62, 127
s_cselect_b32 s66, 0, s66
s_cmp_eq_u32 s66, 1
s_cselect_b32 s33, 0, 0x40000000
v_or_b32 v5, s33, v2
s_xor_b32 s65, s65, 40960
s_mul_i32 s72, s25, 10240
s_mul_i32 s71, s64, 40960
s_add_u32 s71, s71, s72
s_add_u32 s71, s71, 3145728
s_add_u32 s72, s72, s65
s_waitcnt lgkmcnt(5)
v_mfma_f32_16x16x32_bf16 v[48:51], v[16:19], v[96:99], 0
s_mov_b32 m0, s72
s_nop 0
buffer_load_dwordx4 v5, s[4:7], s71 offen offset:0 sc1 lds
v_mfma_f32_16x16x32_bf16 v[56:59], v[16:19], v[100:103], 0
ds_read_b128 v[16:19], v73 offset:1024
s_waitcnt lgkmcnt(5)
v_mfma_f32_16x16x32_bf16 v[52:55], v[20:23], v[96:99], 0
buffer_load_dwordx4 v5, s[4:7], s71 offen offset:1024 sc1 lds
v_mfma_f32_16x16x32_bf16 v[60:63], v[20:23], v[100:103], 0
ds_read_b128 v[20:23], v73 offset:21504
s_waitcnt lgkmcnt(5)
v_mfma_f32_16x16x32_bf16 v[48:51], v[24:27], v[104:107], v[48:51]
v_mfma_f32_16x16x32_bf16 v[56:59], v[24:27], v[108:111], v[56:59]
ds_read_b128 v[24:27], v72 offset:2048
s_waitcnt lgkmcnt(5)
v_mfma_f32_16x16x32_bf16 v[52:55], v[28:31], v[104:107], v[52:55]
buffer_load_dwordx4 v5, s[4:7], s71 offen offset:2048 sc1 lds
v_mfma_f32_16x16x32_bf16 v[60:63], v[28:31], v[108:111], v[60:63]
ds_read_b128 v[28:31], v72 offset:22528
s_waitcnt lgkmcnt(5)
v_mfma_f32_16x16x32_bf16 v[48:51], v[32:35], v[112:115], v[48:51]
v_mfma_f32_16x16x32_bf16 v[56:59], v[32:35], v[116:119], v[56:59]
ds_read_b128 v[32:35], v73 offset:2048
s_waitcnt lgkmcnt(5)
v_mfma_f32_16x16x32_bf16 v[52:55], v[36:39], v[112:115], v[52:55]
buffer_load_dwordx4 v5, s[4:7], s71 offen offset:3072 sc1 lds
v_mfma_f32_16x16x32_bf16 v[60:63], v[36:39], v[116:119], v[60:63]
ds_read_b128 v[36:39], v73 offset:22528
s_waitcnt lgkmcnt(5)
v_mfma_f32_16x16x32_bf16 v[48:51], v[16:19], v[120:123], v[48:51]
v_mfma_f32_16x16x32_bf16 v[56:59], v[16:19], v[124:127], v[56:59]
ds_read_b128 v[16:19], v72 offset:3072
s_waitcnt lgkmcnt(5)
v_mfma_f32_16x16x32_bf16 v[52:55], v[20:23], v[120:123], v[52:55]
s_add_u32 s72, s72, 4096
s_add_u32 s71, s71, 4096
s_mov_b32 m0, s72
s_nop 0
buffer_load_dwordx4 v5, s[4:7], s71 offen offset:0 sc1 lds
v_mfma_f32_16x16x32_bf16 v[60:63], v[20:23], v[124:127], v[60:63]
ds_read_b128 v[20:23], v72 offset:23552
s_waitcnt lgkmcnt(5)
v_mfma_f32_16x16x32_bf16 v[48:51], v[24:27], v[128:131], v[48:51]
v_mfma_f32_16x16x32_bf16 v[56:59], v[24:27], v[132:135], v[56:59]
ds_read_b128 v[24:27], v73 offset:3072
s_waitcnt lgkmcnt(5)
v_mfma_f32_16x16x32_bf16 v[52:55], v[28:31], v[128:131], v[52:55]
buffer_load_dwordx4 v5, s[4:7], s71 offen offset:1024 sc1 lds
v_mfma_f32_16x16x32_bf16 v[60:63], v[28:31], v[132:135], v[60:63]
ds_read_b128 v[28:31], v73 offset:23552
s_waitcnt lgkmcnt(5)
v_mfma_f32_16x16x32_bf16 v[48:51], v[32:35], v[136:139], v[48:51]
buffer_load_dwordx4 v5, s[4:7], s71 offen offset:2048 sc1 lds
v_mfma_f32_16x16x32_bf16 v[56:59], v[32:35], v[140:143], v[56:59]
ds_read_b128 v[32:35], v72 offset:4096
s_waitcnt lgkmcnt(5)
v_mfma_f32_16x16x32_bf16 v[52:55], v[36:39], v[136:139], v[52:55]
v_mfma_f32_16x16x32_bf16 v[60:63], v[36:39], v[140:143], v[60:63]
ds_read_b128 v[36:39], v72 offset:24576
s_waitcnt lgkmcnt(5)
v_mfma_f32_16x16x32_bf16 v[48:51], v[16:19], v[144:147], v[48:51]
buffer_load_dwordx4 v5, s[4:7], s71 offen offset:3072 sc1 lds
v_mfma_f32_16x16x32_bf16 v[56:59], v[16:19], v[148:151], v[56:59]
ds_read_b128 v[16:19], v73 offset:4096
s_waitcnt lgkmcnt(5)
v_mfma_f32_16x16x32_bf16 v[52:55], v[20:23], v[144:147], v[52:55]
v_mfma_f32_16x16x32_bf16 v[60:63], v[20:23], v[148:151], v[60:63]
ds_read_b128 v[20:23], v73 offset:24576
s_waitcnt lgkmcnt(5)
v_mfma_f32_16x16x32_bf16 v[48:51], v[24:27], v[152:155], v[48:51]
s_add_u32 s72, s72, 4096
s_add_u32 s71, s71, 4096
s_mov_b32 m0, s72
s_nop 0
buffer_load_dwordx4 v5, s[4:7], s71 offen offset:0 sc1 lds
v_mfma_f32_16x16x32_bf16 v[56:59], v[24:27], v[156:159], v[56:59]
ds_read_b128 v[24:27], v72 offset:5120
s_waitcnt lgkmcnt(5)
v_mfma_f32_16x16x32_bf16 v[52:55], v[28:31], v[152:155], v[52:55]
v_mfma_f32_16x16x32_bf16 v[60:63], v[28:31], v[156:159], v[60:63]
ds_read_b128 v[28:31], v72 offset:25600
s_waitcnt lgkmcnt(5)
v_mfma_f32_16x16x32_bf16 v[48:51], v[32:35], v[160:163], v[48:51]
buffer_load_dwordx4 v5, s[4:7], s71 offen offset:1024 sc1 lds
v_mfma_f32_16x16x32_bf16 v[56:59], v[32:35], v[164:167], v[56:59]
ds_read_b128 v[32:35], v73 offset:5120
s_waitcnt lgkmcnt(5)
v_mfma_f32_16x16x32_bf16 v[52:55], v[36:39], v[160:163], v[52:55]
s_add_u32 s32, s62, 2
s_cmp_lt_u32 s32, 64
s_cselect_b64 s[60:61], s[54:55], s[56:57]
s_cselect_b32 s33, 0, 22
s_bfm_b64 s[34:35], s32, 0
s_and_b64 s[34:35], s[34:35], s[60:61]
s_bcnt1_i32_b64 s34, s[34:35]
s_add_u32 s33, s33, s34
s_sub_u32 s34, s32, s33
s_add_u32 s33, s33, 64
s_bitcmp1_b64 s[60:61], s32
s_cselect_b32 s74, s33, s34
s_cmp_ge_u32 s32, 128
s_cselect_b32 s74, s32, s74
v_mfma_f32_16x16x32_bf16 v[60:63], v[36:39], v[164:167], v[60:63]
ds_read_b128 v[36:39], v73 offset:25600
s_waitcnt lgkmcnt(5)
v_mfma_f32_16x16x32_bf16 v[48:51], v[16:19], v[168:171], v[48:51]
v_mfma_f32_16x16x32_bf16 v[56:59], v[16:19], v[172:175], v[56:59]
ds_read_b128 v[16:19], v72 offset:6144
s_waitcnt lgkmcnt(5)
v_mfma_f32_16x16x32_bf16 v[52:55], v[20:23], v[168:171], v[52:55]
v_mfma_f32_16x16x32_bf16 v[60:63], v[20:23], v[172:175], v[60:63]
ds_read_b128 v[20:23], v72 offset:26624
s_lshl_b32 s31, s74, 7
s_add_u32 s31, s31, 1048576
buffer_load_dword v9, off, s[4:7], s31 sc1
s_cmp_eq_u32 s66, 1
s_cbranch_scc1 k121
s_cmp_ge_u32 s62, 127
s_cbranch_scc1 k121
s_waitcnt vmcnt(11)
v_readfirstlane_b32 s76, v11
s_nop 0
s_cmp_ge_u32 s76, 32
s_cbranch_scc1 k120
k121:
s_waitcnt lgkmcnt(5)
v_mfma_f32_16x16x32_bf16 v[48:51], v[24:27], v[176:179], v[48:51]
v_mfma_f32_16x16x32_bf16 v[56:59], v[24:27], v[180:183], v[56:59]
ds_read_b128 v[24:27], v73 offset:6144
s_waitcnt lgkmcnt(5)
v_mfma_f32_16x16x32_bf16 v[52:55], v[28:31], v[176:179], v[52:55]
v_mfma_f32_16x16x32_bf16 v[60:63], v[28:31], v[180:183], v[60:63]
ds_read_b128 v[28:31], v73 offset:26624
s_waitcnt lgkmcnt(5)
v_mfma_f32_16x16x32_bf16 v[48:51], v[32:35], v[184:187], v[48:51]
v_mfma_f32_16x16x32_bf16 v[56:59], v[32:35], v[188:191], v[56:59]
ds_read_b128 v[32:35], v72 offset:7168
s_waitcnt lgkmcnt(5)
v_mfma_f32_16x16x32_bf16 v[52:55], v[36:39], v[184:187], v[52:55]
s_waitcnt vmcnt(12)
v_mov_b32 v10, s69
buffer_store_dword v10, off, s[4:7], s67 sc1
v_mfma_f32_16x16x32_bf16 v[60:63], v[36:39], v[188:191], v[60:63]
ds_read_b128 v[36:39], v72 offset:27648
s_waitcnt lgkmcnt(5)
v_mfma_f32_16x16x32_bf16 v[48:51], v[16:19], v[192:195], v[48:51]
v_mfma_f32_16x16x32_bf16 v[56:59], v[16:19], v[196:199], v[56:59]
ds_read_b128 v[16:19], v73 offset:7168
s_waitcnt lgkmcnt(5)
v_mfma_f32_16x16x32_bf16 v[52:55], v[20:23], v[192:195], v[52:55]
v_mfma_f32_16x16x32_bf16 v[60:63], v[20:23], v[196:199], v[60:63]
ds_read_b128 v[20:23], v73 offset:27648
s_waitcnt lgkmcnt(5)
v_mfma_f32_16x16x32_bf16 v[48:51], v[24:27], v[200:203], v[48:51]
v_mfma_f32_16x16x32_bf16 v[56:59], v[24:27], v[204:207], v[56:59]
ds_read_b128 v[24:27], v72 offset:8192
s_waitcnt lgkmcnt(5)
v_mfma_f32_16x16x32_bf16 v[52:55], v[28:31], v[200:203], v[52:55]
v_mfma_f32_16x16x32_bf16 v[60:63], v[28:31], v[204:207], v[60:63]
ds_read_b128 v[28:31], v72 offset:28672
s_waitcnt lgkmcnt(5)
v_mfma_f32_16x16x32_bf16 v[48:51], v[32:35], v[208:211], v[48:51]
v_mfma_f32_16x16x32_bf16 v[56:59], v[32:35], v[212:215], v[56:59]
ds_read_b128 v[32:35], v73 offset:8192
s_waitcnt lgkmcnt(5)
v_mfma_f32_16x16x32_bf16 v[52:55], v[36:39], v[208:211], v[52:55]
v_mfma_f32_16x16x32_bf16 v[60:63], v[36:39], v[212:215], v[60:63]
ds_read_b128 v[36:39], v73 offset:28672
s_waitcnt lgkmcnt(5)
v_mfma_f32_16x16x32_bf16 v[48:51], v[16:19], v[216:219], v[48:51]
v_mfma_f32_16x16x32_bf16 v[56:59], v[16:19], v[220:223], v[56:59]
ds_read_b128 v[16:19], v72 offset:9216
s_waitcnt lgkmcnt(5)
v_mfma_f32_16x16x32_bf16 v[52:55], v[20:23], v[216:219], v[52:55]
v_mfma_f32_16x16x32_bf16 v[60:63], v[20:23], v[220:223], v[60:63]
ds_read_b128 v[20:23], v72 offset:29696
s_waitcnt lgkmcnt(5)
v_mfma_f32_16x16x32_bf16 v[48:51], v[24:27], v[224:227], v[48:51]
v_mfma_f32_16x16x32_bf16 v[56:59], v[24:27], v[228:231], v[56:59]
ds_read_b128 v[24:27], v73 offset:9216
s_waitcnt lgkmcnt(5)
v_mfma_f32_16x16x32_bf16 v[52:55], v[28:31], v[224:227], v[52:55]
s_lshl_b32 s34, s63, 18
s_add_u32 s34, s34, s70
s_lshr_b32 s67, s63, 6
s_lshl_b32 s67, s67, 2
v_mfma_f32_16x16x32_bf16 v[60:63], v[28:31], v[228:231], v[60:63]
ds_read_b128 v[28:31], v73 offset:29696
s_waitcnt lgkmcnt(5)
v_mfma_f32_16x16x32_bf16 v[48:51], v[32:35], v[232:235], v[48:51]
s_add_u32 s67, s67, s68
s_and_b32 s69, s63, 63
s_add_u32 s69, s69, 1
s_add_u32 s62, s62, 1
v_mfma_f32_16x16x32_bf16 v[56:59], v[32:35], v[236:239], v[56:59]
s_waitcnt lgkmcnt(4)
v_mfma_f32_16x16x32_bf16 v[52:55], v[36:39], v[232:235], v[52:55]
s_mov_b32 s63, s64
s_mov_b32 s64, s74
v_mfma_f32_16x16x32_bf16 v[60:63], v[36:39], v[236:239], v[60:63]
s_waitcnt lgkmcnt(3)
v_mfma_f32_16x16x32_bf16 v[48:51], v[16:19], v[240:243], v[48:51]
v_mfma_f32_16x16x32_bf16 v[56:59], v[16:19], v[244:247], v[56:59]
s_waitcnt lgkmcnt(2)
v_mfma_f32_16x16x32_bf16 v[52:55], v[20:23], v[240:243], v[52:55]
v_mfma_f32_16x16x32_bf16 v[60:63], v[20:23], v[244:247], v[60:63]
s_waitcnt lgkmcnt(1)
v_mfma_f32_16x16x32_bf16 v[48:51], v[24:27], v[248:251], v[48:51]
v_mfma_f32_16x16x32_bf16 v[56:59], v[24:27], v[252:255], v[56:59]
s_waitcnt lgkmcnt(0)
v_mfma_f32_16x16x32_bf16 v[52:55], v[28:31], v[248:251], v[52:55]
v_mfma_f32_16x16x32_bf16 v[60:63], v[28:31], v[252:255], v[60:63]
s_branch k122
k120:
s_mov_b32 s66, 1
s_mul_i32 s72, s25, 10240
s_mul_i32 s71, s64, 40960
s_add_u32 s71, s71, s72
s_add_u32 s71, s71, 3145728
s_add_u32 s72, s72, s65
s_waitcnt lgkmcnt(5)
v_mfma_f32_16x16x32_bf16 v[48:51], v[24:27], v[176:179], v[48:51]
s_mov_b32 m0, s72
s_nop 0
buffer_load_dwordx4 v2, s[4:7], s71 offen offset:0 sc1 lds
v_mfma_f32_16x16x32_bf16 v[56:59], v[24:27], v[180:183], v[56:59]
ds_read_b128 v[24:27], v73 offset:6144
s_waitcnt lgkmcnt(5)
v_mfma_f32_16x16x32_bf16 v[52:55], v[28:31], v[176:179], v[52:55]
buffer_load_dwordx4 v2, s[4:7], s71 offen offset:1024 sc1 lds
v_mfma_f32_16x16x32_bf16 v[60:63], v[28:31], v[180:183], v[60:63]
ds_read_b128 v[28:31], v73 offset:26624
s_waitcnt lgkmcnt(5)
v_mfma_f32_16x16x32_bf16 v[48:51], v[32:35], v[184:187], v[48:51]
buffer_load_dwordx4 v2, s[4:7], s71 offen offset:2048 sc1 lds
v_mfma_f32_16x16x32_bf16 v[56:59], v[32:35], v[188:191], v[56:59]
ds_read_b128 v[32:35], v72 offset:7168
s_waitcnt lgkmcnt(5)
v_mfma_f32_16x16x32_bf16 v[52:55], v[36:39], v[184:187], v[52:55]
buffer_load_dwordx4 v2, s[4:7], s71 offen offset:3072 sc1 lds
v_mfma_f32_16x16x32_bf16 v[60:63], v[36:39], v[188:191], v[60:63]
ds_read_b128 v[36:39], v72 offset:27648
s_waitcnt lgkmcnt(5)
v_mfma_f32_16x16x32_bf16 v[48:51], v[16:19], v[192:195], v[48:51]
s_add_u32 s72, s72, 4096
s_add_u32 s71, s71, 4096
s_mov_b32 m0, s72
s_nop 0
buffer_load_dwordx4 v2, s[4:7], s71 offen offset:0 sc1 lds
v_mfma_f32_16x16x32_bf16 v[56:59], v[16:19], v[196:199], v[56:59]
ds_read_b128 v[16:19], v73 offset:7168
s_waitcnt lgkmcnt(5)
v_mfma_f32_16x16x32_bf16 v[52:55], v[20:23], v[192:195], v[52:55]
buffer_load_dwordx4 v2, s[4:7], s71 offen offset:1024 sc1 lds
v_mfma_f32_16x16x32_bf16 v[60:63], v[20:23], v[196:199], v[60:63]
ds_read_b128 v[20:23], v73 offset:27648
s_waitcnt lgkmcnt(5)
v_mfma_f32_16x16x32_bf16 v[48:51], v[24:27], v[200:203], v[48:51]
buffer_load_dwordx4 v2, s[4:7], s71 offen offset:2048 sc1 lds
v_mfma_f32_16x16x32_bf16 v[56:59], v[24:27], v[204:207], v[56:59]
ds_read_b128 v[24:27], v72 offset:8192
s_waitcnt lgkmcnt(5)
v_mfma_f32_16x16x32_bf16 v[52:55], v[28:31], v[200:203], v[52:55]
buffer_load_dwordx4 v2, s[4:7], s71 offen offset:3072 sc1 lds
v_mfma_f32_16x16x32_bf16 v[60:63], v[28:31], v[204:207], v[60:63]
ds_read_b128 v[28:31], v72 offset:28672
s_waitcnt lgkmcnt(5)
v_mfma_f32_16x16x32_bf16 v[48:51], v[32:35], v[208:211], v[48:51]
s_add_u32 s72, s72, 4096
s_add_u32 s71, s71, 4096
s_mov_b32 m0, s72
s_nop 0
buffer_load_dwordx4 v2, s[4:7], s71 offen offset:0 sc1 lds
v_mfma_f32_16x16x32_bf16 v[56:59], v[32:35], v[212:215], v[56:59]
ds_read_b128 v[32:35], v73 offset:8192
s_waitcnt lgkmcnt(5)
v_mfma_f32_16x16x32_bf16 v[52:55], v[36:39], v[208:211], v[52:55]
buffer_load_dwordx4 v2, s[4:7], s71 offen offset:1024 sc1 lds
v_mfma_f32_16x16x32_bf16 v[60:63], v[36:39], v[212:215], v[60:63]
ds_read_b128 v[36:39], v73 offset:28672
s_waitcnt lgkmcnt(5)
v_mfma_f32_16x16x32_bf16 v[48:51], v[16:19], v[216:219], v[48:51]
s_waitcnt vmcnt(22)
v_mov_b32 v10, s69
buffer_store_dword v10, off, s[4:7], s67 sc1
v_mfma_f32_16x16x32_bf16 v[56:59], v[16:19], v[220:223], v[56:59]
ds_read_b128 v[16:19], v72 offset:9216
s_waitcnt lgkmcnt(5)
v_mfma_f32_16x16x32_bf16 v[52:55], v[20:23], v[216:219], v[52:55]
v_mfma_f32_16x16x32_bf16 v[60:63], v[20:23], v[220:223], v[60:63]
ds_read_b128 v[20:23], v72 offset:29696
s_waitcnt lgkmcnt(5)
v_mfma_f32_16x16x32_bf16 v[48:51], v[24:27], v[224:227], v[48:51]
v_mfma_f32_16x16x32_bf16 v[56:59], v[24:27], v[228:231], v[56:59]
ds_read_b128 v[24:27], v73 offset:9216
s_waitcnt lgkmcnt(5)
v_mfma_f32_16x16x32_bf16 v[52:55], v[28:31], v[224:227], v[52:55]
s_lshl_b32 s34, s63, 18
s_add_u32 s34, s34, s70
s_lshr_b32 s67, s63, 6
s_lshl_b32 s67, s67, 2
v_mfma_f32_16x16x32_bf16 v[60:63], v[28:31], v[228:231], v[60:63]
ds_read_b128 v[28:31], v73 offset:29696
s_waitcnt lgkmcnt(5)
v_mfma_f32_16x16x32_bf16 v[48:51], v[32:35], v[232:235], v[48:51]
s_add_u32 s67, s67, s68
s_and_b32 s69, s63, 63
s_add_u32 s69, s69, 1
s_add_u32 s62, s62, 1
v_mfma_f32_16x16x32_bf16 v[56:59], v[32:35], v[236:239], v[56:59]
s_waitcnt lgkmcnt(4)
v_mfma_f32_16x16x32_bf16 v[52:55], v[36:39], v[232:235], v[52:55]
s_mov_b32 s63, s64
s_mov_b32 s64, s74
v_mfma_f32_16x16x32_bf16 v[60:63], v[36:39], v[236:239], v[60:63]
s_waitcnt lgkmcnt(3)
v_mfma_f32_16x16x32_bf16 v[48:51], v[16:19], v[240:243], v[48:51]
v_mfma_f32_16x16x32_bf16 v[56:59], v[16:19], v[244:247], v[56:59]
s_waitcnt lgkmcnt(2)
v_mfma_f32_16x16x32_bf16 v[52:55], v[20:23], v[240:243], v[52:55]
v_mfma_f32_16x16x32_bf16 v[60:63], v[20:23], v[244:247], v[60:63]
s_waitcnt lgkmcnt(1)
v_mfma_f32_16x16x32_bf16 v[48:51], v[24:27], v[248:251], v[48:51]
v_mfma_f32_16x16x32_bf16 v[56:59], v[24:27], v[252:255], v[56:59]
s_waitcnt lgkmcnt(0)
v_mfma_f32_16x16x32_bf16 v[52:55], v[28:31], v[248:251], v[52:55]
v_mfma_f32_16x16x32_bf16 v[60:63], v[28:31], v[252:255], v[60:63]
k122:
v_cvt_pk_bf16_f32 v64, v48, v49
v_cvt_pk_bf16_f32 v65, v50, v51
s_nop 4
v_cvt_pk_bf16_f32 v66, v52, v53
v_cvt_pk_bf16_f32 v67, v54, v55
buffer_store_dwordx4 v[64:67], v2, s[4:7], s34 offen offset:0 sc1
v_cvt_pk_bf16_f32 v68, v56, v57
v_cvt_pk_bf16_f32 v69, v58, v59
v_cvt_pk_bf16_f32 v70, v60, v61
v_cvt_pk_bf16_f32 v71, v62, v63
buffer_store_dwordx4 v[68:71], v2, s[4:7], s34 offen offset:1024 sc1
s_cmp_eq_u32 s66, 1
s_cbranch_scc1 L_Vtop
s_waitcnt vmcnt(0)
v_mov_b32 v10, s69
buffer_store_dword v10, off, s[4:7], s67 sc1
s_cmp_ge_u32 s62, 128
s_cbranch_scc1 L_end
s_mov_b32 s28, 0
k123:
s_lshl_b32 s31, s63, 7
s_add_u32 s31, s31, 1048576
buffer_load_dword v11, off, s[4:7], s31 sc1
s_waitcnt vmcnt(0)
v_readfirstlane_b32 s76, v11
s_nop 0
s_cmp_ge_u32 s76, 32
s_cbranch_scc1 k124
s_sleep 1
s_add_u32 s28, s28, 1
s_cmp_lt_u32 s28, 524288
s_cbranch_scc1 k123
s_mov_b32 s29, 11
s_branch L_abort
k124:
s_mul_i32 s72, s25, 10240
s_mul_i32 s71, s63, 40960
s_add_u32 s71, s71, s72
s_add_u32 s71, s71, 3145728
s_add_u32 s72, s72, s65
s_mov_b32 m0, s72
s_nop 0
buffer_load_dwordx4 v2, s[4:7], s71 offen offset:0 sc1 lds
buffer_load_dwordx4 v2, s[4:7], s71 offen offset:1024 sc1 lds
buffer_load_dwordx4 v2, s[4:7], s71 offen offset:2048 sc1 lds
buffer_load_dwordx4 v2, s[4:7], s71 offen offset:3072 sc1 lds
s_add_u32 s72, s72, 4096
s_add_u32 s71, s71, 4096
s_mov_b32 m0, s72
s_nop 0
buffer_load_dwordx4 v2, s[4:7], s71 offen offset:0 sc1 lds
buffer_load_dwordx4 v2, s[4:7], s71 offen offset:1024 sc1 lds
buffer_load_dwordx4 v2, s[4:7], s71 offen offset:2048 sc1 lds
buffer_load_dwordx4 v2, s[4:7], s71 offen offset:3072 sc1 lds
s_add_u32 s72, s72, 4096
s_add_u32 s71, s71, 4096
s_mov_b32 m0, s72
s_nop 0
buffer_load_dwordx4 v2, s[4:7], s71 offen offset:0 sc1 lds
buffer_load_dwordx4 v2, s[4:7], s71 offen offset:1024 sc1 lds
s_lshl_b32 s31, s64, 7
s_add_u32 s31, s31, 1048576
buffer_load_dword v9, off, s[4:7], s31 sc1
s_waitcnt vmcnt(0)
s_branch L_Vtop
L_roleQ:
v_and_b32 v1, 63, v0
v_lshlrev_b32 v2, 4, v1
v_lshlrev_b32 v8, 2, v1
s_lshl_b32 s33, s24, 8
v_lshrrev_b32 v16, 4, v1
s_lshl_b32 s30, s25, 4
v_add_u32 v16, s30, v16
v_mul_u32_u24 v16, 8192, v16
v_and_b32 v40, 15, v1
v_lshl_add_u32 v16, v40, 4, v16
v_add_u32 v16, s33, v16
s_mov_b32 s12, s40
s_mov_b32 s13, s41
s_mov_b32 s14, 5242880
s_mov_b32 s15, 0x20000
v_bfe_u32 v18, v1, 4, 1
v_mul_u32_u24 v18, 2048, v18
v_bfe_u32 v19, v1, 5, 1
v_mul_u32_u24 v19, 12288, v19
v_add_u32 v18, v18, v19
v_and_b32 v19, 15, v1
v_lshl_add_u32 v18, v19, 2, v18
s_lshl_b32 s30, s25, 6
s_add_u32 s30, s30, 0
v_add_u32 v18, s30, v18
v_add_u32 v19, 24576, v18
s_mov_b32 s31, 0x05040100
s_mov_b32 s32, 0x07060302
s_mul_i32 s34, s25, 12288
s_add_u32 s34, s34, 0
s_add_u32 m0, s34, 0
s_mov_b32 s30, 0
buffer_load_dwordx4 v16, s[12:15], s30 offen  lds
s_add_u32 m0, s34, 1024
s_mov_b32 s30, 32768
buffer_load_dwordx4 v16, s[12:15], s30 offen  lds
s_add_u32 m0, s34, 2048
s_mov_b32 s30, 65536
buffer_load_dwordx4 v16, s[12:15], s30 offen  lds
s_add_u32 m0, s34, 3072
s_mov_b32 s30, 98304
buffer_load_dwordx4 v16, s[12:15], s30 offen  lds
s_add_u32 m0, s34, 4096
s_mov_b32 s30, 524288
buffer_load_dwordx4 v16, s[12:15], s30 offen  lds
s_add_u32 m0, s34, 5120
s_mov_b32 s30, 557056
buffer_load_dwordx4 v16, s[12:15], s30 offen  lds
s_add_u32 m0, s34, 6144
s_mov_b32 s30, 589824
buffer_load_dwordx4 v16, s[12:15], s30 offen  lds
s_add_u32 m0, s34, 7168
s_mov_b32 s30, 622592
buffer_load_dwordx4 v16, s[12:15], s30 offen  lds
s_waitcnt vmcnt(4)
s_barrier
s_cmp_lg_u32 s25, 0
s_cbranch_scc1 ar125
s_or_b32 s33, s3, 0x80
v_mov_b32 v7, s33
s_mov_b64 exec, 1
buffer_store_byte v7, off, s[8:11], s2 sc1
s_mov_b64 exec, -1
ar125:
s_add_u32 m0, s34, 8192
s_mov_b32 s30, 1048576
buffer_load_dwordx4 v16, s[12:15], s30 offen  lds
s_add_u32 m0, s34, 9216
s_mov_b32 s30, 1081344
buffer_load_dwordx4 v16, s[12:15], s30 offen  lds
s_add_u32 m0, s34, 10240
s_mov_b32 s30, 1114112
buffer_load_dwordx4 v16, s[12:15], s30 offen  lds
s_add_u32 m0, s34, 11264
s_mov_b32 s30, 1146880
buffer_load_dwordx4 v16, s[12:15], s30 offen  lds
ds_read2st64_b32 v[24:25], v18 offset0:0 offset1:1
ds_read2st64_b32 v[26:27], v18 offset0:2 offset1:3
ds_read2st64_b32 v[28:29], v18 offset0:4 offset1:5
ds_read2st64_b32 v[30:31], v18 offset0:6 offset1:7
ds_read2st64_b32 v[32:33], v19 offset0:0 offset1:1
ds_read2st64_b32 v[34:35], v19 offset0:2 offset1:3
ds_read2st64_b32 v[36:37], v19 offset0:4 offset1:5
ds_read2st64_b32 v[38:39], v19 offset0:6 offset1:7
s_waitcnt lgkmcnt(4)
v_perm_b32 v96, v25, v24, s31
v_perm_b32 v97, v27, v26, s31
v_perm_b32 v98, v29, v28, s31
v_perm_b32 v99, v31, v30, s31
v_perm_b32 v100, v25, v24, s32
v_perm_b32 v101, v27, v26, s32
v_perm_b32 v102, v29, v28, s32
v_perm_b32 v103, v31, v30, s32
s_waitcnt lgkmcnt(0)
v_perm_b32 v104, v33, v32, s31
v_perm_b32 v105, v35, v34, s31
v_perm_b32 v106, v37, v36, s31
v_perm_b32 v107, v39, v38, s31
v_perm_b32 v108, v33, v32, s32
v_perm_b32 v109, v35, v34, s32
v_perm_b32 v110, v37, v36, s32
v_perm_b32 v111, v39, v38, s32
s_waitcnt vmcnt(4)
s_barrier
s_add_u32 m0, s34, 0
s_mov_b32 s30, 1572864
buffer_load_dwordx4 v16, s[12:15], s30 offen  lds
s_add_u32 m0, s34, 1024
s_mov_b32 s30, 1605632
buffer_load_dwordx4 v16, s[12:15], s30 offen  lds
s_add_u32 m0, s34, 2048
s_mov_b32 s30, 1638400
buffer_load_dwordx4 v16, s[12:15], s30 offen  lds
s_add_u32 m0, s34, 3072
s_mov_b32 s30, 1671168
buffer_load_dwordx4 v16, s[12:15], s30 offen  lds
ds_read2st64_b32 v[24:25], v18 offset0:16 offset1:17
ds_read2st64_b32 v[26:27], v18 offset0:18 offset1:19
ds_read2st64_b32 v[28:29], v18 offset0:20 offset1:21
ds_read2st64_b32 v[30:31], v18 offset0:22 offset1:23
ds_read2st64_b32 v[32:33], v19 offset0:16 offset1:17
ds_read2st64_b32 v[34:35], v19 offset0:18 offset1:19
ds_read2st64_b32 v[36:37], v19 offset0:20 offset1:21
ds_read2st64_b32 v[38:39], v19 offset0:22 offset1:23
s_waitcnt lgkmcnt(4)
v_perm_b32 v112, v25, v24, s31
v_perm_b32 v113, v27, v26, s31
v_perm_b32 v114, v29, v28, s31
v_perm_b32 v115, v31, v30, s31
v_perm_b32 v116, v25, v24, s32
v_perm_b32 v117, v27, v26, s32
v_perm_b32 v118, v29, v28, s32
v_perm_b32 v119, v31, v30, s32
s_waitcnt lgkmcnt(0)
v_perm_b32 v120, v33, v32, s31
v_perm_b32 v121, v35, v34, s31
v_perm_b32 v122, v37, v36, s31
v_perm_b32 v123, v39, v38, s31
v_perm_b32 v124, v33, v32, s32
v_perm_b32 v125, v35, v34, s32
v_perm_b32 v126, v37, v36, s32
v_perm_b32 v127, v39, v38, s32
s_waitcnt vmcnt(4)
s_barrier
s_add_u32 m0, s34, 4096
s_mov_b32 s30, 2097152
buffer_load_dwordx4 v16, s[12:15], s30 offen  lds
s_add_u32 m0, s34, 5120
s_mov_b32 s30, 2129920
buffer_load_dwordx4 v16, s[12:15], s30 offen  lds
s_add_u32 m0, s34, 6144
s_mov_b32 s30, 2162688
buffer_load_dwordx4 v16, s[12:15], s30 offen  lds
s_add_u32 m0, s34, 7168
s_mov_b32 s30, 2195456
buffer_load_dwordx4 v16, s[12:15], s30 offen  lds
ds_read2st64_b32 v[24:25], v18 offset0:32 offset1:33
ds_read2st64_b32 v[26:27], v18 offset0:34 offset1:35
ds_read2st64_b32 v[28:29], v18 offset0:36 offset1:37
ds_read2st64_b32 v[30:31], v18 offset0:38 offset1:39
ds_read2st64_b32 v[32:33], v19 offset0:32 offset1:33
ds_read2st64_b32 v[34:35], v19 offset0:34 offset1:35
ds_read2st64_b32 v[36:37], v19 offset0:36 offset1:37
ds_read2st64_b32 v[38:39], v19 offset0:38 offset1:39
s_waitcnt lgkmcnt(4)
v_perm_b32 v128, v25, v24, s31
v_perm_b32 v129, v27, v26, s31
v_perm_b32 v130, v29, v28, s31
v_perm_b32 v131, v31, v30, s31
v_perm_b32 v132, v25, v24, s32
v_perm_b32 v133, v27, v26, s32
v_perm_b32 v134, v29, v28, s32
v_perm_b32 v135, v31, v30, s32
s_waitcnt lgkmcnt(0)
v_perm_b32 v136, v33, v32, s31
v_perm_b32 v137, v35, v34, s31
v_perm_b32 v138, v37, v36, s31
v_perm_b32 v139, v39, v38, s31
v_perm_b32 v140, v33, v32, s32
v_perm_b32 v141, v35, v34, s32
v_perm_b32 v142, v37, v36, s32
v_perm_b32 v143, v39, v38, s32
s_waitcnt vmcnt(4)
s_barrier
s_add_u32 m0, s34, 8192
s_mov_b32 s30, 2621440
buffer_load_dwordx4 v16, s[12:15], s30 offen  lds
s_add_u32 m0, s34, 9216
s_mov_b32 s30, 2654208
buffer_load_dwordx4 v16, s[12:15], s30 offen  lds
s_add_u32 m0, s34, 10240
s_mov_b32 s30, 2686976
buffer_load_dwordx4 v16, s[12:15], s30 offen  lds
s_add_u32 m0, s34, 11264
s_mov_b32 s30, 2719744
buffer_load_dwordx4 v16, s[12:15], s30 offen  lds
ds_read2st64_b32 v[24:25], v18 offset0:0 offset1:1
ds_read2st64_b32 v[26:27], v18 offset0:2 offset1:3
ds_read2st64_b32 v[28:29], v18 offset0:4 offset1:5
ds_read2st64_b32 v[30:31], v18 offset0:6 offset1:7
ds_read2st64_b32 v[32:33], v19 offset0:0 offset1:1
ds_read2st64_b32 v[34:35], v19 offset0:2 offset1:3
ds_read2st64_b32 v[36:37], v19 offset0:4 offset1:5
ds_read2st64_b32 v[38:39], v19 offset0:6 offset1:7
s_waitcnt lgkmcnt(4)
v_perm_b32 v144, v25, v24, s31
v_perm_b32 v145, v27, v26, s31
v_perm_b32 v146, v29, v28, s31
v_perm_b32 v147, v31, v30, s31
v_perm_b32 v148, v25, v24, s32
v_perm_b32 v149, v27, v26, s32
v_perm_b32 v150, v29, v28, s32
v_perm_b32 v151, v31, v30, s32
s_waitcnt lgkmcnt(0)
v_perm_b32 v152, v33, v32, s31
v_perm_b32 v153, v35, v34, s31
v_perm_b32 v154, v37, v36, s31
v_perm_b32 v155, v39, v38, s31
v_perm_b32 v156, v33, v32, s32
v_perm_b32 v157, v35, v34, s32
v_perm_b32 v158, v37, v36, s32
v_perm_b32 v159, v39, v38, s32
s_waitcnt vmcnt(4)
s_barrier
s_add_u32 m0, s34, 0
s_mov_b32 s30, 3145728
buffer_load_dwordx4 v16, s[12:15], s30 offen  lds
s_add_u32 m0, s34, 1024
s_mov_b32 s30, 3178496
buffer_load_dwordx4 v16, s[12:15], s30 offen  lds
s_add_u32 m0, s34, 2048
s_mov_b32 s30, 3211264
buffer_load_dwordx4 v16, s[12:15], s30 offen  lds
s_add_u32 m0, s34, 3072
s_mov_b32 s30, 3244032
buffer_load_dwordx4 v16, s[12:15], s30 offen  lds
ds_read2st64_b32 v[24:25], v18 offset0:16 offset1:17
ds_read2st64_b32 v[26:27], v18 offset0:18 offset1:19
ds_read2st64_b32 v[28:29], v18 offset0:20 offset1:21
ds_read2st64_b32 v[30:31], v18 offset0:22 offset1:23
ds_read2st64_b32 v[32:33], v19 offset0:16 offset1:17
ds_read2st64_b32 v[34:35], v19 offset0:18 offset1:19
ds_read2st64_b32 v[36:37], v19 offset0:20 offset1:21
ds_read2st64_b32 v[38:39], v19 offset0:22 offset1:23
s_waitcnt lgkmcnt(4)
v_perm_b32 v160, v25, v24, s31
v_perm_b32 v161, v27, v26, s31
v_perm_b32 v162, v29, v28, s31
v_perm_b32 v163, v31, v30, s31
v_perm_b32 v164, v25, v24, s32
v_perm_b32 v165, v27, v26, s32
v_perm_b32 v166, v29, v28, s32
v_perm_b32 v167, v31, v30, s32
s_waitcnt lgkmcnt(0)
v_perm_b32 v168, v33, v32, s31
v_perm_b32 v169, v35, v34, s31
v_perm_b32 v170, v37, v36, s31
v_perm_b32 v171, v39, v38, s31
v_perm_b32 v172, v33, v32, s32
v_perm_b32 v173, v35, v34, s32
v_perm_b32 v174, v37, v36, s32
v_perm_b32 v175, v39, v38, s32
s_waitcnt vmcnt(4)
s_barrier
s_add_u32 m0, s34, 4096
s_mov_b32 s30, 3670016
buffer_load_dwordx4 v16, s[12:15], s30 offen  lds
s_add_u32 m0, s34, 5120
s_mov_b32 s30, 3702784
buffer_load_dwordx4 v16, s[12:15], s30 offen  lds
s_add_u32 m0, s34, 6144
s_mov_b32 s30, 3735552
buffer_load_dwordx4 v16, s[12:15], s30 offen  lds
s_add_u32 m0, s34, 7168
s_mov_b32 s30, 3768320
buffer_load_dwordx4 v16, s[12:15], s30 offen  lds
ds_read2st64_b32 v[24:25], v18 offset0:32 offset1:33
ds_read2st64_b32 v[26:27], v18 offset0:34 offset1:35
ds_read2st64_b32 v[28:29], v18 offset0:36 offset1:37
ds_read2st64_b32 v[30:31], v18 offset0:38 offset1:39
ds_read2st64_b32 v[32:33], v19 offset0:32 offset1:33
ds_read2st64_b32 v[34:35], v19 offset0:34 offset1:35
ds_read2st64_b32 v[36:37], v19 offset0:36 offset1:37
ds_read2st64_b32 v[38:39], v19 offset0:38 offset1:39
s_waitcnt lgkmcnt(4)
v_perm_b32 v176, v25, v24, s31
v_perm_b32 v177, v27, v26, s31
v_perm_b32 v178, v29, v28, s31
v_perm_b32 v179, v31, v30, s31
v_perm_b32 v180, v25, v24, s32
v_perm_b32 v181, v27, v26, s32
v_perm_b32 v182, v29, v28, s32
v_perm_b32 v183, v31, v30, s32
s_waitcnt lgkmcnt(0)
v_perm_b32 v184, v33, v32, s31
v_perm_b32 v185, v35, v34, s31
v_perm_b32 v186, v37, v36, s31
v_perm_b32 v187, v39, v38, s31
v_perm_b32 v188, v33, v32, s32
v_perm_b32 v189, v35, v34, s32
v_perm_b32 v190, v37, v36, s32
v_perm_b32 v191, v39, v38, s32
s_waitcnt vmcnt(4)
s_barrier
s_add_u32 m0, s34, 8192
s_mov_b32 s30, 4194304
buffer_load_dwordx4 v16, s[12:15], s30 offen  lds
s_add_u32 m0, s34, 9216
s_mov_b32 s30, 4227072
buffer_load_dwordx4 v16, s[12:15], s30 offen  lds
s_add_u32 m0, s34, 10240
s_mov_b32 s30, 4259840
buffer_load_dwordx4 v16, s[12:15], s30 offen  lds
s_add_u32 m0, s34, 11264
s_mov_b32 s30, 4292608
buffer_load_dwordx4 v16, s[12:15], s30 offen  lds
ds_read2st64_b32 v[24:25], v18 offset0:0 offset1:1
ds_read2st64_b32 v[26:27], v18 offset0:2 offset1:3
ds_read2st64_b32 v[28:29], v18 offset0:4 offset1:5
ds_read2st64_b32 v[30:31], v18 offset0:6 offset1:7
ds_read2st64_b32 v[32:33], v19 offset0:0 offset1:1
ds_read2st64_b32 v[34:35], v19 offset0:2 offset1:3
ds_read2st64_b32 v[36:37], v19 offset0:4 offset1:5
ds_read2st64_b32 v[38:39], v19 offset0:6 offset1:7
s_waitcnt lgkmcnt(4)
v_perm_b32 v192, v25, v24, s31
v_perm_b32 v193, v27, v26, s31
v_perm_b32 v194, v29, v28, s31
v_perm_b32 v195, v31, v30, s31
v_perm_b32 v196, v25, v24, s32
v_perm_b32 v197, v27, v26, s32
v_perm_b32 v198, v29, v28, s32
v_perm_b32 v199, v31, v30, s32
s_waitcnt lgkmcnt(0)
v_perm_b32 v200, v33, v32, s31
v_perm_b32 v201, v35, v34, s31
v_perm_b32 v202, v37, v36, s31
v_perm_b32 v203, v39, v38, s31
v_perm_b32 v204, v33, v32, s32
v_perm_b32 v205, v35, v34, s32
v_perm_b32 v206, v37, v36, s32
v_perm_b32 v207, v39, v38, s32
s_waitcnt vmcnt(4)
s_barrier
s_add_u32 m0, s34, 0
s_mov_b32 s30, 4718592
buffer_load_dwordx4 v16, s[12:15], s30 offen  lds
s_add_u32 m0, s34, 1024
s_mov_b32 s30, 4751360
buffer_load_dwordx4 v16, s[12:15], s30 offen  lds
s_add_u32 m0, s34, 2048
s_mov_b32 s30, 4784128
buffer_load_dwordx4 v16, s[12:15], s30 offen  lds
s_add_u32 m0, s34, 3072
s_mov_b32 s30, 4816896
buffer_load_dwordx4 v16, s[12:15], s30 offen  lds
ds_read2st64_b32 v[24:25], v18 offset0:16 offset1:17
ds_read2st64_b32 v[26:27], v18 offset0:18 offset1:19
ds_read2st64_b32 v[28:29], v18 offset0:20 offset1:21
ds_read2st64_b32 v[30:31], v18 offset0:22 offset1:23
ds_read2st64_b32 v[32:33], v19 offset0:16 offset1:17
ds_read2st64_b32 v[34:35], v19 offset0:18 offset1:19
ds_read2st64_b32 v[36:37], v19 offset0:20 offset1:21
ds_read2st64_b32 v[38:39], v19 offset0:22 offset1:23
s_waitcnt lgkmcnt(4)
v_perm_b32 v208, v25, v24, s31
v_perm_b32 v209, v27, v26, s31
v_perm_b32 v210, v29, v28, s31
v_perm_b32 v211, v31, v30, s31
v_perm_b32 v212, v25, v24, s32
v_perm_b32 v213, v27, v26, s32
v_perm_b32 v214, v29, v28, s32
v_perm_b32 v215, v31, v30, s32
s_waitcnt lgkmcnt(0)
v_perm_b32 v216, v33, v32, s31
v_perm_b32 v217, v35, v34, s31
v_perm_b32 v218, v37, v36, s31
v_perm_b32 v219, v39, v38, s31
v_perm_b32 v220, v33, v32, s32
v_perm_b32 v221, v35, v34, s32
v_perm_b32 v222, v37, v36, s32
v_perm_b32 v223, v39, v38, s32
s_waitcnt vmcnt(4)
s_barrier
ds_read2st64_b32 v[24:25], v18 offset0:32 offset1:33
ds_read2st64_b32 v[26:27], v18 offset0:34 offset1:35
ds_read2st64_b32 v[28:29], v18 offset0:36 offset1:37
ds_read2st64_b32 v[30:31], v18 offset0:38 offset1:39
ds_read2st64_b32 v[32:33], v19 offset0:32 offset1:33
ds_read2st64_b32 v[34:35], v19 offset0:34 offset1:35
ds_read2st64_b32 v[36:37], v19 offset0:36 offset1:37
ds_read2st64_b32 v[38:39], v19 offset0:38 offset1:39
s_waitcnt lgkmcnt(4)
v_perm_b32 v224, v25, v24, s31
v_perm_b32 v225, v27, v26, s31
v_perm_b32 v226, v29, v28, s31
v_perm_b32 v227, v31, v30, s31
v_perm_b32 v228, v25, v24, s32
v_perm_b32 v229, v27, v26, s32
v_perm_b32 v230, v29, v28, s32
v_perm_b32 v231, v31, v30, s32
s_waitcnt lgkmcnt(0)
v_perm_b32 v232, v33, v32, s31
v_perm_b32 v233, v35, v34, s31
v_perm_b32 v234, v37, v36, s31
v_perm_b32 v235, v39, v38, s31
v_perm_b32 v236, v33, v32, s32
v_perm_b32 v237, v35, v34, s32
v_perm_b32 v238, v37, v36, s32
v_perm_b32 v239, v39, v38, s32
s_waitcnt vmcnt(0)
s_barrier
ds_read2st64_b32 v[24:25], v18 offset0:0 offset1:1
ds_read2st64_b32 v[26:27], v18 offset0:2 offset1:3
ds_read2st64_b32 v[28:29], v18 offset0:4 offset1:5
ds_read2st64_b32 v[30:31], v18 offset0:6 offset1:7
ds_read2st64_b32 v[32:33], v19 offset0:0 offset1:1
ds_read2st64_b32 v[34:35], v19 offset0:2 offset1:3
ds_read2st64_b32 v[36:37], v19 offset0:4 offset1:5
ds_read2st64_b32 v[38:39], v19 offset0:6 offset1:7
s_waitcnt lgkmcnt(4)
v_perm_b32 v240, v25, v24, s31
v_perm_b32 v241, v27, v26, s31
v_perm_b32 v242, v29, v28, s31
v_perm_b32 v243, v31, v30, s31
v_perm_b32 v244, v25, v24, s32
v_perm_b32 v245, v27, v26, s32
v_perm_b32 v246, v29, v28, s32
v_perm_b32 v247, v31, v30, s32
s_waitcnt lgkmcnt(0)
v_perm_b32 v248, v33, v32, s31
v_perm_b32 v249, v35, v34, s31
v_perm_b32 v250, v37, v36, s31
v_perm_b32 v251, v39, v38, s31
v_perm_b32 v252, v33, v32, s32
v_perm_b32 v253, v35, v34, s32
v_perm_b32 v254, v37, v36, s32
v_perm_b32 v255, v39, v38, s32
s_waitcnt vmcnt(0) lgkmcnt(0)
s_barrier
v_bfe_u32 v10, v1, 1, 3
v_lshrrev_b32 v11, 4, v1
v_xor_b32 v10, v10, v11
v_lshlrev_b32 v76, 4, v10
v_and_b32 v10, 7, v1
v_lshl_add_u32 v76, v10, 7, v76
v_bfe_u32 v10, v1, 3, 1
v_mul_u32_u24 v10, 10240, v10
v_add_u32 v76, v76, v10
v_xor_b32 v77, 64, v76
s_mov_b32 s28, 0
s_mov_b32 s30, 0x80808080
v_and_b32 v12, 63, v0
v_lshlrev_b32 v12, 2, v12
sy126:
buffer_load_dword v13, v12, s[8:11], 0 offen sc1
s_waitcnt vmcnt(0)
sy129:
v_and_b32 v14, s30, v13
v_cmp_ne_u32 vcc, s30, v14
s_cbranch_vccz sy127
s_sleep 2
s_add_u32 s28, s28, 1
s_cmp_lt_u32 s28, 524288
s_cbranch_scc1 sy126
s_mov_b32 s29, 1
s_branch L_abort
sy127:
s_cmp_lg_u32 s26, 0
s_cbranch_scc1 sy128
v_mov_b32 v15, 0
v_bfe_u32 v14, v13, 0, 3
v_lshlrev_b32 v14, v14, 1
v_or_b32 v15, v15, v14
v_bfe_u32 v14, v13, 8, 3
v_lshlrev_b32 v14, v14, 1
v_or_b32 v15, v15, v14
v_bfe_u32 v14, v13, 16, 3
v_lshlrev_b32 v14, v14, 1
v_or_b32 v15, v15, v14
v_bfe_u32 v14, v13, 24, 3
v_lshlrev_b32 v14, v14, 1
v_or_b32 v15, v15, v14
s_nop 1
v_mov_b32 v14, v15 quad_perm:[1,0,3,2] row_mask:0xf bank_mask:0xf
v_or_b32 v15, v15, v14
v_cmp_ne_u32 vcc, 0xff, v15
s_cbranch_vccnz L_rank
s_mov_b32 s26, 1
sy128:
s_lshl_b32 s73, s27, 5
s_add_u32 s73, s73, s24
s_lshl_b32 s73, s73, 2
s_add_u32 s73, s73, s25
s_lshl_b32 s73, s73, 13
s_add_u32 s73, s73, 209715200
s_mov_b32 s54, 0xaaa00000
s_mov_b32 s55, 0xaaaaaaaa
s_mov_b32 s56, 0xaaaaaaaa
s_mov_b32 s57, 0xfffffaaa
s_lshl_b32 s68, s24, 11
s_lshl_b32 s33, s25, 9
s_add_u32 s68, s68, s33
s_lshl_b32 s70, s68, 2
s_add_u32 s70, s70, 134217728
s_add_u32 s68, s68, 786688
s_mov_b32 s67, s68
s_mov_b32 s69, 0
s_mov_b32 s62, 0
s_mov_b32 s63, 0
s_mov_b32 s64, 1
s_mov_b32 s65, 0
s_mov_b32 s28, 0
k130:
s_lshl_b32 s31, s63, 7
s_add_u32 s31, s31, 1048576
buffer_load_dword v11, off, s[4:7], s31 sc1
s_waitcnt vmcnt(0)
v_readfirstlane_b32 s76, v11
s_nop 0
s_cmp_ge_u32 s76, 32
s_cbranch_scc1 k131
s_sleep 1
s_add_u32 s28, s28, 1
s_cmp_lt_u32 s28, 524288
s_cbranch_scc1 k130
s_mov_b32 s29, 10
s_branch L_abort
k131:
s_mul_i32 s72, s25, 10240
s_mul_i32 s71, s63, 40960
s_add_u32 s71, s71, s72
s_add_u32 s71, s71, 3145728
s_add_u32 s72, s72, s65
s_mov_b32 m0, s72
s_nop 0
buffer_load_dwordx4 v2, s[4:7], s71 offen offset:0 sc1 lds
buffer_load_dwordx4 v2, s[4:7], s71 offen offset:1024 sc1 lds
buffer_load_dwordx4 v2, s[4:7], s71 offen offset:2048 sc1 lds
buffer_load_dwordx4 v2, s[4:7], s71 offen offset:3072 sc1 lds
s_add_u32 s72, s72, 4096
s_add_u32 s71, s71, 4096
s_mov_b32 m0, s72
s_nop 0
buffer_load_dwordx4 v2, s[4:7], s71 offen offset:0 sc1 lds
buffer_load_dwordx4 v2, s[4:7], s71 offen offset:1024 sc1 lds
buffer_load_dwordx4 v2, s[4:7], s71 offen offset:2048 sc1 lds
buffer_load_dwordx4 v2, s[4:7], s71 offen offset:3072 sc1 lds
s_add_u32 s72, s72, 4096
s_add_u32 s71, s71, 4096
s_mov_b32 m0, s72
s_nop 0
buffer_load_dwordx4 v2, s[4:7], s71 offen offset:0 sc1 lds
buffer_load_dwordx4 v2, s[4:7], s71 offen offset:1024 sc1 lds
s_lshl_b32 s31, s64, 7
s_add_u32 s31, s31, 1048576
buffer_load_dword v9, off, s[4:7], s31 sc1
s_waitcnt vmcnt(0)
.p2align 5
L_Qtop:
v_add_u32 v72, s65, v76
v_add_u32 v73, s65, v77
s_waitcnt vmcnt(3)
s_barrier
ds_read_b128 v[16:19], v72 offset:0
ds_read_b128 v[20:23], v72 offset:20480
ds_read_b128 v[24:27], v73 offset:0
ds_read_b128 v[28:31], v73 offset:20480
ds_read_b128 v[32:35], v72 offset:1024
ds_read_b128 v[36:39], v72 offset:21504
s_lshl_b32 s31, s64, 7
s_add_u32 s31, s31, 1048576
buffer_load_dword v11, off, s[4:7], s31 sc1
v_readfirstlane_b32 s77, v9
s_nop 0
s_cmp_ge_u32 s77, 32
s_cselect_b32 s66, 1, 0
s_cmp_ge_u32 s62, 127
s_cselect_b32 s66, 0, s66
s_cmp_eq_u32 s66, 1
s_cselect_b32 s33, 0, 0x40000000
v_or_b32 v5, s33, v2
s_xor_b32 s65, s65, 40960
s_mul_i32 s72, s25, 10240
s_mul_i32 s71, s64, 40960
s_add_u32 s71, s71, s72
s_add_u32 s71, s71, 3145728
s_add_u32 s72, s72, s65
s_waitcnt lgkmcnt(5)
v_mfma_f32_16x16x32_bf16 v[48:51], v[96:99], v[16:19], 0
s_mov_b32 m0, s72
s_nop 0
buffer_load_dwordx4 v5, s[4:7], s71 offen offset:0 sc1 lds
v_mfma_f32_16x16x32_bf16 v[52:55], v[100:103], v[16:19], 0
ds_read_b128 v[16:19], v73 offset:1024
s_waitcnt lgkmcnt(5)
v_mfma_f32_16x16x32_bf16 v[56:59], v[96:99], v[20:23], 0
buffer_load_dwordx4 v5, s[4:7], s71 offen offset:1024 sc1 lds
v_mfma_f32_16x16x32_bf16 v[60:63], v[100:103], v[20:23], 0
ds_read_b128 v[20:23], v73 offset:21504
s_waitcnt lgkmcnt(5)
v_mfma_f32_16x16x32_bf16 v[48:51], v[104:107], v[24:27], v[48:51]
v_mfma_f32_16x16x32_bf16 v[52:55], v[108:111], v[24:27], v[52:55]
ds_read_b128 v[24:27], v72 offset:2048
s_waitcnt lgkmcnt(5)
v_mfma_f32_16x16x32_bf16 v[56:59], v[104:107], v[28:31], v[56:59]
buffer_load_dwordx4 v5, s[4:7], s71 offen offset:2048 sc1 lds
v_mfma_f32_16x16x32_bf16 v[60:63], v[108:111], v[28:31], v[60:63]
ds_read_b128 v[28:31], v72 offset:22528
s_waitcnt lgkmcnt(5)
v_mfma_f32_16x16x32_bf16 v[48:51], v[112:115], v[32:35], v[48:51]
v_mfma_f32_16x16x32_bf16 v[52:55], v[116:119], v[32:35], v[52:55]
ds_read_b128 v[32:35], v73 offset:2048
s_waitcnt lgkmcnt(5)
v_mfma_f32_16x16x32_bf16 v[56:59], v[112:115], v[36:39], v[56:59]
buffer_load_dwordx4 v5, s[4:7], s71 offen offset:3072 sc1 lds
v_mfma_f32_16x16x32_bf16 v[60:63], v[116:119], v[36:39], v[60:63]
ds_read_b128 v[36:39], v73 offset:22528
s_waitcnt lgkmcnt(5)
v_mfma_f32_16x16x32_bf16 v[48:51], v[120:123], v[16:19], v[48:51]
v_mfma_f32_16x16x32_bf16 v[52:55], v[124:127], v[16:19], v[52:55]
ds_read_b128 v[16:19], v72 offset:3072
s_waitcnt lgkmcnt(5)
v_mfma_f32_16x16x32_bf16 v[56:59], v[120:123], v[20:23], v[56:59]
s_add_u32 s72, s72, 4096
s_add_u32 s71, s71, 4096
s_mov_b32 m0, s72
s_nop 0
buffer_load_dwordx4 v5, s[4:7], s71 offen offset:0 sc1 lds
v_mfma_f32_16x16x32_bf16 v[60:63], v[124:127], v[20:23], v[60:63]
ds_read_b128 v[20:23], v72 offset:23552
s_waitcnt lgkmcnt(5)
v_mfma_f32_16x16x32_bf16 v[48:51], v[128:131], v[24:27], v[48:51]
v_mfma_f32_16x16x32_bf16 v[52:55], v[132:135], v[24:27], v[52:55]
ds_read_b128 v[24:27], v73 offset:3072
s_waitcnt lgkmcnt(5)
v_mfma_f32_16x16x32_bf16 v[56:59], v[128:131], v[28:31], v[56:59]
buffer_load_dwordx4 v5, s[4:7], s71 offen offset:1024 sc1 lds
v_mfma_f32_16x16x32_bf16 v[60:63], v[132:135], v[28:31], v[60:63]
ds_read_b128 v[28:31], v73 offset:23552
s_waitcnt lgkmcnt(5)
v_mfma_f32_16x16x32_bf16 v[48:51], v[136:139], v[32:35], v[48:51]
buffer_load_dwordx4 v5, s[4:7], s71 offen offset:2048 sc1 lds
v_mfma_f32_16x16x32_bf16 v[52:55], v[140:143], v[32:35], v[52:55]
ds_read_b128 v[32:35], v72 offset:4096
s_waitcnt lgkmcnt(5)
v_mfma_f32_16x16x32_bf16 v[56:59], v[136:139], v[36:39], v[56:59]
v_mfma_f32_16x16x32_bf16 v[60:63], v[140:143], v[36:39], v[60:63]
ds_read_b128 v[36:39], v72 offset:24576
s_waitcnt lgkmcnt(5)
v_mfma_f32_16x16x32_bf16 v[48:51], v[144:147], v[16:19], v[48:51]
buffer_load_dwordx4 v5, s[4:7], s71 offen offset:3072 sc1 lds
v_mfma_f32_16x16x32_bf16 v[52:55], v[148:151], v[16:19], v[52:55]
ds_read_b128 v[16:19], v73 offset:4096
s_waitcnt lgkmcnt(5)
v_mfma_f32_16x16x32_bf16 v[56:59], v[144:147], v[20:23], v[56:59]
v_mfma_f32_16x16x32_bf16 v[60:63], v[148:151], v[20:23], v[60:63]
ds_read_b128 v[20:23], v73 offset:24576
s_waitcnt lgkmcnt(5)
v_mfma_f32_16x16x32_bf16 v[48:51], v[152:155], v[24:27], v[48:51]
s_add_u32 s72, s72, 4096
s_add_u32 s71, s71, 4096
s_mov_b32 m0, s72
s_nop 0
buffer_load_dwordx4 v5, s[4:7], s71 offen offset:0 sc1 lds
v_mfma_f32_16x16x32_bf16 v[52:55], v[156:159], v[24:27], v[52:55]
ds_read_b128 v[24:27], v72 offset:5120
s_waitcnt lgkmcnt(5)
v_mfma_f32_16x16x32_bf16 v[56:59], v[152:155], v[28:31], v[56:59]
v_mfma_f32_16x16x32_bf16 v[60:63], v[156:159], v[28:31], v[60:63]
ds_read_b128 v[28:31], v72 offset:25600
s_waitcnt lgkmcnt(5)
v_mfma_f32_16x16x32_bf16 v[48:51], v[160:163], v[32:35], v[48:51]
buffer_load_dwordx4 v5, s[4:7], s71 offen offset:1024 sc1 lds
v_mfma_f32_16x16x32_bf16 v[52:55], v[164:167], v[32:35], v[52:55]
ds_read_b128 v[32:35], v73 offset:5120
s_waitcnt lgkmcnt(5)
v_mfma_f32_16x16x32_bf16 v[56:59], v[160:163], v[36:39], v[56:59]
s_add_u32 s32, s62, 2
s_cmp_lt_u32 s32, 64
s_cselect_b64 s[60:61], s[54:55], s[56:57]
s_cselect_b32 s33, 0, 22
s_bfm_b64 s[34:35], s32, 0
s_and_b64 s[34:35], s[34:35], s[60:61]
s_bcnt1_i32_b64 s34, s[34:35]
s_add_u32 s33, s33, s34
s_sub_u32 s34, s32, s33
s_add_u32 s33, s33, 64
s_bitcmp1_b64 s[60:61], s32
s_cselect_b32 s74, s33, s34
s_cmp_ge_u32 s32, 128
s_cselect_b32 s74, s32, s74
v_mfma_f32_16x16x32_bf16 v[60:63], v[164:167], v[36:39], v[60:63]
ds_read_b128 v[36:39], v73 offset:25600
s_waitcnt lgkmcnt(5)
v_mfma_f32_16x16x32_bf16 v[48:51], v[168:171], v[16:19], v[48:51]
v_mfma_f32_16x16x32_bf16 v[52:55], v[172:175], v[16:19], v[52:55]
ds_read_b128 v[16:19], v72 offset:6144
s_waitcnt lgkmcnt(5)
v_mfma_f32_16x16x32_bf16 v[56:59], v[168:171], v[20:23], v[56:59]
v_mfma_f32_16x16x32_bf16 v[60:63], v[172:175], v[20:23], v[60:63]
ds_read_b128 v[20:23], v72 offset:26624
s_lshl_b32 s31, s74, 7
s_add_u32 s31, s31, 1048576
buffer_load_dword v9, off, s[4:7], s31 sc1
s_cmp_eq_u32 s66, 1
s_cbranch_scc1 k133
s_cmp_ge_u32 s62, 127
s_cbranch_scc1 k133
s_waitcnt vmcnt(11)
v_readfirstlane_b32 s76, v11
s_nop 0
s_cmp_ge_u32 s76, 32
s_cbranch_scc1 k132
k133:
s_waitcnt lgkmcnt(5)
v_mfma_f32_16x16x32_bf16 v[48:51], v[176:179], v[24:27], v[48:51]
v_mfma_f32_16x16x32_bf16 v[52:55], v[180:183], v[24:27], v[52:55]
ds_read_b128 v[24:27], v73 offset:6144
s_waitcnt lgkmcnt(5)
v_mfma_f32_16x16x32_bf16 v[56:59], v[176:179], v[28:31], v[56:59]
v_mfma_f32_16x16x32_bf16 v[60:63], v[180:183], v[28:31], v[60:63]
ds_read_b128 v[28:31], v73 offset:26624
s_waitcnt lgkmcnt(5)
v_mfma_f32_16x16x32_bf16 v[48:51], v[184:187], v[32:35], v[48:51]
v_mfma_f32_16x16x32_bf16 v[52:55], v[188:191], v[32:35], v[52:55]
ds_read_b128 v[32:35], v72 offset:7168
s_waitcnt lgkmcnt(5)
v_mfma_f32_16x16x32_bf16 v[56:59], v[184:187], v[36:39], v[56:59]
s_waitcnt vmcnt(12)
v_mov_b32 v10, s69
buffer_store_dword v10, off, s[4:7], s67 sc1
v_mfma_f32_16x16x32_bf16 v[60:63], v[188:191], v[36:39], v[60:63]
ds_read_b128 v[36:39], v72 offset:27648
s_waitcnt lgkmcnt(5)
v_mfma_f32_16x16x32_bf16 v[48:51], v[192:195], v[16:19], v[48:51]
v_mfma_f32_16x16x32_bf16 v[52:55], v[196:199], v[16:19], v[52:55]
ds_read_b128 v[16:19], v73 offset:7168
s_waitcnt lgkmcnt(5)
v_mfma_f32_16x16x32_bf16 v[56:59], v[192:195], v[20:23], v[56:59]
v_mfma_f32_16x16x32_bf16 v[60:63], v[196:199], v[20:23], v[60:63]
ds_read_b128 v[20:23], v73 offset:27648
s_waitcnt lgkmcnt(5)
v_mfma_f32_16x16x32_bf16 v[48:51], v[200:203], v[24:27], v[48:51]
v_mfma_f32_16x16x32_bf16 v[52:55], v[204:207], v[24:27], v[52:55]
ds_read_b128 v[24:27], v72 offset:8192
s_waitcnt lgkmcnt(5)
v_mfma_f32_16x16x32_bf16 v[56:59], v[200:203], v[28:31], v[56:59]
v_mfma_f32_16x16x32_bf16 v[60:63], v[204:207], v[28:31], v[60:63]
ds_read_b128 v[28:31], v72 offset:28672
s_waitcnt lgkmcnt(5)
v_mfma_f32_16x16x32_bf16 v[48:51], v[208:211], v[32:35], v[48:51]
v_mfma_f32_16x16x32_bf16 v[52:55], v[212:215], v[32:35], v[52:55]
ds_read_b128 v[32:35], v73 offset:8192
s_waitcnt lgkmcnt(5)
v_mfma_f32_16x16x32_bf16 v[56:59], v[208:211], v[36:39], v[56:59]
v_mfma_f32_16x16x32_bf16 v[60:63], v[212:215], v[36:39], v[60:63]
ds_read_b128 v[36:39], v73 offset:28672
s_waitcnt lgkmcnt(5)
v_mfma_f32_16x16x32_bf16 v[48:51], v[216:219], v[16:19], v[48:51]
v_mfma_f32_16x16x32_bf16 v[52:55], v[220:223], v[16:19], v[52:55]
ds_read_b128 v[16:19], v72 offset:9216
s_waitcnt lgkmcnt(5)
v_mfma_f32_16x16x32_bf16 v[56:59], v[216:219], v[20:23], v[56:59]
v_mfma_f32_16x16x32_bf16 v[60:63], v[220:223], v[20:23], v[60:63]
ds_read_b128 v[20:23], v72 offset:29696
s_waitcnt lgkmcnt(5)
v_mfma_f32_16x16x32_bf16 v[48:51], v[224:227], v[24:27], v[48:51]
v_mfma_f32_16x16x32_bf16 v[52:55], v[228:231], v[24:27], v[52:55]
ds_read_b128 v[24:27], v73 offset:9216
s_waitcnt lgkmcnt(5)
v_mfma_f32_16x16x32_bf16 v[56:59], v[224:227], v[28:31], v[56:59]
s_lshl_b32 s34, s63, 18
s_add_u32 s34, s34, s70
s_lshr_b32 s67, s63, 6
s_lshl_b32 s67, s67, 2
v_mfma_f32_16x16x32_bf16 v[60:63], v[228:231], v[28:31], v[60:63]
ds_read_b128 v[28:31], v73 offset:29696
s_waitcnt lgkmcnt(5)
v_mfma_f32_16x16x32_bf16 v[48:51], v[232:235], v[32:35], v[48:51]
s_add_u32 s67, s67, s68
s_and_b32 s69, s63, 63
s_add_u32 s69, s69, 1
s_add_u32 s62, s62, 1
v_mfma_f32_16x16x32_bf16 v[52:55], v[236:239], v[32:35], v[52:55]
s_waitcnt lgkmcnt(4)
v_mfma_f32_16x16x32_bf16 v[56:59], v[232:235], v[36:39], v[56:59]
s_mov_b32 s63, s64
s_mov_b32 s64, s74
v_mfma_f32_16x16x32_bf16 v[60:63], v[236:239], v[36:39], v[60:63]
s_waitcnt lgkmcnt(3)
v_mfma_f32_16x16x32_bf16 v[48:51], v[240:243], v[16:19], v[48:51]
v_mfma_f32_16x16x32_bf16 v[52:55], v[244:247], v[16:19], v[52:55]
s_waitcnt lgkmcnt(2)
v_mfma_f32_16x16x32_bf16 v[56:59], v[240:243], v[20:23], v[56:59]
v_mfma_f32_16x16x32_bf16 v[60:63], v[244:247], v[20:23], v[60:63]
s_waitcnt lgkmcnt(1)
v_mfma_f32_16x16x32_bf16 v[48:51], v[248:251], v[24:27], v[48:51]
v_mfma_f32_16x16x32_bf16 v[52:55], v[252:255], v[24:27], v[52:55]
s_waitcnt lgkmcnt(0)
v_mfma_f32_16x16x32_bf16 v[56:59], v[248:251], v[28:31], v[56:59]
v_mfma_f32_16x16x32_bf16 v[60:63], v[252:255], v[28:31], v[60:63]
s_branch k134
k132:
s_mov_b32 s66, 1
s_mul_i32 s72, s25, 10240
s_mul_i32 s71, s64, 40960
s_add_u32 s71, s71, s72
s_add_u32 s71, s71, 3145728
s_add_u32 s72, s72, s65
s_waitcnt lgkmcnt(5)
v_mfma_f32_16x16x32_bf16 v[48:51], v[176:179], v[24:27], v[48:51]
s_mov_b32 m0, s72
s_nop 0
buffer_load_dwordx4 v2, s[4:7], s71 offen offset:0 sc1 lds
v_mfma_f32_16x16x32_bf16 v[52:55], v[180:183], v[24:27], v[52:55]
ds_read_b128 v[24:27], v73 offset:6144
s_waitcnt lgkmcnt(5)
v_mfma_f32_16x16x32_bf16 v[56:59], v[176:179], v[28:31], v[56:59]
buffer_load_dwordx4 v2, s[4:7], s71 offen offset:1024 sc1 lds
v_mfma_f32_16x16x32_bf16 v[60:63], v[180:183], v[28:31], v[60:63]
ds_read_b128 v[28:31], v73 offset:26624
s_waitcnt lgkmcnt(5)
v_mfma_f32_16x16x32_bf16 v[48:51], v[184:187], v[32:35], v[48:51]
buffer_load_dwordx4 v2, s[4:7], s71 offen offset:2048 sc1 lds
v_mfma_f32_16x16x32_bf16 v[52:55], v[188:191], v[32:35], v[52:55]
ds_read_b128 v[32:35], v72 offset:7168
s_waitcnt lgkmcnt(5)
v_mfma_f32_16x16x32_bf16 v[56:59], v[184:187], v[36:39], v[56:59]
buffer_load_dwordx4 v2, s[4:7], s71 offen offset:3072 sc1 lds
v_mfma_f32_16x16x32_bf16 v[60:63], v[188:191], v[36:39], v[60:63]
ds_read_b128 v[36:39], v72 offset:27648
s_waitcnt lgkmcnt(5)
v_mfma_f32_16x16x32_bf16 v[48:51], v[192:195], v[16:19], v[48:51]
s_add_u32 s72, s72, 4096
s_add_u32 s71, s71, 4096
s_mov_b32 m0, s72
s_nop 0
buffer_load_dwordx4 v2, s[4:7], s71 offen offset:0 sc1 lds
v_mfma_f32_16x16x32_bf16 v[52:55], v[196:199], v[16:19], v[52:55]
ds_read_b128 v[16:19], v73 offset:7168
s_waitcnt lgkmcnt(5)
v_mfma_f32_16x16x32_bf16 v[56:59], v[192:195], v[20:23], v[56:59]
buffer_load_dwordx4 v2, s[4:7], s71 offen offset:1024 sc1 lds
v_mfma_f32_16x16x32_bf16 v[60:63], v[196:199], v[20:23], v[60:63]
ds_read_b128 v[20:23], v73 offset:27648
s_waitcnt lgkmcnt(5)
v_mfma_f32_16x16x32_bf16 v[48:51], v[200:203], v[24:27], v[48:51]
buffer_load_dwordx4 v2, s[4:7], s71 offen offset:2048 sc1 lds
v_mfma_f32_16x16x32_bf16 v[52:55], v[204:207], v[24:27], v[52:55]
ds_read_b128 v[24:27], v72 offset:8192
s_waitcnt lgkmcnt(5)
v_mfma_f32_16x16x32_bf16 v[56:59], v[200:203], v[28:31], v[56:59]
buffer_load_dwordx4 v2, s[4:7], s71 offen offset:3072 sc1 lds
v_mfma_f32_16x16x32_bf16 v[60:63], v[204:207], v[28:31], v[60:63]
ds_read_b128 v[28:31], v72 offset:28672
s_waitcnt lgkmcnt(5)
v_mfma_f32_16x16x32_bf16 v[48:51], v[208:211], v[32:35], v[48:51]
s_add_u32 s72, s72, 4096
s_add_u32 s71, s71, 4096
s_mov_b32 m0, s72
s_nop 0
buffer_load_dwordx4 v2, s[4:7], s71 offen offset:0 sc1 lds
v_mfma_f32_16x16x32_bf16 v[52:55], v[212:215], v[32:35], v[52:55]
ds_read_b128 v[32:35], v73 offset:8192
s_waitcnt lgkmcnt(5)
v_mfma_f32_16x16x32_bf16 v[56:59], v[208:211], v[36:39], v[56:59]
buffer_load_dwordx4 v2, s[4:7], s71 offen offset:1024 sc1 lds
v_mfma_f32_16x16x32_bf16 v[60:63], v[212:215], v[36:39], v[60:63]
ds_read_b128 v[36:39], v73 offset:28672
s_waitcnt lgkmcnt(5)
v_mfma_f32_16x16x32_bf16 v[48:51], v[216:219], v[16:19], v[48:51]
s_waitcnt vmcnt(22)
v_mov_b32 v10, s69
buffer_store_dword v10, off, s[4:7], s67 sc1
v_mfma_f32_16x16x32_bf16 v[52:55], v[220:223], v[16:19], v[52:55]
ds_read_b128 v[16:19], v72 offset:9216
s_waitcnt lgkmcnt(5)
v_mfma_f32_16x16x32_bf16 v[56:59], v[216:219], v[20:23], v[56:59]
v_mfma_f32_16x16x32_bf16 v[60:63], v[220:223], v[20:23], v[60:63]
ds_read_b128 v[20:23], v72 offset:29696
s_waitcnt lgkmcnt(5)
v_mfma_f32_16x16x32_bf16 v[48:51], v[224:227], v[24:27], v[48:51]
v_mfma_f32_16x16x32_bf16 v[52:55], v[228:231], v[24:27], v[52:55]
ds_read_b128 v[24:27], v73 offset:9216
s_waitcnt lgkmcnt(5)
v_mfma_f32_16x16x32_bf16 v[56:59], v[224:227], v[28:31], v[56:59]
s_lshl_b32 s34, s63, 18
s_add_u32 s34, s34, s70
s_lshr_b32 s67, s63, 6
s_lshl_b32 s67, s67, 2
v_mfma_f32_16x16x32_bf16 v[60:63], v[228:231], v[28:31], v[60:63]
ds_read_b128 v[28:31], v73 offset:29696
s_waitcnt lgkmcnt(5)
v_mfma_f32_16x16x32_bf16 v[48:51], v[232:235], v[32:35], v[48:51]
s_add_u32 s67, s67, s68
s_and_b32 s69, s63, 63
s_add_u32 s69, s69, 1
s_add_u32 s62, s62, 1
v_mfma_f32_16x16x32_bf16 v[52:55], v[236:239], v[32:35], v[52:55]
s_waitcnt lgkmcnt(4)
v_mfma_f32_16x16x32_bf16 v[56:59], v[232:235], v[36:39], v[56:59]
s_mov_b32 s63, s64
s_mov_b32 s64, s74
v_mfma_f32_16x16x32_bf16 v[60:63], v[236:239], v[36:39], v[60:63]
s_waitcnt lgkmcnt(3)
v_mfma_f32_16x16x32_bf16 v[48:51], v[240:243], v[16:19], v[48:51]
v_mfma_f32_16x16x32_bf16 v[52:55], v[244:247], v[16:19], v[52:55]
s_waitcnt lgkmcnt(2)
v_mfma_f32_16x16x32_bf16 v[56:59], v[240:243], v[20:23], v[56:59]
v_mfma_f32_16x16x32_bf16 v[60:63], v[244:247], v[20:23], v[60:63]
s_waitcnt lgkmcnt(1)
v_mfma_f32_16x16x32_bf16 v[48:51], v[248:251], v[24:27], v[48:51]
v_mfma_f32_16x16x32_bf16 v[52:55], v[252:255], v[24:27], v[52:55]
s_waitcnt lgkmcnt(0)
v_mfma_f32_16x16x32_bf16 v[56:59], v[248:251], v[28:31], v[56:59]
v_mfma_f32_16x16x32_bf16 v[60:63], v[252:255], v[28:31], v[60:63]
k134:
s_nop 3
v_cvt_pk_bf16_f32 v64, v48, v52
v_cvt_pk_bf16_f32 v65, v49, v53
v_cvt_pk_bf16_f32 v66, v50, v54
v_cvt_pk_bf16_f32 v67, v51, v55
buffer_store_dwordx4 v[64:67], v2, s[4:7], s34 offen offset:0 sc1
v_cvt_pk_bf16_f32 v68, v56, v60
v_cvt_pk_bf16_f32 v69, v57, v61
v_cvt_pk_bf16_f32 v70, v58, v62
v_cvt_pk_bf16_f32 v71, v59, v63
buffer_store_dwordx4 v[68:71], v2, s[4:7], s34 offen offset:1024 sc1
s_cmp_eq_u32 s66, 1
s_cbranch_scc1 L_Qtop
s_waitcnt vmcnt(0)
v_mov_b32 v10, s69
buffer_store_dword v10, off, s[4:7], s67 sc1
s_cmp_ge_u32 s62, 128
s_cbranch_scc1 L_end
s_mov_b32 s28, 0
k135:
s_lshl_b32 s31, s63, 7
s_add_u32 s31, s31, 1048576
buffer_load_dword v11, off, s[4:7], s31 sc1
s_waitcnt vmcnt(0)
v_readfirstlane_b32 s76, v11
s_nop 0
s_cmp_ge_u32 s76, 32
s_cbranch_scc1 k136
s_sleep 1
s_add_u32 s28, s28, 1
s_cmp_lt_u32 s28, 524288
s_cbranch_scc1 k135
s_mov_b32 s29, 11
s_branch L_abort
k136:
s_mul_i32 s72, s25, 10240
s_mul_i32 s71, s63, 40960
s_add_u32 s71, s71, s72
s_add_u32 s71, s71, 3145728
s_add_u32 s72, s72, s65
s_mov_b32 m0, s72
s_nop 0
buffer_load_dwordx4 v2, s[4:7], s71 offen offset:0 sc1 lds
buffer_load_dwordx4 v2, s[4:7], s71 offen offset:1024 sc1 lds
buffer_load_dwordx4 v2, s[4:7], s71 offen offset:2048 sc1 lds
buffer_load_dwordx4 v2, s[4:7], s71 offen offset:3072 sc1 lds
s_add_u32 s72, s72, 4096
s_add_u32 s71, s71, 4096
s_mov_b32 m0, s72
s_nop 0
buffer_load_dwordx4 v2, s[4:7], s71 offen offset:0 sc1 lds
buffer_load_dwordx4 v2, s[4:7], s71 offen offset:1024 sc1 lds
buffer_load_dwordx4 v2, s[4:7], s71 offen offset:2048 sc1 lds
buffer_load_dwordx4 v2, s[4:7], s71 offen offset:3072 sc1 lds
s_add_u32 s72, s72, 4096
s_add_u32 s71, s71, 4096
s_mov_b32 m0, s72
s_nop 0
buffer_load_dwordx4 v2, s[4:7], s71 offen offset:0 sc1 lds
buffer_load_dwordx4 v2, s[4:7], s71 offen offset:1024 sc1 lds
s_lshl_b32 s31, s64, 7
s_add_u32 s31, s31, 1048576
buffer_load_dword v9, off, s[4:7], s31 sc1
s_waitcnt vmcnt(0)
s_branch L_Qtop
L_roleA:
v_and_b32 v1, 63, v0
v_lshlrev_b32 v2, 4, v1
v_lshlrev_b32 v8, 2, v1
s_mov_b32 s16, s46
s_mov_b32 s17, s47
s_mov_b32 s18, 5242880
s_mov_b32 s19, 0x20000
s_mov_b32 s20, s36
s_mov_b32 s21, s37
s_mov_b32 s22, 2621440
s_mov_b32 s23, 0x20000
s_mul_i32 s62, s70, 327680
v_and_b32 v16, 19, v1
v_bfe_u32 v17, v1, 2, 1
v_lshl_add_u32 v16, v17, 3, v16
v_bfe_u32 v17, v1, 3, 1
v_lshl_add_u32 v16, v17, 2, v16
v_and_b32 v17, 1, v16
v_mul_u32_u24 v17, 0x0202, v17
v_mul_u32_u24 v17, 0x10001, v17
v_add_u32 v17, 0x05040100, v17
v_lshrrev_b32 v16, 1, v16
v_lshlrev_b32 v16, 2, v16
v_lshrrev_b32 v40, 5, v1
v_mul_u32_u24 v40, 10240, v40
v_add_u32 v16, v16, v40
s_mul_i32 s30, s25, 320
v_add_u32 v16, s30, v16
v_lshlrev_b32 v18, 4, v1
s_mul_i32 s34, s25, 10240
s_add_u32 s35, s34, s62
s_add_u32 m0, s34, 0
s_add_u32 s30, s35, 0
buffer_load_dwordx4 v18, s[16:19], s30 offen offset:0 lds
buffer_load_dwordx4 v18, s[16:19], s30 offen offset:1024 lds
buffer_load_dwordx4 v18, s[16:19], s30 offen offset:2048 lds
buffer_load_dwordx4 v18, s[16:19], s30 offen offset:3072 lds
s_add_u32 m0, s34, 4096
s_add_u32 s30, s35, 4096
buffer_load_dwordx4 v18, s[16:19], s30 offen offset:0 lds
buffer_load_dwordx4 v18, s[16:19], s30 offen offset:1024 lds
buffer_load_dwordx4 v18, s[16:19], s30 offen offset:2048 lds
buffer_load_dwordx4 v18, s[16:19], s30 offen offset:3072 lds
s_add_u32 m0, s34, 8192
s_add_u32 s30, s35, 8192
buffer_load_dwordx4 v18, s[16:19], s30 offen offset:0 lds
buffer_load_dwordx4 v18, s[16:19], s30 offen offset:1024 lds
s_add_u32 m0, s34, 40960
s_add_u32 s30, s35, 40960
buffer_load_dwordx4 v18, s[16:19], s30 offen offset:0 lds
buffer_load_dwordx4 v18, s[16:19], s30 offen offset:1024 lds
buffer_load_dwordx4 v18, s[16:19], s30 offen offset:2048 lds
buffer_load_dwordx4 v18, s[16:19], s30 offen offset:3072 lds
s_add_u32 m0, s34, 45056
s_add_u32 s30, s35, 45056
buffer_load_dwordx4 v18, s[16:19], s30 offen offset:0 lds
buffer_load_dwordx4 v18, s[16:19], s30 offen offset:1024 lds
buffer_load_dwordx4 v18, s[16:19], s30 offen offset:2048 lds
buffer_load_dwordx4 v18, s[16:19], s30 offen offset:3072 lds
s_add_u32 m0, s34, 49152
s_add_u32 s30, s35, 49152
buffer_load_dwordx4 v18, s[16:19], s30 offen offset:0 lds
buffer_load_dwordx4 v18, s[16:19], s30 offen offset:1024 lds
s_waitcnt vmcnt(10)
s_barrier
s_cmp_lg_u32 s25, 0
s_cbranch_scc1 ar137
s_or_b32 s33, s3, 0x80
v_mov_b32 v7, s33
s_mov_b64 exec, 1
buffer_store_byte v7, off, s[8:11], s2 sc1
s_mov_b64 exec, -1
ar137:
s_add_u32 m0, s34, 81920
s_add_u32 s30, s35, 81920
buffer_load_dwordx4 v18, s[16:19], s30 offen offset:0 lds
buffer_load_dwordx4 v18, s[16:19], s30 offen offset:1024 lds
buffer_load_dwordx4 v18, s[16:19], s30 offen offset:2048 lds
buffer_load_dwordx4 v18, s[16:19], s30 offen offset:3072 lds
s_add_u32 m0, s34, 86016
s_add_u32 s30, s35, 86016
buffer_load_dwordx4 v18, s[16:19], s30 offen offset:0 lds
buffer_load_dwordx4 v18, s[16:19], s30 offen offset:1024 lds
buffer_load_dwordx4 v18, s[16:19], s30 offen offset:2048 lds
buffer_load_dwordx4 v18, s[16:19], s30 offen offset:3072 lds
s_add_u32 m0, s34, 90112
s_add_u32 s30, s35, 90112
buffer_load_dwordx4 v18, s[16:19], s30 offen offset:0 lds
buffer_load_dwordx4 v18, s[16:19], s30 offen offset:1024 lds
v_add_u32 v19, 0, v16
ds_read2st64_b32 v[24:25], v19 offset0:0 offset1:5
ds_read2st64_b32 v[26:27], v19 offset0:10 offset1:15
ds_read2st64_b32 v[28:29], v19 offset0:20 offset1:25
ds_read2st64_b32 v[30:31], v19 offset0:30 offset1:35
ds_read2st64_b32 v[32:33], v19 offset0:80 offset1:85
ds_read2st64_b32 v[34:35], v19 offset0:90 offset1:95
ds_read2st64_b32 v[36:37], v19 offset0:100 offset1:105
ds_read2st64_b32 v[38:39], v19 offset0:110 offset1:115
s_waitcnt lgkmcnt(4)
v_perm_b32 v40, v25, v24, v17
v_perm_b32 v41, v27, v26, v17
v_perm_b32 v42, v29, v28, v17
v_perm_b32 v43, v31, v30, v17
v_add_u32 v19, 64, v16
ds_read2st64_b32 v[24:25], v19 offset0:0 offset1:5
ds_read2st64_b32 v[26:27], v19 offset0:10 offset1:15
ds_read2st64_b32 v[28:29], v19 offset0:20 offset1:25
ds_read2st64_b32 v[30:31], v19 offset0:30 offset1:35
v_accvgpr_write_b32 a0, v40
v_accvgpr_write_b32 a1, v41
v_accvgpr_write_b32 a2, v42
v_accvgpr_write_b32 a3, v43
s_waitcnt lgkmcnt(4)
v_perm_b32 v40, v33, v32, v17
v_perm_b32 v41, v35, v34, v17
v_perm_b32 v42, v37, v36, v17
v_perm_b32 v43, v39, v38, v17
ds_read2st64_b32 v[32:33], v19 offset0:80 offset1:85
ds_read2st64_b32 v[34:35], v19 offset0:90 offset1:95
ds_read2st64_b32 v[36:37], v19 offset0:100 offset1:105
ds_read2st64_b32 v[38:39], v19 offset0:110 offset1:115
v_accvgpr_write_b32 a4, v40
v_accvgpr_write_b32 a5, v41
v_accvgpr_write_b32 a6, v42
v_accvgpr_write_b32 a7, v43
s_waitcnt lgkmcnt(4)
v_perm_b32 v40, v25, v24, v17
v_perm_b32 v41, v27, v26, v17
v_perm_b32 v42, v29, v28, v17
v_perm_b32 v43, v31, v30, v17
v_add_u32 v19, 128, v16
ds_read2st64_b32 v[24:25], v19 offset0:0 offset1:5
ds_read2st64_b32 v[26:27], v19 offset0:10 offset1:15
ds_read2st64_b32 v[28:29], v19 offset0:20 offset1:25
ds_read2st64_b32 v[30:31], v19 offset0:30 offset1:35
v_accvgpr_write_b32 a64, v40
v_accvgpr_write_b32 a65, v41
v_accvgpr_write_b32 a66, v42
v_accvgpr_write_b32 a67, v43
s_waitcnt lgkmcnt(4)
v_perm_b32 v40, v33, v32, v17
v_perm_b32 v41, v35, v34, v17
v_perm_b32 v42, v37, v36, v17
v_perm_b32 v43, v39, v38, v17
ds_read2st64_b32 v[32:33], v19 offset0:80 offset1:85
ds_read2st64_b32 v[34:35], v19 offset0:90 offset1:95
ds_read2st64_b32 v[36:37], v19 offset0:100 offset1:105
ds_read2st64_b32 v[38:39], v19 offset0:110 offset1:115
v_accvgpr_write_b32 a68, v40
v_accvgpr_write_b32 a69, v41
v_accvgpr_write_b32 a70, v42
v_accvgpr_write_b32 a71, v43
s_waitcnt lgkmcnt(4)
v_perm_b32 v40, v25, v24, v17
v_perm_b32 v41, v27, v26, v17
v_perm_b32 v42, v29, v28, v17
v_perm_b32 v43, v31, v30, v17
v_add_u32 v19, 192, v16
ds_read2st64_b32 v[24:25], v19 offset0:0 offset1:5
ds_read2st64_b32 v[26:27], v19 offset0:10 offset1:15
ds_read2st64_b32 v[28:29], v19 offset0:20 offset1:25
ds_read2st64_b32 v[30:31], v19 offset0:30 offset1:35
v_accvgpr_write_b32 a128, v40
v_accvgpr_write_b32 a129, v41
v_accvgpr_write_b32 a130, v42
v_accvgpr_write_b32 a131, v43
s_waitcnt lgkmcnt(4)
v_perm_b32 v40, v33, v32, v17
v_perm_b32 v41, v35, v34, v17
v_perm_b32 v42, v37, v36, v17
v_perm_b32 v43, v39, v38, v17
ds_read2st64_b32 v[32:33], v19 offset0:80 offset1:85
ds_read2st64_b32 v[34:35], v19 offset0:90 offset1:95
ds_read2st64_b32 v[36:37], v19 offset0:100 offset1:105
ds_read2st64_b32 v[38:39], v19 offset0:110 offset1:115
v_accvgpr_write_b32 a132, v40
v_accvgpr_write_b32 a133, v41
v_accvgpr_write_b32 a134, v42
v_accvgpr_write_b32 a135, v43
s_waitcnt lgkmcnt(4)
v_perm_b32 v40, v25, v24, v17
v_perm_b32 v41, v27, v26, v17
v_perm_b32 v42, v29, v28, v17
v_perm_b32 v43, v31, v30, v17
v_add_u32 v19, 256, v16
ds_read2st64_b32 v[24:25], v19 offset0:0 offset1:5
ds_read2st64_b32 v[26:27], v19 offset0:10 offset1:15
ds_read2st64_b32 v[28:29], v19 offset0:20 offset1:25
ds_read2st64_b32 v[30:31], v19 offset0:30 offset1:35
v_accvgpr_write_b32 a192, v40
v_accvgpr_write_b32 a193, v41
v_accvgpr_write_b32 a194, v42
v_accvgpr_write_b32 a195, v43
s_waitcnt lgkmcnt(4)
v_perm_b32 v40, v33, v32, v17
v_perm_b32 v41, v35, v34, v17
v_perm_b32 v42, v37, v36, v17
v_perm_b32 v43, v39, v38, v17
ds_read2st64_b32 v[32:33], v19 offset0:80 offset1:85
ds_read2st64_b32 v[34:35], v19 offset0:90 offset1:95
ds_read2st64_b32 v[36:37], v19 offset0:100 offset1:105
ds_read2st64_b32 v[38:39], v19 offset0:110 offset1:115
v_accvgpr_write_b32 a196, v40
v_accvgpr_write_b32 a197, v41
v_accvgpr_write_b32 a198, v42
v_accvgpr_write_b32 a199, v43
s_waitcnt lgkmcnt(4)
v_perm_b32 v192, v25, v24, v17
v_perm_b32 v193, v27, v26, v17
v_perm_b32 v194, v29, v28, v17
v_perm_b32 v195, v31, v30, v17
s_waitcnt lgkmcnt(0)
v_perm_b32 v196, v33, v32, v17
v_perm_b32 v197, v35, v34, v17
v_perm_b32 v198, v37, v36, v17
v_perm_b32 v199, v39, v38, v17
s_waitcnt vmcnt(10)
s_barrier
s_add_u32 m0, s34, 0
s_add_u32 s30, s35, 122880
buffer_load_dwordx4 v18, s[16:19], s30 offen offset:0 lds
buffer_load_dwordx4 v18, s[16:19], s30 offen offset:1024 lds
buffer_load_dwordx4 v18, s[16:19], s30 offen offset:2048 lds
buffer_load_dwordx4 v18, s[16:19], s30 offen offset:3072 lds
s_add_u32 m0, s34, 4096
s_add_u32 s30, s35, 126976
buffer_load_dwordx4 v18, s[16:19], s30 offen offset:0 lds
buffer_load_dwordx4 v18, s[16:19], s30 offen offset:1024 lds
buffer_load_dwordx4 v18, s[16:19], s30 offen offset:2048 lds
buffer_load_dwordx4 v18, s[16:19], s30 offen offset:3072 lds
s_add_u32 m0, s34, 8192
s_add_u32 s30, s35, 131072
buffer_load_dwordx4 v18, s[16:19], s30 offen offset:0 lds
buffer_load_dwordx4 v18, s[16:19], s30 offen offset:1024 lds
v_add_u32 v19, 40960, v16
ds_read2st64_b32 v[24:25], v19 offset0:0 offset1:5
ds_read2st64_b32 v[26:27], v19 offset0:10 offset1:15
ds_read2st64_b32 v[28:29], v19 offset0:20 offset1:25
ds_read2st64_b32 v[30:31], v19 offset0:30 offset1:35
ds_read2st64_b32 v[32:33], v19 offset0:80 offset1:85
ds_read2st64_b32 v[34:35], v19 offset0:90 offset1:95
ds_read2st64_b32 v[36:37], v19 offset0:100 offset1:105
ds_read2st64_b32 v[38:39], v19 offset0:110 offset1:115
s_waitcnt lgkmcnt(4)
v_perm_b32 v40, v25, v24, v17
v_perm_b32 v41, v27, v26, v17
v_perm_b32 v42, v29, v28, v17
v_perm_b32 v43, v31, v30, v17
v_add_u32 v19, 41024, v16
ds_read2st64_b32 v[24:25], v19 offset0:0 offset1:5
ds_read2st64_b32 v[26:27], v19 offset0:10 offset1:15
ds_read2st64_b32 v[28:29], v19 offset0:20 offset1:25
ds_read2st64_b32 v[30:31], v19 offset0:30 offset1:35
v_accvgpr_write_b32 a8, v40
v_accvgpr_write_b32 a9, v41
v_accvgpr_write_b32 a10, v42
v_accvgpr_write_b32 a11, v43
s_waitcnt lgkmcnt(4)
v_perm_b32 v40, v33, v32, v17
v_perm_b32 v41, v35, v34, v17
v_perm_b32 v42, v37, v36, v17
v_perm_b32 v43, v39, v38, v17
ds_read2st64_b32 v[32:33], v19 offset0:80 offset1:85
ds_read2st64_b32 v[34:35], v19 offset0:90 offset1:95
ds_read2st64_b32 v[36:37], v19 offset0:100 offset1:105
ds_read2st64_b32 v[38:39], v19 offset0:110 offset1:115
v_accvgpr_write_b32 a12, v40
v_accvgpr_write_b32 a13, v41
v_accvgpr_write_b32 a14, v42
v_accvgpr_write_b32 a15, v43
s_waitcnt lgkmcnt(4)
v_perm_b32 v40, v25, v24, v17
v_perm_b32 v41, v27, v26, v17
v_perm_b32 v42, v29, v28, v17
v_perm_b32 v43, v31, v30, v17
v_add_u32 v19, 41088, v16
ds_read2st64_b32 v[24:25], v19 offset0:0 offset1:5
ds_read2st64_b32 v[26:27], v19 offset0:10 offset1:15
ds_read2st64_b32 v[28:29], v19 offset0:20 offset1:25
ds_read2st64_b32 v[30:31], v19 offset0:30 offset1:35
v_accvgpr_write_b32 a72, v40
v_accvgpr_write_b32 a73, v41
v_accvgpr_write_b32 a74, v42
v_accvgpr_write_b32 a75, v43
s_waitcnt lgkmcnt(4)
v_perm_b32 v40, v33, v32, v17
v_perm_b32 v41, v35, v34, v17
v_perm_b32 v42, v37, v36, v17
v_perm_b32 v43, v39, v38, v17
ds_read2st64_b32 v[32:33], v19 offset0:80 offset1:85
ds_read2st64_b32 v[34:35], v19 offset0:90 offset1:95
ds_read2st64_b32 v[36:37], v19 offset0:100 offset1:105
ds_read2st64_b32 v[38:39], v19 offset0:110 offset1:115
v_accvgpr_write_b32 a76, v40
v_accvgpr_write_b32 a77, v41
v_accvgpr_write_b32 a78, v42
v_accvgpr_write_b32 a79, v43
s_waitcnt lgkmcnt(4)
v_perm_b32 v40, v25, v24, v17
v_perm_b32 v41, v27, v26, v17
v_perm_b32 v42, v29, v28, v17
v_perm_b32 v43, v31, v30, v17
v_add_u32 v19, 41152, v16
ds_read2st64_b32 v[24:25], v19 offset0:0 offset1:5
ds_read2st64_b32 v[26:27], v19 offset0:10 offset1:15
ds_read2st64_b32 v[28:29], v19 offset0:20 offset1:25
ds_read2st64_b32 v[30:31], v19 offset0:30 offset1:35
v_accvgpr_write_b32 a136, v40
v_accvgpr_write_b32 a137, v41
v_accvgpr_write_b32 a138, v42
v_accvgpr_write_b32 a139, v43
s_waitcnt lgkmcnt(4)
v_perm_b32 v40, v33, v32, v17
v_perm_b32 v41, v35, v34, v17
v_perm_b32 v42, v37, v36, v17
v_perm_b32 v43, v39, v38, v17
ds_read2st64_b32 v[32:33], v19 offset0:80 offset1:85
ds_read2st64_b32 v[34:35], v19 offset0:90 offset1:95
ds_read2st64_b32 v[36:37], v19 offset0:100 offset1:105
ds_read2st64_b32 v[38:39], v19 offset0:110 offset1:115
v_accvgpr_write_b32 a140, v40
v_accvgpr_write_b32 a141, v41
v_accvgpr_write_b32 a142, v42
v_accvgpr_write_b32 a143, v43
s_waitcnt lgkmcnt(4)
v_perm_b32 v40, v25, v24, v17
v_perm_b32 v41, v27, v26, v17
v_perm_b32 v42, v29, v28, v17
v_perm_b32 v43, v31, v30, v17
v_add_u32 v19, 41216, v16
ds_read2st64_b32 v[24:25], v19 offset0:0 offset1:5
ds_read2st64_b32 v[26:27], v19 offset0:10 offset1:15
ds_read2st64_b32 v[28:29], v19 offset0:20 offset1:25
ds_read2st64_b32 v[30:31], v19 offset0:30 offset1:35
v_accvgpr_write_b32 a200, v40
v_accvgpr_write_b32 a201, v41
v_accvgpr_write_b32 a202, v42
v_accvgpr_write_b32 a203, v43
s_waitcnt lgkmcnt(4)
v_perm_b32 v40, v33, v32, v17
v_perm_b32 v41, v35, v34, v17
v_perm_b32 v42, v37, v36, v17
v_perm_b32 v43, v39, v38, v17
ds_read2st64_b32 v[32:33], v19 offset0:80 offset1:85
ds_read2st64_b32 v[34:35], v19 offset0:90 offset1:95
ds_read2st64_b32 v[36:37], v19 offset0:100 offset1:105
ds_read2st64_b32 v[38:39], v19 offset0:110 offset1:115
v_accvgpr_write_b32 a204, v40
v_accvgpr_write_b32 a205, v41
v_accvgpr_write_b32 a206, v42
v_accvgpr_write_b32 a207, v43
s_waitcnt lgkmcnt(4)
v_perm_b32 v200, v25, v24, v17
v_perm_b32 v201, v27, v26, v17
v_perm_b32 v202, v29, v28, v17
v_perm_b32 v203, v31, v30, v17
s_waitcnt lgkmcnt(0)
v_perm_b32 v204, v33, v32, v17
v_perm_b32 v205, v35, v34, v17
v_perm_b32 v206, v37, v36, v17
v_perm_b32 v207, v39, v38, v17
s_waitcnt vmcnt(10)
s_barrier
s_add_u32 m0, s34, 40960
s_add_u32 s30, s35, 163840
buffer_load_dwordx4 v18, s[16:19], s30 offen offset:0 lds
buffer_load_dwordx4 v18, s[16:19], s30 offen offset:1024 lds
buffer_load_dwordx4 v18, s[16:19], s30 offen offset:2048 lds
buffer_load_dwordx4 v18, s[16:19], s30 offen offset:3072 lds
s_add_u32 m0, s34, 45056
s_add_u32 s30, s35, 167936
buffer_load_dwordx4 v18, s[16:19], s30 offen offset:0 lds
buffer_load_dwordx4 v18, s[16:19], s30 offen offset:1024 lds
buffer_load_dwordx4 v18, s[16:19], s30 offen offset:2048 lds
buffer_load_dwordx4 v18, s[16:19], s30 offen offset:3072 lds
s_add_u32 m0, s34, 49152
s_add_u32 s30, s35, 172032
buffer_load_dwordx4 v18, s[16:19], s30 offen offset:0 lds
buffer_load_dwordx4 v18, s[16:19], s30 offen offset:1024 lds
v_add_u32 v19, 81920, v16
ds_read2st64_b32 v[24:25], v19 offset0:0 offset1:5
ds_read2st64_b32 v[26:27], v19 offset0:10 offset1:15
ds_read2st64_b32 v[28:29], v19 offset0:20 offset1:25
ds_read2st64_b32 v[30:31], v19 offset0:30 offset1:35
ds_read2st64_b32 v[32:33], v19 offset0:80 offset1:85
ds_read2st64_b32 v[34:35], v19 offset0:90 offset1:95
ds_read2st64_b32 v[36:37], v19 offset0:100 offset1:105
ds_read2st64_b32 v[38:39], v19 offset0:110 offset1:115
s_waitcnt lgkmcnt(4)
v_perm_b32 v40, v25, v24, v17
v_perm_b32 v41, v27, v26, v17
v_perm_b32 v42, v29, v28, v17
v_perm_b32 v43, v31, v30, v17
v_add_u32 v19, 81984, v16
ds_read2st64_b32 v[24:25], v19 offset0:0 offset1:5
ds_read2st64_b32 v[26:27], v19 offset0:10 offset1:15
ds_read2st64_b32 v[28:29], v19 offset0:20 offset1:25
ds_read2st64_b32 v[30:31], v19 offset0:30 offset1:35
v_accvgpr_write_b32 a16, v40
v_accvgpr_write_b32 a17, v41
v_accvgpr_write_b32 a18, v42
v_accvgpr_write_b32 a19, v43
s_waitcnt lgkmcnt(4)
v_perm_b32 v40, v33, v32, v17
v_perm_b32 v41, v35, v34, v17
v_perm_b32 v42, v37, v36, v17
v_perm_b32 v43, v39, v38, v17
ds_read2st64_b32 v[32:33], v19 offset0:80 offset1:85
ds_read2st64_b32 v[34:35], v19 offset0:90 offset1:95
ds_read2st64_b32 v[36:37], v19 offset0:100 offset1:105
ds_read2st64_b32 v[38:39], v19 offset0:110 offset1:115
v_accvgpr_write_b32 a20, v40
v_accvgpr_write_b32 a21, v41
v_accvgpr_write_b32 a22, v42
v_accvgpr_write_b32 a23, v43
s_waitcnt lgkmcnt(4)
v_perm_b32 v40, v25, v24, v17
v_perm_b32 v41, v27, v26, v17
v_perm_b32 v42, v29, v28, v17
v_perm_b32 v43, v31, v30, v17
v_add_u32 v19, 82048, v16
ds_read2st64_b32 v[24:25], v19 offset0:0 offset1:5
ds_read2st64_b32 v[26:27], v19 offset0:10 offset1:15
ds_read2st64_b32 v[28:29], v19 offset0:20 offset1:25
ds_read2st64_b32 v[30:31], v19 offset0:30 offset1:35
v_accvgpr_write_b32 a80, v40
v_accvgpr_write_b32 a81, v41
v_accvgpr_write_b32 a82, v42
v_accvgpr_write_b32 a83, v43
s_waitcnt lgkmcnt(4)
v_perm_b32 v40, v33, v32, v17
v_perm_b32 v41, v35, v34, v17
v_perm_b32 v42, v37, v36, v17
v_perm_b32 v43, v39, v38, v17
ds_read2st64_b32 v[32:33], v19 offset0:80 offset1:85
ds_read2st64_b32 v[34:35], v19 offset0:90 offset1:95
ds_read2st64_b32 v[36:37], v19 offset0:100 offset1:105
ds_read2st64_b32 v[38:39], v19 offset0:110 offset1:115
v_accvgpr_write_b32 a84, v40
v_accvgpr_write_b32 a85, v41
v_accvgpr_write_b32 a86, v42
v_accvgpr_write_b32 a87, v43
s_waitcnt lgkmcnt(4)
v_perm_b32 v40, v25, v24, v17
v_perm_b32 v41, v27, v26, v17
v_perm_b32 v42, v29, v28, v17
v_perm_b32 v43, v31, v30, v17
v_add_u32 v19, 82112, v16
ds_read2st64_b32 v[24:25], v19 offset0:0 offset1:5
ds_read2st64_b32 v[26:27], v19 offset0:10 offset1:15
ds_read2st64_b32 v[28:29], v19 offset0:20 offset1:25
ds_read2st64_b32 v[30:31], v19 offset0:30 offset1:35
v_accvgpr_write_b32 a144, v40
v_accvgpr_write_b32 a145, v41
v_accvgpr_write_b32 a146, v42
v_accvgpr_write_b32 a147, v43
s_waitcnt lgkmcnt(4)
v_perm_b32 v40, v33, v32, v17
v_perm_b32 v41, v35, v34, v17
v_perm_b32 v42, v37, v36, v17
v_perm_b32 v43, v39, v38, v17
ds_read2st64_b32 v[32:33], v19 offset0:80 offset1:85
ds_read2st64_b32 v[34:35], v19 offset0:90 offset1:95
ds_read2st64_b32 v[36:37], v19 offset0:100 offset1:105
ds_read2st64_b32 v[38:39], v19 offset0:110 offset1:115
v_accvgpr_write_b32 a148, v40
v_accvgpr_write_b32 a149, v41
v_accvgpr_write_b32 a150, v42
v_accvgpr_write_b32 a151, v43
s_waitcnt lgkmcnt(4)
v_perm_b32 v40, v25, v24, v17
v_perm_b32 v41, v27, v26, v17
v_perm_b32 v42, v29, v28, v17
v_perm_b32 v43, v31, v30, v17
v_add_u32 v19, 82176, v16
ds_read2st64_b32 v[24:25], v19 offset0:0 offset1:5
ds_read2st64_b32 v[26:27], v19 offset0:10 offset1:15
ds_read2st64_b32 v[28:29], v19 offset0:20 offset1:25
ds_read2st64_b32 v[30:31], v19 offset0:30 offset1:35
v_accvgpr_write_b32 a208, v40
v_accvgpr_write_b32 a209, v41
v_accvgpr_write_b32 a210, v42
v_accvgpr_write_b32 a211, v43
s_waitcnt lgkmcnt(4)
v_perm_b32 v40, v33, v32, v17
v_perm_b32 v41, v35, v34, v17
v_perm_b32 v42, v37, v36, v17
v_perm_b32 v43, v39, v38, v17
ds_read2st64_b32 v[32:33], v19 offset0:80 offset1:85
ds_read2st64_b32 v[34:35], v19 offset0:90 offset1:95
ds_read2st64_b32 v[36:37], v19 offset0:100 offset1:105
ds_read2st64_b32 v[38:39], v19 offset0:110 offset1:115
v_accvgpr_write_b32 a212, v40
v_accvgpr_write_b32 a213, v41
v_accvgpr_write_b32 a214, v42
v_accvgpr_write_b32 a215, v43
s_waitcnt lgkmcnt(4)
v_perm_b32 v208, v25, v24, v17
v_perm_b32 v209, v27, v26, v17
v_perm_b32 v210, v29, v28, v17
v_perm_b32 v211, v31, v30, v17
s_waitcnt lgkmcnt(0)
v_perm_b32 v212, v33, v32, v17
v_perm_b32 v213, v35, v34, v17
v_perm_b32 v214, v37, v36, v17
v_perm_b32 v215, v39, v38, v17
s_waitcnt vmcnt(10)
s_barrier
s_add_u32 m0, s34, 81920
s_add_u32 s30, s35, 204800
buffer_load_dwordx4 v18, s[16:19], s30 offen offset:0 lds
buffer_load_dwordx4 v18, s[16:19], s30 offen offset:1024 lds
buffer_load_dwordx4 v18, s[16:19], s30 offen offset:2048 lds
buffer_load_dwordx4 v18, s[16:19], s30 offen offset:3072 lds
s_add_u32 m0, s34, 86016
s_add_u32 s30, s35, 208896
buffer_load_dwordx4 v18, s[16:19], s30 offen offset:0 lds
buffer_load_dwordx4 v18, s[16:19], s30 offen offset:1024 lds
buffer_load_dwordx4 v18, s[16:19], s30 offen offset:2048 lds
buffer_load_dwordx4 v18, s[16:19], s30 offen offset:3072 lds
s_add_u32 m0, s34, 90112
s_add_u32 s30, s35, 212992
buffer_load_dwordx4 v18, s[16:19], s30 offen offset:0 lds
buffer_load_dwordx4 v18, s[16:19], s30 offen offset:1024 lds
v_add_u32 v19, 0, v16
ds_read2st64_b32 v[24:25], v19 offset0:0 offset1:5
ds_read2st64_b32 v[26:27], v19 offset0:10 offset1:15
ds_read2st64_b32 v[28:29], v19 offset0:20 offset1:25
ds_read2st64_b32 v[30:31], v19 offset0:30 offset1:35
ds_read2st64_b32 v[32:33], v19 offset0:80 offset1:85
ds_read2st64_b32 v[34:35], v19 offset0:90 offset1:95
ds_read2st64_b32 v[36:37], v19 offset0:100 offset1:105
ds_read2st64_b32 v[38:39], v19 offset0:110 offset1:115
s_waitcnt lgkmcnt(4)
v_perm_b32 v40, v25, v24, v17
v_perm_b32 v41, v27, v26, v17
v_perm_b32 v42, v29, v28, v17
v_perm_b32 v43, v31, v30, v17
v_add_u32 v19, 64, v16
ds_read2st64_b32 v[24:25], v19 offset0:0 offset1:5
ds_read2st64_b32 v[26:27], v19 offset0:10 offset1:15
ds_read2st64_b32 v[28:29], v19 offset0:20 offset1:25
ds_read2st64_b32 v[30:31], v19 offset0:30 offset1:35
v_accvgpr_write_b32 a24, v40
v_accvgpr_write_b32 a25, v41
v_accvgpr_write_b32 a26, v42
v_accvgpr_write_b32 a27, v43
s_waitcnt lgkmcnt(4)
v_perm_b32 v40, v33, v32, v17
v_perm_b32 v41, v35, v34, v17
v_perm_b32 v42, v37, v36, v17
v_perm_b32 v43, v39, v38, v17
ds_read2st64_b32 v[32:33], v19 offset0:80 offset1:85
ds_read2st64_b32 v[34:35], v19 offset0:90 offset1:95
ds_read2st64_b32 v[36:37], v19 offset0:100 offset1:105
ds_read2st64_b32 v[38:39], v19 offset0:110 offset1:115
v_accvgpr_write_b32 a28, v40
v_accvgpr_write_b32 a29, v41
v_accvgpr_write_b32 a30, v42
v_accvgpr_write_b32 a31, v43
s_waitcnt lgkmcnt(4)
v_perm_b32 v40, v25, v24, v17
v_perm_b32 v41, v27, v26, v17
v_perm_b32 v42, v29, v28, v17
v_perm_b32 v43, v31, v30, v17
v_add_u32 v19, 128, v16
ds_read2st64_b32 v[24:25], v19 offset0:0 offset1:5
ds_read2st64_b32 v[26:27], v19 offset0:10 offset1:15
ds_read2st64_b32 v[28:29], v19 offset0:20 offset1:25
ds_read2st64_b32 v[30:31], v19 offset0:30 offset1:35
v_accvgpr_write_b32 a88, v40
v_accvgpr_write_b32 a89, v41
v_accvgpr_write_b32 a90, v42
v_accvgpr_write_b32 a91, v43
s_waitcnt lgkmcnt(4)
v_perm_b32 v40, v33, v32, v17
v_perm_b32 v41, v35, v34, v17
v_perm_b32 v42, v37, v36, v17
v_perm_b32 v43, v39, v38, v17
ds_read2st64_b32 v[32:33], v19 offset0:80 offset1:85
ds_read2st64_b32 v[34:35], v19 offset0:90 offset1:95
ds_read2st64_b32 v[36:37], v19 offset0:100 offset1:105
ds_read2st64_b32 v[38:39], v19 offset0:110 offset1:115
v_accvgpr_write_b32 a92, v40
v_accvgpr_write_b32 a93, v41
v_accvgpr_write_b32 a94, v42
v_accvgpr_write_b32 a95, v43
s_waitcnt lgkmcnt(4)
v_perm_b32 v40, v25, v24, v17
v_perm_b32 v41, v27, v26, v17
v_perm_b32 v42, v29, v28, v17
v_perm_b32 v43, v31, v30, v17
v_add_u32 v19, 192, v16
ds_read2st64_b32 v[24:25], v19 offset0:0 offset1:5
ds_read2st64_b32 v[26:27], v19 offset0:10 offset1:15
ds_read2st64_b32 v[28:29], v19 offset0:20 offset1:25
ds_read2st64_b32 v[30:31], v19 offset0:30 offset1:35
v_accvgpr_write_b32 a152, v40
v_accvgpr_write_b32 a153, v41
v_accvgpr_write_b32 a154, v42
v_accvgpr_write_b32 a155, v43
s_waitcnt lgkmcnt(4)
v_perm_b32 v40, v33, v32, v17
v_perm_b32 v41, v35, v34, v17
v_perm_b32 v42, v37, v36, v17
v_perm_b32 v43, v39, v38, v17
ds_read2st64_b32 v[32:33], v19 offset0:80 offset1:85
ds_read2st64_b32 v[34:35], v19 offset0:90 offset1:95
ds_read2st64_b32 v[36:37], v19 offset0:100 offset1:105
ds_read2st64_b32 v[38:39], v19 offset0:110 offset1:115
v_accvgpr_write_b32 a156, v40
v_accvgpr_write_b32 a157, v41
v_accvgpr_write_b32 a158, v42
v_accvgpr_write_b32 a159, v43
s_waitcnt lgkmcnt(4)
v_perm_b32 v40, v25, v24, v17
v_perm_b32 v41, v27, v26, v17
v_perm_b32 v42, v29, v28, v17
v_perm_b32 v43, v31, v30, v17
v_add_u32 v19, 256, v16
ds_read2st64_b32 v[24:25], v19 offset0:0 offset1:5
ds_read2st64_b32 v[26:27], v19 offset0:10 offset1:15
ds_read2st64_b32 v[28:29], v19 offset0:20 offset1:25
ds_read2st64_b32 v[30:31], v19 offset0:30 offset1:35
v_accvgpr_write_b32 a216, v40
v_accvgpr_write_b32 a217, v41
v_accvgpr_write_b32 a218, v42
v_accvgpr_write_b32 a219, v43
s_waitcnt lgkmcnt(4)
v_perm_b32 v40, v33, v32, v17
v_perm_b32 v41, v35, v34, v17
v_perm_b32 v42, v37, v36, v17
v_perm_b32 v43, v39, v38, v17
ds_read2st64_b32 v[32:33], v19 offset0:80 offset1:85
ds_read2st64_b32 v[34:35], v19 offset0:90 offset1:95
ds_read2st64_b32 v[36:37], v19 offset0:100 offset1:105
ds_read2st64_b32 v[38:39], v19 offset0:110 offset1:115
v_accvgpr_write_b32 a220, v40
v_accvgpr_write_b32 a221, v41
v_accvgpr_write_b32 a222, v42
v_accvgpr_write_b32 a223, v43
s_waitcnt lgkmcnt(4)
v_perm_b32 v216, v25, v24, v17
v_perm_b32 v217, v27, v26, v17
v_perm_b32 v218, v29, v28, v17
v_perm_b32 v219, v31, v30, v17
s_waitcnt lgkmcnt(0)
v_perm_b32 v220, v33, v32, v17
v_perm_b32 v221, v35, v34, v17
v_perm_b32 v222, v37, v36, v17
v_perm_b32 v223, v39, v38, v17
s_waitcnt vmcnt(10)
s_barrier
s_add_u32 m0, s34, 0
s_add_u32 s30, s35, 245760
buffer_load_dwordx4 v18, s[16:19], s30 offen offset:0 lds
buffer_load_dwordx4 v18, s[16:19], s30 offen offset:1024 lds
buffer_load_dwordx4 v18, s[16:19], s30 offen offset:2048 lds
buffer_load_dwordx4 v18, s[16:19], s30 offen offset:3072 lds
s_add_u32 m0, s34, 4096
s_add_u32 s30, s35, 249856
buffer_load_dwordx4 v18, s[16:19], s30 offen offset:0 lds
buffer_load_dwordx4 v18, s[16:19], s30 offen offset:1024 lds
buffer_load_dwordx4 v18, s[16:19], s30 offen offset:2048 lds
buffer_load_dwordx4 v18, s[16:19], s30 offen offset:3072 lds
s_add_u32 m0, s34, 8192
s_add_u32 s30, s35, 253952
buffer_load_dwordx4 v18, s[16:19], s30 offen offset:0 lds
buffer_load_dwordx4 v18, s[16:19], s30 offen offset:1024 lds
v_add_u32 v19, 40960, v16
ds_read2st64_b32 v[24:25], v19 offset0:0 offset1:5
ds_read2st64_b32 v[26:27], v19 offset0:10 offset1:15
ds_read2st64_b32 v[28:29], v19 offset0:20 offset1:25
ds_read2st64_b32 v[30:31], v19 offset0:30 offset1:35
ds_read2st64_b32 v[32:33], v19 offset0:80 offset1:85
ds_read2st64_b32 v[34:35], v19 offset0:90 offset1:95
ds_read2st64_b32 v[36:37], v19 offset0:100 offset1:105
ds_read2st64_b32 v[38:39], v19 offset0:110 offset1:115
s_waitcnt lgkmcnt(4)
v_perm_b32 v40, v25, v24, v17
v_perm_b32 v41, v27, v26, v17
v_perm_b32 v42, v29, v28, v17
v_perm_b32 v43, v31, v30, v17
v_add_u32 v19, 41024, v16
ds_read2st64_b32 v[24:25], v19 offset0:0 offset1:5
ds_read2st64_b32 v[26:27], v19 offset0:10 offset1:15
ds_read2st64_b32 v[28:29], v19 offset0:20 offset1:25
ds_read2st64_b32 v[30:31], v19 offset0:30 offset1:35
v_accvgpr_write_b32 a32, v40
v_accvgpr_write_b32 a33, v41
v_accvgpr_write_b32 a34, v42
v_accvgpr_write_b32 a35, v43
s_waitcnt lgkmcnt(4)
v_perm_b32 v40, v33, v32, v17
v_perm_b32 v41, v35, v34, v17
v_perm_b32 v42, v37, v36, v17
v_perm_b32 v43, v39, v38, v17
ds_read2st64_b32 v[32:33], v19 offset0:80 offset1:85
ds_read2st64_b32 v[34:35], v19 offset0:90 offset1:95
ds_read2st64_b32 v[36:37], v19 offset0:100 offset1:105
ds_read2st64_b32 v[38:39], v19 offset0:110 offset1:115
v_accvgpr_write_b32 a36, v40
v_accvgpr_write_b32 a37, v41
v_accvgpr_write_b32 a38, v42
v_accvgpr_write_b32 a39, v43
s_waitcnt lgkmcnt(4)
v_perm_b32 v40, v25, v24, v17
v_perm_b32 v41, v27, v26, v17
v_perm_b32 v42, v29, v28, v17
v_perm_b32 v43, v31, v30, v17
v_add_u32 v19, 41088, v16
ds_read2st64_b32 v[24:25], v19 offset0:0 offset1:5
ds_read2st64_b32 v[26:27], v19 offset0:10 offset1:15
ds_read2st64_b32 v[28:29], v19 offset0:20 offset1:25
ds_read2st64_b32 v[30:31], v19 offset0:30 offset1:35
v_accvgpr_write_b32 a96, v40
v_accvgpr_write_b32 a97, v41
v_accvgpr_write_b32 a98, v42
v_accvgpr_write_b32 a99, v43
s_waitcnt lgkmcnt(4)
v_perm_b32 v40, v33, v32, v17
v_perm_b32 v41, v35, v34, v17
v_perm_b32 v42, v37, v36, v17
v_perm_b32 v43, v39, v38, v17
ds_read2st64_b32 v[32:33], v19 offset0:80 offset1:85
ds_read2st64_b32 v[34:35], v19 offset0:90 offset1:95
ds_read2st64_b32 v[36:37], v19 offset0:100 offset1:105
ds_read2st64_b32 v[38:39], v19 offset0:110 offset1:115
v_accvgpr_write_b32 a100, v40
v_accvgpr_write_b32 a101, v41
v_accvgpr_write_b32 a102, v42
v_accvgpr_write_b32 a103, v43
s_waitcnt lgkmcnt(4)
v_perm_b32 v40, v25, v24, v17
v_perm_b32 v41, v27, v26, v17
v_perm_b32 v42, v29, v28, v17
v_perm_b32 v43, v31, v30, v17
v_add_u32 v19, 41152, v16
ds_read2st64_b32 v[24:25], v19 offset0:0 offset1:5
ds_read2st64_b32 v[26:27], v19 offset0:10 offset1:15
ds_read2st64_b32 v[28:29], v19 offset0:20 offset1:25
ds_read2st64_b32 v[30:31], v19 offset0:30 offset1:35
v_accvgpr_write_b32 a160, v40
v_accvgpr_write_b32 a161, v41
v_accvgpr_write_b32 a162, v42
v_accvgpr_write_b32 a163, v43
s_waitcnt lgkmcnt(4)
v_perm_b32 v40, v33, v32, v17
v_perm_b32 v41, v35, v34, v17
v_perm_b32 v42, v37, v36, v17
v_perm_b32 v43, v39, v38, v17
ds_read2st64_b32 v[32:33], v19 offset0:80 offset1:85
ds_read2st64_b32 v[34:35], v19 offset0:90 offset1:95
ds_read2st64_b32 v[36:37], v19 offset0:100 offset1:105
ds_read2st64_b32 v[38:39], v19 offset0:110 offset1:115
v_accvgpr_write_b32 a164, v40
v_accvgpr_write_b32 a165, v41
v_accvgpr_write_b32 a166, v42
v_accvgpr_write_b32 a167, v43
s_waitcnt lgkmcnt(4)
v_perm_b32 v40, v25, v24, v17
v_perm_b32 v41, v27, v26, v17
v_perm_b32 v42, v29, v28, v17
v_perm_b32 v43, v31, v30, v17
v_add_u32 v19, 41216, v16
ds_read2st64_b32 v[24:25], v19 offset0:0 offset1:5
ds_read2st64_b32 v[26:27], v19 offset0:10 offset1:15
ds_read2st64_b32 v[28:29], v19 offset0:20 offset1:25
ds_read2st64_b32 v[30:31], v19 offset0:30 offset1:35
v_accvgpr_write_b32 a224, v40
v_accvgpr_write_b32 a225, v41
v_accvgpr_write_b32 a226, v42
v_accvgpr_write_b32 a227, v43
s_waitcnt lgkmcnt(4)
v_perm_b32 v40, v33, v32, v17
v_perm_b32 v41, v35, v34, v17
v_perm_b32 v42, v37, v36, v17
v_perm_b32 v43, v39, v38, v17
ds_read2st64_b32 v[32:33], v19 offset0:80 offset1:85
ds_read2st64_b32 v[34:35], v19 offset0:90 offset1:95
ds_read2st64_b32 v[36:37], v19 offset0:100 offset1:105
ds_read2st64_b32 v[38:39], v19 offset0:110 offset1:115
v_accvgpr_write_b32 a228, v40
v_accvgpr_write_b32 a229, v41
v_accvgpr_write_b32 a230, v42
v_accvgpr_write_b32 a231, v43
s_waitcnt lgkmcnt(4)
v_perm_b32 v224, v25, v24, v17
v_perm_b32 v225, v27, v26, v17
v_perm_b32 v226, v29, v28, v17
v_perm_b32 v227, v31, v30, v17
s_waitcnt lgkmcnt(0)
v_perm_b32 v228, v33, v32, v17
v_perm_b32 v229, v35, v34, v17
v_perm_b32 v230, v37, v36, v17
v_perm_b32 v231, v39, v38, v17
s_waitcnt vmcnt(10)
s_barrier
s_add_u32 m0, s34, 40960
s_add_u32 s30, s35, 286720
buffer_load_dwordx4 v18, s[16:19], s30 offen offset:0 lds
buffer_load_dwordx4 v18, s[16:19], s30 offen offset:1024 lds
buffer_load_dwordx4 v18, s[16:19], s30 offen offset:2048 lds
buffer_load_dwordx4 v18, s[16:19], s30 offen offset:3072 lds
s_add_u32 m0, s34, 45056
s_add_u32 s30, s35, 290816
buffer_load_dwordx4 v18, s[16:19], s30 offen offset:0 lds
buffer_load_dwordx4 v18, s[16:19], s30 offen offset:1024 lds
buffer_load_dwordx4 v18, s[16:19], s30 offen offset:2048 lds
buffer_load_dwordx4 v18, s[16:19], s30 offen offset:3072 lds
s_add_u32 m0, s34, 49152
s_add_u32 s30, s35, 294912
buffer_load_dwordx4 v18, s[16:19], s30 offen offset:0 lds
buffer_load_dwordx4 v18, s[16:19], s30 offen offset:1024 lds
v_add_u32 v19, 81920, v16
ds_read2st64_b32 v[24:25], v19 offset0:0 offset1:5
ds_read2st64_b32 v[26:27], v19 offset0:10 offset1:15
ds_read2st64_b32 v[28:29], v19 offset0:20 offset1:25
ds_read2st64_b32 v[30:31], v19 offset0:30 offset1:35
ds_read2st64_b32 v[32:33], v19 offset0:80 offset1:85
ds_read2st64_b32 v[34:35], v19 offset0:90 offset1:95
ds_read2st64_b32 v[36:37], v19 offset0:100 offset1:105
ds_read2st64_b32 v[38:39], v19 offset0:110 offset1:115
s_waitcnt lgkmcnt(4)
v_perm_b32 v40, v25, v24, v17
v_perm_b32 v41, v27, v26, v17
v_perm_b32 v42, v29, v28, v17
v_perm_b32 v43, v31, v30, v17
v_add_u32 v19, 81984, v16
ds_read2st64_b32 v[24:25], v19 offset0:0 offset1:5
ds_read2st64_b32 v[26:27], v19 offset0:10 offset1:15
ds_read2st64_b32 v[28:29], v19 offset0:20 offset1:25
ds_read2st64_b32 v[30:31], v19 offset0:30 offset1:35
v_accvgpr_write_b32 a40, v40
v_accvgpr_write_b32 a41, v41
v_accvgpr_write_b32 a42, v42
v_accvgpr_write_b32 a43, v43
s_waitcnt lgkmcnt(4)
v_perm_b32 v40, v33, v32, v17
v_perm_b32 v41, v35, v34, v17
v_perm_b32 v42, v37, v36, v17
v_perm_b32 v43, v39, v38, v17
ds_read2st64_b32 v[32:33], v19 offset0:80 offset1:85
ds_read2st64_b32 v[34:35], v19 offset0:90 offset1:95
ds_read2st64_b32 v[36:37], v19 offset0:100 offset1:105
ds_read2st64_b32 v[38:39], v19 offset0:110 offset1:115
v_accvgpr_write_b32 a44, v40
v_accvgpr_write_b32 a45, v41
v_accvgpr_write_b32 a46, v42
v_accvgpr_write_b32 a47, v43
s_waitcnt lgkmcnt(4)
v_perm_b32 v40, v25, v24, v17
v_perm_b32 v41, v27, v26, v17
v_perm_b32 v42, v29, v28, v17
v_perm_b32 v43, v31, v30, v17
v_add_u32 v19, 82048, v16
ds_read2st64_b32 v[24:25], v19 offset0:0 offset1:5
ds_read2st64_b32 v[26:27], v19 offset0:10 offset1:15
ds_read2st64_b32 v[28:29], v19 offset0:20 offset1:25
ds_read2st64_b32 v[30:31], v19 offset0:30 offset1:35
v_accvgpr_write_b32 a104, v40
v_accvgpr_write_b32 a105, v41
v_accvgpr_write_b32 a106, v42
v_accvgpr_write_b32 a107, v43
s_waitcnt lgkmcnt(4)
v_perm_b32 v40, v33, v32, v17
v_perm_b32 v41, v35, v34, v17
v_perm_b32 v42, v37, v36, v17
v_perm_b32 v43, v39, v38, v17
ds_read2st64_b32 v[32:33], v19 offset0:80 offset1:85
ds_read2st64_b32 v[34:35], v19 offset0:90 offset1:95
ds_read2st64_b32 v[36:37], v19 offset0:100 offset1:105
ds_read2st64_b32 v[38:39], v19 offset0:110 offset1:115
v_accvgpr_write_b32 a108, v40
v_accvgpr_write_b32 a109, v41
v_accvgpr_write_b32 a110, v42
v_accvgpr_write_b32 a111, v43
s_waitcnt lgkmcnt(4)
v_perm_b32 v40, v25, v24, v17
v_perm_b32 v41, v27, v26, v17
v_perm_b32 v42, v29, v28, v17
v_perm_b32 v43, v31, v30, v17
v_add_u32 v19, 82112, v16
ds_read2st64_b32 v[24:25], v19 offset0:0 offset1:5
ds_read2st64_b32 v[26:27], v19 offset0:10 offset1:15
ds_read2st64_b32 v[28:29], v19 offset0:20 offset1:25
ds_read2st64_b32 v[30:31], v19 offset0:30 offset1:35
v_accvgpr_write_b32 a168, v40
v_accvgpr_write_b32 a169, v41
v_accvgpr_write_b32 a170, v42
v_accvgpr_write_b32 a171, v43
s_waitcnt lgkmcnt(4)
v_perm_b32 v40, v33, v32, v17
v_perm_b32 v41, v35, v34, v17
v_perm_b32 v42, v37, v36, v17
v_perm_b32 v43, v39, v38, v17
ds_read2st64_b32 v[32:33], v19 offset0:80 offset1:85
ds_read2st64_b32 v[34:35], v19 offset0:90 offset1:95
ds_read2st64_b32 v[36:37], v19 offset0:100 offset1:105
ds_read2st64_b32 v[38:39], v19 offset0:110 offset1:115
v_accvgpr_write_b32 a172, v40
v_accvgpr_write_b32 a173, v41
v_accvgpr_write_b32 a174, v42
v_accvgpr_write_b32 a175, v43
s_waitcnt lgkmcnt(4)
v_perm_b32 v40, v25, v24, v17
v_perm_b32 v41, v27, v26, v17
v_perm_b32 v42, v29, v28, v17
v_perm_b32 v43, v31, v30, v17
v_add_u32 v19, 82176, v16
ds_read2st64_b32 v[24:25], v19 offset0:0 offset1:5
ds_read2st64_b32 v[26:27], v19 offset0:10 offset1:15
ds_read2st64_b32 v[28:29], v19 offset0:20 offset1:25
ds_read2st64_b32 v[30:31], v19 offset0:30 offset1:35
v_accvgpr_write_b32 a232, v40
v_accvgpr_write_b32 a233, v41
v_accvgpr_write_b32 a234, v42
v_accvgpr_write_b32 a235, v43
s_waitcnt lgkmcnt(4)
v_perm_b32 v40, v33, v32, v17
v_perm_b32 v41, v35, v34, v17
v_perm_b32 v42, v37, v36, v17
v_perm_b32 v43, v39, v38, v17
ds_read2st64_b32 v[32:33], v19 offset0:80 offset1:85
ds_read2st64_b32 v[34:35], v19 offset0:90 offset1:95
ds_read2st64_b32 v[36:37], v19 offset0:100 offset1:105
ds_read2st64_b32 v[38:39], v19 offset0:110 offset1:115
v_accvgpr_write_b32 a236, v40
v_accvgpr_write_b32 a237, v41
v_accvgpr_write_b32 a238, v42
v_accvgpr_write_b32 a239, v43
s_waitcnt lgkmcnt(4)
v_perm_b32 v232, v25, v24, v17
v_perm_b32 v233, v27, v26, v17
v_perm_b32 v234, v29, v28, v17
v_perm_b32 v235, v31, v30, v17
s_waitcnt lgkmcnt(0)
v_perm_b32 v236, v33, v32, v17
v_perm_b32 v237, v35, v34, v17
v_perm_b32 v238, v37, v36, v17
v_perm_b32 v239, v39, v38, v17
s_waitcnt vmcnt(10)
s_barrier
v_add_u32 v19, 0, v16
ds_read2st64_b32 v[24:25], v19 offset0:0 offset1:5
ds_read2st64_b32 v[26:27], v19 offset0:10 offset1:15
ds_read2st64_b32 v[28:29], v19 offset0:20 offset1:25
ds_read2st64_b32 v[30:31], v19 offset0:30 offset1:35
ds_read2st64_b32 v[32:33], v19 offset0:80 offset1:85
ds_read2st64_b32 v[34:35], v19 offset0:90 offset1:95
ds_read2st64_b32 v[36:37], v19 offset0:100 offset1:105
ds_read2st64_b32 v[38:39], v19 offset0:110 offset1:115
s_waitcnt lgkmcnt(4)
v_perm_b32 v40, v25, v24, v17
v_perm_b32 v41, v27, v26, v17
v_perm_b32 v42, v29, v28, v17
v_perm_b32 v43, v31, v30, v17
v_add_u32 v19, 64, v16
ds_read2st64_b32 v[24:25], v19 offset0:0 offset1:5
ds_read2st64_b32 v[26:27], v19 offset0:10 offset1:15
ds_read2st64_b32 v[28:29], v19 offset0:20 offset1:25
ds_read2st64_b32 v[30:31], v19 offset0:30 offset1:35
v_accvgpr_write_b32 a48, v40
v_accvgpr_write_b32 a49, v41
v_accvgpr_write_b32 a50, v42
v_accvgpr_write_b32 a51, v43
s_waitcnt lgkmcnt(4)
v_perm_b32 v40, v33, v32, v17
v_perm_b32 v41, v35, v34, v17
v_perm_b32 v42, v37, v36, v17
v_perm_b32 v43, v39, v38, v17
ds_read2st64_b32 v[32:33], v19 offset0:80 offset1:85
ds_read2st64_b32 v[34:35], v19 offset0:90 offset1:95
ds_read2st64_b32 v[36:37], v19 offset0:100 offset1:105
ds_read2st64_b32 v[38:39], v19 offset0:110 offset1:115
v_accvgpr_write_b32 a52, v40
v_accvgpr_write_b32 a53, v41
v_accvgpr_write_b32 a54, v42
v_accvgpr_write_b32 a55, v43
s_waitcnt lgkmcnt(4)
v_perm_b32 v40, v25, v24, v17
v_perm_b32 v41, v27, v26, v17
v_perm_b32 v42, v29, v28, v17
v_perm_b32 v43, v31, v30, v17
v_add_u32 v19, 128, v16
ds_read2st64_b32 v[24:25], v19 offset0:0 offset1:5
ds_read2st64_b32 v[26:27], v19 offset0:10 offset1:15
ds_read2st64_b32 v[28:29], v19 offset0:20 offset1:25
ds_read2st64_b32 v[30:31], v19 offset0:30 offset1:35
v_accvgpr_write_b32 a112, v40
v_accvgpr_write_b32 a113, v41
v_accvgpr_write_b32 a114, v42
v_accvgpr_write_b32 a115, v43
s_waitcnt lgkmcnt(4)
v_perm_b32 v40, v33, v32, v17
v_perm_b32 v41, v35, v34, v17
v_perm_b32 v42, v37, v36, v17
v_perm_b32 v43, v39, v38, v17
ds_read2st64_b32 v[32:33], v19 offset0:80 offset1:85
ds_read2st64_b32 v[34:35], v19 offset0:90 offset1:95
ds_read2st64_b32 v[36:37], v19 offset0:100 offset1:105
ds_read2st64_b32 v[38:39], v19 offset0:110 offset1:115
v_accvgpr_write_b32 a116, v40
v_accvgpr_write_b32 a117, v41
v_accvgpr_write_b32 a118, v42
v_accvgpr_write_b32 a119, v43
s_waitcnt lgkmcnt(4)
v_perm_b32 v40, v25, v24, v17
v_perm_b32 v41, v27, v26, v17
v_perm_b32 v42, v29, v28, v17
v_perm_b32 v43, v31, v30, v17
v_add_u32 v19, 192, v16
ds_read2st64_b32 v[24:25], v19 offset0:0 offset1:5
ds_read2st64_b32 v[26:27], v19 offset0:10 offset1:15
ds_read2st64_b32 v[28:29], v19 offset0:20 offset1:25
ds_read2st64_b32 v[30:31], v19 offset0:30 offset1:35
v_accvgpr_write_b32 a176, v40
v_accvgpr_write_b32 a177, v41
v_accvgpr_write_b32 a178, v42
v_accvgpr_write_b32 a179, v43
s_waitcnt lgkmcnt(4)
v_perm_b32 v40, v33, v32, v17
v_perm_b32 v41, v35, v34, v17
v_perm_b32 v42, v37, v36, v17
v_perm_b32 v43, v39, v38, v17
ds_read2st64_b32 v[32:33], v19 offset0:80 offset1:85
ds_read2st64_b32 v[34:35], v19 offset0:90 offset1:95
ds_read2st64_b32 v[36:37], v19 offset0:100 offset1:105
ds_read2st64_b32 v[38:39], v19 offset0:110 offset1:115
v_accvgpr_write_b32 a180, v40
v_accvgpr_write_b32 a181, v41
v_accvgpr_write_b32 a182, v42
v_accvgpr_write_b32 a183, v43
s_waitcnt lgkmcnt(4)
v_perm_b32 v40, v25, v24, v17
v_perm_b32 v41, v27, v26, v17
v_perm_b32 v42, v29, v28, v17
v_perm_b32 v43, v31, v30, v17
v_add_u32 v19, 256, v16
ds_read2st64_b32 v[24:25], v19 offset0:0 offset1:5
ds_read2st64_b32 v[26:27], v19 offset0:10 offset1:15
ds_read2st64_b32 v[28:29], v19 offset0:20 offset1:25
ds_read2st64_b32 v[30:31], v19 offset0:30 offset1:35
v_accvgpr_write_b32 a240, v40
v_accvgpr_write_b32 a241, v41
v_accvgpr_write_b32 a242, v42
v_accvgpr_write_b32 a243, v43
s_waitcnt lgkmcnt(4)
v_perm_b32 v40, v33, v32, v17
v_perm_b32 v41, v35, v34, v17
v_perm_b32 v42, v37, v36, v17
v_perm_b32 v43, v39, v38, v17
ds_read2st64_b32 v[32:33], v19 offset0:80 offset1:85
ds_read2st64_b32 v[34:35], v19 offset0:90 offset1:95
ds_read2st64_b32 v[36:37], v19 offset0:100 offset1:105
ds_read2st64_b32 v[38:39], v19 offset0:110 offset1:115
v_accvgpr_write_b32 a244, v40
v_accvgpr_write_b32 a245, v41
v_accvgpr_write_b32 a246, v42
v_accvgpr_write_b32 a247, v43
s_waitcnt lgkmcnt(4)
v_perm_b32 v240, v25, v24, v17
v_perm_b32 v241, v27, v26, v17
v_perm_b32 v242, v29, v28, v17
v_perm_b32 v243, v31, v30, v17
s_waitcnt lgkmcnt(0)
v_perm_b32 v244, v33, v32, v17
v_perm_b32 v245, v35, v34, v17
v_perm_b32 v246, v37, v36, v17
v_perm_b32 v247, v39, v38, v17
s_waitcnt vmcnt(0)
s_barrier
v_add_u32 v19, 40960, v16
ds_read2st64_b32 v[24:25], v19 offset0:0 offset1:5
ds_read2st64_b32 v[26:27], v19 offset0:10 offset1:15
ds_read2st64_b32 v[28:29], v19 offset0:20 offset1:25
ds_read2st64_b32 v[30:31], v19 offset0:30 offset1:35
ds_read2st64_b32 v[32:33], v19 offset0:80 offset1:85
ds_read2st64_b32 v[34:35], v19 offset0:90 offset1:95
ds_read2st64_b32 v[36:37], v19 offset0:100 offset1:105
ds_read2st64_b32 v[38:39], v19 offset0:110 offset1:115
s_waitcnt lgkmcnt(4)
v_perm_b32 v40, v25, v24, v17
v_perm_b32 v41, v27, v26, v17
v_perm_b32 v42, v29, v28, v17
v_perm_b32 v43, v31, v30, v17
v_add_u32 v19, 41024, v16
ds_read2st64_b32 v[24:25], v19 offset0:0 offset1:5
ds_read2st64_b32 v[26:27], v19 offset0:10 offset1:15
ds_read2st64_b32 v[28:29], v19 offset0:20 offset1:25
ds_read2st64_b32 v[30:31], v19 offset0:30 offset1:35
v_accvgpr_write_b32 a56, v40
v_accvgpr_write_b32 a57, v41
v_accvgpr_write_b32 a58, v42
v_accvgpr_write_b32 a59, v43
s_waitcnt lgkmcnt(4)
v_perm_b32 v40, v33, v32, v17
v_perm_b32 v41, v35, v34, v17
v_perm_b32 v42, v37, v36, v17
v_perm_b32 v43, v39, v38, v17
ds_read2st64_b32 v[32:33], v19 offset0:80 offset1:85
ds_read2st64_b32 v[34:35], v19 offset0:90 offset1:95
ds_read2st64_b32 v[36:37], v19 offset0:100 offset1:105
ds_read2st64_b32 v[38:39], v19 offset0:110 offset1:115
v_accvgpr_write_b32 a60, v40
v_accvgpr_write_b32 a61, v41
v_accvgpr_write_b32 a62, v42
v_accvgpr_write_b32 a63, v43
s_waitcnt lgkmcnt(4)
v_perm_b32 v40, v25, v24, v17
v_perm_b32 v41, v27, v26, v17
v_perm_b32 v42, v29, v28, v17
v_perm_b32 v43, v31, v30, v17
v_add_u32 v19, 41088, v16
ds_read2st64_b32 v[24:25], v19 offset0:0 offset1:5
ds_read2st64_b32 v[26:27], v19 offset0:10 offset1:15
ds_read2st64_b32 v[28:29], v19 offset0:20 offset1:25
ds_read2st64_b32 v[30:31], v19 offset0:30 offset1:35
v_accvgpr_write_b32 a120, v40
v_accvgpr_write_b32 a121, v41
v_accvgpr_write_b32 a122, v42
v_accvgpr_write_b32 a123, v43
s_waitcnt lgkmcnt(4)
v_perm_b32 v40, v33, v32, v17
v_perm_b32 v41, v35, v34, v17
v_perm_b32 v42, v37, v36, v17
v_perm_b32 v43, v39, v38, v17
ds_read2st64_b32 v[32:33], v19 offset0:80 offset1:85
ds_read2st64_b32 v[34:35], v19 offset0:90 offset1:95
ds_read2st64_b32 v[36:37], v19 offset0:100 offset1:105
ds_read2st64_b32 v[38:39], v19 offset0:110 offset1:115
v_accvgpr_write_b32 a124, v40
v_accvgpr_write_b32 a125, v41
v_accvgpr_write_b32 a126, v42
v_accvgpr_write_b32 a127, v43
s_waitcnt lgkmcnt(4)
v_perm_b32 v40, v25, v24, v17
v_perm_b32 v41, v27, v26, v17
v_perm_b32 v42, v29, v28, v17
v_perm_b32 v43, v31, v30, v17
v_add_u32 v19, 41152, v16
ds_read2st64_b32 v[24:25], v19 offset0:0 offset1:5
ds_read2st64_b32 v[26:27], v19 offset0:10 offset1:15
ds_read2st64_b32 v[28:29], v19 offset0:20 offset1:25
ds_read2st64_b32 v[30:31], v19 offset0:30 offset1:35
v_accvgpr_write_b32 a184, v40
v_accvgpr_write_b32 a185, v41
v_accvgpr_write_b32 a186, v42
v_accvgpr_write_b32 a187, v43
s_waitcnt lgkmcnt(4)
v_perm_b32 v40, v33, v32, v17
v_perm_b32 v41, v35, v34, v17
v_perm_b32 v42, v37, v36, v17
v_perm_b32 v43, v39, v38, v17
ds_read2st64_b32 v[32:33], v19 offset0:80 offset1:85
ds_read2st64_b32 v[34:35], v19 offset0:90 offset1:95
ds_read2st64_b32 v[36:37], v19 offset0:100 offset1:105
ds_read2st64_b32 v[38:39], v19 offset0:110 offset1:115
v_accvgpr_write_b32 a188, v40
v_accvgpr_write_b32 a189, v41
v_accvgpr_write_b32 a190, v42
v_accvgpr_write_b32 a191, v43
s_waitcnt lgkmcnt(4)
v_perm_b32 v40, v25, v24, v17
v_perm_b32 v41, v27, v26, v17
v_perm_b32 v42, v29, v28, v17
v_perm_b32 v43, v31, v30, v17
v_add_u32 v19, 41216, v16
ds_read2st64_b32 v[24:25], v19 offset0:0 offset1:5
ds_read2st64_b32 v[26:27], v19 offset0:10 offset1:15
ds_read2st64_b32 v[28:29], v19 offset0:20 offset1:25
ds_read2st64_b32 v[30:31], v19 offset0:30 offset1:35
v_accvgpr_write_b32 a248, v40
v_accvgpr_write_b32 a249, v41
v_accvgpr_write_b32 a250, v42
v_accvgpr_write_b32 a251, v43
s_waitcnt lgkmcnt(4)
v_perm_b32 v40, v33, v32, v17
v_perm_b32 v41, v35, v34, v17
v_perm_b32 v42, v37, v36, v17
v_perm_b32 v43, v39, v38, v17
ds_read2st64_b32 v[32:33], v19 offset0:80 offset1:85
ds_read2st64_b32 v[34:35], v19 offset0:90 offset1:95
ds_read2st64_b32 v[36:37], v19 offset0:100 offset1:105
ds_read2st64_b32 v[38:39], v19 offset0:110 offset1:115
v_accvgpr_write_b32 a252, v40
v_accvgpr_write_b32 a253, v41
v_accvgpr_write_b32 a254, v42
v_accvgpr_write_b32 a255, v43
s_waitcnt lgkmcnt(4)
v_perm_b32 v248, v25, v24, v17
v_perm_b32 v249, v27, v26, v17
v_perm_b32 v250, v29, v28, v17
v_perm_b32 v251, v31, v30, v17
s_waitcnt lgkmcnt(0)
v_perm_b32 v252, v33, v32, v17
v_perm_b32 v253, v35, v34, v17
v_perm_b32 v254, v37, v36, v17
v_perm_b32 v255, v39, v38, v17
s_waitcnt vmcnt(0) lgkmcnt(0)
s_barrier
s_mov_b32 s28, 0
s_mov_b32 s30, 0x80808080
v_and_b32 v12, 63, v0
v_lshlrev_b32 v12, 2, v12
sy138:
buffer_load_dword v13, v12, s[8:11], 0 offen sc1
s_waitcnt vmcnt(0)
sy141:
v_and_b32 v14, s30, v13
v_cmp_ne_u32 vcc, s30, v14
s_cbranch_vccz sy139
s_sleep 2
s_add_u32 s28, s28, 1
s_cmp_lt_u32 s28, 524288
s_cbranch_scc1 sy138
s_mov_b32 s29, 1
s_branch L_abort
sy139:
s_cmp_lg_u32 s26, 0
s_cbranch_scc1 sy140
v_mov_b32 v15, 0
v_bfe_u32 v14, v13, 0, 3
v_lshlrev_b32 v14, v14, 1
v_or_b32 v15, v15, v14
v_bfe_u32 v14, v13, 8, 3
v_lshlrev_b32 v14, v14, 1
v_or_b32 v15, v15, v14
v_bfe_u32 v14, v13, 16, 3
v_lshlrev_b32 v14, v14, 1
v_or_b32 v15, v15, v14
v_bfe_u32 v14, v13, 24, 3
v_lshlrev_b32 v14, v14, 1
v_or_b32 v15, v15, v14
s_nop 1
v_mov_b32 v14, v15 quad_perm:[1,0,3,2] row_mask:0xf bank_mask:0xf
v_or_b32 v15, v15, v14
v_cmp_ne_u32 vcc, 0xff, v15
s_cbranch_vccnz L_rank
s_mov_b32 s26, 1
sy140:
v_mov_b64 v[184:185], 0
v_mov_b64 v[186:187], 0
v_mov_b64 v[188:189], 0
s_mul_i32 s33, s25, 10752
s_add_u32 s33, s33, 65536
v_lshrrev_b32 v10, 3, v1
v_and_b32 v11, 7, v1
v_mul_u32_u24 v16, 336, v10
v_lshl_add_u32 v16, v11, 4, v16
v_add_u32 v16, s33, v16
v_mul_u32_u24 v18, 20480, v10
v_lshl_add_u32 v18, v11, 4, v18
v_lshrrev_b32 v10, 2, v1
v_and_b32 v11, 3, v1
v_mul_u32_u24 v17, 336, v10
v_lshl_add_u32 v17, v11, 4, v17
v_add_u32 v17, s33, v17
v_mul_u32_u24 v19, 20480, v10
v_lshl_add_u32 v19, v11, 4, v19
v_lshrrev_b32 v10, 4, v1
v_and_b32 v11, 15, v1
v_and_b32 v6, 31, v1
v_mul_u32_u24 v20, 336, v6
v_lshrrev_b32 v6, 5, v1
v_lshl_add_u32 v20, v6, 4, v20
v_add_u32 v20, s33, v20
v_mul_u32_u24 v21, 1280, v10
v_lshl_add_u32 v21, v11, 4, v21
v_mov_b32 v22, v21
v_mov_b32 v6, 0x40000000
s_and_b32 s33, s25, 1
s_lshl_b32 s33, s33, 3
v_add_u32 v7, s33, v10
v_cmp_gt_u32 vcc, 16, v7
s_nop 1
v_cndmask_b32 v21, v6, v21, vcc
v_add_u32 v7, 4, v7
v_cmp_gt_u32 vcc, 16, v7
s_nop 1
v_cndmask_b32 v22, v6, v22, vcc
v_lshrrev_b32 v7, 5, v1
v_and_b32 v10, 1, v10
v_lshlrev_b32 v23, 8, v7
v_lshl_add_u32 v23, v11, 4, v23
v_lshl_add_u32 v23, v10, 3, v23
v_cmp_gt_u32 vcc, 32, v1
s_nop 1
v_cndmask_b32 v24, v6, v23, vcc
s_lshr_b32 s33, s25, 1
s_mul_i32 s34, s33, 3072
s_add_u32 s34, s34, 49152
v_add_u32 v25, s34, v2
s_lshl_b32 s72, s70, 1
s_add_u32 s72, s72, s33
s_lshl_b32 s74, s71, 8
s_add_u32 s74, s74, 8192
s_lshl_b32 s75, s70, 4
s_lshl_b32 s33, s25, 2
s_add_u32 s75, s75, s33
s_add_u32 s75, s75, s74
s_mul_i32 s76, s71, 1310720
s_add_u32 s76, s76, 35651584
s_add_u32 s77, s76, 655360
s_mul_i32 s78, s70, 1280
s_mul_i32 s33, s25, 320
s_add_u32 s78, s78, s33
s_mul_i32 s79, s72, 20480
s_and_b32 s33, s25, 1
s_mul_i32 s33, s33, 10240
s_add_u32 s79, s79, s33
s_mov_b32 s101, 0x3acccccd
s_mov_b32 s84, 0x30003
s_mov_b32 s85, 0x30003
s_mov_b32 s86, 0xc000c
s_mov_b32 s87, 0xc000c
s_mov_b32 s88, 0x300030
s_mov_b32 s89, 0x300030
s_mov_b32 s90, 0xc000c0
s_mov_b32 s91, 0xc000c0
v_and_b32 v10, 16, v2
v_mov_b32 v28, 0x3f80
v_lshlrev_b32 v10, v10, v28
v_cndmask_b32 v28, 0, v10, s[84:85]
v_cndmask_b32 v29, 0, v10, s[86:87]
v_cndmask_b32 v30, 0, v10, s[88:89]
v_cndmask_b32 v31, 0, v10, s[90:91]
s_mov_b32 s84, 0x3000300
s_mov_b32 s85, 0x3000300
s_mov_b32 s86, 0xc000c00
s_mov_b32 s87, 0xc000c00
s_mov_b32 s88, 0x30003000
s_mov_b32 s89, 0x30003000
s_mov_b32 s90, 0xc000c000
s_mov_b32 s91, 0xc000c000
v_and_b32 v10, 16, v2
v_mov_b32 v32, 0x3f80
v_lshlrev_b32 v10, v10, v32
v_cndmask_b32 v32, 0, v10, s[84:85]
v_cndmask_b32 v33, 0, v10, s[86:87]
v_cndmask_b32 v34, 0, v10, s[88:89]
v_cndmask_b32 v35, 0, v10, s[90:91]
v_bfe_u32 v10, v1, 4, 1
v_lshrrev_b32 v11, 5, v1
v_lshl_add_u32 v10, v10, 1, v11
v_and_b32 v11, 15, v1
v_lshlrev_b32 v4, 4, v11
v_lshl_add_u32 v3, v10, 8, v4
v_add_u32 v4, 1024, v4
s_bfe_u32 s33, s72, 0x30001
v_and_b32 v11, 7, v1
v_xor_b32 v11, s33, v11
v_lshlrev_b32 v27, 4, v11
v_bfe_u32 v11, v1, 3, 1
v_lshl_add_u32 v27, v11, 10, v27
v_lshl_add_u32 v26, v10, 11, v27
v_add_u32 v27, 8192, v27
v_mov_b32 v10, 0x40000000
v_cmp_gt_u32 vcc, 16, v1
s_nop 1
v_cndmask_b32 v4, v10, v4, vcc
v_cndmask_b32 v27, v10, v27, vcc
s_lshr_b32 s73, s72, 3
s_mul_i32 s73, s73, 10240
s_and_b32 s33, s72, 7
s_lshl_b32 s33, s33, 7
s_add_u32 s73, s73, s33
s_mov_b32 s54, 0xaaaaa000
s_mov_b32 s55, 0xaaaaaaaa
s_mov_b32 s56, 0xaaaaaaaa
s_mov_b32 s57, 0xfffaaaaa
s_lshl_b32 s69, s27, 5
s_add_u32 s69, s69, s24
s_lshl_b32 s69, s69, 2
s_add_u32 s69, s69, s25
s_lshl_b32 s69, s69, 13
s_add_u32 s69, s69, 209715200
s_lshr_b32 s32, s25, 1
s_lshl_b32 s12, s70, 1
s_add_u32 s12, s12, s32
s_lshl_b32 s33, s32, 13
v_add_u32 v37, s33, v2
s_and_b32 s34, s25, 1
s_lshl_b32 s35, s34, 10
v_add_u32 v36, s35, v37
s_lshl_b32 s35, s34, 13
s_lshr_b32 s33, s33, 1
s_add_u32 s35, s35, s33
v_add_u32 v39, s35, v2
s_mul_i32 s33, s32, 6144
s_add_u32 s33, s33, 108544
v_add_u32 v12, s33, v2
v_lshrrev_b32 v10, 4, v1
v_and_b32 v11, 7, v1
v_lshlrev_b32 v38, 7, v10
v_lshl_add_u32 v38, v11, 4, v38
v_add_u32 v38, s33, v38
s_mov_b32 s13, s33
s_lshl_b32 s34, s34, 4
v_and_b32 v11, 15, v1
v_add_u32 v11, s34, v11
v_lshlrev_b32 v10, 2, v10
v_sub_u32 v11, v11, v10
s_mov_b32 s98, 0x3e0293ee
s_mov_b32 s99, 0x3e0293ee
s_mov_b32 s62, s71
s_mov_b32 s65, 0
s_mov_b32 s96, 0
s_lshl_b32 s97, s27, 5
s_add_u32 s97, s97, s24
s_lshl_b32 s97, s97, 2
s_add_u32 s97, s97, s25
s_lshl_b32 s97, s97, 2
s_add_u32 s97, s97, 49152
v_cmp_le_i32 s[80:81], 0, v11
v_cmp_le_i32 s[82:83], 1, v11
v_cmp_le_i32 s[84:85], 2, v11
v_cmp_le_i32 s[86:87], 3, v11
v_cmp_le_i32 s[88:89], 16, v11
v_cmp_le_i32 s[90:91], 17, v11
v_cmp_le_i32 s[92:93], 18, v11
v_cmp_le_i32 s[94:95], 19, v11
v_add_u32 v25, 71744, v25
s_lshl_b32 s33, s25, 2
s_add_u32 s33, s33, 120832
v_mov_b32 v13, s33
v_mov_b32 v15, 120832
v_bfe_u32 v10, v1, 4, 1
v_mul_u32_u24 v0, 8192, v10
v_lshrrev_b32 v10, 5, v1
v_lshl_add_u32 v0, v10, 8, v0
v_and_b32 v10, 15, v1
v_lshl_add_u32 v0, v10, 4, v0
v_mov_b32 v6, 0
ds_write_b32 v25, v6 offset:6144
v_mov_b32 v11, 1
ds_write_b32 v13, v11
ds_write_b32 v13, v11 offset:16
s_mov_b32 s66, 0
s_cmp_lt_u32 s62, 64
s_cselect_b64 s[60:61], s[54:55], s[56:57]
s_cselect_b32 s33, 0, 26
s_bfm_b64 s[34:35], s62, 0
s_and_b64 s[34:35], s[34:35], s[60:61]
s_bcnt1_i32_b64 s34, s[34:35]
s_add_u32 s33, s33, s34
s_sub_u32 s34, s62, s33
s_add_u32 s33, s33, 64
s_bitcmp1_b64 s[60:61], s62
s_cselect_b32 s14, s33, s34
s_cmp_ge_u32 s62, 128
s_cselect_b32 s14, s62, s14
s_add_u32 s32, s62, 3
s_cmp_lt_u32 s32, 64
s_cselect_b64 s[60:61], s[54:55], s[56:57]
s_cselect_b32 s33, 0, 26
s_bfm_b64 s[34:35], s32, 0
s_and_b64 s[34:35], s[34:35], s[60:61]
s_bcnt1_i32_b64 s34, s[34:35]
s_add_u32 s33, s33, s34
s_sub_u32 s34, s32, s33
s_add_u32 s33, s33, 64
s_bitcmp1_b64 s[60:61], s32
s_cselect_b32 s15, s33, s34
s_cmp_ge_u32 s32, 128
s_cselect_b32 s15, s32, s15
s_branch L_Ablock
.p2align 5
L_Atop:
ds_read_b128 v[40:43], v0 offset:49152
ds_read_b128 v[44:47], v0 offset:49664
ds_read_b128 v[48:51], v0 offset:50176
ds_read_b128 v[52:55], v0 offset:50688
s_mov_b32 s63, s14
s_mov_b32 s14, s15
s_add_u32 s62, s62, 3
s_add_u32 s65, s65, 1
s_and_b32 s30, s25, 1
s_lshl_b32 s30, s30, 1
s_add_u32 s30, s30, s19
s_cmp_eq_u32 s30, 1
s_cbranch_scc1 L_Ab1
s_cmp_eq_u32 s30, 3
s_cbranch_scc1 L_Ab3
s_cmp_eq_u32 s30, 2
s_cbranch_scc1 L_Ab2
s_waitcnt lgkmcnt(3)
v_mfma_f32_32x32x16_bf16 v[144:159], a[0:3], v[40:43], 0
ds_read_b128 v[56:59], v0 offset:51200
ds_read_b128 v[60:63], v0 offset:51712
s_waitcnt lgkmcnt(4)
v_mfma_f32_32x32x16_bf16 v[144:159], a[4:7], v[44:47], v[144:159]
ds_read_b128 v[64:67], v0 offset:52224
ds_read_b128 v[68:71], v0 offset:52736
s_waitcnt lgkmcnt(5)
v_mfma_f32_32x32x16_bf16 v[144:159], a[8:11], v[48:51], v[144:159]
ds_read_b128 v[72:75], v0 offset:53248
ds_read_b128 v[76:79], v0 offset:53760
s_waitcnt lgkmcnt(6)
v_mfma_f32_32x32x16_bf16 v[144:159], a[12:15], v[52:55], v[144:159]
ds_read_b128 v[80:83], v0 offset:54272
ds_read_b128 v[84:87], v0 offset:54784
s_waitcnt lgkmcnt(7)
v_mfma_f32_32x32x16_bf16 v[144:159], a[16:19], v[56:59], v[144:159]
ds_read_b128 v[88:91], v0 offset:55296
ds_read_b128 v[92:95], v0 offset:55808
s_waitcnt lgkmcnt(8)
v_mfma_f32_32x32x16_bf16 v[144:159], a[20:23], v[60:63], v[144:159]
ds_read_b128 v[96:99], v0 offset:56320
ds_read_b128 v[100:103], v0 offset:56832
s_waitcnt lgkmcnt(9)
v_mfma_f32_32x32x16_bf16 v[144:159], a[24:27], v[64:67], v[144:159]
s_waitcnt lgkmcnt(8)
v_mfma_f32_32x32x16_bf16 v[144:159], a[28:31], v[68:71], v[144:159]
s_add_u32 s32, s62, 3
s_cmp_lt_u32 s32, 64
s_cselect_b64 s[60:61], s[54:55], s[56:57]
s_cselect_b32 s33, 0, 26
s_bfm_b64 s[34:35], s32, 0
s_and_b64 s[34:35], s[34:35], s[60:61]
s_bcnt1_i32_b64 s34, s[34:35]
s_add_u32 s33, s33, s34
s_sub_u32 s34, s32, s33
s_add_u32 s33, s33, 64
s_bitcmp1_b64 s[60:61], s32
s_cselect_b32 s15, s33, s34
s_cmp_ge_u32 s32, 128
s_cselect_b32 s15, s32, s15
s_waitcnt lgkmcnt(7)
v_mfma_f32_32x32x16_bf16 v[144:159], a[32:35], v[72:75], v[144:159]
s_waitcnt lgkmcnt(6)
v_mfma_f32_32x32x16_bf16 v[144:159], a[36:39], v[76:79], v[144:159]
s_waitcnt lgkmcnt(5)
v_mfma_f32_32x32x16_bf16 v[144:159], a[40:43], v[80:83], v[144:159]
s_waitcnt lgkmcnt(4)
v_mfma_f32_32x32x16_bf16 v[144:159], a[44:47], v[84:87], v[144:159]
s_waitcnt lgkmcnt(3)
v_mfma_f32_32x32x16_bf16 v[144:159], a[48:51], v[88:91], v[144:159]
s_waitcnt lgkmcnt(2)
v_mfma_f32_32x32x16_bf16 v[144:159], a[52:55], v[92:95], v[144:159]
s_waitcnt lgkmcnt(1)
v_mfma_f32_32x32x16_bf16 v[144:159], a[56:59], v[96:99], v[144:159]
s_waitcnt lgkmcnt(0)
v_mfma_f32_32x32x16_bf16 v[144:159], a[60:63], v[100:103], v[144:159]
v_mfma_f32_32x32x16_bf16 v[128:143], a[64:67], v[40:43], 0
s_add_u32 s35, s78, s76
v_mfma_f32_32x32x16_bf16 v[128:143], a[68:71], v[44:47], v[128:143]
v_mfma_f32_32x32x16_bf16 v[128:143], a[72:75], v[48:51], v[128:143]
v_cvt_pk_bf16_f32 v104, v144, v145
v_cvt_pk_bf16_f32 v105, v146, v147
v_cvt_pk_bf16_f32 v106, v148, v149
v_cvt_pk_bf16_f32 v107, v150, v151
v_mfma_f32_32x32x16_bf16 v[128:143], a[76:79], v[52:55], v[128:143]
ds_write_b128 v20, v[104:107] offset:0
v_mfma_f32_32x32x16_bf16 v[128:143], a[80:83], v[56:59], v[128:143]
v_cvt_pk_bf16_f32 v108, v152, v153
v_cvt_pk_bf16_f32 v109, v154, v155
v_cvt_pk_bf16_f32 v110, v156, v157
v_cvt_pk_bf16_f32 v111, v158, v159
v_mfma_f32_32x32x16_bf16 v[128:143], a[84:87], v[60:63], v[128:143]
ds_write_b128 v20, v[108:111] offset:32
v_mfma_f32_32x32x16_bf16 v[128:143], a[88:91], v[64:67], v[128:143]
v_mfma_f32_32x32x16_bf16 v[128:143], a[92:95], v[68:71], v[128:143]
v_mfma_f32_32x32x16_bf16 v[128:143], a[96:99], v[72:75], v[128:143]
v_mfma_f32_32x32x16_bf16 v[128:143], a[100:103], v[76:79], v[128:143]
v_mfma_f32_32x32x16_bf16 v[128:143], a[104:107], v[80:83], v[128:143]
v_mfma_f32_32x32x16_bf16 v[128:143], a[108:111], v[84:87], v[128:143]
v_mfma_f32_32x32x16_bf16 v[128:143], a[112:115], v[88:91], v[128:143]
v_mfma_f32_32x32x16_bf16 v[128:143], a[116:119], v[92:95], v[128:143]
v_mfma_f32_32x32x16_bf16 v[128:143], a[120:123], v[96:99], v[128:143]
v_mfma_f32_32x32x16_bf16 v[128:143], a[124:127], v[100:103], v[128:143]
v_mfma_f32_32x32x16_bf16 v[144:159], a[128:131], v[40:43], 0
v_mfma_f32_32x32x16_bf16 v[144:159], a[132:135], v[44:47], v[144:159]
v_mfma_f32_32x32x16_bf16 v[144:159], a[136:139], v[48:51], v[144:159]
buffer_load_dword v10, v8, s[4:7], s74 offen offset:2048 sc1
v_cvt_pk_bf16_f32 v104, v128, v129
v_cvt_pk_bf16_f32 v105, v130, v131
v_cvt_pk_bf16_f32 v106, v132, v133
v_cvt_pk_bf16_f32 v107, v134, v135
v_mfma_f32_32x32x16_bf16 v[144:159], a[140:143], v[52:55], v[144:159]
ds_write_b128 v20, v[104:107] offset:64
v_mfma_f32_32x32x16_bf16 v[144:159], a[144:147], v[56:59], v[144:159]
v_cvt_pk_bf16_f32 v108, v136, v137
v_cvt_pk_bf16_f32 v109, v138, v139
v_cvt_pk_bf16_f32 v110, v140, v141
v_cvt_pk_bf16_f32 v111, v142, v143
v_mfma_f32_32x32x16_bf16 v[144:159], a[148:151], v[60:63], v[144:159]
ds_write_b128 v20, v[108:111] offset:96
v_mfma_f32_32x32x16_bf16 v[144:159], a[152:155], v[64:67], v[144:159]
v_mfma_f32_32x32x16_bf16 v[144:159], a[156:159], v[68:71], v[144:159]
v_mfma_f32_32x32x16_bf16 v[144:159], a[160:163], v[72:75], v[144:159]
v_mfma_f32_32x32x16_bf16 v[144:159], a[164:167], v[76:79], v[144:159]
v_mfma_f32_32x32x16_bf16 v[144:159], a[168:171], v[80:83], v[144:159]
v_mfma_f32_32x32x16_bf16 v[144:159], a[172:175], v[84:87], v[144:159]
v_mfma_f32_32x32x16_bf16 v[144:159], a[176:179], v[88:91], v[144:159]
v_mfma_f32_32x32x16_bf16 v[144:159], a[180:183], v[92:95], v[144:159]
v_mfma_f32_32x32x16_bf16 v[144:159], a[184:187], v[96:99], v[144:159]
v_mfma_f32_32x32x16_bf16 v[144:159], a[188:191], v[100:103], v[144:159]
v_mfma_f32_32x32x16_bf16 v[128:143], a[192:195], v[40:43], 0
v_mfma_f32_32x32x16_bf16 v[128:143], a[196:199], v[44:47], v[128:143]
v_mfma_f32_32x32x16_bf16 v[128:143], a[200:203], v[48:51], v[128:143]
v_cvt_pk_bf16_f32 v104, v144, v145
v_cvt_pk_bf16_f32 v105, v146, v147
v_cvt_pk_bf16_f32 v106, v148, v149
v_cvt_pk_bf16_f32 v107, v150, v151
ds_read_b128 v[112:115], v16 offset:0
ds_read_b128 v[116:119], v16 offset:2688
v_mfma_f32_32x32x16_bf16 v[128:143], a[204:207], v[52:55], v[128:143]
ds_write_b128 v20, v[104:107] offset:128
ds_read_b128 v[120:123], v16 offset:5376
ds_read_b128 v[124:127], v16 offset:8064
v_mfma_f32_32x32x16_bf16 v[128:143], a[208:211], v[56:59], v[128:143]
s_waitcnt vmcnt(0)
v_add_u32 v10, 1, v10
v_cmp_gt_u32 vcc, s65, v10
s_mov_b32 s28, 0
s_cbranch_vccnz sf142
sf143:
v_cvt_pk_bf16_f32 v108, v152, v153
v_cvt_pk_bf16_f32 v109, v154, v155
v_cvt_pk_bf16_f32 v110, v156, v157
v_cvt_pk_bf16_f32 v111, v158, v159
v_mfma_f32_32x32x16_bf16 v[128:143], a[212:215], v[60:63], v[128:143]
ds_write_b128 v20, v[108:111] offset:160
v_mfma_f32_32x32x16_bf16 v[128:143], a[216:219], v[64:67], v[128:143]
s_waitcnt lgkmcnt(5)
s_add_u32 s33, s35, 0
buffer_store_dwordx4 v[112:115], v18, s[4:7], s33 offen offset:0
v_mfma_f32_32x32x16_bf16 v[128:143], a[220:223], v[68:71], v[128:143]
v_mfma_f32_32x32x16_bf16 v[128:143], a[224:227], v[72:75], v[128:143]
s_waitcnt lgkmcnt(4)
s_add_u32 s33, s35, 163840
buffer_store_dwordx4 v[116:119], v18, s[4:7], s33 offen offset:0
v_mfma_f32_32x32x16_bf16 v[128:143], a[228:231], v[76:79], v[128:143]
v_mfma_f32_32x32x16_bf16 v[128:143], a[232:235], v[80:83], v[128:143]
s_waitcnt lgkmcnt(2)
s_add_u32 s33, s35, 327680
buffer_store_dwordx4 v[120:123], v18, s[4:7], s33 offen offset:0
v_mfma_f32_32x32x16_bf16 v[128:143], a[236:239], v[84:87], v[128:143]
v_mfma_f32_32x32x16_bf16 v[128:143], a[240:243], v[88:91], v[128:143]
s_waitcnt lgkmcnt(1)
s_add_u32 s33, s35, 491520
buffer_store_dwordx4 v[124:127], v18, s[4:7], s33 offen offset:0
v_mfma_f32_32x32x16_bf16 v[128:143], a[244:247], v[92:95], v[128:143]
v_mfma_f32_32x32x16_bf16 v[128:143], a[248:251], v[96:99], v[128:143]
v_mfma_f32_32x32x16_bf16 v[128:143], a[252:255], v[100:103], v[128:143]
v_mfma_f32_32x32x16_bf16 v[144:159], v[192:195], v[40:43], 0
v_mfma_f32_32x32x16_bf16 v[144:159], v[196:199], v[44:47], v[144:159]
v_mfma_f32_32x32x16_bf16 v[144:159], v[200:203], v[48:51], v[144:159]
v_cvt_pk_bf16_f32 v104, v128, v129
v_cvt_pk_bf16_f32 v105, v130, v131
v_cvt_pk_bf16_f32 v106, v132, v133
v_cvt_pk_bf16_f32 v107, v134, v135
v_mfma_f32_32x32x16_bf16 v[144:159], v[204:207], v[52:55], v[144:159]
ds_write_b128 v20, v[104:107] offset:192
v_mfma_f32_32x32x16_bf16 v[144:159], v[208:211], v[56:59], v[144:159]
v_cvt_pk_bf16_f32 v108, v136, v137
v_cvt_pk_bf16_f32 v109, v138, v139
v_cvt_pk_bf16_f32 v110, v140, v141
v_cvt_pk_bf16_f32 v111, v142, v143
v_mfma_f32_32x32x16_bf16 v[144:159], v[212:215], v[60:63], v[144:159]
ds_write_b128 v20, v[108:111] offset:224
ds_read_b128 v[112:115], v16 offset:128
ds_read_b128 v[116:119], v16 offset:2816
v_mfma_f32_32x32x16_bf16 v[144:159], v[216:219], v[64:67], v[144:159]
ds_read_b128 v[120:123], v16 offset:5504
ds_read_b128 v[124:127], v16 offset:8192
v_mfma_f32_32x32x16_bf16 v[144:159], v[220:223], v[68:71], v[144:159]
v_mfma_f32_32x32x16_bf16 v[144:159], v[224:227], v[72:75], v[144:159]
v_mfma_f32_32x32x16_bf16 v[144:159], v[228:231], v[76:79], v[144:159]
s_waitcnt lgkmcnt(3)
s_add_u32 s33, s35, 0
buffer_store_dwordx4 v[112:115], v18, s[4:7], s33 offen offset:128
v_mfma_f32_32x32x16_bf16 v[144:159], v[232:235], v[80:83], v[144:159]
s_waitcnt lgkmcnt(2)
s_add_u32 s33, s35, 163840
buffer_store_dwordx4 v[116:119], v18, s[4:7], s33 offen offset:128
v_mfma_f32_32x32x16_bf16 v[144:159], v[236:239], v[84:87], v[144:159]
s_waitcnt lgkmcnt(1)
s_add_u32 s33, s35, 327680
buffer_store_dwordx4 v[120:123], v18, s[4:7], s33 offen offset:128
v_mfma_f32_32x32x16_bf16 v[144:159], v[240:243], v[88:91], v[144:159]
s_waitcnt lgkmcnt(0)
s_add_u32 s33, s35, 491520
buffer_store_dwordx4 v[124:127], v18, s[4:7], s33 offen offset:128
v_mfma_f32_32x32x16_bf16 v[144:159], v[244:247], v[92:95], v[144:159]
v_mfma_f32_32x32x16_bf16 v[144:159], v[248:251], v[96:99], v[144:159]
v_mfma_f32_32x32x16_bf16 v[144:159], v[252:255], v[100:103], v[144:159]
s_branch L_Ajoin
L_Ab1:
s_add_u32 s52, s79, s76
s_add_u32 s53, s52, 5120
buffer_load_dwordx4 v[128:131], v21, s[4:7], s52 offen offset:0 sc1
buffer_load_dwordx4 v[104:107], v21, s[4:7], s52 offen offset:256 sc1
buffer_load_dwordx4 v[108:111], v21, s[4:7], s52 offen offset:512 sc1
buffer_load_dwordx4 v[160:163], v21, s[4:7], s52 offen offset:768 sc1
s_waitcnt lgkmcnt(3)
v_mfma_f32_32x32x16_bf16 v[144:159], a[0:3], v[40:43], 0
buffer_load_dwordx4 v[164:167], v21, s[4:7], s52 offen offset:1024 sc1
buffer_load_dwordx4 v[168:171], v22, s[4:7], s53 offen offset:0 sc1
ds_read_b128 v[56:59], v0 offset:51200
ds_read_b128 v[60:63], v0 offset:51712
s_waitcnt lgkmcnt(4)
v_mfma_f32_32x32x16_bf16 v[144:159], a[4:7], v[44:47], v[144:159]
buffer_load_dwordx4 v[112:115], v22, s[4:7], s53 offen offset:256 sc1
buffer_load_dwordx4 v[116:119], v22, s[4:7], s53 offen offset:512 sc1
ds_read_b128 v[64:67], v0 offset:52224
ds_read_b128 v[68:71], v0 offset:52736
s_waitcnt lgkmcnt(5)
v_mfma_f32_32x32x16_bf16 v[144:159], a[8:11], v[48:51], v[144:159]
buffer_load_dwordx4 v[120:123], v22, s[4:7], s53 offen offset:768 sc1
buffer_load_dwordx4 v[124:127], v22, s[4:7], s53 offen offset:1024 sc1
ds_read_b128 v[72:75], v0 offset:53248
ds_read_b128 v[76:79], v0 offset:53760
s_waitcnt lgkmcnt(6)
v_mfma_f32_32x32x16_bf16 v[144:159], a[12:15], v[52:55], v[144:159]
ds_read_b128 v[80:83], v0 offset:54272
ds_read_b128 v[84:87], v0 offset:54784
s_waitcnt lgkmcnt(7)
v_mfma_f32_32x32x16_bf16 v[144:159], a[16:19], v[56:59], v[144:159]
ds_read_b128 v[88:91], v0 offset:55296
ds_read_b128 v[92:95], v0 offset:55808
s_waitcnt lgkmcnt(8)
v_mfma_f32_32x32x16_bf16 v[144:159], a[20:23], v[60:63], v[144:159]
ds_read_b128 v[96:99], v0 offset:56320
ds_read_b128 v[100:103], v0 offset:56832
s_waitcnt lgkmcnt(9)
v_mfma_f32_32x32x16_bf16 v[144:159], a[24:27], v[64:67], v[144:159]
s_waitcnt lgkmcnt(8)
v_mfma_f32_32x32x16_bf16 v[144:159], a[28:31], v[68:71], v[144:159]
s_add_u32 s32, s62, 3
s_cmp_lt_u32 s32, 64
s_cselect_b64 s[60:61], s[54:55], s[56:57]
s_cselect_b32 s33, 0, 26
s_bfm_b64 s[34:35], s32, 0
s_and_b64 s[34:35], s[34:35], s[60:61]
s_bcnt1_i32_b64 s34, s[34:35]
s_add_u32 s33, s33, s34
s_sub_u32 s34, s32, s33
s_add_u32 s33, s33, 64
s_bitcmp1_b64 s[60:61], s32
s_cselect_b32 s15, s33, s34
s_cmp_ge_u32 s32, 128
s_cselect_b32 s15, s32, s15
s_waitcnt lgkmcnt(7)
v_mfma_f32_32x32x16_bf16 v[144:159], a[32:35], v[72:75], v[144:159]
s_waitcnt lgkmcnt(6)
v_mfma_f32_32x32x16_bf16 v[144:159], a[36:39], v[76:79], v[144:159]
s_waitcnt lgkmcnt(5)
v_mfma_f32_32x32x16_bf16 v[144:159], a[40:43], v[80:83], v[144:159]
s_waitcnt lgkmcnt(4)
v_mfma_f32_32x32x16_bf16 v[144:159], a[44:47], v[84:87], v[144:159]
s_waitcnt lgkmcnt(3)
v_mfma_f32_32x32x16_bf16 v[144:159], a[48:51], v[88:91], v[144:159]
s_waitcnt lgkmcnt(2)
v_mfma_f32_32x32x16_bf16 v[144:159], a[52:55], v[92:95], v[144:159]
s_waitcnt lgkmcnt(1)
v_mfma_f32_32x32x16_bf16 v[144:159], a[56:59], v[96:99], v[144:159]
s_waitcnt lgkmcnt(0)
v_mfma_f32_32x32x16_bf16 v[144:159], a[60:63], v[100:103], v[144:159]
s_waitcnt vmcnt(9)
v_mfma_f32_16x16x32_bf16 v[172:175], v[28:31], v[128:131], 0
v_mfma_f32_32x32x16_bf16 v[128:143], a[64:67], v[40:43], 0
s_waitcnt vmcnt(8)
v_mfma_f32_16x16x32_bf16 v[172:175], v[32:35], v[104:107], v[172:175]
s_add_u32 s35, s78, s76
v_mfma_f32_32x32x16_bf16 v[128:143], a[68:71], v[44:47], v[128:143]
s_waitcnt vmcnt(7)
v_mfma_f32_16x16x32_bf16 v[176:179], v[28:31], v[108:111], 0
s_waitcnt vmcnt(6)
v_mfma_f32_16x16x32_bf16 v[176:179], v[32:35], v[160:163], v[176:179]
v_mfma_f32_32x32x16_bf16 v[128:143], a[72:75], v[48:51], v[128:143]
s_waitcnt vmcnt(5)
v_mfma_f32_16x16x32_bf16 v[180:183], v[28:31], v[164:167], 0
s_waitcnt vmcnt(4)
v_mfma_f32_16x16x32_bf16 v[172:175], v[28:31], v[168:171], v[172:175]
v_mfma_f32_32x32x16_bf16 v[128:143], a[76:79], v[52:55], v[128:143]
s_waitcnt vmcnt(3)
v_mfma_f32_16x16x32_bf16 v[172:175], v[32:35], v[112:115], v[172:175]
s_waitcnt vmcnt(2)
v_mfma_f32_16x16x32_bf16 v[176:179], v[28:31], v[116:119], v[176:179]
v_mfma_f32_32x32x16_bf16 v[128:143], a[80:83], v[56:59], v[128:143]
s_waitcnt vmcnt(1)
v_mfma_f32_16x16x32_bf16 v[176:179], v[32:35], v[120:123], v[176:179]
s_waitcnt vmcnt(0)
v_mfma_f32_16x16x32_bf16 v[180:183], v[28:31], v[124:127], v[180:183]
v_mfma_f32_32x32x16_bf16 v[128:143], a[84:87], v[60:63], v[128:143]
v_mov_b32 v10, s100
s_cmp_eq_u32 s26, 1
s_cbranch_scc0 cs144
buffer_store_dword v10, off, s[4:7], s75 offset:2048
cs145:
v_mfma_f32_32x32x16_bf16 v[128:143], a[88:91], v[64:67], v[128:143]
v_mfma_f32_32x32x16_bf16 v[128:143], a[92:95], v[68:71], v[128:143]
v_mfma_f32_32x32x16_bf16 v[128:143], a[96:99], v[72:75], v[128:143]
ds_read_b32 v6, v25 offset:6144
v_mfma_f32_32x32x16_bf16 v[128:143], a[100:103], v[76:79], v[128:143]
v_mfma_f32_32x32x16_bf16 v[128:143], a[104:107], v[80:83], v[128:143]
v_mfma_f32_32x32x16_bf16 v[128:143], a[108:111], v[84:87], v[128:143]
s_waitcnt lgkmcnt(0)
v_cmp_ne_u32 vcc, s100, v6
s_mov_b32 s28, 0
s_cbranch_vccnz y146
y147:
v_cvt_pk_bf16_f32 v104, v144, v145
v_cvt_pk_bf16_f32 v105, v146, v147
v_cvt_pk_bf16_f32 v106, v148, v149
v_cvt_pk_bf16_f32 v107, v150, v151
v_mfma_f32_32x32x16_bf16 v[128:143], a[112:115], v[88:91], v[128:143]
ds_write_b128 v20, v[104:107] offset:0
ds_read_b128 v[160:163], v25 offset:0
ds_read_b128 v[164:167], v25 offset:1024
v_mfma_f32_32x32x16_bf16 v[128:143], a[116:119], v[92:95], v[128:143]
v_cvt_pk_bf16_f32 v108, v152, v153
v_cvt_pk_bf16_f32 v109, v154, v155
v_cvt_pk_bf16_f32 v110, v156, v157
v_cvt_pk_bf16_f32 v111, v158, v159
ds_read_b128 v[168:171], v25 offset:2048
v_mfma_f32_32x32x16_bf16 v[128:143], a[120:123], v[96:99], v[128:143]
ds_write_b128 v20, v[108:111] offset:32
v_mfma_f32_32x32x16_bf16 v[128:143], a[124:127], v[100:103], v[128:143]
v_mfma_f32_32x32x16_bf16 v[144:159], a[128:131], v[40:43], 0
v_mfma_f32_32x32x16_bf16 v[144:159], a[132:135], v[44:47], v[144:159]
s_waitcnt lgkmcnt(3)
v_add_f32 v172, v172, v160
v_add_f32 v173, v173, v161
v_add_f32 v174, v174, v162
v_add_f32 v175, v175, v163
s_waitcnt lgkmcnt(2)
v_mfma_f32_32x32x16_bf16 v[144:159], a[136:139], v[48:51], v[144:159]
buffer_load_dword v10, v8, s[4:7], s74 offen offset:2048 sc1
v_cvt_pk_bf16_f32 v104, v128, v129
v_cvt_pk_bf16_f32 v105, v130, v131
v_cvt_pk_bf16_f32 v106, v132, v133
v_cvt_pk_bf16_f32 v107, v134, v135
v_mfma_f32_32x32x16_bf16 v[144:159], a[140:143], v[52:55], v[144:159]
ds_write_b128 v20, v[104:107] offset:64
v_add_f32 v176, v176, v164
v_add_f32 v177, v177, v165
v_mfma_f32_32x32x16_bf16 v[144:159], a[144:147], v[56:59], v[144:159]
v_cvt_pk_bf16_f32 v108, v136, v137
v_cvt_pk_bf16_f32 v109, v138, v139
v_cvt_pk_bf16_f32 v110, v140, v141
v_cvt_pk_bf16_f32 v111, v142, v143
v_add_f32 v178, v178, v166
v_add_f32 v179, v179, v167
v_mfma_f32_32x32x16_bf16 v[144:159], a[148:151], v[60:63], v[144:159]
ds_write_b128 v20, v[108:111] offset:96
s_waitcnt lgkmcnt(3)
v_add_f32 v180, v180, v168
v_mfma_f32_32x32x16_bf16 v[144:159], a[152:155], v[64:67], v[144:159]
v_add_f32 v181, v181, v169
v_add_f32 v182, v182, v170
v_add_f32 v183, v183, v171
v_cvt_pk_bf16_f32 v160, v172, v173
v_cvt_pk_bf16_f32 v161, v174, v175
v_cvt_pk_bf16_f32 v162, v176, v177
v_mfma_f32_32x32x16_bf16 v[144:159], a[156:159], v[68:71], v[144:159]
v_cvt_pk_bf16_f32 v163, v178, v179
v_cvt_pk_bf16_f32 v164, v180, v181
v_cvt_pk_bf16_f32 v165, v182, v183
v_mov_b32 v166, v164
v_mov_b32 v167, v165
v_mfma_f32_32x32x16_bf16 v[144:159], a[160:163], v[72:75], v[144:159]
v_permlane16_swap_b32 v160, v162
v_permlane16_swap_b32 v161, v163
v_permlane16_swap_b32 v164, v166
v_mfma_f32_32x32x16_bf16 v[144:159], a[164:167], v[76:79], v[144:159]
v_permlane16_swap_b32 v165, v167
v_mfma_f32_32x32x16_bf16 v[144:159], a[168:171], v[80:83], v[144:159]
s_cmp_eq_u32 s26, 1
s_cbranch_scc0 ls1a
buffer_store_dwordx4 v[160:163], v3, s[4:7], s16 offen
ls1b:
v_mfma_f32_32x32x16_bf16 v[144:159], a[172:175], v[84:87], v[144:159]
s_cmp_eq_u32 s26, 1
s_cbranch_scc0 ls2a
buffer_store_dwordx4 v[164:167], v4, s[4:7], s16 offen
ls2b:
v_mfma_f32_32x32x16_bf16 v[144:159], a[176:179], v[88:91], v[144:159]
v_add_f32 v190, v172, v174
v_add_f32 v191, v173, v175
v_mul_f32 v168, v172, v172
v_mul_f32 v169, v173, v173
v_fma_f32 v168, v174, v174, v168
v_fma_f32 v169, v175, v175, v169
v_mfma_f32_32x32x16_bf16 v[144:159], a[180:183], v[92:95], v[144:159]
v_add_f32 v190, v190, v176
v_add_f32 v191, v191, v177
v_fma_f32 v168, v176, v176, v168
v_fma_f32 v169, v177, v177, v169
v_add_f32 v190, v190, v178
v_add_f32 v191, v191, v179
v_mfma_f32_32x32x16_bf16 v[144:159], a[184:187], v[96:99], v[144:159]
v_fma_f32 v168, v178, v178, v168
v_fma_f32 v169, v179, v179, v169
v_add_f32 v190, v190, v180
v_add_f32 v191, v191, v181
v_fma_f32 v168, v180, v180, v168
v_fma_f32 v169, v181, v181, v169
v_mfma_f32_32x32x16_bf16 v[144:159], a[188:191], v[100:103], v[144:159]
v_add_f32 v190, v190, v182
v_add_f32 v191, v191, v183
v_fma_f32 v168, v182, v182, v168
v_fma_f32 v169, v183, v183, v169
v_add_f32 v190, v190, v191
v_add_f32 v168, v168, v169
v_mfma_f32_32x32x16_bf16 v[128:143], a[192:195], v[40:43], 0
s_add_u32 s18, s17, s73
v_add_f32 v190, v190, v190 row_ror:8 row_mask:0xf bank_mask:0xf
v_add_f32 v168, v168, v168 row_ror:8 row_mask:0xf bank_mask:0xf
s_nop 0
v_add_f32 v190, v190, v190 row_ror:4 row_mask:0xf bank_mask:0xf
v_add_f32 v168, v168, v168 row_ror:4 row_mask:0xf bank_mask:0xf
v_mfma_f32_32x32x16_bf16 v[128:143], a[196:199], v[44:47], v[128:143]
s_nop 0
v_add_f32 v190, v190, v190 row_ror:2 row_mask:0xf bank_mask:0xf
v_add_f32 v168, v168, v168 row_ror:2 row_mask:0xf bank_mask:0xf
s_nop 0
v_add_f32 v190, v190, v190 row_ror:1 row_mask:0xf bank_mask:0xf
v_add_f32 v168, v168, v168 row_ror:1 row_mask:0xf bank_mask:0xf
v_mfma_f32_32x32x16_bf16 v[128:143], a[200:203], v[48:51], v[128:143]
v_cvt_pk_bf16_f32 v104, v144, v145
v_cvt_pk_bf16_f32 v105, v146, v147
v_cvt_pk_bf16_f32 v106, v148, v149
v_cvt_pk_bf16_f32 v107, v150, v151
ds_read_b128 v[112:115], v16 offset:0
ds_read_b128 v[116:119], v16 offset:2688
v_mfma_f32_32x32x16_bf16 v[128:143], a[204:207], v[52:55], v[128:143]
ds_write_b128 v20, v[104:107] offset:128
ds_read_b128 v[120:123], v16 offset:5376
ds_read_b128 v[124:127], v16 offset:8064
v_mfma_f32_32x32x16_bf16 v[128:143], a[208:211], v[56:59], v[128:143]
s_waitcnt vmcnt(2)
v_add_u32 v10, 1, v10
v_cmp_gt_u32 vcc, s65, v10
s_mov_b32 s28, 0
s_cbranch_vccnz sf148
sf149:
v_cvt_pk_bf16_f32 v108, v152, v153
v_cvt_pk_bf16_f32 v109, v154, v155
v_cvt_pk_bf16_f32 v110, v156, v157
v_cvt_pk_bf16_f32 v111, v158, v159
v_mfma_f32_32x32x16_bf16 v[128:143], a[212:215], v[60:63], v[128:143]
ds_write_b128 v20, v[108:111] offset:160
s_nop 0
v_mov_b32 v191, v190
v_mfma_f32_32x32x16_bf16 v[128:143], a[216:219], v[64:67], v[128:143]
s_waitcnt lgkmcnt(5)
s_add_u32 s33, s35, 0
buffer_store_dwordx4 v[112:115], v18, s[4:7], s33 offen offset:0
v_mfma_f32_32x32x16_bf16 v[128:143], a[220:223], v[68:71], v[128:143]
v_mov_b32 v169, v168
s_nop 0
v_permlane32_swap_b32 v190, v191
v_permlane32_swap_b32 v168, v169
v_mfma_f32_32x32x16_bf16 v[128:143], a[224:227], v[72:75], v[128:143]
s_waitcnt lgkmcnt(4)
s_add_u32 s33, s35, 163840
buffer_store_dwordx4 v[116:119], v18, s[4:7], s33 offen offset:0
v_mfma_f32_32x32x16_bf16 v[128:143], a[228:231], v[76:79], v[128:143]
v_add_f32 v190, v190, v191
v_add_f32 v168, v168, v169
v_mov_b32 v191, v190
v_mov_b32 v169, v168
s_nop 0
v_mfma_f32_32x32x16_bf16 v[128:143], a[232:235], v[80:83], v[128:143]
s_waitcnt lgkmcnt(2)
s_add_u32 s33, s35, 327680
buffer_store_dwordx4 v[120:123], v18, s[4:7], s33 offen offset:0
v_mfma_f32_32x32x16_bf16 v[128:143], a[236:239], v[84:87], v[128:143]
v_permlane16_swap_b32 v190, v191
v_permlane16_swap_b32 v168, v169
v_add_f32 v190, v190, v191
v_add_f32 v168, v168, v169
v_mfma_f32_32x32x16_bf16 v[128:143], a[240:243], v[88:91], v[128:143]
s_waitcnt lgkmcnt(1)
s_add_u32 s33, s35, 491520
buffer_store_dwordx4 v[124:127], v18, s[4:7], s33 offen offset:0
v_mfma_f32_32x32x16_bf16 v[128:143], a[244:247], v[92:95], v[128:143]
v_mul_f32 v190, 0xbacccccd, v190
v_mul_f32 v191, v190, v190
v_fma_f32 v168, v168, s101, -v191
v_max_f32 v168, 0, v168
v_add_f32 v168, 0x3727c5ac, v168
v_mfma_f32_32x32x16_bf16 v[128:143], a[248:251], v[96:99], v[128:143]
v_rsq_f32 v168, v168
s_nop 0
v_mul_f32 v190, v190, v168
v_fma_f32 v172, v172, v168, v190
v_fma_f32 v173, v173, v168, v190
v_mfma_f32_32x32x16_bf16 v[128:143], a[252:255], v[100:103], v[128:143]
v_cvt_pk_bf16_f32 v172, v172, v173
v_fma_f32 v174, v174, v168, v190
v_fma_f32 v175, v175, v168, v190
v_cvt_pk_bf16_f32 v173, v174, v175
v_fma_f32 v176, v176, v168, v190
v_fma_f32 v177, v177, v168, v190
v_mfma_f32_32x32x16_bf16 v[144:159], v[192:195], v[40:43], 0
v_cvt_pk_bf16_f32 v174, v176, v177
v_fma_f32 v178, v178, v168, v190
v_fma_f32 v179, v179, v168, v190
v_cvt_pk_bf16_f32 v175, v178, v179
v_fma_f32 v180, v180, v168, v190
v_fma_f32 v181, v181, v168, v190
v_mfma_f32_32x32x16_bf16 v[144:159], v[196:199], v[44:47], v[144:159]
v_cvt_pk_bf16_f32 v176, v180, v181
v_fma_f32 v182, v182, v168, v190
v_fma_f32 v183, v183, v168, v190
v_cvt_pk_bf16_f32 v177, v182, v183
v_mov_b32 v178, v176
v_mov_b32 v179, v177
v_mfma_f32_32x32x16_bf16 v[144:159], v[200:203], v[48:51], v[144:159]
v_cvt_pk_bf16_f32 v104, v128, v129
v_cvt_pk_bf16_f32 v105, v130, v131
v_cvt_pk_bf16_f32 v106, v132, v133
v_cvt_pk_bf16_f32 v107, v134, v135
v_permlane16_swap_b32 v172, v174
v_mfma_f32_32x32x16_bf16 v[144:159], v[204:207], v[52:55], v[144:159]
ds_write_b128 v20, v[104:107] offset:192
v_permlane16_swap_b32 v173, v175
v_mfma_f32_32x32x16_bf16 v[144:159], v[208:211], v[56:59], v[144:159]
v_cvt_pk_bf16_f32 v108, v136, v137
v_cvt_pk_bf16_f32 v109, v138, v139
v_cvt_pk_bf16_f32 v110, v140, v141
v_cvt_pk_bf16_f32 v111, v142, v143
v_permlane16_swap_b32 v176, v178
v_mfma_f32_32x32x16_bf16 v[144:159], v[212:215], v[60:63], v[144:159]
ds_write_b128 v20, v[108:111] offset:224
ds_read_b128 v[112:115], v16 offset:128
ds_read_b128 v[116:119], v16 offset:2816
v_mfma_f32_32x32x16_bf16 v[144:159], v[216:219], v[64:67], v[144:159]
ds_read_b128 v[120:123], v16 offset:5504
ds_read_b128 v[124:127], v16 offset:8192
v_permlane16_swap_b32 v177, v179
v_mfma_f32_32x32x16_bf16 v[144:159], v[220:223], v[68:71], v[144:159]
s_cmp_eq_u32 s26, 1
s_cbranch_scc0 ls3a
buffer_store_dwordx4 v[172:175], v26, s[4:7], s18 offen
ls3b:
v_mfma_f32_32x32x16_bf16 v[144:159], v[224:227], v[72:75], v[144:159]
s_cmp_eq_u32 s26, 1
s_cbranch_scc0 ls4a
buffer_store_dwordx4 v[176:179], v27, s[4:7], s18 offen
ls4b:
v_mfma_f32_32x32x16_bf16 v[144:159], v[228:231], v[76:79], v[144:159]
s_waitcnt lgkmcnt(3)
s_add_u32 s33, s35, 0
buffer_store_dwordx4 v[112:115], v18, s[4:7], s33 offen offset:128
v_mfma_f32_32x32x16_bf16 v[144:159], v[232:235], v[80:83], v[144:159]
s_waitcnt lgkmcnt(2)
s_add_u32 s33, s35, 163840
buffer_store_dwordx4 v[116:119], v18, s[4:7], s33 offen offset:128
v_mfma_f32_32x32x16_bf16 v[144:159], v[236:239], v[84:87], v[144:159]
s_waitcnt lgkmcnt(1)
s_add_u32 s33, s35, 327680
buffer_store_dwordx4 v[120:123], v18, s[4:7], s33 offen offset:128
v_mfma_f32_32x32x16_bf16 v[144:159], v[240:243], v[88:91], v[144:159]
s_waitcnt lgkmcnt(0)
s_add_u32 s33, s35, 491520
buffer_store_dwordx4 v[124:127], v18, s[4:7], s33 offen offset:128
v_mfma_f32_32x32x16_bf16 v[144:159], v[244:247], v[92:95], v[144:159]
v_mfma_f32_32x32x16_bf16 v[144:159], v[248:251], v[96:99], v[144:159]
v_mfma_f32_32x32x16_bf16 v[144:159], v[252:255], v[100:103], v[144:159]
s_waitcnt vmcnt(4)
v_mov_b32 v11, s100
s_cmp_eq_u32 s26, 1
s_cbranch_scc0 ls5a
buffer_store_dword v11, off, s[4:7], s97
ls5b:
s_branch L_Ajoin
L_Ab2:
s_and_b32 s30, s14, 63
v_cmp_ge_u32 vcc, s30, v9
s_lshr_b32 s30, s14, 6
s_lshl_b32 s30, 0x15151515, s30
s_and_b32 s31, vcc_lo, s30
s_cmp_eq_u32 s31, 0
s_cselect_b32 s66, 1, 0
s_cmp_ge_u32 s14, 128
s_cselect_b32 s66, 0, s66
s_cmp_eq_u32 s66, 1
s_cselect_b32 s33, 0, 0x40000000
v_or_b32 v5, s33, v2
s_waitcnt lgkmcnt(3)
v_mfma_f32_32x32x16_bf16 v[144:159], a[0:3], v[40:43], 0
s_lshl_b32 s67, s14, 18
s_lshl_b32 s68, s12, 13
s_add_u32 s67, s67, s68
s_add_u32 s67, s67, 67108864
s_and_b32 s68, s68, 8192
ds_read_b128 v[56:59], v0 offset:51200
ds_read_b128 v[60:63], v0 offset:51712
s_waitcnt lgkmcnt(4)
v_mfma_f32_32x32x16_bf16 v[144:159], a[4:7], v[44:47], v[144:159]
s_mov_b32 m0, s68
s_nop 0
buffer_load_dwordx4 v5, s[4:7], s67 offen offset:0 sc1 lds
ds_read_b128 v[64:67], v0 offset:52224
ds_read_b128 v[68:71], v0 offset:52736
s_waitcnt lgkmcnt(5)
v_mfma_f32_32x32x16_bf16 v[144:159], a[8:11], v[48:51], v[144:159]
buffer_load_dwordx4 v5, s[4:7], s67 offen offset:1024 sc1 lds
ds_read_b128 v[72:75], v0 offset:53248
ds_read_b128 v[76:79], v0 offset:53760
s_waitcnt lgkmcnt(6)
v_mfma_f32_32x32x16_bf16 v[144:159], a[12:15], v[52:55], v[144:159]
buffer_load_dwordx4 v5, s[4:7], s67 offen offset:2048 sc1 lds
ds_read_b128 v[80:83], v0 offset:54272
ds_read_b128 v[84:87], v0 offset:54784
s_waitcnt lgkmcnt(7)
v_mfma_f32_32x32x16_bf16 v[144:159], a[16:19], v[56:59], v[144:159]
ds_read_b128 v[88:91], v0 offset:55296
ds_read_b128 v[92:95], v0 offset:55808
s_waitcnt lgkmcnt(8)
v_mfma_f32_32x32x16_bf16 v[144:159], a[20:23], v[60:63], v[144:159]
buffer_load_dwordx4 v5, s[4:7], s67 offen offset:3072 sc1 lds
ds_read_b128 v[96:99], v0 offset:56320
ds_read_b128 v[100:103], v0 offset:56832
s_waitcnt lgkmcnt(9)
v_mfma_f32_32x32x16_bf16 v[144:159], a[24:27], v[64:67], v[144:159]
s_add_u32 s68, s68, 4096
s_add_u32 s67, s67, 4096
s_mov_b32 m0, s68
s_nop 0
buffer_load_dwordx4 v5, s[4:7], s67 offen offset:0 sc1 lds
s_waitcnt lgkmcnt(8)
v_mfma_f32_32x32x16_bf16 v[144:159], a[28:31], v[68:71], v[144:159]
s_add_u32 s32, s62, 3
s_cmp_lt_u32 s32, 64
s_cselect_b64 s[60:61], s[54:55], s[56:57]
s_cselect_b32 s33, 0, 26
s_bfm_b64 s[34:35], s32, 0
s_and_b64 s[34:35], s[34:35], s[60:61]
s_bcnt1_i32_b64 s34, s[34:35]
s_add_u32 s33, s33, s34
s_sub_u32 s34, s32, s33
s_add_u32 s33, s33, 64
s_bitcmp1_b64 s[60:61], s32
s_cselect_b32 s15, s33, s34
s_cmp_ge_u32 s32, 128
s_cselect_b32 s15, s32, s15
buffer_load_dwordx4 v5, s[4:7], s67 offen offset:1024 sc1 lds
s_waitcnt lgkmcnt(7)
v_mfma_f32_32x32x16_bf16 v[144:159], a[32:35], v[72:75], v[144:159]
buffer_load_dwordx4 v5, s[4:7], s67 offen offset:2048 sc1 lds
s_waitcnt lgkmcnt(6)
v_mfma_f32_32x32x16_bf16 v[144:159], a[36:39], v[76:79], v[144:159]
s_waitcnt lgkmcnt(5)
v_mfma_f32_32x32x16_bf16 v[144:159], a[40:43], v[80:83], v[144:159]
buffer_load_dwordx4 v5, s[4:7], s67 offen offset:3072 sc1 lds
s_waitcnt lgkmcnt(4)
v_mfma_f32_32x32x16_bf16 v[144:159], a[44:47], v[84:87], v[144:159]
s_add_u32 s67, s67, 67104768
s_add_u32 s68, s68, 28672
s_lshr_b32 s31, s14, 6
s_lshl_b32 s31, s31, 5
s_add_u32 s31, s31, s12
s_lshl_b32 s31, s31, 7
s_add_u32 s31, s31, 16384
v_and_b32 v14, 12, v8
buffer_load_dword v14, v14, s[4:7], s31 offen sc1
s_waitcnt lgkmcnt(3)
v_mfma_f32_32x32x16_bf16 v[144:159], a[48:51], v[88:91], v[144:159]
s_mov_b32 m0, s68
s_nop 0
buffer_load_dwordx4 v5, s[4:7], s67 offen offset:0 sc1 nt lds
s_waitcnt lgkmcnt(2)
v_mfma_f32_32x32x16_bf16 v[144:159], a[52:55], v[92:95], v[144:159]
s_and_b32 s33, s63, 63
s_lshl_b32 s33, s33, 5
s_add_u32 s33, s33, s72
s_mul_i32 s33, s33, 1280
s_cmp_lt_u32 s63, 64
s_cbranch_scc1 A_150
s_add_u32 s33, s33, 22020096
buffer_load_dwordx2 v[184:185], v23, s[4:7], s33 offen offset:0 sc1
buffer_load_dwordx2 v[186:187], v23, s[4:7], s33 offen offset:512 sc1
buffer_load_dwordx2 v[188:189], v24, s[4:7], s33 offen offset:1024 sc1
s_branch A_151
A_150:
buffer_load_dwordx2 v[184:185], v23, s[20:23], s33 offen offset:0 sc1
buffer_load_dwordx2 v[186:187], v23, s[20:23], s33 offen offset:512 sc1
buffer_load_dwordx2 v[188:189], v24, s[20:23], s33 offen offset:1024 sc1
A_151:
buffer_load_dwordx4 v5, s[4:7], s67 offen offset:1024 sc1 nt lds
s_waitcnt lgkmcnt(1)
v_mfma_f32_32x32x16_bf16 v[144:159], a[56:59], v[96:99], v[144:159]
s_waitcnt lgkmcnt(0)
v_mfma_f32_32x32x16_bf16 v[144:159], a[60:63], v[100:103], v[144:159]
buffer_load_dwordx4 v5, s[4:7], s67 offen offset:2048 sc1 nt lds
v_mfma_f32_32x32x16_bf16 v[128:143], a[64:67], v[40:43], 0
buffer_load_dwordx4 v5, s[4:7], s67 offen offset:3072 sc1 nt lds
s_add_u32 s35, s78, s76
v_mfma_f32_32x32x16_bf16 v[128:143], a[68:71], v[44:47], v[128:143]
s_add_u32 s68, s68, 4096
s_add_u32 s67, s67, 4096
s_mov_b32 m0, s68
s_nop 0
buffer_load_dwordx4 v5, s[4:7], s67 offen offset:0 sc1 nt lds
v_mfma_f32_32x32x16_bf16 v[128:143], a[72:75], v[48:51], v[128:143]
buffer_load_dwordx4 v5, s[4:7], s67 offen offset:1024 sc1 nt lds
v_cvt_pk_bf16_f32 v104, v144, v145
v_cvt_pk_bf16_f32 v105, v146, v147
v_cvt_pk_bf16_f32 v106, v148, v149
v_cvt_pk_bf16_f32 v107, v150, v151
v_mfma_f32_32x32x16_bf16 v[128:143], a[76:79], v[52:55], v[128:143]
ds_write_b128 v20, v[104:107] offset:0
v_mfma_f32_32x32x16_bf16 v[128:143], a[80:83], v[56:59], v[128:143]
buffer_load_dwordx4 v5, s[4:7], s67 offen offset:2048 sc1 nt lds
v_cvt_pk_bf16_f32 v108, v152, v153
v_cvt_pk_bf16_f32 v109, v154, v155
v_cvt_pk_bf16_f32 v110, v156, v157
v_cvt_pk_bf16_f32 v111, v158, v159
v_mfma_f32_32x32x16_bf16 v[128:143], a[84:87], v[60:63], v[128:143]
buffer_load_dwordx4 v5, s[4:7], s67 offen offset:3072 sc1 nt lds
ds_write_b128 v20, v[108:111] offset:32
v_mfma_f32_32x32x16_bf16 v[128:143], a[88:91], v[64:67], v[128:143]
s_sub_u32 s67, s67, 33558528
s_sub_u32 s68, s68, 20480
v_mfma_f32_32x32x16_bf16 v[128:143], a[92:95], v[68:71], v[128:143]
s_mov_b32 m0, s68
s_nop 0
buffer_load_dwordx4 v5, s[4:7], s67 offen offset:0 sc1 lds
v_mfma_f32_32x32x16_bf16 v[128:143], a[96:99], v[72:75], v[128:143]
v_mfma_f32_32x32x16_bf16 v[128:143], a[100:103], v[76:79], v[128:143]
buffer_load_dwordx4 v5, s[4:7], s67 offen offset:1024 sc1 lds
v_mfma_f32_32x32x16_bf16 v[128:143], a[104:107], v[80:83], v[128:143]
buffer_load_dwordx4 v5, s[4:7], s67 offen offset:2048 sc1 lds
v_mfma_f32_32x32x16_bf16 v[128:143], a[108:111], v[84:87], v[128:143]
buffer_load_dwordx4 v5, s[4:7], s67 offen offset:3072 sc1 lds
v_mfma_f32_32x32x16_bf16 v[128:143], a[112:115], v[88:91], v[128:143]
s_add_u32 s68, s68, 4096
s_add_u32 s67, s67, 4096
s_mov_b32 m0, s68
s_nop 0
buffer_load_dwordx4 v5, s[4:7], s67 offen offset:0 sc1 lds
v_mfma_f32_32x32x16_bf16 v[128:143], a[116:119], v[92:95], v[128:143]
v_mfma_f32_32x32x16_bf16 v[128:143], a[120:123], v[96:99], v[128:143]
buffer_load_dwordx4 v5, s[4:7], s67 offen offset:1024 sc1 lds
v_mfma_f32_32x32x16_bf16 v[128:143], a[124:127], v[100:103], v[128:143]
buffer_load_dwordx4 v5, s[4:7], s67 offen offset:2048 sc1 lds
v_mfma_f32_32x32x16_bf16 v[144:159], a[128:131], v[40:43], 0
buffer_load_dwordx4 v5, s[4:7], s67 offen offset:3072 sc1 lds
v_mfma_f32_32x32x16_bf16 v[144:159], a[132:135], v[44:47], v[144:159]
s_waitcnt vmcnt(19)
s_and_b32 s30, s14, 63
v_cmp_ge_u32 vcc, s30, v14
s_nop 0
s_cmp_eq_u64 vcc, 0
s_cselect_b32 s96, 1, 0
s_cmp_ge_u32 s14, 128
s_cselect_b32 s96, 0, s96
s_cmp_eq_u32 s96, 1
s_cselect_b32 s33, 0, 0x40000000
v_or_b32 v14, s33, v2
v_mfma_f32_32x32x16_bf16 v[144:159], a[136:139], v[48:51], v[144:159]
s_and_b32 s30, s66, s96
v_mov_b32 v11, s30
ds_write_b32 v13, v11
s_lshl_b32 s67, s14, 18
s_lshl_b32 s68, s12, 13
s_add_u32 s67, s67, s68
s_add_u32 s67, s67, 167772160
s_mov_b32 s68, s13
buffer_load_dword v10, v8, s[4:7], s74 offen offset:2048 sc1
v_cvt_pk_bf16_f32 v104, v128, v129
v_cvt_pk_bf16_f32 v105, v130, v131
v_cvt_pk_bf16_f32 v106, v132, v133
v_cvt_pk_bf16_f32 v107, v134, v135
v_mfma_f32_32x32x16_bf16 v[144:159], a[140:143], v[52:55], v[144:159]
s_mov_b32 m0, s68
s_nop 0
buffer_load_dwordx4 v14, s[4:7], s67 offen offset:0 sc1 nt lds
ds_write_b128 v20, v[104:107] offset:64
v_mfma_f32_32x32x16_bf16 v[144:159], a[144:147], v[56:59], v[144:159]
buffer_load_dwordx4 v14, s[4:7], s67 offen offset:1024 sc1 nt lds
v_cvt_pk_bf16_f32 v108, v136, v137
v_cvt_pk_bf16_f32 v109, v138, v139
v_cvt_pk_bf16_f32 v110, v140, v141
v_cvt_pk_bf16_f32 v111, v142, v143
v_mfma_f32_32x32x16_bf16 v[144:159], a[148:151], v[60:63], v[144:159]
buffer_load_dwordx4 v14, s[4:7], s67 offen offset:2048 sc1 nt lds
ds_write_b128 v20, v[108:111] offset:96
v_mfma_f32_32x32x16_bf16 v[144:159], a[152:155], v[64:67], v[144:159]
v_mfma_f32_32x32x16_bf16 v[144:159], a[156:159], v[68:71], v[144:159]
buffer_load_dwordx4 v14, s[4:7], s67 offen offset:3072 sc1 nt lds
v_mfma_f32_32x32x16_bf16 v[144:159], a[160:163], v[72:75], v[144:159]
s_add_u32 s68, s68, 4096
s_add_u32 s67, s67, 4096
s_mov_b32 m0, s68
s_nop 0
buffer_load_dwordx4 v14, s[4:7], s67 offen offset:0 sc1 nt lds
v_mfma_f32_32x32x16_bf16 v[144:159], a[164:167], v[76:79], v[144:159]
buffer_load_dwordx4 v14, s[4:7], s67 offen offset:1024 sc1 nt lds
v_mfma_f32_32x32x16_bf16 v[144:159], a[168:171], v[80:83], v[144:159]
s_lshl_b32 s31, s12, 11
s_add_u32 s31, s31, 786432
v_bfe_u32 v9, v1, 1, 4
v_lshlrev_b32 v9, 7, v9
v_and_or_b32 v9, v8, 4, v9
buffer_load_dword v9, v9, s[4:7], s31 offen sc1
v_mfma_f32_32x32x16_bf16 v[144:159], a[172:175], v[84:87], v[144:159]
v_mfma_f32_32x32x16_bf16 v[144:159], a[176:179], v[88:91], v[144:159]
v_mfma_f32_32x32x16_bf16 v[144:159], a[180:183], v[92:95], v[144:159]
v_mfma_f32_32x32x16_bf16 v[144:159], a[184:187], v[96:99], v[144:159]
v_mfma_f32_32x32x16_bf16 v[144:159], a[188:191], v[100:103], v[144:159]
v_mfma_f32_32x32x16_bf16 v[128:143], a[192:195], v[40:43], 0
v_mfma_f32_32x32x16_bf16 v[128:143], a[196:199], v[44:47], v[128:143]
v_mfma_f32_32x32x16_bf16 v[128:143], a[200:203], v[48:51], v[128:143]
v_cvt_pk_bf16_f32 v104, v144, v145
v_cvt_pk_bf16_f32 v105, v146, v147
v_cvt_pk_bf16_f32 v106, v148, v149
v_cvt_pk_bf16_f32 v107, v150, v151
ds_read_b128 v[112:115], v16 offset:0
ds_read_b128 v[116:119], v16 offset:2688
v_mfma_f32_32x32x16_bf16 v[128:143], a[204:207], v[52:55], v[128:143]
ds_write_b128 v20, v[104:107] offset:128
ds_read_b128 v[120:123], v16 offset:5376
ds_read_b128 v[124:127], v16 offset:8064
v_mfma_f32_32x32x16_bf16 v[128:143], a[208:211], v[56:59], v[128:143]
s_waitcnt vmcnt(7)
v_add_u32 v10, 1, v10
v_cmp_gt_u32 vcc, s65, v10
s_mov_b32 s28, 0
s_cbranch_vccnz sf152
sf153:
v_cvt_pk_bf16_f32 v108, v152, v153
v_cvt_pk_bf16_f32 v109, v154, v155
v_cvt_pk_bf16_f32 v110, v156, v157
v_cvt_pk_bf16_f32 v111, v158, v159
v_mfma_f32_32x32x16_bf16 v[128:143], a[212:215], v[60:63], v[128:143]
ds_write_b128 v20, v[108:111] offset:160
v_mfma_f32_32x32x16_bf16 v[128:143], a[216:219], v[64:67], v[128:143]
s_waitcnt lgkmcnt(5)
s_add_u32 s33, s35, 0
buffer_store_dwordx4 v[112:115], v18, s[4:7], s33 offen offset:0
v_mfma_f32_32x32x16_bf16 v[128:143], a[220:223], v[68:71], v[128:143]
v_mfma_f32_32x32x16_bf16 v[128:143], a[224:227], v[72:75], v[128:143]
s_waitcnt lgkmcnt(4)
s_add_u32 s33, s35, 163840
buffer_store_dwordx4 v[116:119], v18, s[4:7], s33 offen offset:0
v_mfma_f32_32x32x16_bf16 v[128:143], a[228:231], v[76:79], v[128:143]
v_mfma_f32_32x32x16_bf16 v[128:143], a[232:235], v[80:83], v[128:143]
s_waitcnt lgkmcnt(2)
s_add_u32 s33, s35, 327680
buffer_store_dwordx4 v[120:123], v18, s[4:7], s33 offen offset:0
v_mfma_f32_32x32x16_bf16 v[128:143], a[236:239], v[84:87], v[128:143]
v_mfma_f32_32x32x16_bf16 v[128:143], a[240:243], v[88:91], v[128:143]
s_waitcnt lgkmcnt(1)
s_add_u32 s33, s35, 491520
buffer_store_dwordx4 v[124:127], v18, s[4:7], s33 offen offset:0
v_mfma_f32_32x32x16_bf16 v[128:143], a[244:247], v[92:95], v[128:143]
v_mfma_f32_32x32x16_bf16 v[128:143], a[248:251], v[96:99], v[128:143]
v_mfma_f32_32x32x16_bf16 v[128:143], a[252:255], v[100:103], v[128:143]
v_mfma_f32_32x32x16_bf16 v[144:159], v[192:195], v[40:43], 0
v_mfma_f32_32x32x16_bf16 v[144:159], v[196:199], v[44:47], v[144:159]
v_mfma_f32_32x32x16_bf16 v[144:159], v[200:203], v[48:51], v[144:159]
v_cvt_pk_bf16_f32 v104, v128, v129
v_cvt_pk_bf16_f32 v105, v130, v131
v_cvt_pk_bf16_f32 v106, v132, v133
v_cvt_pk_bf16_f32 v107, v134, v135
v_mfma_f32_32x32x16_bf16 v[144:159], v[204:207], v[52:55], v[144:159]
ds_write_b128 v20, v[104:107] offset:192
v_mfma_f32_32x32x16_bf16 v[144:159], v[208:211], v[56:59], v[144:159]
v_cvt_pk_bf16_f32 v108, v136, v137
v_cvt_pk_bf16_f32 v109, v138, v139
v_cvt_pk_bf16_f32 v110, v140, v141
v_cvt_pk_bf16_f32 v111, v142, v143
v_mfma_f32_32x32x16_bf16 v[144:159], v[212:215], v[60:63], v[144:159]
ds_write_b128 v20, v[108:111] offset:224
ds_read_b128 v[112:115], v16 offset:128
ds_read_b128 v[116:119], v16 offset:2816
v_mfma_f32_32x32x16_bf16 v[144:159], v[216:219], v[64:67], v[144:159]
ds_read_b128 v[120:123], v16 offset:5504
ds_read_b128 v[124:127], v16 offset:8192
v_mfma_f32_32x32x16_bf16 v[144:159], v[220:223], v[68:71], v[144:159]
v_mfma_f32_32x32x16_bf16 v[144:159], v[224:227], v[72:75], v[144:159]
v_mfma_f32_32x32x16_bf16 v[144:159], v[228:231], v[76:79], v[144:159]
s_waitcnt lgkmcnt(3)
s_add_u32 s33, s35, 0
buffer_store_dwordx4 v[112:115], v18, s[4:7], s33 offen offset:128
v_mfma_f32_32x32x16_bf16 v[144:159], v[232:235], v[80:83], v[144:159]
s_waitcnt lgkmcnt(2)
s_add_u32 s33, s35, 163840
buffer_store_dwordx4 v[116:119], v18, s[4:7], s33 offen offset:128
v_mfma_f32_32x32x16_bf16 v[144:159], v[236:239], v[84:87], v[144:159]
s_waitcnt lgkmcnt(1)
s_add_u32 s33, s35, 327680
buffer_store_dwordx4 v[120:123], v18, s[4:7], s33 offen offset:128
v_mfma_f32_32x32x16_bf16 v[144:159], v[240:243], v[88:91], v[144:159]
s_waitcnt lgkmcnt(0)
s_add_u32 s33, s35, 491520
buffer_store_dwordx4 v[124:127], v18, s[4:7], s33 offen offset:128
v_mfma_f32_32x32x16_bf16 v[144:159], v[244:247], v[92:95], v[144:159]
v_mfma_f32_32x32x16_bf16 v[144:159], v[248:251], v[96:99], v[144:159]
v_mfma_f32_32x32x16_bf16 v[144:159], v[252:255], v[100:103], v[144:159]
s_waitcnt vmcnt(8)
s_branch L_Ajoin
L_Ab3:
s_add_u32 s52, s79, s76
s_add_u32 s53, s52, 5120
buffer_load_dwordx4 v[128:131], v21, s[4:7], s52 offen offset:0 sc1
buffer_load_dwordx4 v[104:107], v21, s[4:7], s52 offen offset:256 sc1
buffer_load_dwordx4 v[108:111], v21, s[4:7], s52 offen offset:512 sc1
buffer_load_dwordx4 v[160:163], v21, s[4:7], s52 offen offset:768 sc1
s_waitcnt lgkmcnt(3)
v_mfma_f32_32x32x16_bf16 v[144:159], a[0:3], v[40:43], 0
buffer_load_dwordx4 v[164:167], v21, s[4:7], s52 offen offset:1024 sc1
buffer_load_dwordx4 v[168:171], v22, s[4:7], s53 offen offset:0 sc1
ds_read_b128 v[56:59], v0 offset:51200
ds_read_b128 v[60:63], v0 offset:51712
s_waitcnt lgkmcnt(4)
v_mfma_f32_32x32x16_bf16 v[144:159], a[4:7], v[44:47], v[144:159]
buffer_load_dwordx4 v[112:115], v22, s[4:7], s53 offen offset:256 sc1
buffer_load_dwordx4 v[116:119], v22, s[4:7], s53 offen offset:512 sc1
ds_read_b128 v[64:67], v0 offset:52224
ds_read_b128 v[68:71], v0 offset:52736
s_waitcnt lgkmcnt(5)
v_mfma_f32_32x32x16_bf16 v[144:159], a[8:11], v[48:51], v[144:159]
buffer_load_dwordx4 v[120:123], v22, s[4:7], s53 offen offset:768 sc1
buffer_load_dwordx4 v[124:127], v22, s[4:7], s53 offen offset:1024 sc1
ds_read_b128 v[72:75], v0 offset:53248
ds_read_b128 v[76:79], v0 offset:53760
s_waitcnt lgkmcnt(6)
v_mfma_f32_32x32x16_bf16 v[144:159], a[12:15], v[52:55], v[144:159]
ds_read_b128 v[80:83], v0 offset:54272
ds_read_b128 v[84:87], v0 offset:54784
s_waitcnt lgkmcnt(7)
v_mfma_f32_32x32x16_bf16 v[144:159], a[16:19], v[56:59], v[144:159]
s_and_b32 s30, s14, 63
v_cmp_ge_u32 vcc, s30, v9
s_lshr_b32 s30, s14, 6
s_lshl_b32 s30, 0x15151515, s30
s_and_b32 s31, vcc_lo, s30
s_cmp_eq_u32 s31, 0
s_cselect_b32 s66, 1, 0
s_cmp_ge_u32 s14, 128
s_cselect_b32 s66, 0, s66
s_cmp_eq_u32 s66, 1
s_cselect_b32 s33, 0, 0x40000000
v_or_b32 v5, s33, v2
ds_read_b128 v[88:91], v0 offset:55296
ds_read_b128 v[92:95], v0 offset:55808
s_waitcnt lgkmcnt(8)
v_mfma_f32_32x32x16_bf16 v[144:159], a[20:23], v[60:63], v[144:159]
s_lshl_b32 s67, s14, 18
s_lshl_b32 s68, s12, 13
s_add_u32 s67, s67, s68
s_add_u32 s67, s67, 67108864
s_and_b32 s68, s68, 8192
ds_read_b128 v[96:99], v0 offset:56320
ds_read_b128 v[100:103], v0 offset:56832
s_waitcnt lgkmcnt(9)
v_mfma_f32_32x32x16_bf16 v[144:159], a[24:27], v[64:67], v[144:159]
s_mov_b32 m0, s68
s_nop 0
buffer_load_dwordx4 v5, s[4:7], s67 offen offset:0 sc1 lds
s_waitcnt lgkmcnt(8)
v_mfma_f32_32x32x16_bf16 v[144:159], a[28:31], v[68:71], v[144:159]
s_add_u32 s32, s62, 3
s_cmp_lt_u32 s32, 64
s_cselect_b64 s[60:61], s[54:55], s[56:57]
s_cselect_b32 s33, 0, 26
s_bfm_b64 s[34:35], s32, 0
s_and_b64 s[34:35], s[34:35], s[60:61]
s_bcnt1_i32_b64 s34, s[34:35]
s_add_u32 s33, s33, s34
s_sub_u32 s34, s32, s33
s_add_u32 s33, s33, 64
s_bitcmp1_b64 s[60:61], s32
s_cselect_b32 s15, s33, s34
s_cmp_ge_u32 s32, 128
s_cselect_b32 s15, s32, s15
buffer_load_dwordx4 v5, s[4:7], s67 offen offset:1024 sc1 lds
s_waitcnt lgkmcnt(7)
v_mfma_f32_32x32x16_bf16 v[144:159], a[32:35], v[72:75], v[144:159]
buffer_load_dwordx4 v5, s[4:7], s67 offen offset:2048 sc1 lds
s_waitcnt lgkmcnt(6)
v_mfma_f32_32x32x16_bf16 v[144:159], a[36:39], v[76:79], v[144:159]
v_lshlrev_b32 v172, 16, v184
v_and_b32 v173, 0xffff0000, v184
v_lshlrev_b32 v174, 16, v185
v_and_b32 v175, 0xffff0000, v185
s_waitcnt lgkmcnt(5)
v_mfma_f32_32x32x16_bf16 v[144:159], a[40:43], v[80:83], v[144:159]
v_lshlrev_b32 v176, 16, v186
v_and_b32 v177, 0xffff0000, v186
v_lshlrev_b32 v178, 16, v187
v_and_b32 v179, 0xffff0000, v187
buffer_load_dwordx4 v5, s[4:7], s67 offen offset:3072 sc1 lds
s_waitcnt lgkmcnt(4)
v_mfma_f32_32x32x16_bf16 v[144:159], a[44:47], v[84:87], v[144:159]
v_lshlrev_b32 v180, 16, v188
v_and_b32 v181, 0xffff0000, v188
v_lshlrev_b32 v182, 16, v189
v_and_b32 v183, 0xffff0000, v189
s_add_u32 s68, s68, 4096
s_add_u32 s67, s67, 4096
s_mov_b32 m0, s68
s_nop 0
buffer_load_dwordx4 v5, s[4:7], s67 offen offset:0 sc1 lds
s_waitcnt lgkmcnt(3)
v_mfma_f32_32x32x16_bf16 v[144:159], a[48:51], v[88:91], v[144:159]
buffer_load_dwordx4 v5, s[4:7], s67 offen offset:1024 sc1 lds
s_waitcnt lgkmcnt(2)
v_mfma_f32_32x32x16_bf16 v[144:159], a[52:55], v[92:95], v[144:159]
s_and_b32 s33, s63, 63
s_lshl_b32 s33, s33, 5
s_add_u32 s33, s33, s72
s_mul_i32 s33, s33, 1280
s_cmp_lt_u32 s63, 64
s_cbranch_scc1 A_154
s_add_u32 s33, s33, 22020096
buffer_load_dwordx2 v[184:185], v23, s[4:7], s33 offen offset:0 sc1
buffer_load_dwordx2 v[186:187], v23, s[4:7], s33 offen offset:512 sc1
buffer_load_dwordx2 v[188:189], v24, s[4:7], s33 offen offset:1024 sc1
s_branch A_155
A_154:
buffer_load_dwordx2 v[184:185], v23, s[20:23], s33 offen offset:0 sc1
buffer_load_dwordx2 v[186:187], v23, s[20:23], s33 offen offset:512 sc1
buffer_load_dwordx2 v[188:189], v24, s[20:23], s33 offen offset:1024 sc1
A_155:
buffer_load_dwordx4 v5, s[4:7], s67 offen offset:2048 sc1 lds
s_waitcnt lgkmcnt(1)
v_mfma_f32_32x32x16_bf16 v[144:159], a[56:59], v[96:99], v[144:159]
s_waitcnt lgkmcnt(0)
v_mfma_f32_32x32x16_bf16 v[144:159], a[60:63], v[100:103], v[144:159]
s_waitcnt vmcnt(19)
v_mfma_f32_16x16x32_bf16 v[172:175], v[28:31], v[128:131], v[172:175]
buffer_load_dwordx4 v5, s[4:7], s67 offen offset:3072 sc1 lds
v_mfma_f32_32x32x16_bf16 v[128:143], a[64:67], v[40:43], 0
s_waitcnt vmcnt(19)
v_mfma_f32_16x16x32_bf16 v[172:175], v[32:35], v[104:107], v[172:175]
s_add_u32 s67, s67, 67104768
s_add_u32 s68, s68, 28672
s_lshr_b32 s31, s14, 6
s_lshl_b32 s31, s31, 5
s_add_u32 s31, s31, s12
s_lshl_b32 s31, s31, 7
s_add_u32 s31, s31, 16384
v_and_b32 v14, 12, v8
buffer_load_dword v14, v14, s[4:7], s31 offen sc1
s_add_u32 s35, s78, s76
v_mfma_f32_32x32x16_bf16 v[128:143], a[68:71], v[44:47], v[128:143]
s_waitcnt vmcnt(19)
v_mfma_f32_16x16x32_bf16 v[176:179], v[28:31], v[108:111], v[176:179]
s_waitcnt vmcnt(18)
v_mfma_f32_16x16x32_bf16 v[176:179], v[32:35], v[160:163], v[176:179]
s_mov_b32 m0, s68
s_nop 0
buffer_load_dwordx4 v5, s[4:7], s67 offen offset:0 sc1 nt lds
v_mfma_f32_32x32x16_bf16 v[128:143], a[72:75], v[48:51], v[128:143]
s_waitcnt vmcnt(18)
v_mfma_f32_16x16x32_bf16 v[180:183], v[28:31], v[164:167], v[180:183]
s_waitcnt vmcnt(17)
v_mfma_f32_16x16x32_bf16 v[172:175], v[28:31], v[168:171], v[172:175]
buffer_load_dwordx4 v5, s[4:7], s67 offen offset:1024 sc1 nt lds
v_mfma_f32_32x32x16_bf16 v[128:143], a[76:79], v[52:55], v[128:143]
s_waitcnt vmcnt(17)
v_mfma_f32_16x16x32_bf16 v[172:175], v[32:35], v[112:115], v[172:175]
s_waitcnt vmcnt(16)
v_mfma_f32_16x16x32_bf16 v[176:179], v[28:31], v[116:119], v[176:179]
v_mfma_f32_32x32x16_bf16 v[128:143], a[80:83], v[56:59], v[128:143]
s_waitcnt vmcnt(15)
v_mfma_f32_16x16x32_bf16 v[176:179], v[32:35], v[120:123], v[176:179]
s_waitcnt vmcnt(14)
v_mfma_f32_16x16x32_bf16 v[180:183], v[28:31], v[124:127], v[180:183]
buffer_load_dwordx4 v5, s[4:7], s67 offen offset:2048 sc1 nt lds
v_mfma_f32_32x32x16_bf16 v[128:143], a[84:87], v[60:63], v[128:143]
v_mov_b32 v10, s100
s_cmp_eq_u32 s26, 1
s_cbranch_scc0 cs156
buffer_store_dword v10, off, s[4:7], s75 offset:2048
cs157:
ds_write_b128 v25, v[172:175] offset:0
buffer_load_dwordx4 v5, s[4:7], s67 offen offset:3072 sc1 nt lds
v_mfma_f32_32x32x16_bf16 v[128:143], a[88:91], v[64:67], v[128:143]
ds_write_b128 v25, v[176:179] offset:1024
s_add_u32 s68, s68, 4096
s_add_u32 s67, s67, 4096
s_mov_b32 m0, s68
s_nop 0
buffer_load_dwordx4 v5, s[4:7], s67 offen offset:0 sc1 nt lds
v_mfma_f32_32x32x16_bf16 v[128:143], a[92:95], v[68:71], v[128:143]
ds_write_b128 v25, v[180:183] offset:2048
buffer_load_dwordx4 v5, s[4:7], s67 offen offset:1024 sc1 nt lds
v_mfma_f32_32x32x16_bf16 v[128:143], a[96:99], v[72:75], v[128:143]
v_mov_b32 v6, s100
ds_write_b32 v25, v6 offset:6144
v_mfma_f32_32x32x16_bf16 v[128:143], a[100:103], v[76:79], v[128:143]
buffer_load_dwordx4 v5, s[4:7], s67 offen offset:2048 sc1 nt lds
v_mfma_f32_32x32x16_bf16 v[128:143], a[104:107], v[80:83], v[128:143]
buffer_load_dwordx4 v5, s[4:7], s67 offen offset:3072 sc1 nt lds
v_mfma_f32_32x32x16_bf16 v[128:143], a[108:111], v[84:87], v[128:143]
s_sub_u32 s67, s67, 33558528
s_sub_u32 s68, s68, 20480
v_cvt_pk_bf16_f32 v104, v144, v145
v_cvt_pk_bf16_f32 v105, v146, v147
v_cvt_pk_bf16_f32 v106, v148, v149
v_cvt_pk_bf16_f32 v107, v150, v151
v_mfma_f32_32x32x16_bf16 v[128:143], a[112:115], v[88:91], v[128:143]
s_mov_b32 m0, s68
s_nop 0
buffer_load_dwordx4 v5, s[4:7], s67 offen offset:0 sc1 lds
ds_write_b128 v20, v[104:107] offset:0
v_mfma_f32_32x32x16_bf16 v[128:143], a[116:119], v[92:95], v[128:143]
v_cvt_pk_bf16_f32 v108, v152, v153
v_cvt_pk_bf16_f32 v109, v154, v155
v_cvt_pk_bf16_f32 v110, v156, v157
v_cvt_pk_bf16_f32 v111, v158, v159
v_mfma_f32_32x32x16_bf16 v[128:143], a[120:123], v[96:99], v[128:143]
buffer_load_dwordx4 v5, s[4:7], s67 offen offset:1024 sc1 lds
ds_write_b128 v20, v[108:111] offset:32
v_mfma_f32_32x32x16_bf16 v[128:143], a[124:127], v[100:103], v[128:143]
buffer_load_dwordx4 v5, s[4:7], s67 offen offset:2048 sc1 lds
v_mfma_f32_32x32x16_bf16 v[144:159], a[128:131], v[40:43], 0
buffer_load_dwordx4 v5, s[4:7], s67 offen offset:3072 sc1 lds
v_mfma_f32_32x32x16_bf16 v[144:159], a[132:135], v[44:47], v[144:159]
s_add_u32 s68, s68, 4096
s_add_u32 s67, s67, 4096
s_mov_b32 m0, s68
s_nop 0
buffer_load_dwordx4 v5, s[4:7], s67 offen offset:0 sc1 lds
v_mfma_f32_32x32x16_bf16 v[144:159], a[136:139], v[48:51], v[144:159]
buffer_load_dword v10, v8, s[4:7], s74 offen offset:2048 sc1
v_cvt_pk_bf16_f32 v104, v128, v129
v_cvt_pk_bf16_f32 v105, v130, v131
v_cvt_pk_bf16_f32 v106, v132, v133
v_cvt_pk_bf16_f32 v107, v134, v135
v_mfma_f32_32x32x16_bf16 v[144:159], a[140:143], v[52:55], v[144:159]
buffer_load_dwordx4 v5, s[4:7], s67 offen offset:1024 sc1 lds
ds_write_b128 v20, v[104:107] offset:64
v_mfma_f32_32x32x16_bf16 v[144:159], a[144:147], v[56:59], v[144:159]
buffer_load_dwordx4 v5, s[4:7], s67 offen offset:2048 sc1 lds
v_cvt_pk_bf16_f32 v108, v136, v137
v_cvt_pk_bf16_f32 v109, v138, v139
v_cvt_pk_bf16_f32 v110, v140, v141
v_cvt_pk_bf16_f32 v111, v142, v143
v_mfma_f32_32x32x16_bf16 v[144:159], a[148:151], v[60:63], v[144:159]
buffer_load_dwordx4 v5, s[4:7], s67 offen offset:3072 sc1 lds
ds_write_b128 v20, v[108:111] offset:96
v_mfma_f32_32x32x16_bf16 v[144:159], a[152:155], v[64:67], v[144:159]
s_waitcnt vmcnt(18)
s_and_b32 s30, s14, 63
v_cmp_ge_u32 vcc, s30, v14
s_nop 0
s_cmp_eq_u64 vcc, 0
s_cselect_b32 s96, 1, 0
s_cmp_ge_u32 s14, 128
s_cselect_b32 s96, 0, s96
s_cmp_eq_u32 s96, 1
s_cselect_b32 s33, 0, 0x40000000
v_or_b32 v14, s33, v2
v_mfma_f32_32x32x16_bf16 v[144:159], a[156:159], v[68:71], v[144:159]
s_and_b32 s30, s66, s96
v_mov_b32 v11, s30
ds_write_b32 v13, v11
s_lshl_b32 s67, s14, 18
s_lshl_b32 s68, s12, 13
s_add_u32 s67, s67, s68
s_add_u32 s67, s67, 167772160
s_mov_b32 s68, s13
v_mfma_f32_32x32x16_bf16 v[144:159], a[160:163], v[72:75], v[144:159]
s_mov_b32 m0, s68
s_nop 0
buffer_load_dwordx4 v14, s[4:7], s67 offen offset:0 sc1 nt lds
v_mfma_f32_32x32x16_bf16 v[144:159], a[164:167], v[76:79], v[144:159]
buffer_load_dwordx4 v14, s[4:7], s67 offen offset:1024 sc1 nt lds
v_mfma_f32_32x32x16_bf16 v[144:159], a[168:171], v[80:83], v[144:159]
buffer_load_dwordx4 v14, s[4:7], s67 offen offset:2048 sc1 nt lds
v_mfma_f32_32x32x16_bf16 v[144:159], a[172:175], v[84:87], v[144:159]
v_mfma_f32_32x32x16_bf16 v[144:159], a[176:179], v[88:91], v[144:159]
buffer_load_dwordx4 v14, s[4:7], s67 offen offset:3072 sc1 nt lds
v_mfma_f32_32x32x16_bf16 v[144:159], a[180:183], v[92:95], v[144:159]
s_add_u32 s68, s68, 4096
s_add_u32 s67, s67, 4096
s_mov_b32 m0, s68
s_nop 0
buffer_load_dwordx4 v14, s[4:7], s67 offen offset:0 sc1 nt lds
v_mfma_f32_32x32x16_bf16 v[144:159], a[184:187], v[96:99], v[144:159]
buffer_load_dwordx4 v14, s[4:7], s67 offen offset:1024 sc1 nt lds
v_mfma_f32_32x32x16_bf16 v[144:159], a[188:191], v[100:103], v[144:159]
s_lshl_b32 s31, s12, 11
s_add_u32 s31, s31, 786432
v_bfe_u32 v9, v1, 1, 4
v_lshlrev_b32 v9, 7, v9
v_and_or_b32 v9, v8, 4, v9
buffer_load_dword v9, v9, s[4:7], s31 offen sc1
v_mfma_f32_32x32x16_bf16 v[128:143], a[192:195], v[40:43], 0
v_mfma_f32_32x32x16_bf16 v[128:143], a[196:199], v[44:47], v[128:143]
v_mfma_f32_32x32x16_bf16 v[128:143], a[200:203], v[48:51], v[128:143]
v_cvt_pk_bf16_f32 v104, v144, v145
v_cvt_pk_bf16_f32 v105, v146, v147
v_cvt_pk_bf16_f32 v106, v148, v149
v_cvt_pk_bf16_f32 v107, v150, v151
ds_read_b128 v[112:115], v16 offset:0
ds_read_b128 v[116:119], v16 offset:2688
v_mfma_f32_32x32x16_bf16 v[128:143], a[204:207], v[52:55], v[128:143]
ds_write_b128 v20, v[104:107] offset:128
ds_read_b128 v[120:123], v16 offset:5376
ds_read_b128 v[124:127], v16 offset:8064
v_mfma_f32_32x32x16_bf16 v[128:143], a[208:211], v[56:59], v[128:143]
s_waitcnt vmcnt(10)
v_add_u32 v10, 1, v10
v_cmp_gt_u32 vcc, s65, v10
s_mov_b32 s28, 0
s_cbranch_vccnz sf158
sf159:
v_cvt_pk_bf16_f32 v108, v152, v153
v_cvt_pk_bf16_f32 v109, v154, v155
v_cvt_pk_bf16_f32 v110, v156, v157
v_cvt_pk_bf16_f32 v111, v158, v159
v_mfma_f32_32x32x16_bf16 v[128:143], a[212:215], v[60:63], v[128:143]
ds_write_b128 v20, v[108:111] offset:160
v_mfma_f32_32x32x16_bf16 v[128:143], a[216:219], v[64:67], v[128:143]
s_waitcnt lgkmcnt(5)
s_add_u32 s33, s35, 0
buffer_store_dwordx4 v[112:115], v18, s[4:7], s33 offen offset:0
v_mfma_f32_32x32x16_bf16 v[128:143], a[220:223], v[68:71], v[128:143]
v_mfma_f32_32x32x16_bf16 v[128:143], a[224:227], v[72:75], v[128:143]
s_waitcnt lgkmcnt(4)
s_add_u32 s33, s35, 163840
buffer_store_dwordx4 v[116:119], v18, s[4:7], s33 offen offset:0
v_mfma_f32_32x32x16_bf16 v[128:143], a[228:231], v[76:79], v[128:143]
v_mfma_f32_32x32x16_bf16 v[128:143], a[232:235], v[80:83], v[128:143]
s_waitcnt lgkmcnt(2)
s_add_u32 s33, s35, 327680
buffer_store_dwordx4 v[120:123], v18, s[4:7], s33 offen offset:0
v_mfma_f32_32x32x16_bf16 v[128:143], a[236:239], v[84:87], v[128:143]
v_mfma_f32_32x32x16_bf16 v[128:143], a[240:243], v[88:91], v[128:143]
s_waitcnt lgkmcnt(1)
s_add_u32 s33, s35, 491520
buffer_store_dwordx4 v[124:127], v18, s[4:7], s33 offen offset:0
v_mfma_f32_32x32x16_bf16 v[128:143], a[244:247], v[92:95], v[128:143]
v_mfma_f32_32x32x16_bf16 v[128:143], a[248:251], v[96:99], v[128:143]
v_mfma_f32_32x32x16_bf16 v[128:143], a[252:255], v[100:103], v[128:143]
v_mfma_f32_32x32x16_bf16 v[144:159], v[192:195], v[40:43], 0
v_mfma_f32_32x32x16_bf16 v[144:159], v[196:199], v[44:47], v[144:159]
v_mfma_f32_32x32x16_bf16 v[144:159], v[200:203], v[48:51], v[144:159]
v_cvt_pk_bf16_f32 v104, v128, v129
v_cvt_pk_bf16_f32 v105, v130, v131
v_cvt_pk_bf16_f32 v106, v132, v133
v_cvt_pk_bf16_f32 v107, v134, v135
v_mfma_f32_32x32x16_bf16 v[144:159], v[204:207], v[52:55], v[144:159]
ds_write_b128 v20, v[104:107] offset:192
v_mfma_f32_32x32x16_bf16 v[144:159], v[208:211], v[56:59], v[144:159]
v_cvt_pk_bf16_f32 v108, v136, v137
v_cvt_pk_bf16_f32 v109, v138, v139
v_cvt_pk_bf16_f32 v110, v140, v141
v_cvt_pk_bf16_f32 v111, v142, v143
v_mfma_f32_32x32x16_bf16 v[144:159], v[212:215], v[60:63], v[144:159]
ds_write_b128 v20, v[108:111] offset:224
ds_read_b128 v[112:115], v16 offset:128
ds_read_b128 v[116:119], v16 offset:2816
v_mfma_f32_32x32x16_bf16 v[144:159], v[216:219], v[64:67], v[144:159]
ds_read_b128 v[120:123], v16 offset:5504
ds_read_b128 v[124:127], v16 offset:8192
v_mfma_f32_32x32x16_bf16 v[144:159], v[220:223], v[68:71], v[144:159]
v_mfma_f32_32x32x16_bf16 v[144:159], v[224:227], v[72:75], v[144:159]
v_mfma_f32_32x32x16_bf16 v[144:159], v[228:231], v[76:79], v[144:159]
s_waitcnt lgkmcnt(3)
s_add_u32 s33, s35, 0
buffer_store_dwordx4 v[112:115], v18, s[4:7], s33 offen offset:128
v_mfma_f32_32x32x16_bf16 v[144:159], v[232:235], v[80:83], v[144:159]
s_waitcnt lgkmcnt(2)
s_add_u32 s33, s35, 163840
buffer_store_dwordx4 v[116:119], v18, s[4:7], s33 offen offset:128
v_mfma_f32_32x32x16_bf16 v[144:159], v[236:239], v[84:87], v[144:159]
s_waitcnt lgkmcnt(1)
s_add_u32 s33, s35, 327680
buffer_store_dwordx4 v[120:123], v18, s[4:7], s33 offen offset:128
v_mfma_f32_32x32x16_bf16 v[144:159], v[240:243], v[88:91], v[144:159]
s_waitcnt lgkmcnt(0)
s_add_u32 s33, s35, 491520
buffer_store_dwordx4 v[124:127], v18, s[4:7], s33 offen offset:128
v_mfma_f32_32x32x16_bf16 v[144:159], v[244:247], v[92:95], v[144:159]
v_mfma_f32_32x32x16_bf16 v[144:159], v[248:251], v[96:99], v[144:159]
v_mfma_f32_32x32x16_bf16 v[144:159], v[252:255], v[100:103], v[144:159]
s_waitcnt vmcnt(8)
L_Ajoin:
s_barrier
ds_read_b128 v[40:43], v15
s_nop 8
v_cvt_pk_bf16_f32 v104, v144, v145
v_cvt_pk_bf16_f32 v105, v146, v147
v_cvt_pk_bf16_f32 v106, v148, v149
v_cvt_pk_bf16_f32 v107, v150, v151
ds_write_b128 v20, v[104:107] offset:256
v_cvt_pk_bf16_f32 v108, v152, v153
v_cvt_pk_bf16_f32 v109, v154, v155
v_cvt_pk_bf16_f32 v110, v156, v157
v_cvt_pk_bf16_f32 v111, v158, v159
ds_write_b128 v20, v[108:111] offset:288
ds_read_b128 v[104:107], v17 offset:256
ds_read_b128 v[108:111], v17 offset:5632
s_waitcnt lgkmcnt(4)
v_and_b32 v40, v40, v41
v_and_b32 v42, v42, v43
v_and_b32 v40, v40, v42
s_nop 0
v_readfirstlane_b32 s30, v40
s_nop 0
s_cmp_eq_u32 s30, 1
v_xor_b32 v15, 16, v15
v_xor_b32 v13, 16, v13
s_cbranch_scc0 A_160
ds_read_b128 v[40:43], v36 offset:32768
ds_read_b128 v[44:47], v36 offset:34816
ds_read_b128 v[48:51], v36 offset:36864
ds_read_b128 v[52:55], v36 offset:38912
ds_read_b128 v[72:75], v37 offset:0
ds_read_b128 v[76:79], v37 offset:1024
ds_read_b128 v[80:83], v37 offset:2048
ds_read_b128 v[84:87], v37 offset:3072
ds_read_b128 v[88:91], v37 offset:4096
ds_read_b128 v[92:95], v37 offset:5120
ds_read_b128 v[96:99], v37 offset:6144
ds_read_b128 v[100:103], v37 offset:7168
s_waitcnt lgkmcnt(13)
s_add_u32 s33, s35, 0
buffer_store_dwordx4 v[104:107], v19, s[4:7], s33 offen offset:256
s_waitcnt lgkmcnt(12)
s_add_u32 s33, s35, 327680
buffer_store_dwordx4 v[108:111], v19, s[4:7], s33 offen offset:256
s_waitcnt lgkmcnt(7)
v_mfma_f32_16x16x32_bf16 v[112:115], v[72:75], v[40:43], 0
ds_read_b128 v[56:59], v38 offset:4096
ds_read_b128 v[140:143], v37 offset:16384
s_waitcnt lgkmcnt(8)
v_mfma_f32_16x16x32_bf16 v[116:119], v[76:79], v[40:43], 0
ds_read_b128 v[60:63], v38 offset:4608
ds_read_b128 v[144:147], v37 offset:17408
s_waitcnt lgkmcnt(9)
v_mfma_f32_16x16x32_bf16 v[112:115], v[80:83], v[44:47], v[112:115]
ds_read_b128 v[64:67], v38 offset:5120
ds_read_b128 v[148:151], v37 offset:18432
s_waitcnt lgkmcnt(10)
v_mfma_f32_16x16x32_bf16 v[116:119], v[84:87], v[44:47], v[116:119]
ds_read_b128 v[68:71], v38 offset:5632
ds_read_b128 v[152:155], v37 offset:19456
s_waitcnt lgkmcnt(11)
v_mfma_f32_16x16x32_bf16 v[112:115], v[88:91], v[48:51], v[112:115]
ds_read_b128 v[156:159], v37 offset:20480
s_waitcnt lgkmcnt(11)
v_mfma_f32_16x16x32_bf16 v[116:119], v[92:95], v[48:51], v[116:119]
ds_read_b128 v[160:163], v37 offset:21504
s_waitcnt lgkmcnt(11)
v_mfma_f32_16x16x32_bf16 v[112:115], v[96:99], v[52:55], v[112:115]
ds_read_b128 v[164:167], v37 offset:22528
s_waitcnt lgkmcnt(11)
v_mfma_f32_16x16x32_bf16 v[116:119], v[100:103], v[52:55], v[116:119]
ds_read_b128 v[168:171], v37 offset:23552
s_waitcnt lgkmcnt(11)
v_mfma_f32_16x16x32_bf16 v[120:123], v[56:59], v[40:43], 0
s_waitcnt lgkmcnt(9)
v_mfma_f32_16x16x32_bf16 v[120:123], v[60:63], v[44:47], v[120:123]
s_waitcnt lgkmcnt(7)
v_mfma_f32_16x16x32_bf16 v[120:123], v[64:67], v[48:51], v[120:123]
s_waitcnt lgkmcnt(5)
v_mfma_f32_16x16x32_bf16 v[120:123], v[68:71], v[52:55], v[120:123]
v_mov_b32 v7, 0xf149f2ca
v_cndmask_b32 v112, v7, v112, s[80:81]
v_cndmask_b32 v113, v7, v113, s[82:83]
v_cndmask_b32 v114, v7, v114, s[84:85]
v_cndmask_b32 v115, v7, v115, s[86:87]
v_cndmask_b32 v116, v7, v116, s[88:89]
v_cndmask_b32 v117, v7, v117, s[90:91]
v_cndmask_b32 v118, v7, v118, s[92:93]
v_cndmask_b32 v119, v7, v119, s[94:95]
v_max3_f32 v6, v112, v113, v114
v_max3_f32 v6, v6, v115, v116
v_max3_f32 v6, v6, v117, v118
v_max_f32 v6, v6, v119
s_waitcnt vmcnt(0)
v_mov_b32 v10, s65
s_cmp_eq_u32 s26, 1
s_cbranch_scc0 pb161
buffer_store_dword v10, off, s[4:7], s75
pb162:
s_and_b32 s17, s65, 3
s_lshl_b32 s16, s27, 3
s_add_u32 s17, s17, s16
s_mov_b32 s100, s65
s_mov_b32 s45, s63
s_lshl_b32 s16, s17, 5
s_add_u32 s16, s16, s72
s_lshl_b32 s97, s16, 7
s_add_u32 s97, s97, 1572864
s_mul_i32 s16, s16, 1280
s_add_u32 s16, s16, 15728640
s_mul_i32 s17, s17, 40960
s_add_u32 s17, s17, 9437184
ds_read_b128 v[124:127], v12 offset:0
ds_read_b128 v[128:131], v12 offset:1024
ds_read_b128 v[132:135], v12 offset:2048
ds_read_b128 v[136:139], v12 offset:3072
v_max3_f32 v6, v6, v120, v121
v_max3_f32 v6, v6, v122, v123
v_mov_b32 v7, v6
s_nop 1
v_permlane32_swap_b32 v6, v7
v_max_f32 v6, v6, v7
v_mov_b32 v7, v6
s_nop 1
v_permlane16_swap_b32 v6, v7
v_max_f32 v6, v6, v7
v_mul_f32 v6, s98, v6
v_pk_fma_f32 v[112:113], v[112:113], s[98:99], v[6:7] op_sel_hi:[1,1,0] neg_lo:[0,0,1] neg_hi:[0,0,1]
v_pk_fma_f32 v[114:115], v[114:115], s[98:99], v[6:7] op_sel_hi:[1,1,0] neg_lo:[0,0,1] neg_hi:[0,0,1]
v_pk_fma_f32 v[116:117], v[116:117], s[98:99], v[6:7] op_sel_hi:[1,1,0] neg_lo:[0,0,1] neg_hi:[0,0,1]
v_pk_fma_f32 v[118:119], v[118:119], s[98:99], v[6:7] op_sel_hi:[1,1,0] neg_lo:[0,0,1] neg_hi:[0,0,1]
v_pk_fma_f32 v[120:121], v[120:121], s[98:99], v[6:7] op_sel_hi:[1,1,0] neg_lo:[0,0,1] neg_hi:[0,0,1]
v_pk_fma_f32 v[122:123], v[122:123], s[98:99], v[6:7] op_sel_hi:[1,1,0] neg_lo:[0,0,1] neg_hi:[0,0,1]
v_exp_f32 v112, v112
v_exp_f32 v113, v113
v_exp_f32 v114, v114
v_exp_f32 v115, v115
v_exp_f32 v116, v116
v_exp_f32 v117, v117
v_exp_f32 v118, v118
v_exp_f32 v119, v119
v_exp_f32 v120, v120
v_exp_f32 v121, v121
v_exp_f32 v122, v122
v_exp_f32 v123, v123
s_nop 0
v_pk_add_f32 v[190:191], v[120:121], v[122:123]
v_pk_fma_f32 v[190:191], v[190:191], 0.5, v[112:113] op_sel_hi:[1,0,1]
v_pk_add_f32 v[190:191], v[190:191], v[114:115]
v_pk_add_f32 v[190:191], v[190:191], v[116:117]
v_pk_add_f32 v[190:191], v[190:191], v[118:119]
v_add_f32 v190, v190, v191
v_mov_b32 v7, v190
s_nop 1
v_permlane32_swap_b32 v190, v7
v_add_f32 v190, v190, v7
v_mov_b32 v7, v190
s_nop 1
v_permlane16_swap_b32 v190, v7
v_add_f32 v190, v190, v7
v_rcp_f32 v190, v190
s_nop 0
v_pk_mul_f32 v[112:113], v[112:113], v[190:191] op_sel_hi:[1,0]
v_pk_mul_f32 v[114:115], v[114:115], v[190:191] op_sel_hi:[1,0]
v_pk_mul_f32 v[116:117], v[116:117], v[190:191] op_sel_hi:[1,0]
v_pk_mul_f32 v[118:119], v[118:119], v[190:191] op_sel_hi:[1,0]
v_pk_mul_f32 v[120:121], v[120:121], v[190:191] op_sel_hi:[1,0]
v_pk_mul_f32 v[122:123], v[122:123], v[190:191] op_sel_hi:[1,0]
v_cvt_pk_bf16_f32 v112, v112, v113
v_cvt_pk_bf16_f32 v113, v114, v115
v_cvt_pk_bf16_f32 v114, v116, v117
v_cvt_pk_bf16_f32 v115, v118, v119
v_cvt_pk_bf16_f32 v116, v120, v121
v_cvt_pk_bf16_f32 v117, v122, v123
buffer_load_dword v11, v8, s[4:7], s74 offen offset:2816 sc1
buffer_load_dword v10, v8, s[4:7], s74 offen sc1
s_waitcnt lgkmcnt(0)
v_mfma_f32_16x16x32_bf16 v[40:43], v[140:143], v[112:115], 0
v_mfma_f32_16x16x32_bf16 v[44:47], v[144:147], v[112:115], 0
v_mfma_f32_16x16x16_bf16 v[40:43], v[124:125], v[116:117], v[40:43]
v_mfma_f32_16x16x16_bf16 v[44:47], v[126:127], v[116:117], v[44:47]
v_mfma_f32_16x16x32_bf16 v[48:51], v[148:151], v[112:115], 0
v_mfma_f32_16x16x32_bf16 v[52:55], v[152:155], v[112:115], 0
v_mfma_f32_16x16x16_bf16 v[48:51], v[128:129], v[116:117], v[48:51]
v_mfma_f32_16x16x16_bf16 v[52:55], v[130:131], v[116:117], v[52:55]
v_mfma_f32_16x16x32_bf16 v[56:59], v[156:159], v[112:115], 0
v_mfma_f32_16x16x32_bf16 v[60:63], v[160:163], v[112:115], 0
v_mfma_f32_16x16x16_bf16 v[56:59], v[132:133], v[116:117], v[56:59]
v_mfma_f32_16x16x16_bf16 v[60:63], v[134:135], v[116:117], v[60:63]
v_cvt_pk_bf16_f32 v140, v40, v44
v_cvt_pk_bf16_f32 v141, v41, v45
v_cvt_pk_bf16_f32 v142, v42, v46
v_cvt_pk_bf16_f32 v143, v43, v47
ds_write_b128 v39, v[140:143] offset:49152
v_mfma_f32_16x16x32_bf16 v[64:67], v[164:167], v[112:115], 0
v_mfma_f32_16x16x32_bf16 v[68:71], v[168:171], v[112:115], 0
v_mfma_f32_16x16x16_bf16 v[64:67], v[136:137], v[116:117], v[64:67]
v_mfma_f32_16x16x16_bf16 v[68:71], v[138:139], v[116:117], v[68:71]
v_cvt_pk_bf16_f32 v148, v48, v52
v_cvt_pk_bf16_f32 v149, v49, v53
v_cvt_pk_bf16_f32 v150, v50, v54
v_cvt_pk_bf16_f32 v151, v51, v55
ds_write_b128 v39, v[148:151] offset:50176
v_cvt_pk_bf16_f32 v156, v56, v60
v_cvt_pk_bf16_f32 v157, v57, v61
v_cvt_pk_bf16_f32 v158, v58, v62
v_cvt_pk_bf16_f32 v159, v59, v63
ds_write_b128 v39, v[156:159] offset:51200
v_cvt_pk_bf16_f32 v164, v64, v68
v_cvt_pk_bf16_f32 v165, v65, v69
v_cvt_pk_bf16_f32 v166, v66, v70
v_cvt_pk_bf16_f32 v167, v67, v71
ds_write_b128 v39, v[164:167] offset:52224
s_waitcnt vmcnt(1)
v_add_u32 v11, 4, v11
v_cmp_gt_u32 vcc, s65, v11
s_mov_b32 s28, 0
s_cbranch_vccnz rw163
rw164:
s_waitcnt vmcnt(0)
v_cmp_gt_u32 vcc, s65, v10
s_nop 0
s_cmp_eq_u64 vcc, 0
s_cbranch_scc1 g165
s_mov_b32 s28, 0
p166:
buffer_load_dword v10, v8, s[4:7], s74 offen sc1
s_waitcnt vmcnt(0)
v_cmp_gt_u32 vcc, s65, v10
s_nop 0
s_cmp_eq_u64 vcc, 0
s_cbranch_scc1 p167
s_add_u32 s28, s28, 1
s_cmp_lt_u32 s28, 524288
s_cbranch_scc1 p166
s_mov_b32 s29, 23
s_branch L_abort
p167:
g165:
s_cmp_eq_u32 s26, 1
s_cbranch_scc0 gq168
gq169:
s_waitcnt lgkmcnt(0)
s_cmp_ge_u32 s63, 64
s_cbranch_scc1 A_170
s_add_u32 s30, s79, s76
s_add_u32 s31, s30, 5120
buffer_load_dwordx4 v[128:131], v21, s[4:7], s30 offen offset:0 sc1
buffer_load_dwordx4 v[104:107], v21, s[4:7], s30 offen offset:256 sc1
buffer_load_dwordx4 v[108:111], v21, s[4:7], s30 offen offset:512 sc1
buffer_load_dwordx4 v[160:163], v21, s[4:7], s30 offen offset:768 sc1
buffer_load_dwordx4 v[164:167], v21, s[4:7], s30 offen offset:1024 sc1
buffer_load_dwordx4 v[168:171], v22, s[4:7], s31 offen offset:0 sc1
buffer_load_dwordx4 v[112:115], v22, s[4:7], s31 offen offset:256 sc1
buffer_load_dwordx4 v[116:119], v22, s[4:7], s31 offen offset:512 sc1
buffer_load_dwordx4 v[120:123], v22, s[4:7], s31 offen offset:768 sc1
buffer_load_dwordx4 v[124:127], v22, s[4:7], s31 offen offset:1024 sc1
v_lshlrev_b32 v172, 16, v184
v_and_b32 v173, 0xffff0000, v184
v_lshlrev_b32 v174, 16, v185
v_and_b32 v175, 0xffff0000, v185
v_lshlrev_b32 v176, 16, v186
v_and_b32 v177, 0xffff0000, v186
v_lshlrev_b32 v178, 16, v187
v_and_b32 v179, 0xffff0000, v187
v_lshlrev_b32 v180, 16, v188
v_and_b32 v181, 0xffff0000, v188
v_lshlrev_b32 v182, 16, v189
v_and_b32 v183, 0xffff0000, v189
s_waitcnt vmcnt(9)
v_mfma_f32_16x16x32_bf16 v[172:175], v[28:31], v[128:131], v[172:175]
s_waitcnt vmcnt(8)
v_mfma_f32_16x16x32_bf16 v[172:175], v[32:35], v[104:107], v[172:175]
s_waitcnt vmcnt(7)
v_mfma_f32_16x16x32_bf16 v[176:179], v[28:31], v[108:111], v[176:179]
s_waitcnt vmcnt(6)
v_mfma_f32_16x16x32_bf16 v[176:179], v[32:35], v[160:163], v[176:179]
s_waitcnt vmcnt(5)
v_mfma_f32_16x16x32_bf16 v[180:183], v[28:31], v[164:167], v[180:183]
s_waitcnt vmcnt(4)
v_mfma_f32_16x16x32_bf16 v[172:175], v[28:31], v[168:171], v[172:175]
s_waitcnt vmcnt(3)
v_mfma_f32_16x16x32_bf16 v[172:175], v[32:35], v[112:115], v[172:175]
s_waitcnt vmcnt(2)
v_mfma_f32_16x16x32_bf16 v[176:179], v[28:31], v[116:119], v[176:179]
s_waitcnt vmcnt(1)
v_mfma_f32_16x16x32_bf16 v[176:179], v[32:35], v[120:123], v[176:179]
s_waitcnt vmcnt(0)
v_mfma_f32_16x16x32_bf16 v[180:183], v[28:31], v[124:127], v[180:183]
v_mov_b32 v10, s65
s_cmp_eq_u32 s26, 1
s_cbranch_scc0 cs172
buffer_store_dword v10, off, s[4:7], s75 offset:2048
cs173:
s_bitcmp1_b32 s25, 0
s_cbranch_scc0 d174
ds_write_b128 v25, v[172:175] offset:0
ds_write_b128 v25, v[176:179] offset:1024
ds_write_b128 v25, v[180:183] offset:2048
d174:
s_waitcnt lgkmcnt(0)
s_barrier
s_mov_b32 s19, 0
s_bitcmp1_b32 s25, 0
s_cbranch_scc1 L_Atop
ds_read_b128 v[160:163], v25 offset:0
ds_read_b128 v[164:167], v25 offset:1024
ds_read_b128 v[168:171], v25 offset:2048
s_waitcnt lgkmcnt(2)
v_pk_add_f32 v[172:173], v[172:173], v[160:161]
v_pk_add_f32 v[174:175], v[174:175], v[162:163]
s_waitcnt lgkmcnt(1)
v_pk_add_f32 v[176:177], v[176:177], v[164:165]
v_pk_add_f32 v[178:179], v[178:179], v[166:167]
s_waitcnt lgkmcnt(0)
v_pk_add_f32 v[180:181], v[180:181], v[168:169]
v_pk_add_f32 v[182:183], v[182:183], v[170:171]
v_cvt_pk_bf16_f32 v160, v172, v173
v_cvt_pk_bf16_f32 v161, v174, v175
v_cvt_pk_bf16_f32 v162, v176, v177
v_cvt_pk_bf16_f32 v163, v178, v179
v_cvt_pk_bf16_f32 v164, v180, v181
v_cvt_pk_bf16_f32 v165, v182, v183
v_mov_b32 v166, v164
v_mov_b32 v167, v165
v_permlane16_swap_b32 v160, v162
v_permlane16_swap_b32 v161, v163
v_permlane16_swap_b32 v164, v166
v_permlane16_swap_b32 v165, v167
s_cmp_eq_u32 s26, 1
s_cbranch_scc0 ls6a
buffer_store_dwordx4 v[160:163], v3, s[4:7], s16 offen
ls6b:
s_cmp_eq_u32 s26, 1
s_cbranch_scc0 ls7a
buffer_store_dwordx4 v[164:167], v4, s[4:7], s16 offen
ls7b:
v_pk_add_f32 v[190:191], v[172:173], v[174:175]
v_pk_mul_f32 v[168:169], v[172:173], v[172:173]
v_pk_fma_f32 v[168:169], v[174:175], v[174:175], v[168:169]
v_pk_add_f32 v[190:191], v[190:191], v[176:177]
v_pk_fma_f32 v[168:169], v[176:177], v[176:177], v[168:169]
v_pk_add_f32 v[190:191], v[190:191], v[178:179]
v_pk_fma_f32 v[168:169], v[178:179], v[178:179], v[168:169]
v_pk_add_f32 v[190:191], v[190:191], v[180:181]
v_pk_fma_f32 v[168:169], v[180:181], v[180:181], v[168:169]
v_pk_add_f32 v[190:191], v[190:191], v[182:183]
v_pk_fma_f32 v[168:169], v[182:183], v[182:183], v[168:169]
v_add_f32 v190, v190, v191
v_add_f32 v168, v168, v169
s_add_u32 s18, s17, s73
v_add_f32 v190, v190, v190 row_ror:8 row_mask:0xf bank_mask:0xf
v_add_f32 v168, v168, v168 row_ror:8 row_mask:0xf bank_mask:0xf
s_nop 0
v_add_f32 v190, v190, v190 row_ror:4 row_mask:0xf bank_mask:0xf
v_add_f32 v168, v168, v168 row_ror:4 row_mask:0xf bank_mask:0xf
s_nop 0
v_add_f32 v190, v190, v190 row_ror:2 row_mask:0xf bank_mask:0xf
v_add_f32 v168, v168, v168 row_ror:2 row_mask:0xf bank_mask:0xf
s_nop 0
v_add_f32 v190, v190, v190 row_ror:1 row_mask:0xf bank_mask:0xf
v_add_f32 v168, v168, v168 row_ror:1 row_mask:0xf bank_mask:0xf
s_nop 0
v_mov_b32 v191, v190
v_mov_b32 v169, v168
s_nop 0
v_permlane32_swap_b32 v190, v191
v_permlane32_swap_b32 v168, v169
v_add_f32 v190, v190, v191
v_add_f32 v168, v168, v169
v_mov_b32 v191, v190
v_mov_b32 v169, v168
s_nop 0
v_permlane16_swap_b32 v190, v191
v_permlane16_swap_b32 v168, v169
v_add_f32 v190, v190, v191
v_add_f32 v168, v168, v169
v_mul_f32 v190, 0xbacccccd, v190
v_mul_f32 v191, v190, v190
v_fma_f32 v168, v168, s101, -v191
v_max_f32 v168, 0, v168
v_add_f32 v168, 0x3727c5ac, v168
v_rsq_f32 v168, v168
s_nop 0
v_mul_f32 v190, v190, v168
v_pk_fma_f32 v[172:173], v[172:173], v[168:169], v[190:191] op_sel_hi:[1,0,0]
v_cvt_pk_bf16_f32 v172, v172, v173
v_pk_fma_f32 v[174:175], v[174:175], v[168:169], v[190:191] op_sel_hi:[1,0,0]
v_cvt_pk_bf16_f32 v173, v174, v175
v_pk_fma_f32 v[176:177], v[176:177], v[168:169], v[190:191] op_sel_hi:[1,0,0]
v_cvt_pk_bf16_f32 v174, v176, v177
v_pk_fma_f32 v[178:179], v[178:179], v[168:169], v[190:191] op_sel_hi:[1,0,0]
v_cvt_pk_bf16_f32 v175, v178, v179
v_pk_fma_f32 v[180:181], v[180:181], v[168:169], v[190:191] op_sel_hi:[1,0,0]
v_cvt_pk_bf16_f32 v176, v180, v181
v_pk_fma_f32 v[182:183], v[182:183], v[168:169], v[190:191] op_sel_hi:[1,0,0]
v_cvt_pk_bf16_f32 v177, v182, v183
v_mov_b32 v178, v176
v_mov_b32 v179, v177
v_permlane16_swap_b32 v172, v174
v_permlane16_swap_b32 v173, v175
v_permlane16_swap_b32 v176, v178
v_permlane16_swap_b32 v177, v179
s_cmp_eq_u32 s26, 1
s_cbranch_scc0 ls8a
buffer_store_dwordx4 v[172:175], v26, s[4:7], s18 offen
ls8b:
s_cmp_eq_u32 s26, 1
s_cbranch_scc0 ls9a
buffer_store_dwordx4 v[176:179], v27, s[4:7], s18 offen
ls9b:
s_waitcnt vmcnt(0)
v_mov_b32 v11, s100
s_cmp_eq_u32 s26, 1
s_cbranch_scc0 ls10a
buffer_store_dword v11, off, s[4:7], s97
ls10b:
s_branch L_Atop
A_170:
s_barrier
s_mov_b32 s19, 1
s_branch L_Atop
A_160:
s_waitcnt lgkmcnt(1)
s_add_u32 s33, s35, 0
buffer_store_dwordx4 v[104:107], v19, s[4:7], s33 offen offset:256
s_waitcnt lgkmcnt(0)
s_add_u32 s33, s35, 327680
buffer_store_dwordx4 v[108:111], v19, s[4:7], s33 offen offset:256
s_waitcnt vmcnt(0)
v_mov_b32 v10, s65
s_cmp_eq_u32 s26, 1
s_cbranch_scc0 pb175
buffer_store_dword v10, off, s[4:7], s75
pb176:
s_and_b32 s17, s65, 3
s_lshl_b32 s16, s27, 3
s_add_u32 s17, s17, s16
s_mov_b32 s100, s65
s_mov_b32 s45, s63
s_lshl_b32 s16, s17, 5
s_add_u32 s16, s16, s72
s_lshl_b32 s97, s16, 7
s_add_u32 s97, s97, 1572864
s_mul_i32 s16, s16, 1280
s_add_u32 s16, s16, 15728640
s_mul_i32 s17, s17, 40960
s_add_u32 s17, s17, 9437184
s_sleep 3
buffer_load_dword v11, v8, s[4:7], s74 offen offset:2816 sc1
s_mov_b32 s28, 0
p178:
buffer_load_dword v10, v8, s[4:7], s74 offen sc1
s_waitcnt vmcnt(0)
v_cmp_gt_u32 vcc, s65, v10
s_nop 0
s_cmp_eq_u64 vcc, 0
s_cbranch_scc1 p179
s_add_u32 s28, s28, 1
s_cmp_lt_u32 s28, 524288
s_cbranch_scc1 p178
s_mov_b32 s29, 25
s_branch L_abort
p179:
g177:
s_cmp_eq_u32 s26, 1
s_cbranch_scc0 gq180
gq181:
v_add_u32 v11, 4, v11
v_cmp_gt_u32 vcc, s65, v11
s_mov_b32 s28, 0
s_cbranch_vccnz rw182
rw183:
s_add_u32 s30, s79, s76
s_add_u32 s31, s30, 5120
buffer_load_dwordx4 v[128:131], v21, s[4:7], s30 offen offset:0 sc1
buffer_load_dwordx4 v[104:107], v21, s[4:7], s30 offen offset:256 sc1
buffer_load_dwordx4 v[108:111], v21, s[4:7], s30 offen offset:512 sc1
buffer_load_dwordx4 v[160:163], v21, s[4:7], s30 offen offset:768 sc1
buffer_load_dwordx4 v[164:167], v21, s[4:7], s30 offen offset:1024 sc1
buffer_load_dwordx4 v[168:171], v22, s[4:7], s31 offen offset:0 sc1
buffer_load_dwordx4 v[112:115], v22, s[4:7], s31 offen offset:256 sc1
buffer_load_dwordx4 v[116:119], v22, s[4:7], s31 offen offset:512 sc1
buffer_load_dwordx4 v[120:123], v22, s[4:7], s31 offen offset:768 sc1
buffer_load_dwordx4 v[124:127], v22, s[4:7], s31 offen offset:1024 sc1
v_lshlrev_b32 v172, 16, v184
v_and_b32 v173, 0xffff0000, v184
v_lshlrev_b32 v174, 16, v185
v_and_b32 v175, 0xffff0000, v185
v_lshlrev_b32 v176, 16, v186
v_and_b32 v177, 0xffff0000, v186
v_lshlrev_b32 v178, 16, v187
v_and_b32 v179, 0xffff0000, v187
v_lshlrev_b32 v180, 16, v188
v_and_b32 v181, 0xffff0000, v188
v_lshlrev_b32 v182, 16, v189
v_and_b32 v183, 0xffff0000, v189
s_waitcnt vmcnt(9)
v_mfma_f32_16x16x32_bf16 v[172:175], v[28:31], v[128:131], v[172:175]
s_waitcnt vmcnt(8)
v_mfma_f32_16x16x32_bf16 v[172:175], v[32:35], v[104:107], v[172:175]
s_waitcnt vmcnt(7)
v_mfma_f32_16x16x32_bf16 v[176:179], v[28:31], v[108:111], v[176:179]
s_waitcnt vmcnt(6)
v_mfma_f32_16x16x32_bf16 v[176:179], v[32:35], v[160:163], v[176:179]
s_waitcnt vmcnt(5)
v_mfma_f32_16x16x32_bf16 v[180:183], v[28:31], v[164:167], v[180:183]
s_waitcnt vmcnt(4)
v_mfma_f32_16x16x32_bf16 v[172:175], v[28:31], v[168:171], v[172:175]
s_waitcnt vmcnt(3)
v_mfma_f32_16x16x32_bf16 v[172:175], v[32:35], v[112:115], v[172:175]
s_waitcnt vmcnt(2)
v_mfma_f32_16x16x32_bf16 v[176:179], v[28:31], v[116:119], v[176:179]
s_waitcnt vmcnt(1)
v_mfma_f32_16x16x32_bf16 v[176:179], v[32:35], v[120:123], v[176:179]
s_waitcnt vmcnt(0)
v_mfma_f32_16x16x32_bf16 v[180:183], v[28:31], v[124:127], v[180:183]
v_mov_b32 v10, s65
s_cmp_eq_u32 s26, 1
s_cbranch_scc0 cs184
buffer_store_dword v10, off, s[4:7], s75 offset:2048
cs185:
s_bitcmp1_b32 s25, 0
s_cbranch_scc0 d186
ds_write_b128 v25, v[172:175] offset:0
ds_write_b128 v25, v[176:179] offset:1024
ds_write_b128 v25, v[180:183] offset:2048
d186:
s_waitcnt lgkmcnt(0)
s_barrier
s_bitcmp1_b32 s25, 0
s_cbranch_scc1 A_187
ds_read_b128 v[160:163], v25 offset:0
ds_read_b128 v[164:167], v25 offset:1024
ds_read_b128 v[168:171], v25 offset:2048
s_waitcnt lgkmcnt(2)
v_pk_add_f32 v[172:173], v[172:173], v[160:161]
v_pk_add_f32 v[174:175], v[174:175], v[162:163]
s_waitcnt lgkmcnt(1)
v_pk_add_f32 v[176:177], v[176:177], v[164:165]
v_pk_add_f32 v[178:179], v[178:179], v[166:167]
s_waitcnt lgkmcnt(0)
v_pk_add_f32 v[180:181], v[180:181], v[168:169]
v_pk_add_f32 v[182:183], v[182:183], v[170:171]
v_cvt_pk_bf16_f32 v160, v172, v173
v_cvt_pk_bf16_f32 v161, v174, v175
v_cvt_pk_bf16_f32 v162, v176, v177
v_cvt_pk_bf16_f32 v163, v178, v179
v_cvt_pk_bf16_f32 v164, v180, v181
v_cvt_pk_bf16_f32 v165, v182, v183
v_mov_b32 v166, v164
v_mov_b32 v167, v165
v_permlane16_swap_b32 v160, v162
v_permlane16_swap_b32 v161, v163
v_permlane16_swap_b32 v164, v166
v_permlane16_swap_b32 v165, v167
s_cmp_eq_u32 s26, 1
s_cbranch_scc0 ls11a
buffer_store_dwordx4 v[160:163], v3, s[4:7], s16 offen
ls11b:
s_cmp_eq_u32 s26, 1
s_cbranch_scc0 ls12a
buffer_store_dwordx4 v[164:167], v4, s[4:7], s16 offen
ls12b:
v_pk_add_f32 v[190:191], v[172:173], v[174:175]
v_pk_mul_f32 v[168:169], v[172:173], v[172:173]
v_pk_fma_f32 v[168:169], v[174:175], v[174:175], v[168:169]
v_pk_add_f32 v[190:191], v[190:191], v[176:177]
v_pk_fma_f32 v[168:169], v[176:177], v[176:177], v[168:169]
v_pk_add_f32 v[190:191], v[190:191], v[178:179]
v_pk_fma_f32 v[168:169], v[178:179], v[178:179], v[168:169]
v_pk_add_f32 v[190:191], v[190:191], v[180:181]
v_pk_fma_f32 v[168:169], v[180:181], v[180:181], v[168:169]
v_pk_add_f32 v[190:191], v[190:191], v[182:183]
v_pk_fma_f32 v[168:169], v[182:183], v[182:183], v[168:169]
v_add_f32 v190, v190, v191
v_add_f32 v168, v168, v169
s_add_u32 s18, s17, s73
v_add_f32 v190, v190, v190 row_ror:8 row_mask:0xf bank_mask:0xf
v_add_f32 v168, v168, v168 row_ror:8 row_mask:0xf bank_mask:0xf
s_nop 0
v_add_f32 v190, v190, v190 row_ror:4 row_mask:0xf bank_mask:0xf
v_add_f32 v168, v168, v168 row_ror:4 row_mask:0xf bank_mask:0xf
s_nop 0
v_add_f32 v190, v190, v190 row_ror:2 row_mask:0xf bank_mask:0xf
v_add_f32 v168, v168, v168 row_ror:2 row_mask:0xf bank_mask:0xf
s_nop 0
v_add_f32 v190, v190, v190 row_ror:1 row_mask:0xf bank_mask:0xf
v_add_f32 v168, v168, v168 row_ror:1 row_mask:0xf bank_mask:0xf
s_nop 0
v_mov_b32 v191, v190
v_mov_b32 v169, v168
s_nop 0
v_permlane32_swap_b32 v190, v191
v_permlane32_swap_b32 v168, v169
v_add_f32 v190, v190, v191
v_add_f32 v168, v168, v169
v_mov_b32 v191, v190
v_mov_b32 v169, v168
s_nop 0
v_permlane16_swap_b32 v190, v191
v_permlane16_swap_b32 v168, v169
v_add_f32 v190, v190, v191
v_add_f32 v168, v168, v169
v_mul_f32 v190, 0xbacccccd, v190
v_mul_f32 v191, v190, v190
v_fma_f32 v168, v168, s101, -v191
v_max_f32 v168, 0, v168
v_add_f32 v168, 0x3727c5ac, v168
v_rsq_f32 v168, v168
s_nop 0
v_mul_f32 v190, v190, v168
v_pk_fma_f32 v[172:173], v[172:173], v[168:169], v[190:191] op_sel_hi:[1,0,0]
v_cvt_pk_bf16_f32 v172, v172, v173
v_pk_fma_f32 v[174:175], v[174:175], v[168:169], v[190:191] op_sel_hi:[1,0,0]
v_cvt_pk_bf16_f32 v173, v174, v175
v_pk_fma_f32 v[176:177], v[176:177], v[168:169], v[190:191] op_sel_hi:[1,0,0]
v_cvt_pk_bf16_f32 v174, v176, v177
v_pk_fma_f32 v[178:179], v[178:179], v[168:169], v[190:191] op_sel_hi:[1,0,0]
v_cvt_pk_bf16_f32 v175, v178, v179
v_pk_fma_f32 v[180:181], v[180:181], v[168:169], v[190:191] op_sel_hi:[1,0,0]
v_cvt_pk_bf16_f32 v176, v180, v181
v_pk_fma_f32 v[182:183], v[182:183], v[168:169], v[190:191] op_sel_hi:[1,0,0]
v_cvt_pk_bf16_f32 v177, v182, v183
v_mov_b32 v178, v176
v_mov_b32 v179, v177
v_permlane16_swap_b32 v172, v174
v_permlane16_swap_b32 v173, v175
v_permlane16_swap_b32 v176, v178
v_permlane16_swap_b32 v177, v179
s_cmp_eq_u32 s26, 1
s_cbranch_scc0 ls13a
buffer_store_dwordx4 v[172:175], v26, s[4:7], s18 offen
ls13b:
s_cmp_eq_u32 s26, 1
s_cbranch_scc0 ls14a
buffer_store_dwordx4 v[176:179], v27, s[4:7], s18 offen
ls14b:
s_waitcnt vmcnt(0)
v_mov_b32 v11, s100
s_cmp_eq_u32 s26, 1
s_cbranch_scc0 ls15a
buffer_store_dword v11, off, s[4:7], s97
ls15b:
A_187:
s_cmp_ge_u32 s14, 128
s_cbranch_scc1 L_wb
L_Ablock:
s_bitcmp1_b32 s25, 0
s_cbranch_scc0 A_188
s_cmp_eq_u32 s66, 1
s_cbranch_scc1 A_189
s_mov_b32 s28, 0
p191:
s_lshl_b32 s31, s12, 11
s_add_u32 s31, s31, 786432
v_bfe_u32 v9, v1, 1, 4
v_lshlrev_b32 v9, 7, v9
v_and_or_b32 v9, v8, 4, v9
buffer_load_dword v9, v9, s[4:7], s31 offen sc1
s_waitcnt vmcnt(0)
s_and_b32 s30, s14, 63
v_cmp_ge_u32 vcc, s30, v9
s_lshr_b32 s30, s14, 6
s_lshl_b32 s30, 0x15151515, s30
s_and_b32 s31, vcc_lo, s30
s_cmp_eq_u32 s31, 0
s_cbranch_scc1 p192
s_sleep 1
s_add_u32 s28, s28, 1
s_cmp_lt_u32 s28, 524288
s_cbranch_scc1 p191
s_mov_b32 s29, 26
s_branch L_abort
p192:
s_lshl_b32 s67, s14, 18
s_lshl_b32 s68, s12, 13
s_add_u32 s67, s67, s68
s_add_u32 s67, s67, 67108864
s_and_b32 s68, s68, 8192
s_mov_b32 m0, s68
s_nop 0
buffer_load_dwordx4 v2, s[4:7], s67 offen offset:0 sc1 lds
buffer_load_dwordx4 v2, s[4:7], s67 offen offset:1024 sc1 lds
buffer_load_dwordx4 v2, s[4:7], s67 offen offset:2048 sc1 lds
buffer_load_dwordx4 v2, s[4:7], s67 offen offset:3072 sc1 lds
s_add_u32 s68, s68, 4096
s_add_u32 s67, s67, 4096
s_mov_b32 m0, s68
s_nop 0
buffer_load_dwordx4 v2, s[4:7], s67 offen offset:0 sc1 lds
buffer_load_dwordx4 v2, s[4:7], s67 offen offset:1024 sc1 lds
buffer_load_dwordx4 v2, s[4:7], s67 offen offset:2048 sc1 lds
buffer_load_dwordx4 v2, s[4:7], s67 offen offset:3072 sc1 lds
s_add_u32 s67, s67, 67104768
s_add_u32 s68, s68, 28672
s_mov_b32 m0, s68
s_nop 0
buffer_load_dwordx4 v2, s[4:7], s67 offen offset:0 sc1 nt lds
buffer_load_dwordx4 v2, s[4:7], s67 offen offset:1024 sc1 nt lds
buffer_load_dwordx4 v2, s[4:7], s67 offen offset:2048 sc1 nt lds
buffer_load_dwordx4 v2, s[4:7], s67 offen offset:3072 sc1 nt lds
s_add_u32 s68, s68, 4096
s_add_u32 s67, s67, 4096
s_mov_b32 m0, s68
s_nop 0
buffer_load_dwordx4 v2, s[4:7], s67 offen offset:0 sc1 nt lds
buffer_load_dwordx4 v2, s[4:7], s67 offen offset:1024 sc1 nt lds
buffer_load_dwordx4 v2, s[4:7], s67 offen offset:2048 sc1 nt lds
buffer_load_dwordx4 v2, s[4:7], s67 offen offset:3072 sc1 nt lds
s_sub_u32 s67, s67, 33558528
s_sub_u32 s68, s68, 20480
s_mov_b32 m0, s68
s_nop 0
buffer_load_dwordx4 v2, s[4:7], s67 offen offset:0 sc1 lds
buffer_load_dwordx4 v2, s[4:7], s67 offen offset:1024 sc1 lds
buffer_load_dwordx4 v2, s[4:7], s67 offen offset:2048 sc1 lds
buffer_load_dwordx4 v2, s[4:7], s67 offen offset:3072 sc1 lds
s_add_u32 s68, s68, 4096
s_add_u32 s67, s67, 4096
s_mov_b32 m0, s68
s_nop 0
buffer_load_dwordx4 v2, s[4:7], s67 offen offset:0 sc1 lds
buffer_load_dwordx4 v2, s[4:7], s67 offen offset:1024 sc1 lds
buffer_load_dwordx4 v2, s[4:7], s67 offen offset:2048 sc1 lds
buffer_load_dwordx4 v2, s[4:7], s67 offen offset:3072 sc1 lds
s_waitcnt vmcnt(0)
A_189:
s_cmp_eq_u32 s96, 1
s_cbranch_scc1 A_190
s_lshr_b32 s31, s14, 6
s_lshl_b32 s31, s31, 5
s_add_u32 s31, s31, s12
s_lshl_b32 s31, s31, 7
s_add_u32 s31, s31, 16384
v_and_b32 v14, 12, v8
buffer_load_dword v14, v14, s[4:7], s31 offen sc1
s_waitcnt vmcnt(0)
s_and_b32 s30, s14, 63
v_cmp_ge_u32 vcc, s30, v14
s_nop 0
s_cmp_eq_u64 vcc, 0
s_cbranch_scc0 A_190
s_mov_b32 s96, 1
s_lshl_b32 s67, s14, 18
s_lshl_b32 s68, s12, 13
s_add_u32 s67, s67, s68
s_add_u32 s67, s67, 167772160
s_mov_b32 s68, s13
s_mov_b32 m0, s68
s_nop 0
buffer_load_dwordx4 v2, s[4:7], s67 offen offset:0 sc1 nt lds
buffer_load_dwordx4 v2, s[4:7], s67 offen offset:1024 sc1 nt lds
buffer_load_dwordx4 v2, s[4:7], s67 offen offset:2048 sc1 nt lds
buffer_load_dwordx4 v2, s[4:7], s67 offen offset:3072 sc1 nt lds
s_add_u32 s68, s68, 4096
s_add_u32 s67, s67, 4096
s_mov_b32 m0, s68
s_nop 0
buffer_load_dwordx4 v2, s[4:7], s67 offen offset:0 sc1 nt lds
buffer_load_dwordx4 v2, s[4:7], s67 offen offset:1024 sc1 nt lds
A_190:
A_188:
s_barrier
ds_read_b128 v[40:43], v36 offset:32768
ds_read_b128 v[44:47], v36 offset:34816
ds_read_b128 v[48:51], v36 offset:36864
ds_read_b128 v[52:55], v36 offset:38912
ds_read_b128 v[72:75], v37 offset:0
ds_read_b128 v[76:79], v37 offset:1024
ds_read_b128 v[80:83], v37 offset:2048
ds_read_b128 v[84:87], v37 offset:3072
ds_read_b128 v[88:91], v37 offset:4096
ds_read_b128 v[92:95], v37 offset:5120
ds_read_b128 v[96:99], v37 offset:6144
ds_read_b128 v[100:103], v37 offset:7168
s_waitcnt lgkmcnt(7)
v_mfma_f32_16x16x32_bf16 v[112:115], v[72:75], v[40:43], 0
ds_read_b128 v[140:143], v37 offset:16384
s_waitcnt lgkmcnt(7)
v_mfma_f32_16x16x32_bf16 v[116:119], v[76:79], v[40:43], 0
ds_read_b128 v[144:147], v37 offset:17408
s_waitcnt lgkmcnt(7)
v_mfma_f32_16x16x32_bf16 v[112:115], v[80:83], v[44:47], v[112:115]
ds_read_b128 v[148:151], v37 offset:18432
s_waitcnt lgkmcnt(7)
v_mfma_f32_16x16x32_bf16 v[116:119], v[84:87], v[44:47], v[116:119]
ds_read_b128 v[152:155], v37 offset:19456
s_waitcnt lgkmcnt(7)
v_mfma_f32_16x16x32_bf16 v[112:115], v[88:91], v[48:51], v[112:115]
ds_read_b128 v[156:159], v37 offset:20480
s_waitcnt lgkmcnt(7)
v_mfma_f32_16x16x32_bf16 v[116:119], v[92:95], v[48:51], v[116:119]
ds_read_b128 v[160:163], v37 offset:21504
s_waitcnt lgkmcnt(7)
v_mfma_f32_16x16x32_bf16 v[112:115], v[96:99], v[52:55], v[112:115]
ds_read_b128 v[164:167], v37 offset:22528
s_waitcnt lgkmcnt(7)
v_mfma_f32_16x16x32_bf16 v[116:119], v[100:103], v[52:55], v[116:119]
ds_read_b128 v[168:171], v37 offset:23552
v_mov_b32 v7, 0xf149f2ca
s_nop 2
v_cndmask_b32 v112, v7, v112, s[80:81]
v_cndmask_b32 v113, v7, v113, s[82:83]
v_cndmask_b32 v114, v7, v114, s[84:85]
v_cndmask_b32 v115, v7, v115, s[86:87]
v_cndmask_b32 v116, v7, v116, s[88:89]
v_cndmask_b32 v117, v7, v117, s[90:91]
v_cndmask_b32 v118, v7, v118, s[92:93]
v_cndmask_b32 v119, v7, v119, s[94:95]
v_max3_f32 v6, v112, v113, v114
v_max3_f32 v6, v6, v115, v116
v_max3_f32 v6, v6, v117, v118
v_max_f32 v6, v6, v119
s_bitcmp1_b32 s25, 0
s_cbranch_scc0 A_193
s_cmp_eq_u32 s96, 1
s_cbranch_scc1 A_194
s_mov_b32 s28, 0
p195:
s_lshr_b32 s31, s14, 6
s_lshl_b32 s31, s31, 5
s_add_u32 s31, s31, s12
s_lshl_b32 s31, s31, 7
s_add_u32 s31, s31, 16384
v_and_b32 v14, 12, v8
buffer_load_dword v14, v14, s[4:7], s31 offen sc1
s_waitcnt vmcnt(0)
s_and_b32 s30, s14, 63
v_cmp_ge_u32 vcc, s30, v14
s_nop 0
s_cmp_eq_u64 vcc, 0
s_cbranch_scc1 p196
s_sleep 1
s_add_u32 s28, s28, 1
s_cmp_lt_u32 s28, 524288
s_cbranch_scc1 p195
s_mov_b32 s29, 27
s_branch L_abort
p196:
s_lshl_b32 s67, s14, 18
s_lshl_b32 s68, s12, 13
s_add_u32 s67, s67, s68
s_add_u32 s67, s67, 167772160
s_mov_b32 s68, s13
s_mov_b32 m0, s68
s_nop 0
buffer_load_dwordx4 v2, s[4:7], s67 offen offset:0 sc1 nt lds
buffer_load_dwordx4 v2, s[4:7], s67 offen offset:1024 sc1 nt lds
buffer_load_dwordx4 v2, s[4:7], s67 offen offset:2048 sc1 nt lds
buffer_load_dwordx4 v2, s[4:7], s67 offen offset:3072 sc1 nt lds
s_add_u32 s68, s68, 4096
s_add_u32 s67, s67, 4096
s_mov_b32 m0, s68
s_nop 0
buffer_load_dwordx4 v2, s[4:7], s67 offen offset:0 sc1 nt lds
buffer_load_dwordx4 v2, s[4:7], s67 offen offset:1024 sc1 nt lds
A_194:
s_waitcnt vmcnt(0)
A_193:
s_barrier
ds_read_b128 v[56:59], v38 offset:4096
ds_read_b128 v[60:63], v38 offset:4608
ds_read_b128 v[64:67], v38 offset:5120
ds_read_b128 v[68:71], v38 offset:5632
ds_read_b128 v[124:127], v12 offset:0
ds_read_b128 v[128:131], v12 offset:1024
ds_read_b128 v[132:135], v12 offset:2048
ds_read_b128 v[136:139], v12 offset:3072
s_bitcmp1_b32 s25, 0
s_cbranch_scc0 A_197
s_lshl_b32 s31, s12, 11
s_add_u32 s31, s31, 786432
v_bfe_u32 v9, v1, 1, 4
v_lshlrev_b32 v9, 7, v9
v_and_or_b32 v9, v8, 4, v9
buffer_load_dword v9, v9, s[4:7], s31 offen sc1
A_197:
s_waitcnt lgkmcnt(7)
v_mfma_f32_16x16x32_bf16 v[120:123], v[56:59], v[40:43], 0
s_waitcnt lgkmcnt(6)
v_mfma_f32_16x16x32_bf16 v[120:123], v[60:63], v[44:47], v[120:123]
s_waitcnt lgkmcnt(5)
v_mfma_f32_16x16x32_bf16 v[120:123], v[64:67], v[48:51], v[120:123]
s_waitcnt lgkmcnt(4)
v_mfma_f32_16x16x32_bf16 v[120:123], v[68:71], v[52:55], v[120:123]
s_nop 7
v_max3_f32 v6, v6, v120, v121
v_max3_f32 v6, v6, v122, v123
v_mov_b32 v7, v6
s_nop 1
v_permlane32_swap_b32 v6, v7
v_max_f32 v6, v6, v7
v_mov_b32 v7, v6
s_nop 1
v_permlane16_swap_b32 v6, v7
v_max_f32 v6, v6, v7
v_mul_f32 v6, s98, v6
v_pk_fma_f32 v[112:113], v[112:113], s[98:99], v[6:7] op_sel_hi:[1,1,0] neg_lo:[0,0,1] neg_hi:[0,0,1]
v_pk_fma_f32 v[114:115], v[114:115], s[98:99], v[6:7] op_sel_hi:[1,1,0] neg_lo:[0,0,1] neg_hi:[0,0,1]
v_pk_fma_f32 v[116:117], v[116:117], s[98:99], v[6:7] op_sel_hi:[1,1,0] neg_lo:[0,0,1] neg_hi:[0,0,1]
v_pk_fma_f32 v[118:119], v[118:119], s[98:99], v[6:7] op_sel_hi:[1,1,0] neg_lo:[0,0,1] neg_hi:[0,0,1]
v_pk_fma_f32 v[120:121], v[120:121], s[98:99], v[6:7] op_sel_hi:[1,1,0] neg_lo:[0,0,1] neg_hi:[0,0,1]
v_pk_fma_f32 v[122:123], v[122:123], s[98:99], v[6:7] op_sel_hi:[1,1,0] neg_lo:[0,0,1] neg_hi:[0,0,1]
v_exp_f32 v112, v112
v_exp_f32 v113, v113
v_exp_f32 v114, v114
v_exp_f32 v115, v115
v_exp_f32 v116, v116
v_exp_f32 v117, v117
v_exp_f32 v118, v118
v_exp_f32 v119, v119
v_exp_f32 v120, v120
v_exp_f32 v121, v121
v_exp_f32 v122, v122
v_exp_f32 v123, v123
s_nop 0
v_pk_add_f32 v[190:191], v[120:121], v[122:123]
v_pk_fma_f32 v[190:191], v[190:191], 0.5, v[112:113] op_sel_hi:[1,0,1]
v_pk_add_f32 v[190:191], v[190:191], v[114:115]
v_pk_add_f32 v[190:191], v[190:191], v[116:117]
v_pk_add_f32 v[190:191], v[190:191], v[118:119]
v_add_f32 v190, v190, v191
v_mov_b32 v7, v190
s_nop 1
v_permlane32_swap_b32 v190, v7
v_add_f32 v190, v190, v7
v_mov_b32 v7, v190
s_nop 1
v_permlane16_swap_b32 v190, v7
v_add_f32 v190, v190, v7
v_rcp_f32 v190, v190
s_nop 0
v_pk_mul_f32 v[112:113], v[112:113], v[190:191] op_sel_hi:[1,0]
v_pk_mul_f32 v[114:115], v[114:115], v[190:191] op_sel_hi:[1,0]
v_pk_mul_f32 v[116:117], v[116:117], v[190:191] op_sel_hi:[1,0]
v_pk_mul_f32 v[118:119], v[118:119], v[190:191] op_sel_hi:[1,0]
v_pk_mul_f32 v[120:121], v[120:121], v[190:191] op_sel_hi:[1,0]
v_pk_mul_f32 v[122:123], v[122:123], v[190:191] op_sel_hi:[1,0]
v_cvt_pk_bf16_f32 v112, v112, v113
v_cvt_pk_bf16_f32 v113, v114, v115
v_cvt_pk_bf16_f32 v114, v116, v117
v_cvt_pk_bf16_f32 v115, v118, v119
v_cvt_pk_bf16_f32 v116, v120, v121
v_cvt_pk_bf16_f32 v117, v122, v123
s_waitcnt vmcnt(0) lgkmcnt(0)
v_mfma_f32_16x16x32_bf16 v[40:43], v[140:143], v[112:115], 0
v_mfma_f32_16x16x32_bf16 v[44:47], v[144:147], v[112:115], 0
v_mfma_f32_16x16x16_bf16 v[40:43], v[124:125], v[116:117], v[40:43]
v_mfma_f32_16x16x16_bf16 v[44:47], v[126:127], v[116:117], v[44:47]
v_mfma_f32_16x16x32_bf16 v[48:51], v[148:151], v[112:115], 0
v_mfma_f32_16x16x32_bf16 v[52:55], v[152:155], v[112:115], 0
v_mfma_f32_16x16x16_bf16 v[48:51], v[128:129], v[116:117], v[48:51]
v_mfma_f32_16x16x16_bf16 v[52:55], v[130:131], v[116:117], v[52:55]
v_mfma_f32_16x16x32_bf16 v[56:59], v[156:159], v[112:115], 0
v_mfma_f32_16x16x32_bf16 v[60:63], v[160:163], v[112:115], 0
v_mfma_f32_16x16x16_bf16 v[56:59], v[132:133], v[116:117], v[56:59]
v_mfma_f32_16x16x16_bf16 v[60:63], v[134:135], v[116:117], v[60:63]
v_cvt_pk_bf16_f32 v140, v40, v44
v_cvt_pk_bf16_f32 v141, v41, v45
v_cvt_pk_bf16_f32 v142, v42, v46
v_cvt_pk_bf16_f32 v143, v43, v47
ds_write_b128 v39, v[140:143] offset:49152
v_mfma_f32_16x16x32_bf16 v[64:67], v[164:167], v[112:115], 0
v_mfma_f32_16x16x32_bf16 v[68:71], v[168:171], v[112:115], 0
v_mfma_f32_16x16x16_bf16 v[64:67], v[136:137], v[116:117], v[64:67]
v_mfma_f32_16x16x16_bf16 v[68:71], v[138:139], v[116:117], v[68:71]
v_cvt_pk_bf16_f32 v148, v48, v52
v_cvt_pk_bf16_f32 v149, v49, v53
v_cvt_pk_bf16_f32 v150, v50, v54
v_cvt_pk_bf16_f32 v151, v51, v55
ds_write_b128 v39, v[148:151] offset:50176
v_cvt_pk_bf16_f32 v156, v56, v60
v_cvt_pk_bf16_f32 v157, v57, v61
v_cvt_pk_bf16_f32 v158, v58, v62
v_cvt_pk_bf16_f32 v159, v59, v63
ds_write_b128 v39, v[156:159] offset:51200
v_cvt_pk_bf16_f32 v164, v64, v68
v_cvt_pk_bf16_f32 v165, v65, v69
v_cvt_pk_bf16_f32 v166, v66, v70
v_cvt_pk_bf16_f32 v167, v67, v71
ds_write_b128 v39, v[164:167] offset:52224
s_waitcnt lgkmcnt(0)
s_barrier
s_mov_b32 s19, 0
s_branch L_Atop
sf142:
buffer_load_dword v10, v8, s[4:7], s74 offen offset:2048 sc1
s_waitcnt vmcnt(0)
v_add_u32 v10, 1, v10
v_cmp_gt_u32 vcc, s65, v10
s_cbranch_vccz sf143
s_add_u32 s28, s28, 1
s_cmp_lt_u32 s28, 524288
s_cbranch_scc1 sf142
s_mov_b32 s29, 27
s_branch L_abort
ls1a:
buffer_store_dwordx4 v[160:163], v3, s[4:7], s16 offen sc1
s_branch ls1b
ls2a:
buffer_store_dwordx4 v[164:167], v4, s[4:7], s16 offen sc1
s_branch ls2b
ls3a:
buffer_store_dwordx4 v[172:175], v26, s[4:7], s18 offen sc1
s_branch ls3b
ls4a:
buffer_store_dwordx4 v[176:179], v27, s[4:7], s18 offen sc1
s_branch ls4b
cs144:
buffer_store_dword v10, off, s[4:7], s75 offset:2048 sc1
s_branch cs145
y146:
ds_read_b32 v6, v25 offset:6144
s_waitcnt lgkmcnt(0)
v_cmp_ne_u32 vcc, s100, v6
s_cbranch_vccz y147
s_add_u32 s28, s28, 1
s_cmp_lt_u32 s28, 4194304
s_cbranch_scc1 y146
s_mov_b32 s29, 29
s_branch L_abort
sf148:
buffer_load_dword v10, v8, s[4:7], s74 offen offset:2048 sc1
s_waitcnt vmcnt(0)
v_add_u32 v10, 1, v10
v_cmp_gt_u32 vcc, s65, v10
s_cbranch_vccz sf149
s_add_u32 s28, s28, 1
s_cmp_lt_u32 s28, 524288
s_cbranch_scc1 sf148
s_mov_b32 s29, 27
s_branch L_abort
ls5a:
buffer_store_dword v11, off, s[4:7], s97 sc1
s_branch ls5b
sf152:
buffer_load_dword v10, v8, s[4:7], s74 offen offset:2048 sc1
s_waitcnt vmcnt(0)
v_add_u32 v10, 1, v10
v_cmp_gt_u32 vcc, s65, v10
s_cbranch_vccz sf153
s_add_u32 s28, s28, 1
s_cmp_lt_u32 s28, 524288
s_cbranch_scc1 sf152
s_mov_b32 s29, 27
s_branch L_abort
cs156:
buffer_store_dword v10, off, s[4:7], s75 offset:2048 sc1
s_branch cs157
sf158:
buffer_load_dword v10, v8, s[4:7], s74 offen offset:2048 sc1
s_waitcnt vmcnt(0)
v_add_u32 v10, 1, v10
v_cmp_gt_u32 vcc, s65, v10
s_cbranch_vccz sf159
s_add_u32 s28, s28, 1
s_cmp_lt_u32 s28, 524288
s_cbranch_scc1 sf158
s_mov_b32 s29, 27
s_branch L_abort
pb161:
buffer_wbl2 sc1
s_waitcnt vmcnt(0)
buffer_store_dword v10, off, s[4:7], s75 sc1
s_branch pb162
rw163:
buffer_load_dword v11, v8, s[4:7], s74 offen offset:2816 sc1
s_waitcnt vmcnt(0)
v_add_u32 v11, 4, v11
v_cmp_gt_u32 vcc, s65, v11
s_cbranch_vccz rw164
s_add_u32 s28, s28, 1
s_cmp_lt_u32 s28, 524288
s_cbranch_scc1 rw163
s_mov_b32 s29, 28
s_branch L_abort
gq168:
buffer_inv sc1
s_waitcnt vmcnt(0)
s_branch gq169
cs172:
buffer_store_dword v10, off, s[4:7], s75 offset:2048 sc1
s_branch cs173
ls6a:
buffer_store_dwordx4 v[160:163], v3, s[4:7], s16 offen sc1
s_branch ls6b
ls7a:
buffer_store_dwordx4 v[164:167], v4, s[4:7], s16 offen sc1
s_branch ls7b
ls8a:
buffer_store_dwordx4 v[172:175], v26, s[4:7], s18 offen sc1
s_branch ls8b
ls9a:
buffer_store_dwordx4 v[176:179], v27, s[4:7], s18 offen sc1
s_branch ls9b
ls10a:
buffer_store_dword v11, off, s[4:7], s97 sc1
s_branch ls10b
pb175:
buffer_wbl2 sc1
s_waitcnt vmcnt(0)
buffer_store_dword v10, off, s[4:7], s75 sc1
s_branch pb176
gq180:
buffer_inv sc1
s_waitcnt vmcnt(0)
s_branch gq181
rw182:
buffer_load_dword v11, v8, s[4:7], s74 offen offset:2816 sc1
s_waitcnt vmcnt(0)
v_add_u32 v11, 4, v11
v_cmp_gt_u32 vcc, s65, v11
s_cbranch_vccz rw183
s_add_u32 s28, s28, 1
s_cmp_lt_u32 s28, 524288
s_cbranch_scc1 rw182
s_mov_b32 s29, 28
s_branch L_abort
cs184:
buffer_store_dword v10, off, s[4:7], s75 offset:2048 sc1
s_branch cs185
ls11a:
buffer_store_dwordx4 v[160:163], v3, s[4:7], s16 offen sc1
s_branch ls11b
ls12a:
buffer_store_dwordx4 v[164:167], v4, s[4:7], s16 offen sc1
s_branch ls12b
ls13a:
buffer_store_dwordx4 v[172:175], v26, s[4:7], s18 offen sc1
s_branch ls13b
ls14a:
buffer_store_dwordx4 v[176:179], v27, s[4:7], s18 offen sc1
s_branch ls14b
ls15a:
buffer_store_dword v11, off, s[4:7], s97 sc1
s_branch ls15b
L_codeend:
s_endpgm
.section .rodata,"a"
.p2align 6
.amdhsa_kernel interleave_layers__memory_aug_recurrent_mem_tr__dense_activation_silu__prompt_kernel
  .amdhsa_next_free_vgpr 512
  .amdhsa_next_free_sgpr 102
  .amdhsa_accum_offset 256
  .amdhsa_group_segment_fixed_size 0
  .amdhsa_kernarg_size 104
  .amdhsa_user_sgpr_count 2
  .amdhsa_user_sgpr_kernarg_segment_ptr 1
  .amdhsa_system_sgpr_workgroup_id_x 1
.end_amdhsa_kernel
```
